```python
import torch

def _softmax(x, axis=-1):
    return torch.softmax(x, dim=axis)

def _gelu(x):
    return torch.nn.functional.gelu(x, approximate='tanh')

def _silu(x):
    return torch.nn.functional.silu(x)

def _sigmoid(x):
    return torch.sigmoid(x)

def _layernorm(x, axis=-1, eps=1e-05):
    m = x.mean(dim=axis, keepdim=True)
    v = x.var(dim=axis, keepdim=True, unbiased=False)
    return (x - m) / torch.sqrt(v + eps)

def _scatter_add(tgt, idx, src, axis=0):
    return tgt.clone().index_add_(axis, idx, src)

def _segment_sum(src, seg, n):
    out = torch.zeros((n,) + src.shape[1:], dtype=src.dtype)
    return out.index_add_(0, seg, src)

def _pad(x, pw):
    flat = tuple((v for pair in reversed(pw) for v in pair))
    return torch.nn.functional.pad(x, flat)
kernel_name = 'parallel_sum__sliding_local_dilated__mixer_gmlp__prompt'

def setup_inputs():

    _w = lambda a: (lambda t: t.to(torch.bfloat16) if t.is_floating_point() else t)(torch.as_tensor(a))

    def _A_setup():
        B, S, D = (1, 2048, 1024)
        return {'x': _w((lambda *s: torch.randn(*s, dtype=torch.bfloat16) * 0.05)(B, S, D)), 'wqkv': _w((lambda *s: torch.randn(*s, dtype=torch.bfloat16) * 0.2)(D, 3 * D)), 'wo': _w((lambda *s: torch.randn(*s, dtype=torch.bfloat16) * 0.1)(D, D))}
    _A_in = _A_setup()

    def _B_setup():
        B, S, D, F = (1, 2048, 1024, 3584)
        Fh = F // 2
        return {'x': _w((lambda *s: torch.randn(*s, dtype=torch.bfloat16) * 0.05)(B, S, D)), 'w_in': _w((lambda *s: torch.randn(*s, dtype=torch.bfloat16) * 1.6)(D, 2 * Fh)), 'w_sp': _w(0.01 * (lambda *s: torch.randn(*s, dtype=torch.bfloat16) * 1.6)(S, S)), 'b_sp': _w(1.0 + 0.01 * (lambda *s: torch.randn(*s, dtype=torch.bfloat16) * 0.05)(S)), 'w_out': _w((lambda *s: torch.randn(*s, dtype=torch.bfloat16) * 0.05)(Fh, D))}
    _B_in = _B_setup()
    return {'A_x': _A_in['x'], 'A_wqkv': _A_in['wqkv'], 'A_wo': _A_in['wo'], 'B_x': _B_in['x'], 'B_w_in': _B_in['w_in'], 'B_w_sp': _B_in['w_sp'], 'B_b_sp': _B_in['b_sp'], 'B_w_out': _B_in['w_out']}

def reference(A_x, A_wqkv, A_wo, B_x, B_w_in, B_w_sp, B_b_sp, B_w_out):

    def _A_ref(x, wqkv, wo):
        B, S, D = x.shape
        H = 32
        Dh = D // H
        W, dil = (8, 2)
        qkv = (lambda x, *d: x.permute(*d))((x @ wqkv).reshape(B, S, 3, H, Dh), 2, 0, 3, 1, 4)
        q, k, v = (qkv[0], qkv[1], qkv[2])
        scale = Dh ** (-0.5)
        pos = torch.arange(S)
        off = torch.arange(W) * dil
        idx = pos[:, None] - off[None, :]
        mask = idx >= 0
        idx_c = torch.where(mask, idx, 0).reshape(-1)
        kg = k[:, :, idx_c, :].reshape(B, H, S, W, Dh)
        vg = v[:, :, idx_c, :].reshape(B, H, S, W, Dh)
        logits = torch.einsum('bhsd,bhswd->bhsw', q, kg) * scale
        logits = torch.where(mask[None, None, :, :], logits, -1000000000.0)
        attn = _softmax(logits, axis=-1)
        o = torch.einsum('bhsw,bhswd->bhsd', attn, vg)
        return (lambda x, *d: x.permute(*d))(o, 0, 2, 1, 3).reshape(B, S, D) @ wo

    def _B_ref(x, w_in, w_sp, b_sp, w_out):
        B, S, D = x.shape
        F = w_in.shape[-1]
        Fh = F // 2
        z = _gelu(torch.einsum('bsd,df->bsf', x, w_in))
        z1 = z[..., :Fh].clone()
        z2 = _layernorm(z[..., Fh:], axis=-1)
        g = torch.einsum('ts,bsf->btf', w_sp, z2) + b_sp[None, :, None]
        return torch.einsum('bsf,fd->bsd', z1 * g, w_out)
    x = A_x
    xn = _layernorm(x, axis=-1)
    return x + _A_ref(xn, A_wqkv, A_wo) + _B_ref(xn, B_w_in, B_w_sp, B_b_sp, B_w_out)
```

```asm
; @launch grid=(256,1,1) block=(256,1,1) lds=163840
.amdgcn_target "amdgcn-amd-amdhsa--gfx950"
.text
.globl parallel_sum__sliding_local_dilated__mixer_gmlp__prompt_kernel
.p2align 8
.type parallel_sum__sliding_local_dilated__mixer_gmlp__prompt_kernel,@function
parallel_sum__sliding_local_dilated__mixer_gmlp__prompt_kernel:
s_cmp_ge_u32 s2, 256
s_cbranch_scc1 L_end
s_load_dwordx16 s[56:71], s[0:1], 0
s_load_dwordx4 s[72:75], s[0:1], 64
s_load_dwordx2 s[76:77], s[0:1], 80
s_memrealtime s[78:79]
s_getpc_b64 s[32:33]
L_pc:
s_mov_b32 s34, L_end-L_pc
s_mov_b32 s35, 0x20000
s_lshr_b32 s5, s2, 3
s_mul_i32 s27, s5, 3072
v_mul_u32_u24 v1, 12, v0
buffer_load_dword v57, v1, s[32:35], s27 offen
v_lshrrev_b32 v1, 6, v0
v_lshrrev_b32 v2, 5, v0
v_and_b32 v3, 31, v0
v_readfirstlane_b32 s3, v1
v_and_b32 v0, 63, v0
s_lshl_b32 s27, s2, 14
v_lshl_add_u32 v2, v2, 11, s27
v_lshl_add_u32 v2, v3, 4, v2
s_mov_b32 s50, 4194304
s_mov_b32 s51, 0x20000
s_waitcnt lgkmcnt(0)
s_mov_b32 s48, s56
s_mov_b32 s49, s57
buffer_load_dwordx4 v[32:35], v2, s[48:51], 0 offen offset:0
buffer_load_dwordx4 v[36:39], v2, s[48:51], 0 offen offset:512
buffer_load_dwordx4 v[40:43], v2, s[48:51], 0 offen offset:1024
buffer_load_dwordx4 v[44:47], v2, s[48:51], 0 offen offset:1536
s_mov_b32 s38, 256
s_mov_b32 s39, 0x20000
s_mov_b32 s36, s74
s_mov_b32 s37, s75
s_or_b32 s27, s2, s3
s_cselect_b32 s27, 2147483648, 0
v_or_b32 v1, 1, s78
buffer_store_dword v1, off, s[36:39], s27 sc1
s_and_b32 s4, s2, 7
s_lshr_b32 s5, s2, 3
s_mov_b32 s44, s64
s_mov_b32 s45, s65
s_mov_b32 s46, 7340032
s_mov_b32 s47, 0x20000
s_mov_b32 s15, 0x20000
s_cmp_ge_u32 s5, 18
s_cbranch_scc1 L_hz
s_mov_b32 s12, s58
s_mov_b32 s13, s59
s_mov_b32 s14, 6291456
s_cmp_ge_u32 s5, 9
s_cselect_b32 s7, 1, 0
s_cselect_b32 s6, 9, 0
s_sub_u32 s6, s5, s6
s_lshl1_add_u32 s7, s4, s7
s_lshl_b32 s27, s7, 7
s_mul_i32 s85, s6, 14
s_movk_i32 s20, 6144
s_movk_i32 s21, 2048
s_movk_i32 s31, 4096
s_branch L_hj
L_hz:
s_mov_b32 s12, s64
s_mov_b32 s13, s65
s_mov_b32 s14, 7340032
s_mul_i32 s7, s4, 14
s_add_u32 s7, s7, s5
s_sub_u32 s7, s7, 18
s_and_b32 s6, s7, 7
s_lshr_b32 s7, s7, 3
s_lshl_b32 s27, s7, 8
s_add_u32 s27, s27, 3584
s_lshl_b32 s85, s6, 4
s_movk_i32 s20, 7168
s_movk_i32 s21, 128
s_mov_b32 s31, 2147483648
L_hj:
v_lshrrev_b32 v1, 3, v0
v_lshl_add_u32 v1, s3, 4, v1
v_mul_u32_u24 v1, s20, v1
v_add_u32 v1, s27, v1
v_bfe_u32 v2, v0, 4, 1
v_lshlrev_b32 v2, 1, v2
v_and_b32 v3, 7, v0
v_xor_b32 v2, v2, v3
s_lshl_b32 s27, s20, 3
s_sub_u32 s27, s27, 1024
v_lshl_add_u32 v8, v2, 4, v1
v_xor_b32 v9, 64, v8
v_add_u32 v9, s27, v9
v_add_u32 v10, s21, v8
v_add_u32 v11, s21, v9
v_add_u32 v12, s31, v8
v_add_u32 v13, s31, v9
s_lshl_b32 s62, s6, 1
s_and_b32 s62, s62, 15
s_mov_b32 s31, s62
s_lshl_b32 s20, s20, 6
s_mul_i32 s22, s31, s20
s_lshl_b32 s23, s3, 11
s_and_b32 s80, s4, 3
s_lshl_b32 s80, s80, 2
s_and_b32 s27, s5, 3
s_add_u32 s80, s80, s27
s_lshr_b32 s27, s5, 2
s_lshr_b32 s31, s4, 2
s_mul_i32 s81, s31, 7
s_add_u32 s81, s81, s27
s_min_u32 s81, s81, 13
s_lshl1_add_u32 s82, s27, s31
s_mov_b32 s0, s31
s_add_u32 s63, s27, s5
s_and_b32 s63, s63, 3
s_lshr_b32 s83, s3, 1
s_and_b32 s84, s3, 1
s_lshl_b32 s1, s2, 9
s_cmp_eq_u32 s3, 0
s_cselect_b32 s1, s1, 2147483648
s_mov_b32 s8, s76
s_mov_b32 s9, s77
s_mov_b32 s10, 4194304
s_mov_b32 s11, 0x20000
s_add_u32 s16, s76, 12582912
s_addc_u32 s17, s77, 0
s_mov_b32 s18, 11534336
s_mov_b32 s19, 0x20000
s_add_u32 s40, s76, 25165824
s_addc_u32 s41, s77, 0
s_mov_b32 s42, 655360
s_mov_b32 s43, 0x20000
s_add_u32 s52, s76, 4194304
s_addc_u32 s53, s77, 0
s_mov_b32 s54, 7340032
s_mov_b32 s55, 0x20000
s_lshl_b32 s24, s3, 12
s_add_u32 s25, s24, 16384
s_add_u32 s26, s23, 16384
v_lshrrev_b32 v1, 4, v0
v_lshlrev_b32 v1, 10, v1
v_bfe_u32 v2, v0, 2, 2
v_lshl_add_u32 v1, v2, 7, v1
v_and_b32 v2, 3, v0
v_lshl_add_u32 v1, v2, 3, v1
v_bfe_u32 v2, v0, 3, 2
v_xor_b32 v16, 0, v2
v_lshl_add_u32 v16, v16, 5, v1
v_xor_b32 v17, 1, v2
v_lshl_add_u32 v17, v17, 5, v1
v_xor_b32 v18, 2, v2
v_lshl_add_u32 v18, v18, 5, v1
v_xor_b32 v19, 3, v2
v_lshl_add_u32 v19, v19, 5, v1
v_add_u32 v20, 65536, v16
v_add_u32 v21, 65536, v17
v_add_u32 v22, 65536, v18
v_add_u32 v23, 65536, v19
v_and_b32 v1, 31, v0
v_lshrrev_b32 v2, 5, v0
s_lshl_b32 s27, s3, 1
v_add_u32 v2, s27, v2
v_xor_b32 v2, v2, v1
v_and_b32 v2, 7, v2
s_mov_b32 s27, 131072
v_lshl_add_u32 v52, v1, 7, s27
v_lshl_add_u32 v52, v2, 4, v52
v_lshrrev_b32 v1, 3, v0
v_and_b32 v2, 7, v0
v_xor_b32 v3, v1, v2
s_add_u32 s27, s24, 131072
v_lshl_add_u32 v53, v1, 7, s27
v_lshl_add_u32 v53, v3, 4, v53
s_lshr_b32 s27, s2, 1
s_mul_i32 s27, s27, 32768
s_and_b32 s31, s2, 1
s_lshl_b32 s31, s31, 7
s_add_u32 s27, s27, s31
s_lshl_b32 s31, s3, 13
s_add_u32 s27, s27, s31
v_lshlrev_b32 v54, 8, v1
v_lshl_add_u32 v54, v2, 4, v54
v_add_u32 v54, s27, v54
v_add_u32 v55, 4096, v54
s_mov_b32 s27, 0x3f803f80
s_waitcnt vmcnt(4)
v_dot2_f32_bf16 v48, v32, s27, 0
v_dot2_f32_bf16 v49, v32, v32, 0
v_dot2_f32_bf16 v50, v33, s27, 0
v_dot2_f32_bf16 v51, v33, v33, 0
v_dot2_f32_bf16 v48, v34, s27, v48
v_dot2_f32_bf16 v49, v34, v34, v49
v_dot2_f32_bf16 v50, v35, s27, v50
v_dot2_f32_bf16 v51, v35, v35, v51
s_add_u32 m0, s23, 0
s_nop 0
buffer_load_dwordx4 v8, s[12:15], s22 offen offset:0 lds
buffer_load_dwordx4 v9, s[12:15], s22 offen offset:1024 lds
s_add_u32 m0, s23, 8192
s_nop 0
buffer_load_dwordx4 v10, s[12:15], s22 offen offset:0 lds
buffer_load_dwordx4 v11, s[12:15], s22 offen offset:1024 lds
s_add_u32 m0, s23, 16384
s_nop 0
buffer_load_dwordx4 v12, s[12:15], s22 offen offset:0 lds
buffer_load_dwordx4 v13, s[12:15], s22 offen offset:1024 lds
s_add_u32 s22, s22, s20
s_waitcnt vmcnt(9)
v_dot2_f32_bf16 v48, v36, s27, v48
v_dot2_f32_bf16 v49, v36, v36, v49
v_dot2_f32_bf16 v50, v37, s27, v50
v_dot2_f32_bf16 v51, v37, v37, v51
v_dot2_f32_bf16 v48, v38, s27, v48
v_dot2_f32_bf16 v49, v38, v38, v49
v_dot2_f32_bf16 v50, v39, s27, v50
v_dot2_f32_bf16 v51, v39, v39, v51
s_waitcnt vmcnt(8)
v_dot2_f32_bf16 v48, v40, s27, v48
v_dot2_f32_bf16 v49, v40, v40, v49
v_dot2_f32_bf16 v50, v41, s27, v50
v_dot2_f32_bf16 v51, v41, v41, v51
v_dot2_f32_bf16 v48, v42, s27, v48
v_dot2_f32_bf16 v49, v42, v42, v49
v_dot2_f32_bf16 v50, v43, s27, v50
v_dot2_f32_bf16 v51, v43, v43, v51
s_waitcnt vmcnt(7)
v_dot2_f32_bf16 v48, v44, s27, v48
v_dot2_f32_bf16 v49, v44, v44, v49
v_dot2_f32_bf16 v50, v45, s27, v50
v_dot2_f32_bf16 v51, v45, v45, v51
v_dot2_f32_bf16 v48, v46, s27, v48
v_dot2_f32_bf16 v49, v46, v46, v49
v_dot2_f32_bf16 v50, v47, s27, v50
v_dot2_f32_bf16 v51, v47, v47, v51
buffer_load_dword v56, off, s[36:39], 0 sc1
v_lshlrev_b32 v64, 16, v32
v_and_b32 v65, 0xffff0000, v32
v_pk_add_f32 v[48:49], v[48:49], v[50:51]
v_lshlrev_b32 v66, 16, v33
v_and_b32 v67, 0xffff0000, v33
v_add_f32_dpp v48, v48, v48 row_ror:8 row_mask:0xf bank_mask:0xf
v_add_f32_dpp v49, v49, v49 row_ror:8 row_mask:0xf bank_mask:0xf
v_lshlrev_b32 v68, 16, v34
v_and_b32 v69, 0xffff0000, v34
v_add_f32_dpp v48, v48, v48 row_ror:4 row_mask:0xf bank_mask:0xf
v_add_f32_dpp v49, v49, v49 row_ror:4 row_mask:0xf bank_mask:0xf
v_lshlrev_b32 v70, 16, v35
v_and_b32 v71, 0xffff0000, v35
v_add_f32_dpp v48, v48, v48 row_ror:2 row_mask:0xf bank_mask:0xf
v_add_f32_dpp v49, v49, v49 row_ror:2 row_mask:0xf bank_mask:0xf
v_lshlrev_b32 v72, 16, v36
v_and_b32 v73, 0xffff0000, v36
v_add_f32_dpp v48, v48, v48 row_ror:1 row_mask:0xf bank_mask:0xf
v_add_f32_dpp v49, v49, v49 row_ror:1 row_mask:0xf bank_mask:0xf
v_lshlrev_b32 v74, 16, v37
v_and_b32 v75, 0xffff0000, v37
v_mov_b32 v50, v48
v_mov_b32 v51, v49
v_lshlrev_b32 v76, 16, v38
v_and_b32 v77, 0xffff0000, v38
v_permlane16_swap_b32 v48, v50
v_permlane16_swap_b32 v49, v51
v_lshlrev_b32 v78, 16, v39
v_and_b32 v79, 0xffff0000, v39
v_pk_add_f32 v[48:49], v[48:49], v[50:51]
v_mul_f32 v48, 0x3a800000, v48
v_mul_f32 v49, 0x3a800000, v49
v_fma_f32 v49, -v48, v48, v49
v_max_f32 v49, 0, v49
v_cvt_pk_bf16_f32 v49, v48, v49
v_lshlrev_b32 v48, 16, v49
v_and_b32 v49, 0xffff0000, v49
v_add_f32 v49, 0x3727c5ac, v49
v_cvt_pk_bf16_f32 v49, v49, v49
v_and_b32 v49, 0xffff0000, v49
v_sqrt_f32 v49, v49
v_lshlrev_b32 v80, 16, v40
v_and_b32 v81, 0xffff0000, v40
v_cvt_pk_bf16_f32 v49, v49, v49
v_and_b32 v49, 0xffff0000, v49
v_rcp_f32 v50, v49
v_lshlrev_b32 v82, 16, v41
v_and_b32 v83, 0xffff0000, v41
v_lshlrev_b32 v84, 16, v42
v_and_b32 v85, 0xffff0000, v42
v_lshlrev_b32 v86, 16, v43
v_and_b32 v87, 0xffff0000, v43
v_lshlrev_b32 v88, 16, v44
v_and_b32 v89, 0xffff0000, v44
v_lshlrev_b32 v90, 16, v45
v_and_b32 v91, 0xffff0000, v45
v_lshlrev_b32 v92, 16, v46
v_and_b32 v93, 0xffff0000, v46
v_lshlrev_b32 v94, 16, v47
v_and_b32 v95, 0xffff0000, v47
v_pk_add_f32 v[64:65], v[64:65], v[48:49] op_sel_hi:[1,0] neg_lo:[0,1] neg_hi:[0,1]
v_pk_add_f32 v[66:67], v[66:67], v[48:49] op_sel_hi:[1,0] neg_lo:[0,1] neg_hi:[0,1]
v_pk_add_f32 v[68:69], v[68:69], v[48:49] op_sel_hi:[1,0] neg_lo:[0,1] neg_hi:[0,1]
v_pk_add_f32 v[70:71], v[70:71], v[48:49] op_sel_hi:[1,0] neg_lo:[0,1] neg_hi:[0,1]
v_cvt_pk_bf16_f32 v32, v64, v65
v_cvt_pk_bf16_f32 v33, v66, v67
v_cvt_pk_bf16_f32 v34, v68, v69
v_cvt_pk_bf16_f32 v35, v70, v71
v_lshlrev_b32 v64, 16, v32
v_and_b32 v65, 0xffff0000, v32
v_lshlrev_b32 v66, 16, v33
v_and_b32 v67, 0xffff0000, v33
v_lshlrev_b32 v68, 16, v34
v_and_b32 v69, 0xffff0000, v34
v_lshlrev_b32 v70, 16, v35
v_and_b32 v71, 0xffff0000, v35
v_pk_mul_f32 v[64:65], v[64:65], v[50:51] op_sel_hi:[1,0]
v_pk_mul_f32 v[66:67], v[66:67], v[50:51] op_sel_hi:[1,0]
v_pk_mul_f32 v[68:69], v[68:69], v[50:51] op_sel_hi:[1,0]
v_pk_mul_f32 v[70:71], v[70:71], v[50:51] op_sel_hi:[1,0]
v_cvt_pk_bf16_f32 v32, v64, v65
v_cvt_pk_bf16_f32 v33, v66, v67
v_cvt_pk_bf16_f32 v34, v68, v69
v_cvt_pk_bf16_f32 v35, v70, v71
ds_write_b128 v52, v[32:35] offset:0
v_pk_add_f32 v[72:73], v[72:73], v[48:49] op_sel_hi:[1,0] neg_lo:[0,1] neg_hi:[0,1]
v_pk_add_f32 v[74:75], v[74:75], v[48:49] op_sel_hi:[1,0] neg_lo:[0,1] neg_hi:[0,1]
v_pk_add_f32 v[76:77], v[76:77], v[48:49] op_sel_hi:[1,0] neg_lo:[0,1] neg_hi:[0,1]
v_pk_add_f32 v[78:79], v[78:79], v[48:49] op_sel_hi:[1,0] neg_lo:[0,1] neg_hi:[0,1]
v_cvt_pk_bf16_f32 v36, v72, v73
v_cvt_pk_bf16_f32 v37, v74, v75
v_cvt_pk_bf16_f32 v38, v76, v77
v_cvt_pk_bf16_f32 v39, v78, v79
v_lshlrev_b32 v72, 16, v36
v_and_b32 v73, 0xffff0000, v36
v_lshlrev_b32 v74, 16, v37
v_and_b32 v75, 0xffff0000, v37
v_lshlrev_b32 v76, 16, v38
v_and_b32 v77, 0xffff0000, v38
v_lshlrev_b32 v78, 16, v39
v_and_b32 v79, 0xffff0000, v39
v_pk_mul_f32 v[72:73], v[72:73], v[50:51] op_sel_hi:[1,0]
v_pk_mul_f32 v[74:75], v[74:75], v[50:51] op_sel_hi:[1,0]
v_pk_mul_f32 v[76:77], v[76:77], v[50:51] op_sel_hi:[1,0]
v_pk_mul_f32 v[78:79], v[78:79], v[50:51] op_sel_hi:[1,0]
v_cvt_pk_bf16_f32 v36, v72, v73
v_cvt_pk_bf16_f32 v37, v74, v75
v_cvt_pk_bf16_f32 v38, v76, v77
v_cvt_pk_bf16_f32 v39, v78, v79
ds_write_b128 v52, v[36:39] offset:4096
v_pk_add_f32 v[80:81], v[80:81], v[48:49] op_sel_hi:[1,0] neg_lo:[0,1] neg_hi:[0,1]
v_pk_add_f32 v[82:83], v[82:83], v[48:49] op_sel_hi:[1,0] neg_lo:[0,1] neg_hi:[0,1]
v_pk_add_f32 v[84:85], v[84:85], v[48:49] op_sel_hi:[1,0] neg_lo:[0,1] neg_hi:[0,1]
v_pk_add_f32 v[86:87], v[86:87], v[48:49] op_sel_hi:[1,0] neg_lo:[0,1] neg_hi:[0,1]
v_cvt_pk_bf16_f32 v40, v80, v81
v_cvt_pk_bf16_f32 v41, v82, v83
v_cvt_pk_bf16_f32 v42, v84, v85
v_cvt_pk_bf16_f32 v43, v86, v87
v_lshlrev_b32 v80, 16, v40
v_and_b32 v81, 0xffff0000, v40
v_lshlrev_b32 v82, 16, v41
v_and_b32 v83, 0xffff0000, v41
v_lshlrev_b32 v84, 16, v42
v_and_b32 v85, 0xffff0000, v42
v_lshlrev_b32 v86, 16, v43
v_and_b32 v87, 0xffff0000, v43
v_pk_mul_f32 v[80:81], v[80:81], v[50:51] op_sel_hi:[1,0]
v_pk_mul_f32 v[82:83], v[82:83], v[50:51] op_sel_hi:[1,0]
v_pk_mul_f32 v[84:85], v[84:85], v[50:51] op_sel_hi:[1,0]
v_pk_mul_f32 v[86:87], v[86:87], v[50:51] op_sel_hi:[1,0]
v_cvt_pk_bf16_f32 v40, v80, v81
v_cvt_pk_bf16_f32 v41, v82, v83
v_cvt_pk_bf16_f32 v42, v84, v85
v_cvt_pk_bf16_f32 v43, v86, v87
ds_write_b128 v52, v[40:43] offset:8192
v_pk_add_f32 v[88:89], v[88:89], v[48:49] op_sel_hi:[1,0] neg_lo:[0,1] neg_hi:[0,1]
v_pk_add_f32 v[90:91], v[90:91], v[48:49] op_sel_hi:[1,0] neg_lo:[0,1] neg_hi:[0,1]
v_pk_add_f32 v[92:93], v[92:93], v[48:49] op_sel_hi:[1,0] neg_lo:[0,1] neg_hi:[0,1]
v_pk_add_f32 v[94:95], v[94:95], v[48:49] op_sel_hi:[1,0] neg_lo:[0,1] neg_hi:[0,1]
v_cvt_pk_bf16_f32 v44, v88, v89
v_cvt_pk_bf16_f32 v45, v90, v91
v_cvt_pk_bf16_f32 v46, v92, v93
v_cvt_pk_bf16_f32 v47, v94, v95
v_lshlrev_b32 v88, 16, v44
v_and_b32 v89, 0xffff0000, v44
v_lshlrev_b32 v90, 16, v45
v_and_b32 v91, 0xffff0000, v45
v_lshlrev_b32 v92, 16, v46
v_and_b32 v93, 0xffff0000, v46
v_lshlrev_b32 v94, 16, v47
v_and_b32 v95, 0xffff0000, v47
v_pk_mul_f32 v[88:89], v[88:89], v[50:51] op_sel_hi:[1,0]
v_pk_mul_f32 v[90:91], v[90:91], v[50:51] op_sel_hi:[1,0]
v_pk_mul_f32 v[92:93], v[92:93], v[50:51] op_sel_hi:[1,0]
v_pk_mul_f32 v[94:95], v[94:95], v[50:51] op_sel_hi:[1,0]
v_cvt_pk_bf16_f32 v44, v88, v89
v_cvt_pk_bf16_f32 v45, v90, v91
v_cvt_pk_bf16_f32 v46, v92, v93
v_cvt_pk_bf16_f32 v47, v94, v95
ds_write_b128 v52, v[44:47] offset:12288
s_waitcnt lgkmcnt(0)
s_barrier
ds_read_b128 v[32:35], v53 offset:0
ds_read_b128 v[36:39], v53 offset:1024
ds_read_b128 v[40:43], v53 offset:2048
ds_read_b128 v[44:47], v53 offset:3072
s_waitcnt lgkmcnt(3)
buffer_store_dwordx4 v[32:35], v54, s[8:11], 0 offen offset:0 sc1
s_waitcnt lgkmcnt(2)
buffer_store_dwordx4 v[36:39], v54, s[8:11], 0 offen offset:2048 sc1
s_waitcnt lgkmcnt(1)
buffer_store_dwordx4 v[40:43], v55, s[8:11], 0 offen offset:0 sc1
s_waitcnt lgkmcnt(0)
buffer_store_dwordx4 v[44:47], v55, s[8:11], 0 offen offset:2048 sc1
v_pk_mov_b32 v[60:61], 0, 0
v_pk_mov_b32 v[62:63], 0, 0
s_nop 1
v_mfma_f32_32x32x16_bf16 v[64:79], v[60:63], v[60:63], 0
v_mfma_f32_32x32x16_bf16 v[80:95], v[60:63], v[60:63], 0
v_mfma_f32_32x32x16_bf16 v[96:111], v[60:63], v[60:63], 0
v_mfma_f32_32x32x16_bf16 v[112:127], v[60:63], v[60:63], 0
v_mfma_f32_32x32x16_bf16 v[128:143], v[60:63], v[60:63], 0
v_mfma_f32_32x32x16_bf16 v[144:159], v[60:63], v[60:63], 0
v_mfma_f32_32x32x16_bf16 v[160:175], v[60:63], v[60:63], 0
v_mfma_f32_32x32x16_bf16 v[176:191], v[60:63], v[60:63], 0
v_mfma_f32_32x32x16_bf16 v[192:207], v[60:63], v[60:63], 0
v_mfma_f32_32x32x16_bf16 v[208:223], v[60:63], v[60:63], 0
v_mfma_f32_32x32x16_bf16 v[224:239], v[60:63], v[60:63], 0
v_mfma_f32_32x32x16_bf16 v[240:255], v[60:63], v[60:63], 0
s_cmp_ge_u32 s5, 18
s_cbranch_scc1 L_z
v_mov_b32 v24, v0
v_add_u32 v24, s62, v24
v_and_b32 v24, 15, v24
v_subrev_u32 v25, 16, v0
v_subrev_u32 v1, 1, v25
v_and_b32 v2, 3, v1
v_cmp_eq_u32 vcc, s63, v2
v_add_u32 v2, 4, v25
v_min_u32 v2, 16, v2
v_subrev_u32 v2, 1, v2
v_cndmask_b32 v1, v1, v2, vcc
v_cmp_eq_u32 vcc, 0, v25
v_mov_b32 v2, s63
s_nop 0
v_cndmask_b32 v25, v1, v2, vcc
v_subrev_u32 v26, 32, v0
v_lshrrev_b32 v26, 1, v26
v_subrev_u32 v1, 1, v26
v_and_b32 v2, 3, v1
v_cmp_eq_u32 vcc, s63, v2
v_add_u32 v2, 4, v26
v_min_u32 v2, 16, v2
v_subrev_u32 v2, 1, v2
v_cndmask_b32 v1, v1, v2, vcc
v_cmp_eq_u32 vcc, 0, v26
v_mov_b32 v2, s63
s_nop 0
v_cndmask_b32 v26, v1, v2, vcc
v_and_b32 v1, 1, v0
v_lshl_add_u32 v26, v26, 1, v1
v_cmp_gt_u32 vcc, 16, v0
v_mul_u32_u24 v15, 393216, v24
v_lshlrev_b32 v14, 7, v26
v_cndmask_b32 v25, v25, v24, vcc
v_cmp_gt_u32 vcc, 32, v0
v_lshlrev_b32 v27, 11, v25
s_nop 0
v_cndmask_b32 v14, v14, v27, vcc
s_mov_b32 vcc_lo, 0
s_mov_b32 vcc_hi, 2863311530
v_mul_u32_u24 v1, 16, v14
v_cndmask_b32 v14, v14, v1, vcc
s_lshl_b32 s27, s3, 2
s_add_u32 s27, s27, s85
s_mul_i32 s31, s27, 32768
v_lshl_add_u32 v4, v0, 4, s31
v_add_u32 v5, 32768, v4
v_add_u32 v6, 65536, v4
v_add_u32 v7, 98304, v4
s_cmp_eq_u32 s3, 0
s_cselect_b32 s31, s6, 0
s_cmp_lg_u32 s31, 0
s_cselect_b32 s31, 2147483648, 0
v_or_b32 v4, s31, v4
s_lshl_b32 s27, s27, 10
v_lshrrev_b32 v1, 3, v0
v_lshl_add_u32 v24, v1, 9, s27
s_lshl_b32 s27, s80, 13
v_lshrrev_b32 v1, 2, v0
v_lshl_add_u32 v29, v1, 9, s27
s_waitcnt vmcnt(0)
v_readfirstlane_b32 s78, v56
s_nop 0
s_cmp_lg_u32 s78, 0
s_cbranch_scc1 Lnok_2
s_mov_b32 s79, 32768
Lnon_1:
buffer_load_dword v56, off, s[36:39], 0 sc1
s_waitcnt vmcnt(0)
v_readfirstlane_b32 s78, v56
s_sub_u32 s79, s79, 1
s_cbranch_scc1 Lnok_2
s_cmp_eq_u32 s78, 0
s_cbranch_scc1 Lnon_1
Lnok_2:
s_barrier
v_mov_b32 v56, s78
buffer_store_dword v56, off, s[40:43], s1 offset:0 sc1
s_add_u32 m0, s23, 32768
s_nop 0
buffer_load_dwordx4 v8, s[12:15], s22 offen offset:0 lds
buffer_load_dwordx4 v9, s[12:15], s22 offen offset:1024 lds
s_add_u32 m0, s23, 40960
s_nop 0
buffer_load_dwordx4 v10, s[12:15], s22 offen offset:0 lds
buffer_load_dwordx4 v11, s[12:15], s22 offen offset:1024 lds
s_add_u32 m0, s23, 49152
s_nop 0
buffer_load_dwordx4 v12, s[12:15], s22 offen offset:0 lds
buffer_load_dwordx4 v13, s[12:15], s22 offen offset:1024 lds
ds_read_b64_tr_b16 a[0:1], v16 offset:0
ds_read_b64_tr_b16 a[2:3], v16 offset:512
ds_read_b64_tr_b16 a[4:5], v17 offset:0
ds_read_b64_tr_b16 a[6:7], v17 offset:512
ds_read_b64_tr_b16 a[8:9], v18 offset:0
ds_read_b64_tr_b16 a[10:11], v18 offset:512
ds_read_b64_tr_b16 a[12:13], v19 offset:0
ds_read_b64_tr_b16 a[14:15], v19 offset:512
ds_read_b64_tr_b16 a[16:17], v16 offset:8192
ds_read_b64_tr_b16 a[18:19], v16 offset:8704
ds_read_b64_tr_b16 a[20:21], v17 offset:8192
ds_read_b64_tr_b16 a[22:23], v17 offset:8704
ds_read_b64_tr_b16 a[24:25], v18 offset:8192
ds_read_b64_tr_b16 a[26:27], v18 offset:8704
ds_read_b64_tr_b16 a[28:29], v19 offset:8192
ds_read_b64_tr_b16 a[30:31], v19 offset:8704
ds_read_b64_tr_b16 a[32:33], v16 offset:16384
ds_read_b64_tr_b16 a[34:35], v16 offset:16896
ds_read_b64_tr_b16 a[36:37], v17 offset:16384
ds_read_b64_tr_b16 a[38:39], v17 offset:16896
ds_read_b64_tr_b16 a[40:41], v18 offset:16384
ds_read_b64_tr_b16 a[42:43], v18 offset:16896
ds_read_b64_tr_b16 a[44:45], v19 offset:16384
ds_read_b64_tr_b16 a[46:47], v19 offset:16896
s_mul_i32 s31, s80, 262144
s_mul_i32 s27, s3, 65536
s_add_u32 s27, s27, s31
v_lshl_add_u32 v32, v0, 4, s27
v_add_u32 v33, 30720, v32
v_lshrrev_b32 v1, 3, v0
s_lshl_b32 s27, s84, 5
v_add_u32 v1, s27, v1
v_mul_u32_u24 v1, 7168, v1
s_lshl_b32 s27, s81, 8
s_lshl_b32 s31, s83, 7
s_add_u32 s27, s27, s31
v_add_u32 v1, s27, v1
v_bfe_u32 v2, v0, 4, 1
v_lshlrev_b32 v2, 1, v2
v_and_b32 v3, 7, v0
v_xor_b32 v2, v2, v3
v_xor_b32 v3, 0, v2
v_lshl_add_u32 v34, v3, 4, v1
v_xor_b32 v3, 4, v2
v_lshl_add_u32 v35, v3, 4, v1
v_add_u32 v35, 56320, v35
v_xor_b32 v3, 0, v2
v_lshl_add_u32 v36, v3, 4, v1
v_add_u32 v36, 112640, v36
v_xor_b32 v3, 4, v2
v_lshl_add_u32 v37, v3, 4, v1
v_add_u32 v37, 168960, v37
s_cmp_ge_u32 s5, 28
s_cselect_b32 s27, 2147483648, 0
v_or_b32 v32, s27, v32
v_or_b32 v33, s27, v33
v_or_b32 v34, s27, v34
v_or_b32 v35, s27, v35
v_or_b32 v36, s27, v36
v_or_b32 v37, s27, v37
v_accvgpr_write_b32 a208, v32
v_accvgpr_write_b32 a209, v33
v_accvgpr_write_b32 a210, v34
v_accvgpr_write_b32 a211, v35
v_accvgpr_write_b32 a212, v36
v_accvgpr_write_b32 a213, v37
s_mul_i32 s31, s80, 720896
s_mul_i32 s27, s3, 180224
s_add_u32 s27, s27, s31
v_lshl_add_u32 v32, v0, 4, s27
v_add_u32 v33, 88064, v32
v_lshrrev_b32 v1, 5, v0
v_bfe_u32 v3, v0, 3, 2
v_lshl_add_u32 v1, v1, 4, v3
v_lshlrev_b32 v1, 11, v1
v_lshl_add_u32 v1, v2, 4, v1
v_xor_b32 v3, 64, v1
v_add_u32 v3, 7168, v3
s_xor_b32 s27, s82, s83
s_lshl_b32 s27, s27, 7
s_lshl_b32 s31, s84, 16
s_add_u32 s27, s27, s31
v_add_u32 v34, s27, v1
v_add_u32 v35, s27, v3
v_add_u32 v36, 14336, v34
v_add_u32 v37, 14336, v35
s_lshl_b32 s27, s82, 7
s_lshl_b32 s31, s83, 16
s_add_u32 s27, s27, s31
s_lshl_b32 s31, s84, 14
s_add_u32 s27, s27, s31
v_add_u32 v38, s27, v1
v_add_u32 v39, s27, v3
v_accvgpr_write_b32 a238, v32
v_accvgpr_write_b32 a239, v33
v_accvgpr_write_b32 a240, v34
v_accvgpr_write_b32 a241, v35
v_accvgpr_write_b32 a242, v36
v_accvgpr_write_b32 a243, v37
v_accvgpr_write_b32 a244, v38
v_accvgpr_write_b32 a245, v39
s_lshl_b32 s27, s84, 6
v_xor_b32 v1, s27, v16
v_xor_b32 v3, s27, v17
v_add_u32 v32, 16384, v1
v_add_u32 v33, 16384, v3
v_accvgpr_write_b32 a252, v32
v_accvgpr_write_b32 a253, v33
v_lshrrev_b32 v1, 3, v0
s_lshl_b32 s27, s80, 7
s_lshl_b32 s31, s3, 5
s_add_u32 s27, s27, s31
v_add_u32 v1, s27, v1
v_lshlrev_b32 v1, 12, v1
v_lshrrev_b32 v2, 4, v0
v_and_b32 v3, 7, v0
v_xor_b32 v2, v2, v3
v_xor_b32 v3, 0, v2
v_lshl_add_u32 v32, v3, 4, v1
v_xor_b32 v3, 4, v2
v_lshl_add_u32 v33, v3, 4, v1
v_add_u32 v33, 31744, v33
v_xor_b32 v3, 0, v2
v_lshl_add_u32 v34, v3, 4, v1
v_add_u32 v34, 63488, v34
v_xor_b32 v3, 4, v2
v_lshl_add_u32 v35, v3, 4, v1
v_add_u32 v35, 95232, v35
s_mul_i32 s31, s81, 524288
s_mul_i32 s27, s3, 131072
s_add_u32 s27, s27, s31
v_lshl_add_u32 v36, v0, 4, s27
v_add_u32 v37, 63488, v36
v_accvgpr_write_b32 a224, v32
v_accvgpr_write_b32 a225, v33
v_accvgpr_write_b32 a226, v34
v_accvgpr_write_b32 a227, v35
v_accvgpr_write_b32 a228, v36
v_accvgpr_write_b32 a229, v37
s_lshl_b32 s27, s84, 13
s_add_u32 s27, s27, 16384
v_add_u32 v32, s27, v16
v_add_u32 v33, s27, v17
v_add_u32 v34, s27, v18
v_add_u32 v35, s27, v19
v_lshl_add_u32 v39, v0, 4, s27
s_lshl_b32 s27, s83, 13
v_lshl_add_u32 v36, v0, 4, s27
v_and_b32 v1, 15, v0
v_lshrrev_b32 v2, 1, v1
v_lshrrev_b32 v3, 4, v0
v_xor_b32 v2, v2, v3
v_lshl_add_u32 v1, v1, 7, s27
v_lshl_add_u32 v37, v2, 4, v1
v_xor_b32 v2, 4, v2
v_lshl_add_u32 v38, v2, 4, v1
v_accvgpr_write_b32 a230, v32
v_accvgpr_write_b32 a231, v33
v_accvgpr_write_b32 a232, v34
v_accvgpr_write_b32 a233, v35
v_accvgpr_write_b32 a234, v36
v_accvgpr_write_b32 a235, v37
v_accvgpr_write_b32 a236, v38
v_accvgpr_write_b32 a237, v39
v_mov_b32 v32, v0
v_subrev_u32 v1, 1, v32
v_and_b32 v2, 3, v1
v_cmp_eq_u32 vcc, s63, v2
v_add_u32 v2, 4, v32
v_min_u32 v2, 8, v2
v_subrev_u32 v2, 1, v2
v_cndmask_b32 v1, v1, v2, vcc
v_cmp_eq_u32 vcc, 0, v32
v_mov_b32 v2, s63
s_nop 0
v_cndmask_b32 v32, v1, v2, vcc
v_subrev_u32 v33, 8, v0
v_subrev_u32 v1, 1, v33
v_and_b32 v2, 3, v1
v_cmp_eq_u32 vcc, s63, v2
v_add_u32 v2, 4, v33
v_min_u32 v2, 12, v2
v_subrev_u32 v2, 1, v2
v_cndmask_b32 v1, v1, v2, vcc
v_cmp_eq_u32 vcc, 0, v33
v_mov_b32 v2, s63
s_nop 0
v_cndmask_b32 v33, v1, v2, vcc
v_subrev_u32 v34, 20, v0
v_subrev_u32 v1, 1, v34
v_and_b32 v2, 3, v1
v_cmp_eq_u32 vcc, s63, v2
v_add_u32 v2, 4, v34
v_min_u32 v2, 4, v2
v_subrev_u32 v2, 1, v2
v_cndmask_b32 v1, v1, v2, vcc
v_cmp_eq_u32 vcc, 0, v34
v_mov_b32 v2, s63
s_nop 0
v_cndmask_b32 v34, v1, v2, vcc
s_lshl_b32 s27, s0, 3
v_add_u32 v32, s27, v32
s_mul_i32 s27, s0, 14
s_add_u32 s27, s27, 2
v_add_u32 v33, s27, v33
v_add_u32 v1, 12, v34
v_cmp_gt_u32 vcc, 2, v34
s_nop 1
v_cndmask_b32 v34, v1, v34, vcc
v_cmp_gt_u32 vcc, 20, v0
s_nop 1
v_cndmask_b32 v33, v34, v33, vcc
v_cmp_gt_u32 vcc, 8, v0
s_nop 1
v_cndmask_b32 v32, v33, v32, vcc
v_lshlrev_b32 v32, 11, v32
s_mov_b32 vcc_lo, 16777215
s_mov_b32 vcc_hi, 0
v_mul_u32_u24 v1, 64, v32
v_cndmask_b32 v32, v32, v1, vcc
v_accvgpr_write_b32 a246, v32
s_lshl_b32 s27, s81, 3
v_lshrrev_b32 v1, 3, v0
v_add_u32 v1, s27, v1
v_mul_u32_u24 v2, 4682, v1
v_lshrrev_b32 v2, 16, v2
v_mul_u32_u24 v32, 14, v2
v_sub_u32 v32, v1, v32
v_add_u32 v32, 18, v32
v_lshl_add_u32 v32, v32, 3, v2
s_lshl_b32 s27, s80, 3
v_lshrrev_b32 v1, 5, v0
v_mul_u32_u24 v1, 7, v1
v_add_u32 v1, s27, v1
v_max_u32 v1, 2, v1
v_subrev_u32 v1, 2, v1
v_mul_u32_u24 v1, 4682, v1
v_lshrrev_b32 v1, 16, v1
v_bfe_u32 v2, v0, 1, 1
v_mul_u32_u24 v2, 9, v2
v_add_u32 v1, v1, v2
v_bfe_u32 v2, v0, 2, 3
v_lshl_add_u32 v33, v1, 3, v2
s_and_b32 s27, s2, 31
v_lshrrev_b32 v1, 3, v0
v_min_u32 v1, 5, v1
v_add_u32 v1, 1, v1
v_lshl_add_u32 v34, v1, 5, s27
s_and_b32 s27, s2, 27
v_bfe_u32 v1, v0, 3, 2
v_min_u32 v1, 0, v1
v_lshl_add_u32 v1, v1, 5, s27
v_lshrrev_b32 v2, 5, v0
v_lshl_add_u32 v35, v2, 2, v1
s_movk_i32 s27, 128
s_movk_i32 s31, 256
v_lshl_add_u32 v32, v32, 9, s27
v_lshl_add_u32 v33, v33, 9, s27
v_lshl_add_u32 v34, v34, 9, s31
v_lshl_add_u32 v35, v35, 9, s31
s_xor_b32 s27, s2, 4
s_lshl_b32 s27, s27, 9
s_add_u32 s27, s27, 384
v_mov_b32 v36, s27
v_accvgpr_write_b32 a247, v32
v_accvgpr_write_b32 a248, v33
v_accvgpr_write_b32 a249, v34
v_accvgpr_write_b32 a250, v35
v_accvgpr_write_b32 a251, v36
v_lshrrev_b32 v1, 3, v0
v_and_b32 v2, 7, v0
v_xor_b32 v2, v1, v2
s_lshl2_add_u32 s27, s80, s3
s_lshl_b32 s27, s27, 16
s_lshl_b32 s31, s82, 7
s_add_u32 s27, s27, s31
v_lshl_add_u32 v1, v1, 11, s27
v_lshl_add_u32 v33, v2, 4, v1
v_add_u32 v34, 15360, v33
v_add_u32 v35, 30720, v33
v_add_u32 v36, 46080, v33
v_readlane_b32 s21, v14, 0
v_readlane_b32 s22, v15, 2
s_mov_b32 s79, 32768
Lspin_3:
buffer_load_dword v28, v24, s[40:43], 0 offen sc1
s_waitcnt vmcnt(0)
v_cmp_ne_u32 vcc, s78, v28
s_sub_u32 s79, s79, 1
s_cbranch_scc1 Lok_4
s_cbranch_vccnz Lspin_3
Lok_4:
buffer_load_dwordx4 a[96:99], v4, s[8:11], s21 offen offset:0 sc1
buffer_load_dwordx4 a[100:103], v5, s[8:11], s21 offen offset:0 sc1
buffer_load_dwordx4 a[104:107], v6, s[8:11], s21 offen offset:0 sc1
buffer_load_dwordx4 a[108:111], v7, s[8:11], s21 offen offset:0 sc1
buffer_load_dwordx4 a[112:115], v4, s[8:11], s21 offen offset:1024 sc1
buffer_load_dwordx4 a[116:119], v5, s[8:11], s21 offen offset:1024 sc1
buffer_load_dwordx4 a[120:123], v6, s[8:11], s21 offen offset:1024 sc1
buffer_load_dwordx4 a[124:127], v7, s[8:11], s21 offen offset:1024 sc1
v_readlane_b32 s21, v14, 1
s_mov_b32 s20, 2
s_nop 3
buffer_load_dwordx4 a[128:131], v4, s[8:11], s21 offen offset:0 sc1
buffer_load_dwordx4 a[132:135], v5, s[8:11], s21 offen offset:0 sc1
buffer_load_dwordx4 a[136:139], v6, s[8:11], s21 offen offset:0 sc1
buffer_load_dwordx4 a[140:143], v7, s[8:11], s21 offen offset:0 sc1
s_add_u32 m0, s23, 65536
s_nop 0
buffer_load_dwordx4 v8, s[12:15], s22 offen offset:0 lds
buffer_load_dwordx4 v9, s[12:15], s22 offen offset:1024 lds
s_add_u32 m0, s23, 73728
s_nop 0
buffer_load_dwordx4 v10, s[12:15], s22 offen offset:0 lds
s_waitcnt vmcnt(11) lgkmcnt(0)
s_mov_b32 s30, 2
s_cmp_eq_u32 s3, 0
s_cselect_b32 s27, s6, 0
s_cmp_lg_u32 s27, 0
s_cbranch_scc1 Lq_loop1a
Lq_loop1:
v_mfma_f32_16x16x32_bf16 v[128:131], a[0:3], a[96:99], v[128:131]
ds_read_b64_tr_b16 a[48:49], v16 offset:4096
v_mfma_f32_16x16x32_bf16 v[160:163], a[0:3], a[100:103], v[160:163]
ds_read_b64_tr_b16 a[50:51], v16 offset:4608
v_mfma_f32_16x16x32_bf16 v[192:195], a[0:3], a[104:107], v[192:195]
buffer_load_dwordx4 a[144:147], v4, s[8:11], s21 offen offset:1024 sc1
v_mfma_f32_16x16x32_bf16 v[224:227], a[0:3], a[108:111], v[224:227]
v_mfma_f32_16x16x32_bf16 v[228:231], a[4:7], a[108:111], v[228:231]
ds_read_b64_tr_b16 a[52:53], v17 offset:4096
v_mfma_f32_16x16x32_bf16 v[196:199], a[4:7], a[104:107], v[196:199]
ds_read_b64_tr_b16 a[54:55], v17 offset:4608
v_mfma_f32_16x16x32_bf16 v[164:167], a[4:7], a[100:103], v[164:167]
v_mfma_f32_16x16x32_bf16 v[132:135], a[4:7], a[96:99], v[132:135]
ds_read_b64_tr_b16 a[56:57], v18 offset:4096
v_mfma_f32_16x16x32_bf16 v[136:139], a[8:11], a[96:99], v[136:139]
buffer_load_dwordx4 a[148:151], v5, s[8:11], s21 offen offset:1024 sc1
v_mfma_f32_16x16x32_bf16 v[168:171], a[8:11], a[100:103], v[168:171]
ds_read_b64_tr_b16 a[58:59], v18 offset:4608
v_mfma_f32_16x16x32_bf16 v[200:203], a[8:11], a[104:107], v[200:203]
v_mfma_f32_16x16x32_bf16 v[232:235], a[8:11], a[108:111], v[232:235]
ds_read_b64_tr_b16 a[60:61], v19 offset:4096
v_mfma_f32_16x16x32_bf16 v[236:239], a[12:15], a[108:111], v[236:239]
ds_read_b64_tr_b16 a[62:63], v19 offset:4608
v_mfma_f32_16x16x32_bf16 v[204:207], a[12:15], a[104:107], v[204:207]
v_mfma_f32_16x16x32_bf16 v[172:175], a[12:15], a[100:103], v[172:175]
buffer_load_dwordx4 a[152:155], v6, s[8:11], s21 offen offset:1024 sc1
v_mfma_f32_16x16x32_bf16 v[140:143], a[12:15], a[96:99], v[140:143]
ds_read_b64_tr_b16 a[64:65], v16 offset:12288
s_waitcnt lgkmcnt(3)
v_mfma_f32_16x16x32_bf16 v[144:147], a[16:19], a[96:99], v[144:147]
ds_read_b64_tr_b16 a[66:67], v16 offset:12800
v_mfma_f32_16x16x32_bf16 v[176:179], a[16:19], a[100:103], v[176:179]
v_mfma_f32_16x16x32_bf16 v[208:211], a[16:19], a[104:107], v[208:211]
ds_read_b64_tr_b16 a[68:69], v17 offset:12288
v_mfma_f32_16x16x32_bf16 v[240:243], a[16:19], a[108:111], v[240:243]
ds_read_b64_tr_b16 a[70:71], v17 offset:12800
v_mfma_f32_16x16x32_bf16 v[244:247], a[20:23], a[108:111], v[244:247]
buffer_load_dwordx4 a[156:159], v7, s[8:11], s21 offen offset:1024 sc1
v_mfma_f32_16x16x32_bf16 v[212:215], a[20:23], a[104:107], v[212:215]
v_mfma_f32_16x16x32_bf16 v[180:183], a[20:23], a[100:103], v[180:183]
ds_read_b64_tr_b16 a[72:73], v18 offset:12288
v_mfma_f32_16x16x32_bf16 v[148:151], a[20:23], a[96:99], v[148:151]
ds_read_b64_tr_b16 a[74:75], v18 offset:12800
v_mfma_f32_16x16x32_bf16 v[152:155], a[24:27], a[96:99], v[152:155]
v_mfma_f32_16x16x32_bf16 v[184:187], a[24:27], a[100:103], v[184:187]
ds_read_b64_tr_b16 a[76:77], v19 offset:12288
v_mfma_f32_16x16x32_bf16 v[216:219], a[24:27], a[104:107], v[216:219]
buffer_load_dwordx4 v11, s[12:15], s22 offen offset:1024 lds
v_mfma_f32_16x16x32_bf16 v[248:251], a[24:27], a[108:111], v[248:251]
ds_read_b64_tr_b16 a[78:79], v19 offset:12800
v_mfma_f32_16x16x32_bf16 v[252:255], a[28:31], a[108:111], v[252:255]
v_mfma_f32_16x16x32_bf16 v[220:223], a[28:31], a[104:107], v[220:223]
ds_read_b64_tr_b16 a[80:81], v16 offset:20480
v_mfma_f32_16x16x32_bf16 v[188:191], a[28:31], a[100:103], v[188:191]
ds_read_b64_tr_b16 a[82:83], v16 offset:20992
v_mfma_f32_16x16x32_bf16 v[156:159], a[28:31], a[96:99], v[156:159]
s_add_u32 m0, s23, 81920
v_mfma_f32_16x16x32_bf16 v[64:67], a[96:99], a[32:35], v[64:67]
buffer_load_dwordx4 v12, s[12:15], s22 offen offset:0 lds
v_mfma_f32_16x16x32_bf16 v[80:83], a[100:103], a[32:35], v[80:83]
v_mfma_f32_16x16x32_bf16 v[96:99], a[104:107], a[32:35], v[96:99]
ds_read_b64_tr_b16 a[84:85], v17 offset:20480
v_mfma_f32_16x16x32_bf16 v[112:115], a[108:111], a[32:35], v[112:115]
ds_read_b64_tr_b16 a[86:87], v17 offset:20992
v_mfma_f32_16x16x32_bf16 v[116:119], a[108:111], a[36:39], v[116:119]
v_mfma_f32_16x16x32_bf16 v[100:103], a[104:107], a[36:39], v[100:103]
ds_read_b64_tr_b16 a[88:89], v18 offset:20480
v_mfma_f32_16x16x32_bf16 v[84:87], a[100:103], a[36:39], v[84:87]
buffer_load_dwordx4 v13, s[12:15], s22 offen offset:1024 lds
v_mfma_f32_16x16x32_bf16 v[68:71], a[96:99], a[36:39], v[68:71]
v_readlane_b32 s21, v14, s20
v_mfma_f32_16x16x32_bf16 v[72:75], a[96:99], a[40:43], v[72:75]
ds_read_b64_tr_b16 a[90:91], v18 offset:20992
v_mfma_f32_16x16x32_bf16 v[88:91], a[100:103], a[40:43], v[88:91]
s_add_u32 s20, s20, 1
v_mfma_f32_16x16x32_bf16 v[104:107], a[104:107], a[40:43], v[104:107]
v_mfma_f32_16x16x32_bf16 v[120:123], a[108:111], a[40:43], v[120:123]
v_readlane_b32 s22, v15, s20
v_mfma_f32_16x16x32_bf16 v[124:127], a[108:111], a[44:47], v[124:127]
ds_read_b64_tr_b16 a[92:93], v19 offset:20480
v_mfma_f32_16x16x32_bf16 v[108:111], a[104:107], a[44:47], v[108:111]
ds_read_b64_tr_b16 a[94:95], v19 offset:20992
v_mfma_f32_16x16x32_bf16 v[92:95], a[100:103], a[44:47], v[92:95]
v_mfma_f32_16x16x32_bf16 v[76:79], a[96:99], a[44:47], v[76:79]
s_waitcnt vmcnt(14)
v_mfma_f32_16x16x32_bf16 v[128:131], a[48:51], a[112:115], v[128:131]
s_barrier
v_mfma_f32_16x16x32_bf16 v[160:163], a[48:51], a[116:119], v[160:163]
ds_read_b64_tr_b16 a[0:1], v16 offset:32768
v_mfma_f32_16x16x32_bf16 v[192:195], a[48:51], a[120:123], v[192:195]
buffer_load_dwordx4 a[96:99], v4, s[8:11], s21 offen offset:0 sc1
v_mfma_f32_16x16x32_bf16 v[224:227], a[48:51], a[124:127], v[224:227]
ds_read_b64_tr_b16 a[2:3], v16 offset:33280
v_mfma_f32_16x16x32_bf16 v[228:231], a[52:55], a[124:127], v[228:231]
v_mfma_f32_16x16x32_bf16 v[196:199], a[52:55], a[120:123], v[196:199]
ds_read_b64_tr_b16 a[4:5], v17 offset:32768
v_mfma_f32_16x16x32_bf16 v[164:167], a[52:55], a[116:119], v[164:167]
ds_read_b64_tr_b16 a[6:7], v17 offset:33280
v_mfma_f32_16x16x32_bf16 v[132:135], a[52:55], a[112:115], v[132:135]
v_mfma_f32_16x16x32_bf16 v[136:139], a[56:59], a[112:115], v[136:139]
buffer_load_dwordx4 a[100:103], v5, s[8:11], s21 offen offset:0 sc1
v_mfma_f32_16x16x32_bf16 v[168:171], a[56:59], a[116:119], v[168:171]
ds_read_b64_tr_b16 a[8:9], v18 offset:32768
v_mfma_f32_16x16x32_bf16 v[200:203], a[56:59], a[120:123], v[200:203]
ds_read_b64_tr_b16 a[10:11], v18 offset:33280
v_mfma_f32_16x16x32_bf16 v[232:235], a[56:59], a[124:127], v[232:235]
s_waitcnt lgkmcnt(2)
v_mfma_f32_16x16x32_bf16 v[236:239], a[60:63], a[124:127], v[236:239]
ds_read_b64_tr_b16 a[12:13], v19 offset:32768
v_mfma_f32_16x16x32_bf16 v[204:207], a[60:63], a[120:123], v[204:207]
ds_read_b64_tr_b16 a[14:15], v19 offset:33280
v_mfma_f32_16x16x32_bf16 v[172:175], a[60:63], a[116:119], v[172:175]
buffer_load_dwordx4 a[104:107], v6, s[8:11], s21 offen offset:0 sc1
v_mfma_f32_16x16x32_bf16 v[140:143], a[60:63], a[112:115], v[140:143]
v_mfma_f32_16x16x32_bf16 v[144:147], a[64:67], a[112:115], v[144:147]
ds_read_b64_tr_b16 a[16:17], v16 offset:40960
v_mfma_f32_16x16x32_bf16 v[176:179], a[64:67], a[116:119], v[176:179]
ds_read_b64_tr_b16 a[18:19], v16 offset:41472
v_mfma_f32_16x16x32_bf16 v[208:211], a[64:67], a[120:123], v[208:211]
v_mfma_f32_16x16x32_bf16 v[240:243], a[64:67], a[124:127], v[240:243]
ds_read_b64_tr_b16 a[20:21], v17 offset:40960
v_mfma_f32_16x16x32_bf16 v[244:247], a[68:71], a[124:127], v[244:247]
buffer_load_dwordx4 a[108:111], v7, s[8:11], s21 offen offset:0 sc1
v_mfma_f32_16x16x32_bf16 v[212:215], a[68:71], a[120:123], v[212:215]
ds_read_b64_tr_b16 a[22:23], v17 offset:41472
v_mfma_f32_16x16x32_bf16 v[180:183], a[68:71], a[116:119], v[180:183]
v_mfma_f32_16x16x32_bf16 v[148:151], a[68:71], a[112:115], v[148:151]
ds_read_b64_tr_b16 a[24:25], v18 offset:40960
v_mfma_f32_16x16x32_bf16 v[152:155], a[72:75], a[112:115], v[152:155]
v_mfma_f32_16x16x32_bf16 v[184:187], a[72:75], a[116:119], v[184:187]
s_add_u32 m0, s23, 98304
v_mfma_f32_16x16x32_bf16 v[216:219], a[72:75], a[120:123], v[216:219]
buffer_load_dwordx4 v8, s[12:15], s22 offen offset:0 lds
v_mfma_f32_16x16x32_bf16 v[248:251], a[72:75], a[124:127], v[248:251]
ds_read_b64_tr_b16 a[26:27], v18 offset:41472
v_mfma_f32_16x16x32_bf16 v[252:255], a[76:79], a[124:127], v[252:255]
ds_read_b64_tr_b16 a[28:29], v19 offset:40960
v_mfma_f32_16x16x32_bf16 v[220:223], a[76:79], a[120:123], v[220:223]
v_mfma_f32_16x16x32_bf16 v[188:191], a[76:79], a[116:119], v[188:191]
ds_read_b64_tr_b16 a[30:31], v19 offset:41472
v_mfma_f32_16x16x32_bf16 v[156:159], a[76:79], a[112:115], v[156:159]
ds_read_b64_tr_b16 a[32:33], v16 offset:49152
v_mfma_f32_16x16x32_bf16 v[64:67], a[112:115], a[80:83], v[64:67]
buffer_load_dwordx4 v9, s[12:15], s22 offen offset:1024 lds
v_mfma_f32_16x16x32_bf16 v[80:83], a[116:119], a[80:83], v[80:83]
v_mfma_f32_16x16x32_bf16 v[96:99], a[120:123], a[80:83], v[96:99]
ds_read_b64_tr_b16 a[34:35], v16 offset:49664
v_mfma_f32_16x16x32_bf16 v[112:115], a[124:127], a[80:83], v[112:115]
ds_read_b64_tr_b16 a[36:37], v17 offset:49152
v_mfma_f32_16x16x32_bf16 v[116:119], a[124:127], a[84:87], v[116:119]
v_mfma_f32_16x16x32_bf16 v[100:103], a[120:123], a[84:87], v[100:103]
s_add_u32 m0, s23, 106496
v_mfma_f32_16x16x32_bf16 v[84:87], a[116:119], a[84:87], v[84:87]
buffer_load_dwordx4 v10, s[12:15], s22 offen offset:0 lds
v_mfma_f32_16x16x32_bf16 v[68:71], a[112:115], a[84:87], v[68:71]
ds_read_b64_tr_b16 a[38:39], v17 offset:49664
v_mfma_f32_16x16x32_bf16 v[72:75], a[112:115], a[88:91], v[72:75]
ds_read_b64_tr_b16 a[40:41], v18 offset:49152
v_mfma_f32_16x16x32_bf16 v[88:91], a[116:119], a[88:91], v[88:91]
v_mfma_f32_16x16x32_bf16 v[104:107], a[120:123], a[88:91], v[104:107]
ds_read_b64_tr_b16 a[42:43], v18 offset:49664
v_mfma_f32_16x16x32_bf16 v[120:123], a[124:127], a[88:91], v[120:123]
ds_read_b64_tr_b16 a[44:45], v19 offset:49152
v_mfma_f32_16x16x32_bf16 v[124:127], a[124:127], a[92:95], v[124:127]
v_mfma_f32_16x16x32_bf16 v[108:111], a[120:123], a[92:95], v[108:111]
ds_read_b64_tr_b16 a[46:47], v19 offset:49664
v_mfma_f32_16x16x32_bf16 v[92:95], a[116:119], a[92:95], v[92:95]
v_mfma_f32_16x16x32_bf16 v[76:79], a[112:115], a[92:95], v[76:79]
s_waitcnt vmcnt(17)
v_mfma_f32_16x16x32_bf16 v[128:131], a[0:3], a[128:131], v[128:131]
ds_read_b64_tr_b16 a[48:49], v16 offset:36864
v_mfma_f32_16x16x32_bf16 v[160:163], a[0:3], a[132:135], v[160:163]
ds_read_b64_tr_b16 a[50:51], v16 offset:37376
v_mfma_f32_16x16x32_bf16 v[192:195], a[0:3], a[136:139], v[192:195]
buffer_load_dwordx4 a[112:115], v4, s[8:11], s21 offen offset:1024 sc1
v_mfma_f32_16x16x32_bf16 v[224:227], a[0:3], a[140:143], v[224:227]
v_mfma_f32_16x16x32_bf16 v[228:231], a[4:7], a[140:143], v[228:231]
ds_read_b64_tr_b16 a[52:53], v17 offset:36864
v_mfma_f32_16x16x32_bf16 v[196:199], a[4:7], a[136:139], v[196:199]
ds_read_b64_tr_b16 a[54:55], v17 offset:37376
v_mfma_f32_16x16x32_bf16 v[164:167], a[4:7], a[132:135], v[164:167]
v_mfma_f32_16x16x32_bf16 v[132:135], a[4:7], a[128:131], v[132:135]
ds_read_b64_tr_b16 a[56:57], v18 offset:36864
s_waitcnt lgkmcnt(3)
v_mfma_f32_16x16x32_bf16 v[136:139], a[8:11], a[128:131], v[136:139]
buffer_load_dwordx4 a[116:119], v5, s[8:11], s21 offen offset:1024 sc1
v_mfma_f32_16x16x32_bf16 v[168:171], a[8:11], a[132:135], v[168:171]
ds_read_b64_tr_b16 a[58:59], v18 offset:37376
v_mfma_f32_16x16x32_bf16 v[200:203], a[8:11], a[136:139], v[200:203]
v_mfma_f32_16x16x32_bf16 v[232:235], a[8:11], a[140:143], v[232:235]
ds_read_b64_tr_b16 a[60:61], v19 offset:36864
v_mfma_f32_16x16x32_bf16 v[236:239], a[12:15], a[140:143], v[236:239]
ds_read_b64_tr_b16 a[62:63], v19 offset:37376
v_mfma_f32_16x16x32_bf16 v[204:207], a[12:15], a[136:139], v[204:207]
v_mfma_f32_16x16x32_bf16 v[172:175], a[12:15], a[132:135], v[172:175]
buffer_load_dwordx4 a[120:123], v6, s[8:11], s21 offen offset:1024 sc1
v_mfma_f32_16x16x32_bf16 v[140:143], a[12:15], a[128:131], v[140:143]
ds_read_b64_tr_b16 a[64:65], v16 offset:45056
v_mfma_f32_16x16x32_bf16 v[144:147], a[16:19], a[128:131], v[144:147]
ds_read_b64_tr_b16 a[66:67], v16 offset:45568
v_mfma_f32_16x16x32_bf16 v[176:179], a[16:19], a[132:135], v[176:179]
v_mfma_f32_16x16x32_bf16 v[208:211], a[16:19], a[136:139], v[208:211]
ds_read_b64_tr_b16 a[68:69], v17 offset:45056
v_mfma_f32_16x16x32_bf16 v[240:243], a[16:19], a[140:143], v[240:243]
ds_read_b64_tr_b16 a[70:71], v17 offset:45568
v_mfma_f32_16x16x32_bf16 v[244:247], a[20:23], a[140:143], v[244:247]
buffer_load_dwordx4 a[124:127], v7, s[8:11], s21 offen offset:1024 sc1
v_mfma_f32_16x16x32_bf16 v[212:215], a[20:23], a[136:139], v[212:215]
v_mfma_f32_16x16x32_bf16 v[180:183], a[20:23], a[132:135], v[180:183]
ds_read_b64_tr_b16 a[72:73], v18 offset:45056
v_mfma_f32_16x16x32_bf16 v[148:151], a[20:23], a[128:131], v[148:151]
ds_read_b64_tr_b16 a[74:75], v18 offset:45568
v_mfma_f32_16x16x32_bf16 v[152:155], a[24:27], a[128:131], v[152:155]
v_mfma_f32_16x16x32_bf16 v[184:187], a[24:27], a[132:135], v[184:187]
ds_read_b64_tr_b16 a[76:77], v19 offset:45056
v_mfma_f32_16x16x32_bf16 v[216:219], a[24:27], a[136:139], v[216:219]
buffer_load_dwordx4 v11, s[12:15], s22 offen offset:1024 lds
v_mfma_f32_16x16x32_bf16 v[248:251], a[24:27], a[140:143], v[248:251]
ds_read_b64_tr_b16 a[78:79], v19 offset:45568
v_mfma_f32_16x16x32_bf16 v[252:255], a[28:31], a[140:143], v[252:255]
v_mfma_f32_16x16x32_bf16 v[220:223], a[28:31], a[136:139], v[220:223]
ds_read_b64_tr_b16 a[80:81], v16 offset:53248
v_mfma_f32_16x16x32_bf16 v[188:191], a[28:31], a[132:135], v[188:191]
ds_read_b64_tr_b16 a[82:83], v16 offset:53760
v_mfma_f32_16x16x32_bf16 v[156:159], a[28:31], a[128:131], v[156:159]
s_add_u32 m0, s23, 114688
v_mfma_f32_16x16x32_bf16 v[64:67], a[128:131], a[32:35], v[64:67]
buffer_load_dwordx4 v12, s[12:15], s22 offen offset:0 lds
v_mfma_f32_16x16x32_bf16 v[80:83], a[132:135], a[32:35], v[80:83]
v_mfma_f32_16x16x32_bf16 v[96:99], a[136:139], a[32:35], v[96:99]
ds_read_b64_tr_b16 a[84:85], v17 offset:53248
v_mfma_f32_16x16x32_bf16 v[112:115], a[140:143], a[32:35], v[112:115]
ds_read_b64_tr_b16 a[86:87], v17 offset:53760
v_mfma_f32_16x16x32_bf16 v[116:119], a[140:143], a[36:39], v[116:119]
v_mfma_f32_16x16x32_bf16 v[100:103], a[136:139], a[36:39], v[100:103]
ds_read_b64_tr_b16 a[88:89], v18 offset:53248
v_mfma_f32_16x16x32_bf16 v[84:87], a[132:135], a[36:39], v[84:87]
buffer_load_dwordx4 v13, s[12:15], s22 offen offset:1024 lds
v_mfma_f32_16x16x32_bf16 v[68:71], a[128:131], a[36:39], v[68:71]
v_readlane_b32 s21, v14, s20
v_mfma_f32_16x16x32_bf16 v[72:75], a[128:131], a[40:43], v[72:75]
ds_read_b64_tr_b16 a[90:91], v18 offset:53760
v_mfma_f32_16x16x32_bf16 v[88:91], a[132:135], a[40:43], v[88:91]
s_add_u32 s20, s20, 1
v_mfma_f32_16x16x32_bf16 v[104:107], a[136:139], a[40:43], v[104:107]
v_mfma_f32_16x16x32_bf16 v[120:123], a[140:143], a[40:43], v[120:123]
v_readlane_b32 s22, v15, s20
v_mfma_f32_16x16x32_bf16 v[124:127], a[140:143], a[44:47], v[124:127]
ds_read_b64_tr_b16 a[92:93], v19 offset:53248
v_mfma_f32_16x16x32_bf16 v[108:111], a[136:139], a[44:47], v[108:111]
ds_read_b64_tr_b16 a[94:95], v19 offset:53760
v_mfma_f32_16x16x32_bf16 v[92:95], a[132:135], a[44:47], v[92:95]
v_mfma_f32_16x16x32_bf16 v[76:79], a[128:131], a[44:47], v[76:79]
s_waitcnt vmcnt(14)
v_mfma_f32_16x16x32_bf16 v[128:131], a[48:51], a[144:147], v[128:131]
s_barrier
v_mfma_f32_16x16x32_bf16 v[160:163], a[48:51], a[148:151], v[160:163]
ds_read_b64_tr_b16 a[0:1], v20 offset:0
v_mfma_f32_16x16x32_bf16 v[192:195], a[48:51], a[152:155], v[192:195]
buffer_load_dwordx4 a[128:131], v4, s[8:11], s21 offen offset:0 sc1
v_mfma_f32_16x16x32_bf16 v[224:227], a[48:51], a[156:159], v[224:227]
ds_read_b64_tr_b16 a[2:3], v20 offset:512
s_waitcnt lgkmcnt(2)
v_mfma_f32_16x16x32_bf16 v[228:231], a[52:55], a[156:159], v[228:231]
v_mfma_f32_16x16x32_bf16 v[196:199], a[52:55], a[152:155], v[196:199]
ds_read_b64_tr_b16 a[4:5], v21 offset:0
v_mfma_f32_16x16x32_bf16 v[164:167], a[52:55], a[148:151], v[164:167]
ds_read_b64_tr_b16 a[6:7], v21 offset:512
v_mfma_f32_16x16x32_bf16 v[132:135], a[52:55], a[144:147], v[132:135]
v_mfma_f32_16x16x32_bf16 v[136:139], a[56:59], a[144:147], v[136:139]
buffer_load_dwordx4 a[132:135], v5, s[8:11], s21 offen offset:0 sc1
v_mfma_f32_16x16x32_bf16 v[168:171], a[56:59], a[148:151], v[168:171]
ds_read_b64_tr_b16 a[8:9], v22 offset:0
v_mfma_f32_16x16x32_bf16 v[200:203], a[56:59], a[152:155], v[200:203]
ds_read_b64_tr_b16 a[10:11], v22 offset:512
v_mfma_f32_16x16x32_bf16 v[232:235], a[56:59], a[156:159], v[232:235]
v_mfma_f32_16x16x32_bf16 v[236:239], a[60:63], a[156:159], v[236:239]
ds_read_b64_tr_b16 a[12:13], v23 offset:0
v_mfma_f32_16x16x32_bf16 v[204:207], a[60:63], a[152:155], v[204:207]
ds_read_b64_tr_b16 a[14:15], v23 offset:512
v_mfma_f32_16x16x32_bf16 v[172:175], a[60:63], a[148:151], v[172:175]
buffer_load_dwordx4 a[136:139], v6, s[8:11], s21 offen offset:0 sc1
v_mfma_f32_16x16x32_bf16 v[140:143], a[60:63], a[144:147], v[140:143]
v_mfma_f32_16x16x32_bf16 v[144:147], a[64:67], a[144:147], v[144:147]
ds_read_b64_tr_b16 a[16:17], v20 offset:8192
v_mfma_f32_16x16x32_bf16 v[176:179], a[64:67], a[148:151], v[176:179]
ds_read_b64_tr_b16 a[18:19], v20 offset:8704
v_mfma_f32_16x16x32_bf16 v[208:211], a[64:67], a[152:155], v[208:211]
v_mfma_f32_16x16x32_bf16 v[240:243], a[64:67], a[156:159], v[240:243]
ds_read_b64_tr_b16 a[20:21], v21 offset:8192
v_mfma_f32_16x16x32_bf16 v[244:247], a[68:71], a[156:159], v[244:247]
buffer_load_dwordx4 a[140:143], v7, s[8:11], s21 offen offset:0 sc1
v_mfma_f32_16x16x32_bf16 v[212:215], a[68:71], a[152:155], v[212:215]
ds_read_b64_tr_b16 a[22:23], v21 offset:8704
v_mfma_f32_16x16x32_bf16 v[180:183], a[68:71], a[148:151], v[180:183]
v_mfma_f32_16x16x32_bf16 v[148:151], a[68:71], a[144:147], v[148:151]
ds_read_b64_tr_b16 a[24:25], v22 offset:8192
v_mfma_f32_16x16x32_bf16 v[152:155], a[72:75], a[144:147], v[152:155]
v_mfma_f32_16x16x32_bf16 v[184:187], a[72:75], a[148:151], v[184:187]
s_add_u32 m0, s23, 0
v_mfma_f32_16x16x32_bf16 v[216:219], a[72:75], a[152:155], v[216:219]
buffer_load_dwordx4 v8, s[12:15], s22 offen offset:0 lds
v_mfma_f32_16x16x32_bf16 v[248:251], a[72:75], a[156:159], v[248:251]
ds_read_b64_tr_b16 a[26:27], v22 offset:8704
v_mfma_f32_16x16x32_bf16 v[252:255], a[76:79], a[156:159], v[252:255]
ds_read_b64_tr_b16 a[28:29], v23 offset:8192
v_mfma_f32_16x16x32_bf16 v[220:223], a[76:79], a[152:155], v[220:223]
v_mfma_f32_16x16x32_bf16 v[188:191], a[76:79], a[148:151], v[188:191]
ds_read_b64_tr_b16 a[30:31], v23 offset:8704
v_mfma_f32_16x16x32_bf16 v[156:159], a[76:79], a[144:147], v[156:159]
ds_read_b64_tr_b16 a[32:33], v20 offset:16384
v_mfma_f32_16x16x32_bf16 v[64:67], a[144:147], a[80:83], v[64:67]
buffer_load_dwordx4 v9, s[12:15], s22 offen offset:1024 lds
v_mfma_f32_16x16x32_bf16 v[80:83], a[148:151], a[80:83], v[80:83]
v_mfma_f32_16x16x32_bf16 v[96:99], a[152:155], a[80:83], v[96:99]
ds_read_b64_tr_b16 a[34:35], v20 offset:16896
v_mfma_f32_16x16x32_bf16 v[112:115], a[156:159], a[80:83], v[112:115]
ds_read_b64_tr_b16 a[36:37], v21 offset:16384
v_mfma_f32_16x16x32_bf16 v[116:119], a[156:159], a[84:87], v[116:119]
v_mfma_f32_16x16x32_bf16 v[100:103], a[152:155], a[84:87], v[100:103]
s_add_u32 m0, s23, 8192
v_mfma_f32_16x16x32_bf16 v[84:87], a[148:151], a[84:87], v[84:87]
buffer_load_dwordx4 v10, s[12:15], s22 offen offset:0 lds
v_mfma_f32_16x16x32_bf16 v[68:71], a[144:147], a[84:87], v[68:71]
ds_read_b64_tr_b16 a[38:39], v21 offset:16896
v_mfma_f32_16x16x32_bf16 v[72:75], a[144:147], a[88:91], v[72:75]
ds_read_b64_tr_b16 a[40:41], v22 offset:16384
v_mfma_f32_16x16x32_bf16 v[88:91], a[148:151], a[88:91], v[88:91]
v_mfma_f32_16x16x32_bf16 v[104:107], a[152:155], a[88:91], v[104:107]
ds_read_b64_tr_b16 a[42:43], v22 offset:16896
v_mfma_f32_16x16x32_bf16 v[120:123], a[156:159], a[88:91], v[120:123]
ds_read_b64_tr_b16 a[44:45], v23 offset:16384
v_mfma_f32_16x16x32_bf16 v[124:127], a[156:159], a[92:95], v[124:127]
v_mfma_f32_16x16x32_bf16 v[108:111], a[152:155], a[92:95], v[108:111]
ds_read_b64_tr_b16 a[46:47], v23 offset:16896
v_mfma_f32_16x16x32_bf16 v[92:95], a[148:151], a[92:95], v[92:95]
v_mfma_f32_16x16x32_bf16 v[76:79], a[144:147], a[92:95], v[76:79]
s_waitcnt vmcnt(17) lgkmcnt(2)
v_mfma_f32_16x16x32_bf16 v[128:131], a[0:3], a[96:99], v[128:131]
ds_read_b64_tr_b16 a[48:49], v20 offset:4096
v_mfma_f32_16x16x32_bf16 v[160:163], a[0:3], a[100:103], v[160:163]
ds_read_b64_tr_b16 a[50:51], v20 offset:4608
v_mfma_f32_16x16x32_bf16 v[192:195], a[0:3], a[104:107], v[192:195]
buffer_load_dwordx4 a[144:147], v4, s[8:11], s21 offen offset:1024 sc1
v_mfma_f32_16x16x32_bf16 v[224:227], a[0:3], a[108:111], v[224:227]
v_mfma_f32_16x16x32_bf16 v[228:231], a[4:7], a[108:111], v[228:231]
ds_read_b64_tr_b16 a[52:53], v21 offset:4096
v_mfma_f32_16x16x32_bf16 v[196:199], a[4:7], a[104:107], v[196:199]
ds_read_b64_tr_b16 a[54:55], v21 offset:4608
v_mfma_f32_16x16x32_bf16 v[164:167], a[4:7], a[100:103], v[164:167]
v_mfma_f32_16x16x32_bf16 v[132:135], a[4:7], a[96:99], v[132:135]
ds_read_b64_tr_b16 a[56:57], v22 offset:4096
v_mfma_f32_16x16x32_bf16 v[136:139], a[8:11], a[96:99], v[136:139]
buffer_load_dwordx4 a[148:151], v5, s[8:11], s21 offen offset:1024 sc1
v_mfma_f32_16x16x32_bf16 v[168:171], a[8:11], a[100:103], v[168:171]
ds_read_b64_tr_b16 a[58:59], v22 offset:4608
v_mfma_f32_16x16x32_bf16 v[200:203], a[8:11], a[104:107], v[200:203]
v_mfma_f32_16x16x32_bf16 v[232:235], a[8:11], a[108:111], v[232:235]
ds_read_b64_tr_b16 a[60:61], v23 offset:4096
v_mfma_f32_16x16x32_bf16 v[236:239], a[12:15], a[108:111], v[236:239]
ds_read_b64_tr_b16 a[62:63], v23 offset:4608
v_mfma_f32_16x16x32_bf16 v[204:207], a[12:15], a[104:107], v[204:207]
v_mfma_f32_16x16x32_bf16 v[172:175], a[12:15], a[100:103], v[172:175]
buffer_load_dwordx4 a[152:155], v6, s[8:11], s21 offen offset:1024 sc1
v_mfma_f32_16x16x32_bf16 v[140:143], a[12:15], a[96:99], v[140:143]
ds_read_b64_tr_b16 a[64:65], v20 offset:12288
v_mfma_f32_16x16x32_bf16 v[144:147], a[16:19], a[96:99], v[144:147]
ds_read_b64_tr_b16 a[66:67], v20 offset:12800
v_mfma_f32_16x16x32_bf16 v[176:179], a[16:19], a[100:103], v[176:179]
v_mfma_f32_16x16x32_bf16 v[208:211], a[16:19], a[104:107], v[208:211]
ds_read_b64_tr_b16 a[68:69], v21 offset:12288
v_mfma_f32_16x16x32_bf16 v[240:243], a[16:19], a[108:111], v[240:243]
ds_read_b64_tr_b16 a[70:71], v21 offset:12800
v_mfma_f32_16x16x32_bf16 v[244:247], a[20:23], a[108:111], v[244:247]
buffer_load_dwordx4 a[156:159], v7, s[8:11], s21 offen offset:1024 sc1
v_mfma_f32_16x16x32_bf16 v[212:215], a[20:23], a[104:107], v[212:215]
v_mfma_f32_16x16x32_bf16 v[180:183], a[20:23], a[100:103], v[180:183]
ds_read_b64_tr_b16 a[72:73], v22 offset:12288
v_mfma_f32_16x16x32_bf16 v[148:151], a[20:23], a[96:99], v[148:151]
ds_read_b64_tr_b16 a[74:75], v22 offset:12800
v_mfma_f32_16x16x32_bf16 v[152:155], a[24:27], a[96:99], v[152:155]
v_mfma_f32_16x16x32_bf16 v[184:187], a[24:27], a[100:103], v[184:187]
ds_read_b64_tr_b16 a[76:77], v23 offset:12288
v_mfma_f32_16x16x32_bf16 v[216:219], a[24:27], a[104:107], v[216:219]
buffer_load_dwordx4 v11, s[12:15], s22 offen offset:1024 lds
v_mfma_f32_16x16x32_bf16 v[248:251], a[24:27], a[108:111], v[248:251]
ds_read_b64_tr_b16 a[78:79], v23 offset:12800
v_mfma_f32_16x16x32_bf16 v[252:255], a[28:31], a[108:111], v[252:255]
v_mfma_f32_16x16x32_bf16 v[220:223], a[28:31], a[104:107], v[220:223]
ds_read_b64_tr_b16 a[80:81], v20 offset:20480
v_mfma_f32_16x16x32_bf16 v[188:191], a[28:31], a[100:103], v[188:191]
ds_read_b64_tr_b16 a[82:83], v20 offset:20992
v_mfma_f32_16x16x32_bf16 v[156:159], a[28:31], a[96:99], v[156:159]
s_add_u32 m0, s23, 16384
v_mfma_f32_16x16x32_bf16 v[64:67], a[96:99], a[32:35], v[64:67]
buffer_load_dwordx4 v12, s[12:15], s22 offen offset:0 lds
v_mfma_f32_16x16x32_bf16 v[80:83], a[100:103], a[32:35], v[80:83]
v_mfma_f32_16x16x32_bf16 v[96:99], a[104:107], a[32:35], v[96:99]
ds_read_b64_tr_b16 a[84:85], v21 offset:20480
v_mfma_f32_16x16x32_bf16 v[112:115], a[108:111], a[32:35], v[112:115]
ds_read_b64_tr_b16 a[86:87], v21 offset:20992
v_mfma_f32_16x16x32_bf16 v[116:119], a[108:111], a[36:39], v[116:119]
v_mfma_f32_16x16x32_bf16 v[100:103], a[104:107], a[36:39], v[100:103]
ds_read_b64_tr_b16 a[88:89], v22 offset:20480
v_mfma_f32_16x16x32_bf16 v[84:87], a[100:103], a[36:39], v[84:87]
buffer_load_dwordx4 v13, s[12:15], s22 offen offset:1024 lds
v_mfma_f32_16x16x32_bf16 v[68:71], a[96:99], a[36:39], v[68:71]
v_readlane_b32 s21, v14, s20
v_mfma_f32_16x16x32_bf16 v[72:75], a[96:99], a[40:43], v[72:75]
ds_read_b64_tr_b16 a[90:91], v22 offset:20992
v_mfma_f32_16x16x32_bf16 v[88:91], a[100:103], a[40:43], v[88:91]
s_add_u32 s20, s20, 1
v_mfma_f32_16x16x32_bf16 v[104:107], a[104:107], a[40:43], v[104:107]
v_mfma_f32_16x16x32_bf16 v[120:123], a[108:111], a[40:43], v[120:123]
v_readlane_b32 s22, v15, s20
s_waitcnt lgkmcnt(1)
v_mfma_f32_16x16x32_bf16 v[124:127], a[108:111], a[44:47], v[124:127]
ds_read_b64_tr_b16 a[92:93], v23 offset:20480
v_mfma_f32_16x16x32_bf16 v[108:111], a[104:107], a[44:47], v[108:111]
ds_read_b64_tr_b16 a[94:95], v23 offset:20992
v_mfma_f32_16x16x32_bf16 v[92:95], a[100:103], a[44:47], v[92:95]
v_mfma_f32_16x16x32_bf16 v[76:79], a[96:99], a[44:47], v[76:79]
s_waitcnt vmcnt(14)
v_mfma_f32_16x16x32_bf16 v[128:131], a[48:51], a[112:115], v[128:131]
s_barrier
v_mfma_f32_16x16x32_bf16 v[160:163], a[48:51], a[116:119], v[160:163]
ds_read_b64_tr_b16 a[0:1], v20 offset:32768
v_mfma_f32_16x16x32_bf16 v[192:195], a[48:51], a[120:123], v[192:195]
buffer_load_dwordx4 a[96:99], v4, s[8:11], s21 offen offset:0 sc1
v_mfma_f32_16x16x32_bf16 v[224:227], a[48:51], a[124:127], v[224:227]
ds_read_b64_tr_b16 a[2:3], v20 offset:33280
v_mfma_f32_16x16x32_bf16 v[228:231], a[52:55], a[124:127], v[228:231]
v_mfma_f32_16x16x32_bf16 v[196:199], a[52:55], a[120:123], v[196:199]
ds_read_b64_tr_b16 a[4:5], v21 offset:32768
v_mfma_f32_16x16x32_bf16 v[164:167], a[52:55], a[116:119], v[164:167]
ds_read_b64_tr_b16 a[6:7], v21 offset:33280
v_mfma_f32_16x16x32_bf16 v[132:135], a[52:55], a[112:115], v[132:135]
v_mfma_f32_16x16x32_bf16 v[136:139], a[56:59], a[112:115], v[136:139]
buffer_load_dwordx4 a[100:103], v5, s[8:11], s21 offen offset:0 sc1
v_mfma_f32_16x16x32_bf16 v[168:171], a[56:59], a[116:119], v[168:171]
ds_read_b64_tr_b16 a[8:9], v22 offset:32768
v_mfma_f32_16x16x32_bf16 v[200:203], a[56:59], a[120:123], v[200:203]
ds_read_b64_tr_b16 a[10:11], v22 offset:33280
v_mfma_f32_16x16x32_bf16 v[232:235], a[56:59], a[124:127], v[232:235]
v_mfma_f32_16x16x32_bf16 v[236:239], a[60:63], a[124:127], v[236:239]
ds_read_b64_tr_b16 a[12:13], v23 offset:32768
v_mfma_f32_16x16x32_bf16 v[204:207], a[60:63], a[120:123], v[204:207]
ds_read_b64_tr_b16 a[14:15], v23 offset:33280
v_mfma_f32_16x16x32_bf16 v[172:175], a[60:63], a[116:119], v[172:175]
buffer_load_dwordx4 a[104:107], v6, s[8:11], s21 offen offset:0 sc1
v_mfma_f32_16x16x32_bf16 v[140:143], a[60:63], a[112:115], v[140:143]
v_mfma_f32_16x16x32_bf16 v[144:147], a[64:67], a[112:115], v[144:147]
ds_read_b64_tr_b16 a[16:17], v20 offset:40960
v_mfma_f32_16x16x32_bf16 v[176:179], a[64:67], a[116:119], v[176:179]
ds_read_b64_tr_b16 a[18:19], v20 offset:41472
v_mfma_f32_16x16x32_bf16 v[208:211], a[64:67], a[120:123], v[208:211]
v_mfma_f32_16x16x32_bf16 v[240:243], a[64:67], a[124:127], v[240:243]
ds_read_b64_tr_b16 a[20:21], v21 offset:40960
v_mfma_f32_16x16x32_bf16 v[244:247], a[68:71], a[124:127], v[244:247]
buffer_load_dwordx4 a[108:111], v7, s[8:11], s21 offen offset:0 sc1
v_mfma_f32_16x16x32_bf16 v[212:215], a[68:71], a[120:123], v[212:215]
ds_read_b64_tr_b16 a[22:23], v21 offset:41472
v_mfma_f32_16x16x32_bf16 v[180:183], a[68:71], a[116:119], v[180:183]
v_mfma_f32_16x16x32_bf16 v[148:151], a[68:71], a[112:115], v[148:151]
ds_read_b64_tr_b16 a[24:25], v22 offset:40960
v_mfma_f32_16x16x32_bf16 v[152:155], a[72:75], a[112:115], v[152:155]
v_mfma_f32_16x16x32_bf16 v[184:187], a[72:75], a[116:119], v[184:187]
s_add_u32 m0, s23, 32768
v_mfma_f32_16x16x32_bf16 v[216:219], a[72:75], a[120:123], v[216:219]
buffer_load_dwordx4 v8, s[12:15], s22 offen offset:0 lds
v_mfma_f32_16x16x32_bf16 v[248:251], a[72:75], a[124:127], v[248:251]
ds_read_b64_tr_b16 a[26:27], v22 offset:41472
v_mfma_f32_16x16x32_bf16 v[252:255], a[76:79], a[124:127], v[252:255]
ds_read_b64_tr_b16 a[28:29], v23 offset:40960
v_mfma_f32_16x16x32_bf16 v[220:223], a[76:79], a[120:123], v[220:223]
v_mfma_f32_16x16x32_bf16 v[188:191], a[76:79], a[116:119], v[188:191]
ds_read_b64_tr_b16 a[30:31], v23 offset:41472
v_mfma_f32_16x16x32_bf16 v[156:159], a[76:79], a[112:115], v[156:159]
ds_read_b64_tr_b16 a[32:33], v20 offset:49152
v_mfma_f32_16x16x32_bf16 v[64:67], a[112:115], a[80:83], v[64:67]
buffer_load_dwordx4 v9, s[12:15], s22 offen offset:1024 lds
v_mfma_f32_16x16x32_bf16 v[80:83], a[116:119], a[80:83], v[80:83]
v_mfma_f32_16x16x32_bf16 v[96:99], a[120:123], a[80:83], v[96:99]
ds_read_b64_tr_b16 a[34:35], v20 offset:49664
v_mfma_f32_16x16x32_bf16 v[112:115], a[124:127], a[80:83], v[112:115]
ds_read_b64_tr_b16 a[36:37], v21 offset:49152
v_mfma_f32_16x16x32_bf16 v[116:119], a[124:127], a[84:87], v[116:119]
v_mfma_f32_16x16x32_bf16 v[100:103], a[120:123], a[84:87], v[100:103]
s_add_u32 m0, s23, 40960
v_mfma_f32_16x16x32_bf16 v[84:87], a[116:119], a[84:87], v[84:87]
buffer_load_dwordx4 v10, s[12:15], s22 offen offset:0 lds
v_mfma_f32_16x16x32_bf16 v[68:71], a[112:115], a[84:87], v[68:71]
ds_read_b64_tr_b16 a[38:39], v21 offset:49664
s_waitcnt lgkmcnt(2)
v_mfma_f32_16x16x32_bf16 v[72:75], a[112:115], a[88:91], v[72:75]
ds_read_b64_tr_b16 a[40:41], v22 offset:49152
v_mfma_f32_16x16x32_bf16 v[88:91], a[116:119], a[88:91], v[88:91]
v_mfma_f32_16x16x32_bf16 v[104:107], a[120:123], a[88:91], v[104:107]
ds_read_b64_tr_b16 a[42:43], v22 offset:49664
v_mfma_f32_16x16x32_bf16 v[120:123], a[124:127], a[88:91], v[120:123]
ds_read_b64_tr_b16 a[44:45], v23 offset:49152
v_mfma_f32_16x16x32_bf16 v[124:127], a[124:127], a[92:95], v[124:127]
v_mfma_f32_16x16x32_bf16 v[108:111], a[120:123], a[92:95], v[108:111]
ds_read_b64_tr_b16 a[46:47], v23 offset:49664
v_mfma_f32_16x16x32_bf16 v[92:95], a[116:119], a[92:95], v[92:95]
v_mfma_f32_16x16x32_bf16 v[76:79], a[112:115], a[92:95], v[76:79]
s_waitcnt vmcnt(17)
v_mfma_f32_16x16x32_bf16 v[128:131], a[0:3], a[128:131], v[128:131]
ds_read_b64_tr_b16 a[48:49], v20 offset:36864
v_mfma_f32_16x16x32_bf16 v[160:163], a[0:3], a[132:135], v[160:163]
ds_read_b64_tr_b16 a[50:51], v20 offset:37376
v_mfma_f32_16x16x32_bf16 v[192:195], a[0:3], a[136:139], v[192:195]
buffer_load_dwordx4 a[112:115], v4, s[8:11], s21 offen offset:1024 sc1
v_mfma_f32_16x16x32_bf16 v[224:227], a[0:3], a[140:143], v[224:227]
v_mfma_f32_16x16x32_bf16 v[228:231], a[4:7], a[140:143], v[228:231]
ds_read_b64_tr_b16 a[52:53], v21 offset:36864
v_mfma_f32_16x16x32_bf16 v[196:199], a[4:7], a[136:139], v[196:199]
ds_read_b64_tr_b16 a[54:55], v21 offset:37376
v_mfma_f32_16x16x32_bf16 v[164:167], a[4:7], a[132:135], v[164:167]
v_mfma_f32_16x16x32_bf16 v[132:135], a[4:7], a[128:131], v[132:135]
ds_read_b64_tr_b16 a[56:57], v22 offset:36864
v_mfma_f32_16x16x32_bf16 v[136:139], a[8:11], a[128:131], v[136:139]
buffer_load_dwordx4 a[116:119], v5, s[8:11], s21 offen offset:1024 sc1
v_mfma_f32_16x16x32_bf16 v[168:171], a[8:11], a[132:135], v[168:171]
ds_read_b64_tr_b16 a[58:59], v22 offset:37376
v_mfma_f32_16x16x32_bf16 v[200:203], a[8:11], a[136:139], v[200:203]
v_mfma_f32_16x16x32_bf16 v[232:235], a[8:11], a[140:143], v[232:235]
ds_read_b64_tr_b16 a[60:61], v23 offset:36864
v_mfma_f32_16x16x32_bf16 v[236:239], a[12:15], a[140:143], v[236:239]
ds_read_b64_tr_b16 a[62:63], v23 offset:37376
v_mfma_f32_16x16x32_bf16 v[204:207], a[12:15], a[136:139], v[204:207]
v_mfma_f32_16x16x32_bf16 v[172:175], a[12:15], a[132:135], v[172:175]
buffer_load_dwordx4 a[120:123], v6, s[8:11], s21 offen offset:1024 sc1
v_mfma_f32_16x16x32_bf16 v[140:143], a[12:15], a[128:131], v[140:143]
ds_read_b64_tr_b16 a[64:65], v20 offset:45056
v_mfma_f32_16x16x32_bf16 v[144:147], a[16:19], a[128:131], v[144:147]
ds_read_b64_tr_b16 a[66:67], v20 offset:45568
v_mfma_f32_16x16x32_bf16 v[176:179], a[16:19], a[132:135], v[176:179]
v_mfma_f32_16x16x32_bf16 v[208:211], a[16:19], a[136:139], v[208:211]
ds_read_b64_tr_b16 a[68:69], v21 offset:45056
v_mfma_f32_16x16x32_bf16 v[240:243], a[16:19], a[140:143], v[240:243]
ds_read_b64_tr_b16 a[70:71], v21 offset:45568
v_mfma_f32_16x16x32_bf16 v[244:247], a[20:23], a[140:143], v[244:247]
buffer_load_dwordx4 a[124:127], v7, s[8:11], s21 offen offset:1024 sc1
v_mfma_f32_16x16x32_bf16 v[212:215], a[20:23], a[136:139], v[212:215]
v_mfma_f32_16x16x32_bf16 v[180:183], a[20:23], a[132:135], v[180:183]
ds_read_b64_tr_b16 a[72:73], v22 offset:45056
v_mfma_f32_16x16x32_bf16 v[148:151], a[20:23], a[128:131], v[148:151]
ds_read_b64_tr_b16 a[74:75], v22 offset:45568
v_mfma_f32_16x16x32_bf16 v[152:155], a[24:27], a[128:131], v[152:155]
v_mfma_f32_16x16x32_bf16 v[184:187], a[24:27], a[132:135], v[184:187]
ds_read_b64_tr_b16 a[76:77], v23 offset:45056
v_mfma_f32_16x16x32_bf16 v[216:219], a[24:27], a[136:139], v[216:219]
buffer_load_dwordx4 v11, s[12:15], s22 offen offset:1024 lds
v_mfma_f32_16x16x32_bf16 v[248:251], a[24:27], a[140:143], v[248:251]
ds_read_b64_tr_b16 a[78:79], v23 offset:45568
v_mfma_f32_16x16x32_bf16 v[252:255], a[28:31], a[140:143], v[252:255]
v_mfma_f32_16x16x32_bf16 v[220:223], a[28:31], a[136:139], v[220:223]
ds_read_b64_tr_b16 a[80:81], v20 offset:53248
v_mfma_f32_16x16x32_bf16 v[188:191], a[28:31], a[132:135], v[188:191]
ds_read_b64_tr_b16 a[82:83], v20 offset:53760
v_mfma_f32_16x16x32_bf16 v[156:159], a[28:31], a[128:131], v[156:159]
s_add_u32 m0, s23, 49152
v_mfma_f32_16x16x32_bf16 v[64:67], a[128:131], a[32:35], v[64:67]
buffer_load_dwordx4 v12, s[12:15], s22 offen offset:0 lds
v_mfma_f32_16x16x32_bf16 v[80:83], a[132:135], a[32:35], v[80:83]
v_mfma_f32_16x16x32_bf16 v[96:99], a[136:139], a[32:35], v[96:99]
ds_read_b64_tr_b16 a[84:85], v21 offset:53248
v_mfma_f32_16x16x32_bf16 v[112:115], a[140:143], a[32:35], v[112:115]
ds_read_b64_tr_b16 a[86:87], v21 offset:53760
s_waitcnt lgkmcnt(2)
v_mfma_f32_16x16x32_bf16 v[116:119], a[140:143], a[36:39], v[116:119]
v_mfma_f32_16x16x32_bf16 v[100:103], a[136:139], a[36:39], v[100:103]
ds_read_b64_tr_b16 a[88:89], v22 offset:53248
v_mfma_f32_16x16x32_bf16 v[84:87], a[132:135], a[36:39], v[84:87]
buffer_load_dwordx4 v13, s[12:15], s22 offen offset:1024 lds
v_mfma_f32_16x16x32_bf16 v[68:71], a[128:131], a[36:39], v[68:71]
v_readlane_b32 s21, v14, s20
v_mfma_f32_16x16x32_bf16 v[72:75], a[128:131], a[40:43], v[72:75]
ds_read_b64_tr_b16 a[90:91], v22 offset:53760
v_mfma_f32_16x16x32_bf16 v[88:91], a[132:135], a[40:43], v[88:91]
s_add_u32 s20, s20, 1
v_mfma_f32_16x16x32_bf16 v[104:107], a[136:139], a[40:43], v[104:107]
v_mfma_f32_16x16x32_bf16 v[120:123], a[140:143], a[40:43], v[120:123]
v_readlane_b32 s22, v15, s20
v_mfma_f32_16x16x32_bf16 v[124:127], a[140:143], a[44:47], v[124:127]
ds_read_b64_tr_b16 a[92:93], v23 offset:53248
v_mfma_f32_16x16x32_bf16 v[108:111], a[136:139], a[44:47], v[108:111]
ds_read_b64_tr_b16 a[94:95], v23 offset:53760
v_mfma_f32_16x16x32_bf16 v[92:95], a[132:135], a[44:47], v[92:95]
v_mfma_f32_16x16x32_bf16 v[76:79], a[128:131], a[44:47], v[76:79]
s_waitcnt vmcnt(14)
v_mfma_f32_16x16x32_bf16 v[128:131], a[48:51], a[144:147], v[128:131]
s_barrier
v_mfma_f32_16x16x32_bf16 v[160:163], a[48:51], a[148:151], v[160:163]
ds_read_b64_tr_b16 a[0:1], v16 offset:0
v_mfma_f32_16x16x32_bf16 v[192:195], a[48:51], a[152:155], v[192:195]
buffer_load_dwordx4 a[128:131], v4, s[8:11], s21 offen offset:0 sc1
v_mfma_f32_16x16x32_bf16 v[224:227], a[48:51], a[156:159], v[224:227]
ds_read_b64_tr_b16 a[2:3], v16 offset:512
v_mfma_f32_16x16x32_bf16 v[228:231], a[52:55], a[156:159], v[228:231]
v_mfma_f32_16x16x32_bf16 v[196:199], a[52:55], a[152:155], v[196:199]
ds_read_b64_tr_b16 a[4:5], v17 offset:0
v_mfma_f32_16x16x32_bf16 v[164:167], a[52:55], a[148:151], v[164:167]
ds_read_b64_tr_b16 a[6:7], v17 offset:512
v_mfma_f32_16x16x32_bf16 v[132:135], a[52:55], a[144:147], v[132:135]
v_mfma_f32_16x16x32_bf16 v[136:139], a[56:59], a[144:147], v[136:139]
buffer_load_dwordx4 a[132:135], v5, s[8:11], s21 offen offset:0 sc1
v_mfma_f32_16x16x32_bf16 v[168:171], a[56:59], a[148:151], v[168:171]
ds_read_b64_tr_b16 a[8:9], v18 offset:0
v_mfma_f32_16x16x32_bf16 v[200:203], a[56:59], a[152:155], v[200:203]
ds_read_b64_tr_b16 a[10:11], v18 offset:512
v_mfma_f32_16x16x32_bf16 v[232:235], a[56:59], a[156:159], v[232:235]
v_mfma_f32_16x16x32_bf16 v[236:239], a[60:63], a[156:159], v[236:239]
ds_read_b64_tr_b16 a[12:13], v19 offset:0
v_mfma_f32_16x16x32_bf16 v[204:207], a[60:63], a[152:155], v[204:207]
ds_read_b64_tr_b16 a[14:15], v19 offset:512
v_mfma_f32_16x16x32_bf16 v[172:175], a[60:63], a[148:151], v[172:175]
buffer_load_dwordx4 a[136:139], v6, s[8:11], s21 offen offset:0 sc1
v_mfma_f32_16x16x32_bf16 v[140:143], a[60:63], a[144:147], v[140:143]
v_mfma_f32_16x16x32_bf16 v[144:147], a[64:67], a[144:147], v[144:147]
ds_read_b64_tr_b16 a[16:17], v16 offset:8192
v_mfma_f32_16x16x32_bf16 v[176:179], a[64:67], a[148:151], v[176:179]
ds_read_b64_tr_b16 a[18:19], v16 offset:8704
v_mfma_f32_16x16x32_bf16 v[208:211], a[64:67], a[152:155], v[208:211]
v_mfma_f32_16x16x32_bf16 v[240:243], a[64:67], a[156:159], v[240:243]
ds_read_b64_tr_b16 a[20:21], v17 offset:8192
v_mfma_f32_16x16x32_bf16 v[244:247], a[68:71], a[156:159], v[244:247]
buffer_load_dwordx4 a[140:143], v7, s[8:11], s21 offen offset:0 sc1
v_mfma_f32_16x16x32_bf16 v[212:215], a[68:71], a[152:155], v[212:215]
ds_read_b64_tr_b16 a[22:23], v17 offset:8704
v_mfma_f32_16x16x32_bf16 v[180:183], a[68:71], a[148:151], v[180:183]
v_mfma_f32_16x16x32_bf16 v[148:151], a[68:71], a[144:147], v[148:151]
ds_read_b64_tr_b16 a[24:25], v18 offset:8192
v_mfma_f32_16x16x32_bf16 v[152:155], a[72:75], a[144:147], v[152:155]
v_mfma_f32_16x16x32_bf16 v[184:187], a[72:75], a[148:151], v[184:187]
s_add_u32 m0, s23, 65536
v_mfma_f32_16x16x32_bf16 v[216:219], a[72:75], a[152:155], v[216:219]
buffer_load_dwordx4 v8, s[12:15], s22 offen offset:0 lds
v_mfma_f32_16x16x32_bf16 v[248:251], a[72:75], a[156:159], v[248:251]
ds_read_b64_tr_b16 a[26:27], v18 offset:8704
v_mfma_f32_16x16x32_bf16 v[252:255], a[76:79], a[156:159], v[252:255]
ds_read_b64_tr_b16 a[28:29], v19 offset:8192
v_mfma_f32_16x16x32_bf16 v[220:223], a[76:79], a[152:155], v[220:223]
v_mfma_f32_16x16x32_bf16 v[188:191], a[76:79], a[148:151], v[188:191]
ds_read_b64_tr_b16 a[30:31], v19 offset:8704
v_mfma_f32_16x16x32_bf16 v[156:159], a[76:79], a[144:147], v[156:159]
ds_read_b64_tr_b16 a[32:33], v16 offset:16384
v_mfma_f32_16x16x32_bf16 v[64:67], a[144:147], a[80:83], v[64:67]
buffer_load_dwordx4 v9, s[12:15], s22 offen offset:1024 lds
v_mfma_f32_16x16x32_bf16 v[80:83], a[148:151], a[80:83], v[80:83]
v_mfma_f32_16x16x32_bf16 v[96:99], a[152:155], a[80:83], v[96:99]
ds_read_b64_tr_b16 a[34:35], v16 offset:16896
v_mfma_f32_16x16x32_bf16 v[112:115], a[156:159], a[80:83], v[112:115]
ds_read_b64_tr_b16 a[36:37], v17 offset:16384
s_waitcnt lgkmcnt(3)
v_mfma_f32_16x16x32_bf16 v[116:119], a[156:159], a[84:87], v[116:119]
v_mfma_f32_16x16x32_bf16 v[100:103], a[152:155], a[84:87], v[100:103]
s_add_u32 m0, s23, 73728
v_mfma_f32_16x16x32_bf16 v[84:87], a[148:151], a[84:87], v[84:87]
buffer_load_dwordx4 v10, s[12:15], s22 offen offset:0 lds
v_mfma_f32_16x16x32_bf16 v[68:71], a[144:147], a[84:87], v[68:71]
ds_read_b64_tr_b16 a[38:39], v17 offset:16896
v_mfma_f32_16x16x32_bf16 v[72:75], a[144:147], a[88:91], v[72:75]
ds_read_b64_tr_b16 a[40:41], v18 offset:16384
v_mfma_f32_16x16x32_bf16 v[88:91], a[148:151], a[88:91], v[88:91]
v_mfma_f32_16x16x32_bf16 v[104:107], a[152:155], a[88:91], v[104:107]
ds_read_b64_tr_b16 a[42:43], v18 offset:16896
v_mfma_f32_16x16x32_bf16 v[120:123], a[156:159], a[88:91], v[120:123]
ds_read_b64_tr_b16 a[44:45], v19 offset:16384
v_mfma_f32_16x16x32_bf16 v[124:127], a[156:159], a[92:95], v[124:127]
v_mfma_f32_16x16x32_bf16 v[108:111], a[152:155], a[92:95], v[108:111]
ds_read_b64_tr_b16 a[46:47], v19 offset:16896
v_mfma_f32_16x16x32_bf16 v[92:95], a[148:151], a[92:95], v[92:95]
s_sub_u32 s30, s30, 1
v_mfma_f32_16x16x32_bf16 v[76:79], a[144:147], a[92:95], v[76:79]
s_waitcnt vmcnt(17)
s_cbranch_scc0 Lq_loop1
s_waitcnt lgkmcnt(2)
v_mfma_f32_16x16x32_bf16 v[128:131], a[0:3], a[96:99], v[128:131]
ds_read_b64_tr_b16 a[48:49], v16 offset:4096
v_mfma_f32_16x16x32_bf16 v[160:163], a[0:3], a[100:103], v[160:163]
ds_read_b64_tr_b16 a[50:51], v16 offset:4608
v_mfma_f32_16x16x32_bf16 v[192:195], a[0:3], a[104:107], v[192:195]
buffer_load_dwordx4 a[144:147], v4, s[8:11], s21 offen offset:1024 sc1
v_mfma_f32_16x16x32_bf16 v[224:227], a[0:3], a[108:111], v[224:227]
ds_read_b64_tr_b16 a[52:53], v17 offset:4096
v_mfma_f32_16x16x32_bf16 v[228:231], a[4:7], a[108:111], v[228:231]
v_mfma_f32_16x16x32_bf16 v[196:199], a[4:7], a[104:107], v[196:199]
ds_read_b64_tr_b16 a[54:55], v17 offset:4608
v_mfma_f32_16x16x32_bf16 v[164:167], a[4:7], a[100:103], v[164:167]
ds_read_b64_tr_b16 a[56:57], v18 offset:4096
v_mfma_f32_16x16x32_bf16 v[132:135], a[4:7], a[96:99], v[132:135]
buffer_load_dwordx4 a[148:151], v5, s[8:11], s21 offen offset:1024 sc1
v_mfma_f32_16x16x32_bf16 v[136:139], a[8:11], a[96:99], v[136:139]
v_mfma_f32_16x16x32_bf16 v[168:171], a[8:11], a[100:103], v[168:171]
ds_read_b64_tr_b16 a[58:59], v18 offset:4608
v_mfma_f32_16x16x32_bf16 v[200:203], a[8:11], a[104:107], v[200:203]
ds_read_b64_tr_b16 a[60:61], v19 offset:4096
v_mfma_f32_16x16x32_bf16 v[232:235], a[8:11], a[108:111], v[232:235]
v_mfma_f32_16x16x32_bf16 v[236:239], a[12:15], a[108:111], v[236:239]
buffer_load_dwordx4 a[152:155], v6, s[8:11], s21 offen offset:1024 sc1
v_mfma_f32_16x16x32_bf16 v[204:207], a[12:15], a[104:107], v[204:207]
ds_read_b64_tr_b16 a[62:63], v19 offset:4608
v_mfma_f32_16x16x32_bf16 v[172:175], a[12:15], a[100:103], v[172:175]
ds_read_b64_tr_b16 a[64:65], v16 offset:12288
v_mfma_f32_16x16x32_bf16 v[140:143], a[12:15], a[96:99], v[140:143]
v_mfma_f32_16x16x32_bf16 v[144:147], a[16:19], a[96:99], v[144:147]
ds_read_b64_tr_b16 a[66:67], v16 offset:12800
v_mfma_f32_16x16x32_bf16 v[176:179], a[16:19], a[100:103], v[176:179]
buffer_load_dwordx4 a[156:159], v7, s[8:11], s21 offen offset:1024 sc1
v_mfma_f32_16x16x32_bf16 v[208:211], a[16:19], a[104:107], v[208:211]
ds_read_b64_tr_b16 a[68:69], v17 offset:12288
v_mfma_f32_16x16x32_bf16 v[240:243], a[16:19], a[108:111], v[240:243]
v_mfma_f32_16x16x32_bf16 v[244:247], a[20:23], a[108:111], v[244:247]
ds_read_b64_tr_b16 a[70:71], v17 offset:12800
v_mfma_f32_16x16x32_bf16 v[212:215], a[20:23], a[104:107], v[212:215]
ds_read_b64_tr_b16 a[72:73], v18 offset:12288
v_mfma_f32_16x16x32_bf16 v[180:183], a[20:23], a[100:103], v[180:183]
buffer_load_dwordx4 v11, s[12:15], s22 offen offset:1024 lds
v_mfma_f32_16x16x32_bf16 v[148:151], a[20:23], a[96:99], v[148:151]
ds_read_b64_tr_b16 a[74:75], v18 offset:12800
v_mfma_f32_16x16x32_bf16 v[152:155], a[24:27], a[96:99], v[152:155]
v_mfma_f32_16x16x32_bf16 v[184:187], a[24:27], a[100:103], v[184:187]
ds_read_b64_tr_b16 a[76:77], v19 offset:12288
v_mfma_f32_16x16x32_bf16 v[216:219], a[24:27], a[104:107], v[216:219]
s_add_u32 m0, s23, 81920
v_mfma_f32_16x16x32_bf16 v[248:251], a[24:27], a[108:111], v[248:251]
buffer_load_dwordx4 v12, s[12:15], s22 offen offset:0 lds
v_mfma_f32_16x16x32_bf16 v[252:255], a[28:31], a[108:111], v[252:255]
ds_read_b64_tr_b16 a[78:79], v19 offset:12800
v_mfma_f32_16x16x32_bf16 v[220:223], a[28:31], a[104:107], v[220:223]
v_mfma_f32_16x16x32_bf16 v[188:191], a[28:31], a[100:103], v[188:191]
ds_read_b64_tr_b16 a[80:81], v16 offset:20480
v_mfma_f32_16x16x32_bf16 v[156:159], a[28:31], a[96:99], v[156:159]
ds_read_b64_tr_b16 a[82:83], v16 offset:20992
v_mfma_f32_16x16x32_bf16 v[64:67], a[96:99], a[32:35], v[64:67]
buffer_load_dwordx4 v13, s[12:15], s22 offen offset:1024 lds
v_mfma_f32_16x16x32_bf16 v[80:83], a[100:103], a[32:35], v[80:83]
v_mfma_f32_16x16x32_bf16 v[96:99], a[104:107], a[32:35], v[96:99]
ds_read_b64_tr_b16 a[84:85], v17 offset:20480
v_mfma_f32_16x16x32_bf16 v[112:115], a[108:111], a[32:35], v[112:115]
ds_read_b64_tr_b16 a[86:87], v17 offset:20992
v_mfma_f32_16x16x32_bf16 v[116:119], a[108:111], a[36:39], v[116:119]
v_mfma_f32_16x16x32_bf16 v[100:103], a[104:107], a[36:39], v[100:103]
buffer_load_dword v28, v29, s[40:43], 0 offen sc1
v_mfma_f32_16x16x32_bf16 v[84:87], a[100:103], a[36:39], v[84:87]
v_readlane_b32 s21, v14, s20
v_mfma_f32_16x16x32_bf16 v[68:71], a[96:99], a[36:39], v[68:71]
ds_read_b64_tr_b16 a[88:89], v18 offset:20480
v_mfma_f32_16x16x32_bf16 v[72:75], a[96:99], a[40:43], v[72:75]
s_add_u32 s20, s20, 1
v_mfma_f32_16x16x32_bf16 v[88:91], a[100:103], a[40:43], v[88:91]
ds_read_b64_tr_b16 a[90:91], v18 offset:20992
v_mfma_f32_16x16x32_bf16 v[104:107], a[104:107], a[40:43], v[104:107]
v_readlane_b32 s22, v15, s20
v_mfma_f32_16x16x32_bf16 v[120:123], a[108:111], a[40:43], v[120:123]
s_waitcnt lgkmcnt(2)
v_mfma_f32_16x16x32_bf16 v[124:127], a[108:111], a[44:47], v[124:127]
ds_read_b64_tr_b16 a[92:93], v19 offset:20480
v_mfma_f32_16x16x32_bf16 v[108:111], a[104:107], a[44:47], v[108:111]
ds_read_b64_tr_b16 a[94:95], v19 offset:20992
v_mfma_f32_16x16x32_bf16 v[92:95], a[100:103], a[44:47], v[92:95]
v_mfma_f32_16x16x32_bf16 v[76:79], a[96:99], a[44:47], v[76:79]
s_waitcnt vmcnt(15)
v_mfma_f32_16x16x32_bf16 v[128:131], a[48:51], a[112:115], v[128:131]
s_barrier
v_mfma_f32_16x16x32_bf16 v[160:163], a[48:51], a[116:119], v[160:163]
ds_read_b64_tr_b16 a[0:1], v16 offset:32768
v_mfma_f32_16x16x32_bf16 v[192:195], a[48:51], a[120:123], v[192:195]
buffer_load_dwordx4 a[96:99], v4, s[8:11], s21 offen offset:0 sc1
v_mfma_f32_16x16x32_bf16 v[224:227], a[48:51], a[124:127], v[224:227]
ds_read_b64_tr_b16 a[2:3], v16 offset:33280
v_mfma_f32_16x16x32_bf16 v[228:231], a[52:55], a[124:127], v[228:231]
v_mfma_f32_16x16x32_bf16 v[196:199], a[52:55], a[120:123], v[196:199]
ds_read_b64_tr_b16 a[4:5], v17 offset:32768
v_mfma_f32_16x16x32_bf16 v[164:167], a[52:55], a[116:119], v[164:167]
ds_read_b64_tr_b16 a[6:7], v17 offset:33280
v_mfma_f32_16x16x32_bf16 v[132:135], a[52:55], a[112:115], v[132:135]
v_mfma_f32_16x16x32_bf16 v[136:139], a[56:59], a[112:115], v[136:139]
buffer_load_dwordx4 a[100:103], v5, s[8:11], s21 offen offset:0 sc1
v_mfma_f32_16x16x32_bf16 v[168:171], a[56:59], a[116:119], v[168:171]
ds_read_b64_tr_b16 a[8:9], v18 offset:32768
v_mfma_f32_16x16x32_bf16 v[200:203], a[56:59], a[120:123], v[200:203]
ds_read_b64_tr_b16 a[10:11], v18 offset:33280
v_mfma_f32_16x16x32_bf16 v[232:235], a[56:59], a[124:127], v[232:235]
v_mfma_f32_16x16x32_bf16 v[236:239], a[60:63], a[124:127], v[236:239]
ds_read_b64_tr_b16 a[12:13], v19 offset:32768
v_mfma_f32_16x16x32_bf16 v[204:207], a[60:63], a[120:123], v[204:207]
ds_read_b64_tr_b16 a[14:15], v19 offset:33280
v_mfma_f32_16x16x32_bf16 v[172:175], a[60:63], a[116:119], v[172:175]
buffer_load_dwordx4 a[104:107], v6, s[8:11], s21 offen offset:0 sc1
v_mfma_f32_16x16x32_bf16 v[140:143], a[60:63], a[112:115], v[140:143]
v_mfma_f32_16x16x32_bf16 v[144:147], a[64:67], a[112:115], v[144:147]
ds_read_b64_tr_b16 a[16:17], v16 offset:40960
v_mfma_f32_16x16x32_bf16 v[176:179], a[64:67], a[116:119], v[176:179]
ds_read_b64_tr_b16 a[18:19], v16 offset:41472
v_mfma_f32_16x16x32_bf16 v[208:211], a[64:67], a[120:123], v[208:211]
v_mfma_f32_16x16x32_bf16 v[240:243], a[64:67], a[124:127], v[240:243]
ds_read_b64_tr_b16 a[20:21], v17 offset:40960
v_mfma_f32_16x16x32_bf16 v[244:247], a[68:71], a[124:127], v[244:247]
buffer_load_dwordx4 a[108:111], v7, s[8:11], s21 offen offset:0 sc1
v_mfma_f32_16x16x32_bf16 v[212:215], a[68:71], a[120:123], v[212:215]
ds_read_b64_tr_b16 a[22:23], v17 offset:41472
v_mfma_f32_16x16x32_bf16 v[180:183], a[68:71], a[116:119], v[180:183]
v_mfma_f32_16x16x32_bf16 v[148:151], a[68:71], a[112:115], v[148:151]
ds_read_b64_tr_b16 a[24:25], v18 offset:40960
v_mfma_f32_16x16x32_bf16 v[152:155], a[72:75], a[112:115], v[152:155]
v_mfma_f32_16x16x32_bf16 v[184:187], a[72:75], a[116:119], v[184:187]
s_add_u32 m0, s23, 98304
v_mfma_f32_16x16x32_bf16 v[216:219], a[72:75], a[120:123], v[216:219]
buffer_load_dwordx4 v8, s[12:15], s22 offen offset:0 lds
v_mfma_f32_16x16x32_bf16 v[248:251], a[72:75], a[124:127], v[248:251]
ds_read_b64_tr_b16 a[26:27], v18 offset:41472
v_mfma_f32_16x16x32_bf16 v[252:255], a[76:79], a[124:127], v[252:255]
ds_read_b64_tr_b16 a[28:29], v19 offset:40960
v_mfma_f32_16x16x32_bf16 v[220:223], a[76:79], a[120:123], v[220:223]
v_mfma_f32_16x16x32_bf16 v[188:191], a[76:79], a[116:119], v[188:191]
ds_read_b64_tr_b16 a[30:31], v19 offset:41472
v_mfma_f32_16x16x32_bf16 v[156:159], a[76:79], a[112:115], v[156:159]
ds_read_b64_tr_b16 a[32:33], v16 offset:49152
v_mfma_f32_16x16x32_bf16 v[64:67], a[112:115], a[80:83], v[64:67]
buffer_load_dwordx4 v9, s[12:15], s22 offen offset:1024 lds
v_mfma_f32_16x16x32_bf16 v[80:83], a[116:119], a[80:83], v[80:83]
v_mfma_f32_16x16x32_bf16 v[96:99], a[120:123], a[80:83], v[96:99]
ds_read_b64_tr_b16 a[34:35], v16 offset:49664
v_mfma_f32_16x16x32_bf16 v[112:115], a[124:127], a[80:83], v[112:115]
ds_read_b64_tr_b16 a[36:37], v17 offset:49152
v_mfma_f32_16x16x32_bf16 v[116:119], a[124:127], a[84:87], v[116:119]
v_mfma_f32_16x16x32_bf16 v[100:103], a[120:123], a[84:87], v[100:103]
s_add_u32 m0, s23, 106496
v_mfma_f32_16x16x32_bf16 v[84:87], a[116:119], a[84:87], v[84:87]
buffer_load_dwordx4 v10, s[12:15], s22 offen offset:0 lds
v_mfma_f32_16x16x32_bf16 v[68:71], a[112:115], a[84:87], v[68:71]
ds_read_b64_tr_b16 a[38:39], v17 offset:49664
s_waitcnt lgkmcnt(2)
v_mfma_f32_16x16x32_bf16 v[72:75], a[112:115], a[88:91], v[72:75]
ds_read_b64_tr_b16 a[40:41], v18 offset:49152
v_mfma_f32_16x16x32_bf16 v[88:91], a[116:119], a[88:91], v[88:91]
v_mfma_f32_16x16x32_bf16 v[104:107], a[120:123], a[88:91], v[104:107]
ds_read_b64_tr_b16 a[42:43], v18 offset:49664
v_mfma_f32_16x16x32_bf16 v[120:123], a[124:127], a[88:91], v[120:123]
ds_read_b64_tr_b16 a[44:45], v19 offset:49152
v_mfma_f32_16x16x32_bf16 v[124:127], a[124:127], a[92:95], v[124:127]
v_mfma_f32_16x16x32_bf16 v[108:111], a[120:123], a[92:95], v[108:111]
ds_read_b64_tr_b16 a[46:47], v19 offset:49664
v_mfma_f32_16x16x32_bf16 v[92:95], a[116:119], a[92:95], v[92:95]
v_mfma_f32_16x16x32_bf16 v[76:79], a[112:115], a[92:95], v[76:79]
s_waitcnt vmcnt(18)
v_mfma_f32_16x16x32_bf16 v[128:131], a[0:3], a[128:131], v[128:131]
ds_read_b64_tr_b16 a[48:49], v16 offset:36864
v_mfma_f32_16x16x32_bf16 v[160:163], a[0:3], a[132:135], v[160:163]
ds_read_b64_tr_b16 a[50:51], v16 offset:37376
s_mov_b32 s31, 16
v_mfma_f32_16x16x32_bf16 v[192:195], a[0:3], a[136:139], v[192:195]
buffer_load_dwordx4 a[112:115], v4, s[8:11], s21 offen offset:1024 sc1
v_readlane_b32 s28, v14, s31
v_mfma_f32_16x16x32_bf16 v[224:227], a[0:3], a[140:143], v[224:227]
ds_read_b64_tr_b16 a[52:53], v17 offset:36864
v_mfma_f32_16x16x32_bf16 v[228:231], a[4:7], a[140:143], v[228:231]
v_mfma_f32_16x16x32_bf16 v[196:199], a[4:7], a[136:139], v[196:199]
ds_read_b64_tr_b16 a[54:55], v17 offset:37376
v_mfma_f32_16x16x32_bf16 v[164:167], a[4:7], a[132:135], v[164:167]
ds_read_b64_tr_b16 a[56:57], v18 offset:36864
v_mfma_f32_16x16x32_bf16 v[132:135], a[4:7], a[128:131], v[132:135]
v_mfma_f32_16x16x32_bf16 v[136:139], a[8:11], a[128:131], v[136:139]
buffer_load_dwordx4 a[116:119], v5, s[8:11], s21 offen offset:1024 sc1
v_mfma_f32_16x16x32_bf16 v[168:171], a[8:11], a[132:135], v[168:171]
ds_read_b64_tr_b16 a[58:59], v18 offset:37376
v_mfma_f32_16x16x32_bf16 v[200:203], a[8:11], a[136:139], v[200:203]
ds_read_b64_tr_b16 a[60:61], v19 offset:36864
s_waitcnt vmcnt(9)
v_cmp_ne_u32 vcc, s78, v28
v_mfma_f32_16x16x32_bf16 v[232:235], a[8:11], a[140:143], v[232:235]
v_mfma_f32_16x16x32_bf16 v[236:239], a[12:15], a[140:143], v[236:239]
ds_read_b64_tr_b16 a[62:63], v19 offset:37376
v_mfma_f32_16x16x32_bf16 v[204:207], a[12:15], a[136:139], v[204:207]
ds_read_b64_tr_b16 a[64:65], v16 offset:45056
s_cbranch_vccz Lok_6
s_mov_b32 s79, 32768
Lspin_5:
buffer_load_dword v28, v29, s[40:43], 0 offen sc1
s_waitcnt vmcnt(0)
v_cmp_ne_u32 vcc, s78, v28
s_sub_u32 s79, s79, 1
s_cbranch_scc1 Lok_6
s_cbranch_vccnz Lspin_5
Lok_6:
v_mfma_f32_16x16x32_bf16 v[172:175], a[12:15], a[132:135], v[172:175]
buffer_load_dwordx4 a[120:123], v6, s[8:11], s21 offen offset:1024 sc1
v_mfma_f32_16x16x32_bf16 v[140:143], a[12:15], a[128:131], v[140:143]
v_mfma_f32_16x16x32_bf16 v[144:147], a[16:19], a[128:131], v[144:147]
ds_read_b64_tr_b16 a[66:67], v16 offset:45568
v_mfma_f32_16x16x32_bf16 v[176:179], a[16:19], a[132:135], v[176:179]
ds_read_b64_tr_b16 a[68:69], v17 offset:45056
v_mfma_f32_16x16x32_bf16 v[208:211], a[16:19], a[136:139], v[208:211]
v_mfma_f32_16x16x32_bf16 v[240:243], a[16:19], a[140:143], v[240:243]
ds_read_b64_tr_b16 a[70:71], v17 offset:45568
v_mfma_f32_16x16x32_bf16 v[244:247], a[20:23], a[140:143], v[244:247]
buffer_load_dwordx4 a[124:127], v7, s[8:11], s21 offen offset:1024 sc1
v_mfma_f32_16x16x32_bf16 v[212:215], a[20:23], a[136:139], v[212:215]
ds_read_b64_tr_b16 a[72:73], v18 offset:45056
v_mfma_f32_16x16x32_bf16 v[180:183], a[20:23], a[132:135], v[180:183]
ds_read_b64_tr_b16 a[74:75], v18 offset:45568
v_mfma_f32_16x16x32_bf16 v[148:151], a[20:23], a[128:131], v[148:151]
v_mfma_f32_16x16x32_bf16 v[152:155], a[24:27], a[128:131], v[152:155]
ds_read_b64_tr_b16 a[76:77], v19 offset:45056
v_mfma_f32_16x16x32_bf16 v[184:187], a[24:27], a[132:135], v[184:187]
ds_read_b64_tr_b16 a[78:79], v19 offset:45568
v_mfma_f32_16x16x32_bf16 v[216:219], a[24:27], a[136:139], v[216:219]
buffer_load_dwordx4 v11, s[12:15], s22 offen offset:1024 lds
v_mfma_f32_16x16x32_bf16 v[248:251], a[24:27], a[140:143], v[248:251]
v_mfma_f32_16x16x32_bf16 v[252:255], a[28:31], a[140:143], v[252:255]
ds_read_b64_tr_b16 a[80:81], v16 offset:53248
v_mfma_f32_16x16x32_bf16 v[220:223], a[28:31], a[136:139], v[220:223]
ds_read_b64_tr_b16 a[82:83], v16 offset:53760
v_mfma_f32_16x16x32_bf16 v[188:191], a[28:31], a[132:135], v[188:191]
v_mfma_f32_16x16x32_bf16 v[156:159], a[28:31], a[128:131], v[156:159]
s_add_u32 m0, s23, 114688
v_mfma_f32_16x16x32_bf16 v[64:67], a[128:131], a[32:35], v[64:67]
buffer_load_dwordx4 v12, s[12:15], s22 offen offset:0 lds
v_mfma_f32_16x16x32_bf16 v[80:83], a[132:135], a[32:35], v[80:83]
ds_read_b64_tr_b16 a[84:85], v17 offset:53248
v_mfma_f32_16x16x32_bf16 v[96:99], a[136:139], a[32:35], v[96:99]
ds_read_b64_tr_b16 a[86:87], v17 offset:53760
v_mfma_f32_16x16x32_bf16 v[112:115], a[140:143], a[32:35], v[112:115]
s_waitcnt lgkmcnt(2)
v_mfma_f32_16x16x32_bf16 v[116:119], a[140:143], a[36:39], v[116:119]
ds_read_b64_tr_b16 a[88:89], v18 offset:53248
v_mfma_f32_16x16x32_bf16 v[100:103], a[136:139], a[36:39], v[100:103]
ds_read_b64_tr_b16 a[90:91], v18 offset:53760
v_mfma_f32_16x16x32_bf16 v[84:87], a[132:135], a[36:39], v[84:87]
buffer_load_dwordx4 v13, s[12:15], s22 offen offset:1024 lds
v_mfma_f32_16x16x32_bf16 v[68:71], a[128:131], a[36:39], v[68:71]
v_readlane_b32 s21, v14, s20
v_mfma_f32_16x16x32_bf16 v[72:75], a[128:131], a[40:43], v[72:75]
v_mfma_f32_16x16x32_bf16 v[88:91], a[132:135], a[40:43], v[88:91]
v_accvgpr_read_b32 v8, a208
v_accvgpr_read_b32 v9, a209
v_mfma_f32_16x16x32_bf16 v[104:107], a[136:139], a[40:43], v[104:107]
ds_read_b64_tr_b16 a[92:93], v19 offset:53248
v_mfma_f32_16x16x32_bf16 v[120:123], a[140:143], a[40:43], v[120:123]
v_accvgpr_read_b32 v10, a210
v_accvgpr_read_b32 v11, a211
v_mfma_f32_16x16x32_bf16 v[124:127], a[140:143], a[44:47], v[124:127]
ds_read_b64_tr_b16 a[94:95], v19 offset:53760
v_mfma_f32_16x16x32_bf16 v[108:111], a[136:139], a[44:47], v[108:111]
v_accvgpr_read_b32 v12, a212
v_accvgpr_read_b32 v13, a213
v_mfma_f32_16x16x32_bf16 v[92:95], a[132:135], a[44:47], v[92:95]
v_mfma_f32_16x16x32_bf16 v[76:79], a[128:131], a[44:47], v[76:79]
v_mfma_f32_16x16x32_bf16 v[128:131], a[48:51], a[144:147], v[128:131]
s_barrier
v_mfma_f32_16x16x32_bf16 v[160:163], a[48:51], a[148:151], v[160:163]
ds_read_b64_tr_b16 a[0:1], v20 offset:0
v_mfma_f32_16x16x32_bf16 v[192:195], a[48:51], a[152:155], v[192:195]
buffer_load_dwordx4 a[128:131], v4, s[8:11], s21 offen offset:0 sc1
v_mfma_f32_16x16x32_bf16 v[224:227], a[48:51], a[156:159], v[224:227]
ds_read_b64_tr_b16 a[2:3], v20 offset:512
v_mfma_f32_16x16x32_bf16 v[228:231], a[52:55], a[156:159], v[228:231]
ds_read_b64_tr_b16 a[4:5], v21 offset:0
v_mfma_f32_16x16x32_bf16 v[196:199], a[52:55], a[152:155], v[196:199]
buffer_load_dwordx4 a[132:135], v5, s[8:11], s21 offen offset:0 sc1
v_mfma_f32_16x16x32_bf16 v[164:167], a[52:55], a[148:151], v[164:167]
v_mfma_f32_16x16x32_bf16 v[132:135], a[52:55], a[144:147], v[132:135]
ds_read_b64_tr_b16 a[6:7], v21 offset:512
v_mfma_f32_16x16x32_bf16 v[136:139], a[56:59], a[144:147], v[136:139]
buffer_load_dwordx4 a[136:139], v6, s[8:11], s21 offen offset:0 sc1
v_mfma_f32_16x16x32_bf16 v[168:171], a[56:59], a[148:151], v[168:171]
ds_read_b64_tr_b16 a[8:9], v22 offset:0
v_mfma_f32_16x16x32_bf16 v[200:203], a[56:59], a[152:155], v[200:203]
ds_read_b64_tr_b16 a[10:11], v22 offset:512
v_mfma_f32_16x16x32_bf16 v[232:235], a[56:59], a[156:159], v[232:235]
buffer_load_dwordx4 a[140:143], v7, s[8:11], s21 offen offset:0 sc1
v_mfma_f32_16x16x32_bf16 v[236:239], a[60:63], a[156:159], v[236:239]
v_mfma_f32_16x16x32_bf16 v[204:207], a[60:63], a[152:155], v[204:207]
s_add_u32 m0, s24, 0
v_mfma_f32_16x16x32_bf16 v[172:175], a[60:63], a[148:151], v[172:175]
buffer_load_dwordx4 v8, s[8:11], s28 offen offset:0 sc1 lds
v_mfma_f32_16x16x32_bf16 v[140:143], a[60:63], a[144:147], v[140:143]
ds_read_b64_tr_b16 a[12:13], v23 offset:0
v_mfma_f32_16x16x32_bf16 v[144:147], a[64:67], a[144:147], v[144:147]
ds_read_b64_tr_b16 a[14:15], v23 offset:512
v_mfma_f32_16x16x32_bf16 v[176:179], a[64:67], a[148:151], v[176:179]
buffer_load_dwordx4 v8, s[8:11], s28 offen offset:1024 sc1 lds
v_mfma_f32_16x16x32_bf16 v[208:211], a[64:67], a[152:155], v[208:211]
ds_read_b64_tr_b16 a[16:17], v20 offset:8192
v_mfma_f32_16x16x32_bf16 v[240:243], a[64:67], a[156:159], v[240:243]
v_mfma_f32_16x16x32_bf16 v[244:247], a[68:71], a[156:159], v[244:247]
buffer_load_dwordx4 v9, s[8:11], s28 offen offset:2048 sc1 lds
v_mfma_f32_16x16x32_bf16 v[212:215], a[68:71], a[152:155], v[212:215]
ds_read_b64_tr_b16 a[18:19], v20 offset:8704
v_mfma_f32_16x16x32_bf16 v[180:183], a[68:71], a[148:151], v[180:183]
ds_read_b64_tr_b16 a[20:21], v21 offset:8192
v_mfma_f32_16x16x32_bf16 v[148:151], a[68:71], a[144:147], v[148:151]
buffer_load_dwordx4 v9, s[8:11], s28 offen offset:3072 sc1 lds
v_mfma_f32_16x16x32_bf16 v[152:155], a[72:75], a[144:147], v[152:155]
ds_read_b64_tr_b16 a[22:23], v21 offset:8704
s_mul_i32 s29, s28, 224
v_mfma_f32_16x16x32_bf16 v[184:187], a[72:75], a[148:151], v[184:187]
s_add_u32 m0, s24, 147456
v_mfma_f32_16x16x32_bf16 v[216:219], a[72:75], a[152:155], v[216:219]
buffer_load_dwordx4 v33, s[48:51], 0 offen offset:0 lds
v_mfma_f32_16x16x32_bf16 v[248:251], a[72:75], a[156:159], v[248:251]
v_mfma_f32_16x16x32_bf16 v[252:255], a[76:79], a[156:159], v[252:255]
ds_read_b64_tr_b16 a[24:25], v22 offset:8192
v_mfma_f32_16x16x32_bf16 v[220:223], a[76:79], a[152:155], v[220:223]
buffer_load_dwordx4 v34, s[48:51], 0 offen offset:1024 lds
v_mfma_f32_16x16x32_bf16 v[188:191], a[76:79], a[148:151], v[188:191]
ds_read_b64_tr_b16 a[26:27], v22 offset:8704
v_mfma_f32_16x16x32_bf16 v[156:159], a[76:79], a[144:147], v[156:159]
ds_read_b64_tr_b16 a[28:29], v23 offset:8192
v_mfma_f32_16x16x32_bf16 v[64:67], a[144:147], a[80:83], v[64:67]
buffer_load_dwordx4 v35, s[48:51], 0 offen offset:2048 lds
v_mfma_f32_16x16x32_bf16 v[80:83], a[148:151], a[80:83], v[80:83]
v_mfma_f32_16x16x32_bf16 v[96:99], a[152:155], a[80:83], v[96:99]
ds_read_b64_tr_b16 a[30:31], v23 offset:8704
v_mfma_f32_16x16x32_bf16 v[112:115], a[156:159], a[80:83], v[112:115]
buffer_load_dwordx4 v36, s[48:51], 0 offen offset:3072 lds
s_waitcnt lgkmcnt(2)
v_mfma_f32_16x16x32_bf16 v[116:119], a[156:159], a[84:87], v[116:119]
ds_read_b64_tr_b16 a[32:33], v20 offset:16384
v_mfma_f32_16x16x32_bf16 v[100:103], a[152:155], a[84:87], v[100:103]
ds_read_b64_tr_b16 a[34:35], v20 offset:16896
v_mfma_f32_16x16x32_bf16 v[84:87], a[148:151], a[84:87], v[84:87]
v_mfma_f32_16x16x32_bf16 v[68:71], a[144:147], a[84:87], v[68:71]
ds_read_b64_tr_b16 a[36:37], v21 offset:16384
v_mfma_f32_16x16x32_bf16 v[72:75], a[144:147], a[88:91], v[72:75]
ds_read_b64_tr_b16 a[38:39], v21 offset:16896
v_mfma_f32_16x16x32_bf16 v[88:91], a[148:151], a[88:91], v[88:91]
ds_read_b64_tr_b16 a[40:41], v22 offset:16384
v_mfma_f32_16x16x32_bf16 v[104:107], a[152:155], a[88:91], v[104:107]
v_mfma_f32_16x16x32_bf16 v[120:123], a[156:159], a[88:91], v[120:123]
ds_read_b64_tr_b16 a[42:43], v22 offset:16896
v_mfma_f32_16x16x32_bf16 v[124:127], a[156:159], a[92:95], v[124:127]
ds_read_b64_tr_b16 a[44:45], v23 offset:16384
v_mfma_f32_16x16x32_bf16 v[108:111], a[152:155], a[92:95], v[108:111]
ds_read_b64_tr_b16 a[46:47], v23 offset:16896
v_mfma_f32_16x16x32_bf16 v[92:95], a[148:151], a[92:95], v[92:95]
v_mfma_f32_16x16x32_bf16 v[76:79], a[144:147], a[92:95], v[76:79]
s_waitcnt vmcnt(22)
v_mfma_f32_16x16x32_bf16 v[128:131], a[0:3], a[96:99], v[128:131]
ds_read_b64_tr_b16 a[48:49], v20 offset:4096
v_mfma_f32_16x16x32_bf16 v[160:163], a[0:3], a[100:103], v[160:163]
ds_read_b64_tr_b16 a[50:51], v20 offset:4608
s_add_u32 s31, s31, 1
v_mfma_f32_16x16x32_bf16 v[192:195], a[0:3], a[104:107], v[192:195]
buffer_load_dwordx4 a[144:147], v4, s[8:11], s21 offen offset:1024 sc1
v_readlane_b32 s28, v14, s31
v_mfma_f32_16x16x32_bf16 v[224:227], a[0:3], a[108:111], v[224:227]
ds_read_b64_tr_b16 a[52:53], v21 offset:4096
v_mfma_f32_16x16x32_bf16 v[228:231], a[4:7], a[108:111], v[228:231]
v_mfma_f32_16x16x32_bf16 v[196:199], a[4:7], a[104:107], v[196:199]
ds_read_b64_tr_b16 a[54:55], v21 offset:4608
v_mfma_f32_16x16x32_bf16 v[164:167], a[4:7], a[100:103], v[164:167]
ds_read_b64_tr_b16 a[56:57], v22 offset:4096
v_mfma_f32_16x16x32_bf16 v[132:135], a[4:7], a[96:99], v[132:135]
buffer_load_dwordx4 a[148:151], v5, s[8:11], s21 offen offset:1024 sc1
v_mfma_f32_16x16x32_bf16 v[136:139], a[8:11], a[96:99], v[136:139]
v_mfma_f32_16x16x32_bf16 v[168:171], a[8:11], a[100:103], v[168:171]
ds_read_b64_tr_b16 a[58:59], v22 offset:4608
v_mfma_f32_16x16x32_bf16 v[200:203], a[8:11], a[104:107], v[200:203]
ds_read_b64_tr_b16 a[60:61], v23 offset:4096
v_mfma_f32_16x16x32_bf16 v[232:235], a[8:11], a[108:111], v[232:235]
v_mfma_f32_16x16x32_bf16 v[236:239], a[12:15], a[108:111], v[236:239]
buffer_load_dwordx4 a[152:155], v6, s[8:11], s21 offen offset:1024 sc1
v_mfma_f32_16x16x32_bf16 v[204:207], a[12:15], a[104:107], v[204:207]
ds_read_b64_tr_b16 a[62:63], v23 offset:4608
v_mfma_f32_16x16x32_bf16 v[172:175], a[12:15], a[100:103], v[172:175]
ds_read_b64_tr_b16 a[64:65], v20 offset:12288
v_mfma_f32_16x16x32_bf16 v[140:143], a[12:15], a[96:99], v[140:143]
v_mfma_f32_16x16x32_bf16 v[144:147], a[16:19], a[96:99], v[144:147]
ds_read_b64_tr_b16 a[66:67], v20 offset:12800
v_mfma_f32_16x16x32_bf16 v[176:179], a[16:19], a[100:103], v[176:179]
buffer_load_dwordx4 a[156:159], v7, s[8:11], s21 offen offset:1024 sc1
v_mfma_f32_16x16x32_bf16 v[208:211], a[16:19], a[104:107], v[208:211]
ds_read_b64_tr_b16 a[68:69], v21 offset:12288
v_mfma_f32_16x16x32_bf16 v[240:243], a[16:19], a[108:111], v[240:243]
v_mfma_f32_16x16x32_bf16 v[244:247], a[20:23], a[108:111], v[244:247]
ds_read_b64_tr_b16 a[70:71], v21 offset:12800
v_mfma_f32_16x16x32_bf16 v[212:215], a[20:23], a[104:107], v[212:215]
s_add_u32 m0, s25, 0
v_mfma_f32_16x16x32_bf16 v[180:183], a[20:23], a[100:103], v[180:183]
buffer_load_dwordx4 v10, s[44:47], s29 offen offset:0 lds
v_mfma_f32_16x16x32_bf16 v[148:151], a[20:23], a[96:99], v[148:151]
ds_read_b64_tr_b16 a[72:73], v22 offset:12288
v_mfma_f32_16x16x32_bf16 v[152:155], a[24:27], a[96:99], v[152:155]
ds_read_b64_tr_b16 a[74:75], v22 offset:12800
v_mfma_f32_16x16x32_bf16 v[184:187], a[24:27], a[100:103], v[184:187]
v_mfma_f32_16x16x32_bf16 v[216:219], a[24:27], a[104:107], v[216:219]
ds_read_b64_tr_b16 a[76:77], v23 offset:12288
v_mfma_f32_16x16x32_bf16 v[248:251], a[24:27], a[108:111], v[248:251]
buffer_load_dwordx4 v11, s[44:47], s29 offen offset:1024 lds
s_waitcnt lgkmcnt(3)
v_mfma_f32_16x16x32_bf16 v[252:255], a[28:31], a[108:111], v[252:255]
ds_read_b64_tr_b16 a[78:79], v23 offset:12800
v_mfma_f32_16x16x32_bf16 v[220:223], a[28:31], a[104:107], v[220:223]
v_mfma_f32_16x16x32_bf16 v[188:191], a[28:31], a[100:103], v[188:191]
ds_read_b64_tr_b16 a[80:81], v20 offset:20480
v_mfma_f32_16x16x32_bf16 v[156:159], a[28:31], a[96:99], v[156:159]
ds_read_b64_tr_b16 a[82:83], v20 offset:20992
v_mfma_f32_16x16x32_bf16 v[64:67], a[96:99], a[32:35], v[64:67]
buffer_load_dwordx4 v12, s[44:47], s29 offen offset:2048 lds
v_mfma_f32_16x16x32_bf16 v[80:83], a[100:103], a[32:35], v[80:83]
v_mfma_f32_16x16x32_bf16 v[96:99], a[104:107], a[32:35], v[96:99]
ds_read_b64_tr_b16 a[84:85], v21 offset:20480
v_mfma_f32_16x16x32_bf16 v[112:115], a[108:111], a[32:35], v[112:115]
ds_read_b64_tr_b16 a[86:87], v21 offset:20992
v_mfma_f32_16x16x32_bf16 v[116:119], a[108:111], a[36:39], v[116:119]
v_mfma_f32_16x16x32_bf16 v[100:103], a[104:107], a[36:39], v[100:103]
buffer_load_dwordx4 v13, s[44:47], s29 offen offset:3072 lds
v_mfma_f32_16x16x32_bf16 v[84:87], a[100:103], a[36:39], v[84:87]
s_mov_b32 s48, s66
v_mfma_f32_16x16x32_bf16 v[68:71], a[96:99], a[36:39], v[68:71]
ds_read_b64_tr_b16 a[88:89], v22 offset:20480
v_mfma_f32_16x16x32_bf16 v[72:75], a[96:99], a[40:43], v[72:75]
s_mov_b32 s49, s67
v_mfma_f32_16x16x32_bf16 v[88:91], a[100:103], a[40:43], v[88:91]
ds_read_b64_tr_b16 a[90:91], v22 offset:20992
v_mfma_f32_16x16x32_bf16 v[104:107], a[104:107], a[40:43], v[104:107]
s_mov_b32 s50, 8388608
v_mfma_f32_16x16x32_bf16 v[120:123], a[108:111], a[40:43], v[120:123]
v_mfma_f32_16x16x32_bf16 v[124:127], a[108:111], a[44:47], v[124:127]
ds_read_b64_tr_b16 a[92:93], v23 offset:20480
v_mfma_f32_16x16x32_bf16 v[108:111], a[104:107], a[44:47], v[108:111]
ds_read_b64_tr_b16 a[94:95], v23 offset:20992
v_mfma_f32_16x16x32_bf16 v[92:95], a[100:103], a[44:47], v[92:95]
v_mfma_f32_16x16x32_bf16 v[76:79], a[96:99], a[44:47], v[76:79]
s_waitcnt vmcnt(20)
v_mfma_f32_16x16x32_bf16 v[128:131], a[48:51], a[112:115], v[128:131]
s_barrier
v_mfma_f32_16x16x32_bf16 v[160:163], a[48:51], a[116:119], v[160:163]
s_add_u32 m0, s24, 32768
v_mfma_f32_16x16x32_bf16 v[192:195], a[48:51], a[120:123], v[192:195]
buffer_load_dwordx4 v8, s[8:11], s28 offen offset:0 sc1 lds
v_mfma_f32_16x16x32_bf16 v[224:227], a[48:51], a[124:127], v[224:227]
ds_read_b64_tr_b16 a[0:1], v20 offset:32768
v_mfma_f32_16x16x32_bf16 v[228:231], a[52:55], a[124:127], v[228:231]
ds_read_b64_tr_b16 a[2:3], v20 offset:33280
v_mfma_f32_16x16x32_bf16 v[196:199], a[52:55], a[120:123], v[196:199]
v_mfma_f32_16x16x32_bf16 v[164:167], a[52:55], a[116:119], v[164:167]
ds_read_b64_tr_b16 a[4:5], v21 offset:32768
v_mfma_f32_16x16x32_bf16 v[132:135], a[52:55], a[112:115], v[132:135]
v_mfma_f32_16x16x32_bf16 v[136:139], a[56:59], a[112:115], v[136:139]
ds_read_b64_tr_b16 a[6:7], v21 offset:33280
v_mfma_f32_16x16x32_bf16 v[168:171], a[56:59], a[116:119], v[168:171]
ds_read_b64_tr_b16 a[8:9], v22 offset:32768
v_mfma_f32_16x16x32_bf16 v[200:203], a[56:59], a[120:123], v[200:203]
v_mfma_f32_16x16x32_bf16 v[232:235], a[56:59], a[124:127], v[232:235]
ds_read_b64_tr_b16 a[10:11], v22 offset:33280
v_mfma_f32_16x16x32_bf16 v[236:239], a[60:63], a[124:127], v[236:239]
v_mfma_f32_16x16x32_bf16 v[204:207], a[60:63], a[120:123], v[204:207]
buffer_load_dwordx4 v8, s[8:11], s28 offen offset:1024 sc1 lds
v_mfma_f32_16x16x32_bf16 v[172:175], a[60:63], a[116:119], v[172:175]
ds_read_b64_tr_b16 a[12:13], v23 offset:32768
v_mfma_f32_16x16x32_bf16 v[140:143], a[60:63], a[112:115], v[140:143]
ds_read_b64_tr_b16 a[14:15], v23 offset:33280
v_mfma_f32_16x16x32_bf16 v[144:147], a[64:67], a[112:115], v[144:147]
v_mfma_f32_16x16x32_bf16 v[176:179], a[64:67], a[116:119], v[176:179]
ds_read_b64_tr_b16 a[16:17], v20 offset:40960
v_mfma_f32_16x16x32_bf16 v[208:211], a[64:67], a[120:123], v[208:211]
v_mfma_f32_16x16x32_bf16 v[240:243], a[64:67], a[124:127], v[240:243]
ds_read_b64_tr_b16 a[18:19], v20 offset:41472
v_mfma_f32_16x16x32_bf16 v[244:247], a[68:71], a[124:127], v[244:247]
v_mfma_f32_16x16x32_bf16 v[212:215], a[68:71], a[120:123], v[212:215]
ds_read_b64_tr_b16 a[20:21], v21 offset:40960
v_mfma_f32_16x16x32_bf16 v[180:183], a[68:71], a[116:119], v[180:183]
ds_read_b64_tr_b16 a[22:23], v21 offset:41472
v_mfma_f32_16x16x32_bf16 v[148:151], a[68:71], a[112:115], v[148:151]
s_waitcnt lgkmcnt(3)
v_mfma_f32_16x16x32_bf16 v[152:155], a[72:75], a[112:115], v[152:155]
buffer_load_dwordx4 v9, s[8:11], s28 offen offset:2048 sc1 lds
s_mul_i32 s29, s28, 224
v_mfma_f32_16x16x32_bf16 v[184:187], a[72:75], a[116:119], v[184:187]
ds_read_b64_tr_b16 a[24:25], v22 offset:40960
v_mfma_f32_16x16x32_bf16 v[216:219], a[72:75], a[120:123], v[216:219]
v_mfma_f32_16x16x32_bf16 v[248:251], a[72:75], a[124:127], v[248:251]
ds_read_b64_tr_b16 a[26:27], v22 offset:41472
v_mfma_f32_16x16x32_bf16 v[252:255], a[76:79], a[124:127], v[252:255]
ds_read_b64_tr_b16 a[28:29], v23 offset:40960
v_mfma_f32_16x16x32_bf16 v[220:223], a[76:79], a[120:123], v[220:223]
v_mfma_f32_16x16x32_bf16 v[188:191], a[76:79], a[116:119], v[188:191]
ds_read_b64_tr_b16 a[30:31], v23 offset:41472
v_mfma_f32_16x16x32_bf16 v[156:159], a[76:79], a[112:115], v[156:159]
v_mfma_f32_16x16x32_bf16 v[64:67], a[112:115], a[80:83], v[64:67]
ds_read_b64_tr_b16 a[32:33], v20 offset:49152
v_mfma_f32_16x16x32_bf16 v[80:83], a[116:119], a[80:83], v[80:83]
v_mfma_f32_16x16x32_bf16 v[96:99], a[120:123], a[80:83], v[96:99]
ds_read_b64_tr_b16 a[34:35], v20 offset:49664
v_mfma_f32_16x16x32_bf16 v[112:115], a[124:127], a[80:83], v[112:115]
buffer_load_dwordx4 v9, s[8:11], s28 offen offset:3072 sc1 lds
v_mfma_f32_16x16x32_bf16 v[116:119], a[124:127], a[84:87], v[116:119]
ds_read_b64_tr_b16 a[36:37], v21 offset:49152
v_mfma_f32_16x16x32_bf16 v[100:103], a[120:123], a[84:87], v[100:103]
v_mfma_f32_16x16x32_bf16 v[84:87], a[116:119], a[84:87], v[84:87]
ds_read_b64_tr_b16 a[38:39], v21 offset:49664
v_mfma_f32_16x16x32_bf16 v[68:71], a[112:115], a[84:87], v[68:71]
v_mfma_f32_16x16x32_bf16 v[72:75], a[112:115], a[88:91], v[72:75]
ds_read_b64_tr_b16 a[40:41], v22 offset:49152
v_mfma_f32_16x16x32_bf16 v[88:91], a[116:119], a[88:91], v[88:91]
ds_read_b64_tr_b16 a[42:43], v22 offset:49664
v_mfma_f32_16x16x32_bf16 v[104:107], a[120:123], a[88:91], v[104:107]
v_mfma_f32_16x16x32_bf16 v[120:123], a[124:127], a[88:91], v[120:123]
ds_read_b64_tr_b16 a[44:45], v23 offset:49152
v_mfma_f32_16x16x32_bf16 v[124:127], a[124:127], a[92:95], v[124:127]
v_mfma_f32_16x16x32_bf16 v[108:111], a[120:123], a[92:95], v[108:111]
ds_read_b64_tr_b16 a[46:47], v23 offset:49664
v_mfma_f32_16x16x32_bf16 v[92:95], a[116:119], a[92:95], v[92:95]
v_mfma_f32_16x16x32_bf16 v[76:79], a[112:115], a[92:95], v[76:79]
s_waitcnt vmcnt(20)
Lq_join:
v_mfma_f32_16x16x32_bf16 v[128:131], a[0:3], a[128:131], v[128:131]
ds_read_b64_tr_b16 a[48:49], v20 offset:36864
s_lshl2_add_u32 s37, s3, s85
v_mfma_f32_16x16x32_bf16 v[160:163], a[0:3], a[132:135], v[160:163]
s_add_u32 m0, s25, 32768
s_add_u32 s31, s31, 1
v_mfma_f32_16x16x32_bf16 v[192:195], a[0:3], a[136:139], v[192:195]
buffer_load_dwordx4 v10, s[44:47], s29 offen offset:0 lds
v_readlane_b32 s28, v14, s31
v_mfma_f32_16x16x32_bf16 v[224:227], a[0:3], a[140:143], v[224:227]
ds_read_b64_tr_b16 a[50:51], v20 offset:37376
s_mul_i32 s37, s37, 90112
v_mfma_f32_16x16x32_bf16 v[228:231], a[4:7], a[140:143], v[228:231]
s_lshl_b32 s36, s7, 11
s_add_u32 s37, s37, s36
v_mfma_f32_16x16x32_bf16 v[196:199], a[4:7], a[136:139], v[196:199]
ds_read_b64_tr_b16 a[52:53], v21 offset:36864
s_cmp_eq_u32 s3, 0
s_cselect_b32 s36, s6, 0
s_cselect_b32 s33, 0xf149f2ca, 0
v_mfma_f32_16x16x32_bf16 v[164:167], a[4:7], a[132:135], v[164:167]
s_cmp_lg_u32 s36, 0
s_cselect_b32 s36, 2147483648, 0
s_or_b32 s20, s37, s36
v_mfma_f32_16x16x32_bf16 v[132:135], a[4:7], a[128:131], v[132:135]
ds_read_b64_tr_b16 a[54:55], v21 offset:37376
s_add_u32 s21, s20, 90112
v_mfma_f32_16x16x32_bf16 v[136:139], a[8:11], a[128:131], v[136:139]
s_add_u32 s22, s37, 180224
s_add_u32 s23, s37, 270336
v_mfma_f32_16x16x32_bf16 v[168:171], a[8:11], a[132:135], v[168:171]
ds_read_b64_tr_b16 a[56:57], v22 offset:36864
s_mov_b32 s32, 0x3e3504f3
v_mfma_f32_16x16x32_bf16 v[200:203], a[8:11], a[136:139], v[200:203]
ds_read_b64_tr_b16 a[58:59], v22 offset:37376
s_mov_b32 s34, 0x3fb8aa3b
v_mfma_f32_16x16x32_bf16 v[232:235], a[8:11], a[140:143], v[232:235]
s_mov_b32 s58, 0xaaaaaaaa
s_mov_b32 s59, 0xaaaaaaaa
v_mfma_f32_16x16x32_bf16 v[236:239], a[12:15], a[140:143], v[236:239]
ds_read_b64_tr_b16 a[60:61], v23 offset:36864
v_lshrrev_b32 v56, 4, v0
v_mfma_f32_16x16x32_bf16 v[204:207], a[12:15], a[136:139], v[204:207]
buffer_load_dwordx4 v11, s[44:47], s29 offen offset:1024 lds
v_and_b32 v57, 1, v0
v_mfma_f32_16x16x32_bf16 v[172:175], a[12:15], a[132:135], v[172:175]
v_lshl_add_u32 v56, v56, 2, v57
v_and_b32 v58, 15, v0
v_mfma_f32_16x16x32_bf16 v[140:143], a[12:15], a[128:131], v[140:143]
ds_read_b64_tr_b16 a[62:63], v23 offset:37376
v_cmp_le_u32 s[64:65], v56, v58
s_waitcnt lgkmcnt(2)
v_mfma_f32_16x16x32_bf16 v[144:147], a[16:19], a[128:131], v[144:147]
v_add_u32 v56, 2, v56
v_cmp_le_u32 s[66:67], v56, v58
v_mfma_f32_16x16x32_bf16 v[176:179], a[16:19], a[132:135], v[176:179]
ds_read_b64_tr_b16 a[64:65], v20 offset:45056
v_mov_b32 v56, 0x0c0c0100
v_mfma_f32_16x16x32_bf16 v[208:211], a[16:19], a[136:139], v[208:211]
ds_read_b64_tr_b16 a[66:67], v20 offset:45568
v_mov_b32 v57, 0x01000c0c
v_mfma_f32_16x16x32_bf16 v[240:243], a[16:19], a[140:143], v[240:243]
v_cndmask_b32 v56, v56, v57, s[58:59]
v_mov_b32 v57, 0x0c0c0302
v_mfma_f32_16x16x32_bf16 v[244:247], a[20:23], a[140:143], v[244:247]
ds_read_b64_tr_b16 a[68:69], v21 offset:45056
v_mov_b32 v58, 0x03020c0c
v_mfma_f32_16x16x32_bf16 v[212:215], a[20:23], a[136:139], v[212:215]
v_cndmask_b32 v57, v57, v58, s[58:59]
v_mov_b32 v58, 0x0c0c0c0c
v_mfma_f32_16x16x32_bf16 v[180:183], a[20:23], a[132:135], v[180:183]
ds_read_b64_tr_b16 a[70:71], v21 offset:45568
v_cndmask_b32 v16, v56, v58, s[64:65]
v_mfma_f32_16x16x32_bf16 v[148:151], a[20:23], a[128:131], v[148:151]
v_cndmask_b32 v17, v57, v58, s[66:67]
v_cndmask_b32 v18, v58, v56, s[64:65]
v_mfma_f32_16x16x32_bf16 v[152:155], a[24:27], a[128:131], v[152:155]
buffer_load_dwordx4 v12, s[44:47], s29 offen offset:2048 lds
v_cndmask_b32 v19, v58, v57, s[66:67]
v_mfma_f32_16x16x32_bf16 v[184:187], a[24:27], a[132:135], v[184:187]
ds_read_b64_tr_b16 a[72:73], v22 offset:45056
s_add_u32 s27, s24, 131072
v_mfma_f32_16x16x32_bf16 v[216:219], a[24:27], a[136:139], v[216:219]
ds_read_b64_tr_b16 a[74:75], v22 offset:45568
v_lshl_add_u32 v1, v0, 4, s27
v_mfma_f32_16x16x32_bf16 v[248:251], a[24:27], a[140:143], v[248:251]
v_lshl_add_u32 v2, v0, 3, s27
v_lshlrev_b32 v4, 4, v0
v_mfma_f32_16x16x32_bf16 v[252:255], a[28:31], a[140:143], v[252:255]
ds_read_b64_tr_b16 a[76:77], v23 offset:45056
s_add_u32 s27, s27, 4096
v_mfma_f32_16x16x32_bf16 v[220:223], a[28:31], a[136:139], v[220:223]
s_and_b32 s27, s27, 143360
v_lshl_add_u32 v24, v0, 4, s27
v_mfma_f32_16x16x32_bf16 v[188:191], a[28:31], a[132:135], v[188:191]
ds_read_b64_tr_b16 a[78:79], v23 offset:45568
v_lshl_add_u32 v25, v0, 3, s27
v_mfma_f32_16x16x32_bf16 v[156:159], a[28:31], a[128:131], v[156:159]
v_accvgpr_read_b32 v3, a230
v_accvgpr_read_b32 v15, a231
v_mfma_f32_16x16x32_bf16 v[64:67], a[128:131], a[32:35], v[64:67]
ds_read_b64_tr_b16 a[80:81], v20 offset:53248
v_accvgpr_read_b32 v5, a232
v_mfma_f32_16x16x32_bf16 v[80:83], a[132:135], a[32:35], v[80:83]
ds_read_b64_tr_b16 a[82:83], v20 offset:53760
v_accvgpr_read_b32 v6, a233
v_mfma_f32_16x16x32_bf16 v[96:99], a[136:139], a[32:35], v[96:99]
v_accvgpr_read_b32 v7, a234
v_mfma_f32_16x16x32_bf16 v[112:115], a[140:143], a[32:35], v[112:115]
buffer_load_dwordx4 v13, s[44:47], s29 offen offset:3072 lds
v_mfma_f32_16x16x32_bf16 v[116:119], a[140:143], a[36:39], v[116:119]
ds_read_b64_tr_b16 a[84:85], v21 offset:53248
v_mfma_f32_16x16x32_bf16 v[100:103], a[136:139], a[36:39], v[100:103]
v_mfma_f32_16x16x32_bf16 v[84:87], a[132:135], a[36:39], v[84:87]
ds_read_b64_tr_b16 a[86:87], v21 offset:53760
v_mfma_f32_16x16x32_bf16 v[68:71], a[128:131], a[36:39], v[68:71]
v_mfma_f32_16x16x32_bf16 v[72:75], a[128:131], a[40:43], v[72:75]
ds_read_b64_tr_b16 a[88:89], v22 offset:53248
v_mfma_f32_16x16x32_bf16 v[88:91], a[132:135], a[40:43], v[88:91]
ds_read_b64_tr_b16 a[90:91], v22 offset:53760
v_mfma_f32_16x16x32_bf16 v[104:107], a[136:139], a[40:43], v[104:107]
v_mfma_f32_16x16x32_bf16 v[120:123], a[140:143], a[40:43], v[120:123]
ds_read_b64_tr_b16 a[92:93], v23 offset:53248
v_mfma_f32_16x16x32_bf16 v[124:127], a[140:143], a[44:47], v[124:127]
v_mfma_f32_16x16x32_bf16 v[108:111], a[136:139], a[44:47], v[108:111]
ds_read_b64_tr_b16 a[94:95], v23 offset:53760
v_mfma_f32_16x16x32_bf16 v[92:95], a[132:135], a[44:47], v[92:95]
v_mfma_f32_16x16x32_bf16 v[76:79], a[128:131], a[44:47], v[76:79]
s_waitcnt vmcnt(8) lgkmcnt(2)
v_mfma_f32_16x16x32_bf16 v[64:67], a[144:147], a[80:83], v[64:67]
s_barrier
v_mfma_f32_16x16x32_bf16 v[80:83], a[148:151], a[80:83], v[80:83]
s_add_u32 m0, s24, 65536
v_mfma_f32_16x16x32_bf16 v[96:99], a[152:155], a[80:83], v[96:99]
buffer_load_dwordx4 v8, s[8:11], s28 offen offset:0 sc1 lds
v_mfma_f32_16x16x32_bf16 v[112:115], a[156:159], a[80:83], v[112:115]
ds_read_b64_tr_b16 a[176:177], v3 offset:0
v_mfma_f32_16x16x32_bf16 v[116:119], a[156:159], a[84:87], v[116:119]
ds_read_b64_tr_b16 a[178:179], v3 offset:512
v_mfma_f32_16x16x32_bf16 v[100:103], a[152:155], a[84:87], v[100:103]
ds_read_b128 a[160:163], v7 offset:0
v_mfma_f32_16x16x32_bf16 v[84:87], a[148:151], a[84:87], v[84:87]
ds_read_b128 a[164:167], v7 offset:2048
v_mfma_f32_16x16x32_bf16 v[68:71], a[144:147], a[84:87], v[68:71]
ds_read_b128 a[168:171], v7 offset:4096
v_mfma_f32_16x16x32_bf16 v[72:75], a[144:147], a[88:91], v[72:75]
ds_read_b128 a[172:175], v7 offset:6144
v_mfma_f32_16x16x32_bf16 v[88:91], a[148:151], a[88:91], v[88:91]
ds_read_b64_tr_b16 a[180:181], v15 offset:0
v_mfma_f32_16x16x32_bf16 v[104:107], a[152:155], a[88:91], v[104:107]
ds_read_b64_tr_b16 a[182:183], v15 offset:512
v_mfma_f32_16x16x32_bf16 v[120:123], a[156:159], a[88:91], v[120:123]
ds_read_b64_tr_b16 a[184:185], v5 offset:0
s_waitcnt lgkmcnt(5)
v_mfma_f32_16x16x32_bf16 v[124:127], a[156:159], a[92:95], v[124:127]
ds_read_b64_tr_b16 a[186:187], v5 offset:512
v_mfma_f32_16x16x32_bf16 v[108:111], a[152:155], a[92:95], v[108:111]
buffer_load_dwordx4 v8, s[8:11], s28 offen offset:1024 sc1 lds
v_mfma_f32_16x16x32_bf16 v[92:95], a[148:151], a[92:95], v[92:95]
ds_read_b64_tr_b16 a[188:189], v6 offset:0
v_mfma_f32_16x16x32_bf16 v[76:79], a[144:147], a[92:95], v[76:79]
ds_read_b64_tr_b16 a[190:191], v6 offset:512
v_mfma_f32_16x16x32_bf16 v[144:147], a[64:67], a[144:147], v[144:147]
v_cvt_pk_bf16_f32 v26, v64, v65
v_cvt_pk_bf16_f32 v27, v66, v67
v_mfma_f32_16x16x32_bf16 v[176:179], a[64:67], a[148:151], v[176:179]
v_cvt_pk_bf16_f32 v28, v80, v81
v_cvt_pk_bf16_f32 v29, v82, v83
v_mfma_f32_16x16x32_bf16 v[208:211], a[64:67], a[152:155], v[208:211]
v_cvt_pk_bf16_f32 v30, v96, v97
v_cvt_pk_bf16_f32 v31, v98, v99
v_mfma_f32_16x16x32_bf16 v[240:243], a[64:67], a[156:159], v[240:243]
v_cvt_pk_bf16_f32 v32, v112, v113
v_cvt_pk_bf16_f32 v33, v114, v115
v_mfma_f32_16x16x32_bf16 v[244:247], a[68:71], a[156:159], v[244:247]
ds_write_b64 v25, v[32:33] offset:2048
v_cvt_pk_bf16_f32 v42, v116, v117
v_mfma_f32_16x16x32_bf16 v[212:215], a[68:71], a[152:155], v[212:215]
v_cvt_pk_bf16_f32 v43, v118, v119
v_cvt_pk_bf16_f32 v40, v100, v101
v_mfma_f32_16x16x32_bf16 v[180:183], a[68:71], a[148:151], v[180:183]
v_cvt_pk_bf16_f32 v41, v102, v103
v_cvt_pk_bf16_f32 v38, v84, v85
v_mfma_f32_16x16x32_bf16 v[148:151], a[68:71], a[144:147], v[148:151]
v_cvt_pk_bf16_f32 v39, v86, v87
v_cvt_pk_bf16_f32 v36, v68, v69
v_mfma_f32_16x16x32_bf16 v[152:155], a[72:75], a[144:147], v[152:155]
buffer_load_dwordx4 v9, s[8:11], s28 offen offset:2048 sc1 lds
s_mul_i32 s29, s28, 224
v_mfma_f32_16x16x32_bf16 v[184:187], a[72:75], a[148:151], v[184:187]
v_cvt_pk_bf16_f32 v37, v70, v71
v_mfma_f32_16x16x32_bf16 v[216:219], a[72:75], a[152:155], v[216:219]
ds_write_b64 v25, v[42:43] offset:2560
v_cvt_pk_bf16_f32 v46, v72, v73
v_mfma_f32_16x16x32_bf16 v[248:251], a[72:75], a[156:159], v[248:251]
v_cvt_pk_bf16_f32 v47, v74, v75
v_cvt_pk_bf16_f32 v48, v88, v89
v_mfma_f32_16x16x32_bf16 v[252:255], a[76:79], a[156:159], v[252:255]
v_cvt_pk_bf16_f32 v49, v90, v91
v_cvt_pk_bf16_f32 v50, v104, v105
v_mfma_f32_16x16x32_bf16 v[220:223], a[76:79], a[152:155], v[220:223]
v_cvt_pk_bf16_f32 v51, v106, v107
v_cvt_pk_bf16_f32 v52, v120, v121
v_mfma_f32_16x16x32_bf16 v[188:191], a[76:79], a[148:151], v[188:191]
v_cvt_pk_bf16_f32 v53, v122, v123
v_mfma_f32_16x16x32_bf16 v[156:159], a[76:79], a[144:147], v[156:159]
ds_write_b64 v25, v[52:53] offset:3072
v_cvt_pk_bf16_f32 v62, v124, v125
v_mfma_f32_16x16x32_bf16 v[128:131], a[48:51], a[144:147], v[128:131]
v_cvt_pk_bf16_f32 v63, v126, v127
v_cvt_pk_bf16_f32 v60, v108, v109
v_mfma_f32_16x16x32_bf16 v[160:163], a[48:51], a[148:151], v[160:163]
v_cvt_pk_bf16_f32 v61, v110, v111
v_cvt_pk_bf16_f32 v58, v92, v93
v_mfma_f32_16x16x32_bf16 v[192:195], a[48:51], a[152:155], v[192:195]
v_cvt_pk_bf16_f32 v59, v94, v95
v_cvt_pk_bf16_f32 v56, v76, v77
v_mfma_f32_16x16x32_bf16 v[224:227], a[48:51], a[156:159], v[224:227]
buffer_load_dwordx4 v9, s[8:11], s28 offen offset:3072 sc1 lds
v_mfma_f32_16x16x32_bf16 v[228:231], a[52:55], a[156:159], v[228:231]
v_cvt_pk_bf16_f32 v57, v78, v79
v_mfma_f32_16x16x32_bf16 v[196:199], a[52:55], a[152:155], v[196:199]
ds_write_b64 v25, v[62:63] offset:3584
v_cvt_pk_bf16_f32 v240, v240, v241
v_mfma_f32_16x16x32_bf16 v[164:167], a[52:55], a[148:151], v[164:167]
v_cvt_pk_bf16_f32 v241, v242, v243
v_cvt_pk_bf16_f32 v242, v244, v245
v_mfma_f32_16x16x32_bf16 v[132:135], a[52:55], a[144:147], v[132:135]
v_cvt_pk_bf16_f32 v243, v246, v247
v_mfma_f32_16x16x32_bf16 v[136:139], a[56:59], a[144:147], v[136:139]
ds_write_b128 v24, v[240:243] offset:0
v_cvt_pk_bf16_f32 v248, v248, v249
v_mfma_f32_16x16x32_bf16 v[168:171], a[56:59], a[148:151], v[168:171]
v_cvt_pk_bf16_f32 v249, v250, v251
v_cvt_pk_bf16_f32 v250, v252, v253
v_mfma_f32_16x16x32_bf16 v[200:203], a[56:59], a[152:155], v[200:203]
v_cvt_pk_bf16_f32 v251, v254, v255
v_mfma_f32_16x16x32_bf16 v[232:235], a[56:59], a[156:159], v[232:235]
ds_write_b128 v24, v[248:251] offset:1024
v_cvt_pk_bf16_f32 v208, v208, v209
v_mfma_f32_16x16x32_bf16 v[236:239], a[60:63], a[156:159], v[236:239]
v_cvt_pk_bf16_f32 v209, v210, v211
v_cvt_pk_bf16_f32 v210, v212, v213
v_mfma_f32_16x16x32_bf16 v[204:207], a[60:63], a[152:155], v[204:207]
v_cvt_pk_bf16_f32 v211, v214, v215
v_cvt_pk_bf16_f32 v216, v216, v217
v_mfma_f32_16x16x32_bf16 v[172:175], a[60:63], a[148:151], v[172:175]
v_cvt_pk_bf16_f32 v217, v218, v219
v_cvt_pk_bf16_f32 v218, v220, v221
v_mfma_f32_16x16x32_bf16 v[140:143], a[60:63], a[144:147], v[140:143]
v_cvt_pk_bf16_f32 v219, v222, v223
v_cvt_pk_bf16_f32 v176, v176, v177
v_mfma_f32_16x16x32_bf16 v[64:67], a[176:179], a[160:163], 0
ds_read_b64_tr_b16 a[208:209], v3 offset:4096
v_cvt_pk_bf16_f32 v177, v178, v179
v_mfma_f32_16x16x32_bf16 v[80:83], a[176:179], a[164:167], 0
ds_read_b64_tr_b16 a[210:211], v3 offset:4608
s_add_u32 m0, s25, 65536
s_waitcnt lgkmcnt(2)
v_mfma_f32_16x16x32_bf16 v[96:99], a[176:179], a[168:171], 0
buffer_load_dwordx4 v10, s[44:47], s29 offen offset:0 lds
v_cvt_pk_bf16_f32 v178, v180, v181
v_mfma_f32_16x16x32_bf16 v[112:115], a[176:179], a[172:175], 0
ds_read_b128 a[192:195], v7 offset:1024
v_cvt_pk_bf16_f32 v179, v182, v183
v_mfma_f32_16x16x32_bf16 v[116:119], a[180:183], a[172:175], 0
ds_read_b128 a[196:199], v7 offset:3072
s_add_u32 s31, s31, 1
v_mfma_f32_16x16x32_bf16 v[100:103], a[180:183], a[168:171], 0
ds_read_b128 a[200:203], v7 offset:5120
v_cvt_pk_bf16_f32 v184, v184, v185
v_mfma_f32_16x16x32_bf16 v[84:87], a[180:183], a[164:167], 0
buffer_load_dwordx4 v11, s[44:47], s29 offen offset:1024 lds
v_cvt_pk_bf16_f32 v185, v186, v187
v_mfma_f32_16x16x32_bf16 v[68:71], a[180:183], a[160:163], 0
ds_read_b128 a[204:207], v7 offset:7168
v_cvt_pk_bf16_f32 v186, v188, v189
v_mfma_f32_16x16x32_bf16 v[72:75], a[184:187], a[160:163], 0
ds_read_b64_tr_b16 a[212:213], v15 offset:4096
v_readlane_b32 s28, v14, s31
v_mfma_f32_16x16x32_bf16 v[88:91], a[184:187], a[164:167], 0
ds_read_b64_tr_b16 a[214:215], v15 offset:4608
v_cvt_pk_bf16_f32 v187, v190, v191
v_mfma_f32_16x16x32_bf16 v[104:107], a[184:187], a[168:171], 0
buffer_load_dwordx4 v12, s[44:47], s29 offen offset:2048 lds
v_cvt_pk_bf16_f32 v144, v144, v145
v_mfma_f32_16x16x32_bf16 v[120:123], a[184:187], a[172:175], 0
ds_read_b64_tr_b16 a[216:217], v5 offset:4096
v_cvt_pk_bf16_f32 v145, v146, v147
v_mfma_f32_16x16x32_bf16 v[124:127], a[188:191], a[172:175], 0
ds_read_b64_tr_b16 a[218:219], v5 offset:4608
v_cvt_pk_bf16_f32 v146, v148, v149
v_mfma_f32_16x16x32_bf16 v[108:111], a[188:191], a[168:171], 0
ds_read_b64_tr_b16 a[220:221], v6 offset:4096
v_cvt_pk_bf16_f32 v147, v150, v151
v_mfma_f32_16x16x32_bf16 v[92:95], a[188:191], a[164:167], 0
buffer_load_dwordx4 v13, s[44:47], s29 offen offset:3072 lds
v_cvt_pk_bf16_f32 v152, v152, v153
v_mfma_f32_16x16x32_bf16 v[76:79], a[188:191], a[160:163], 0
ds_read_b64_tr_b16 a[222:223], v6 offset:4608
s_waitcnt vmcnt(8) lgkmcnt(8)
v_mfma_f32_16x16x32_bf16 v[64:67], a[208:211], a[192:195], v[64:67]
s_barrier
ds_read_b64_tr_b16 a[176:177], v3 offset:32768
v_mfma_f32_16x16x32_bf16 v[80:83], a[208:211], a[196:199], v[80:83]
ds_read_b64_tr_b16 a[178:179], v3 offset:33280
s_add_u32 m0, s24, 98304
s_waitcnt lgkmcnt(4)
v_mfma_f32_16x16x32_bf16 v[96:99], a[208:211], a[200:203], v[96:99]
buffer_load_dwordx4 v8, s[8:11], s28 offen offset:0 sc1 lds
ds_read_b128 a[100:103], v1 offset:0
v_cvt_pk_bf16_f32 v153, v154, v155
v_mfma_f32_16x16x32_bf16 v[112:115], a[208:211], a[204:207], v[112:115]
ds_read_b128 a[160:163], v7 offset:32768
v_cvt_pk_bf16_f32 v154, v156, v157
v_mfma_f32_16x16x32_bf16 v[116:119], a[212:215], a[204:207], v[116:119]
ds_read_b128 a[164:167], v7 offset:34816
v_cvt_pk_bf16_f32 v155, v158, v159
v_mfma_f32_16x16x32_bf16 v[100:103], a[212:215], a[200:203], v[100:103]
ds_read_b128 a[168:171], v7 offset:36864
ds_read_b64 v[24:25], v2 offset:2048
v_cvt_pk_bf16_f32 v224, v224, v225
v_mfma_f32_16x16x32_bf16 v[84:87], a[212:215], a[196:199], v[84:87]
buffer_load_dwordx4 v8, s[8:11], s28 offen offset:1024 sc1 lds
ds_read_b64 v[34:35], v2 offset:2560
v_cvt_pk_bf16_f32 v225, v226, v227
v_mfma_f32_16x16x32_bf16 v[68:71], a[212:215], a[192:195], v[68:71]
ds_read_b128 a[172:175], v7 offset:38912
v_cvt_pk_bf16_f32 v226, v228, v229
v_mfma_f32_16x16x32_bf16 v[72:75], a[216:219], a[192:195], v[72:75]
ds_read_b64_tr_b16 a[180:181], v15 offset:32768
s_mul_i32 s29, s28, 224
v_mfma_f32_16x16x32_bf16 v[88:91], a[216:219], a[196:199], v[88:91]
ds_read_b64_tr_b16 a[182:183], v15 offset:33280
v_cvt_pk_bf16_f32 v227, v230, v231
v_mfma_f32_16x16x32_bf16 v[104:107], a[216:219], a[200:203], v[104:107]
buffer_load_dwordx4 v9, s[8:11], s28 offen offset:2048 sc1 lds
ds_read_b128 a[104:107], v1 offset:1024
v_cvt_pk_bf16_f32 v232, v232, v233
v_mfma_f32_16x16x32_bf16 v[120:123], a[216:219], a[204:207], v[120:123]
ds_read_b64_tr_b16 a[184:185], v5 offset:32768
v_cvt_pk_bf16_f32 v233, v234, v235
s_waitcnt lgkmcnt(5)
v_mfma_f32_16x16x32_bf16 v[124:127], a[220:223], a[204:207], v[124:127]
ds_read_b64_tr_b16 a[186:187], v5 offset:33280
v_cvt_pk_bf16_f32 v234, v236, v237
v_mfma_f32_16x16x32_bf16 v[108:111], a[220:223], a[200:203], v[108:111]
ds_read_b64_tr_b16 a[188:189], v6 offset:32768
ds_read_b64 v[44:45], v2 offset:3072
v_cvt_pk_bf16_f32 v235, v238, v239
v_mfma_f32_16x16x32_bf16 v[92:95], a[220:223], a[196:199], v[92:95]
buffer_load_dwordx4 v9, s[8:11], s28 offen offset:3072 sc1 lds
ds_read_b64 v[54:55], v2 offset:3584
v_cvt_pk_bf16_f32 v192, v192, v193
v_mfma_f32_16x16x32_bf16 v[76:79], a[220:223], a[192:195], v[76:79]
ds_read_b64_tr_b16 a[190:191], v6 offset:33280
v_cvt_pk_bf16_f32 v193, v194, v195
v_mfma_f32_16x16x32_bf16 v[64:67], a[176:179], a[160:163], v[64:67]
ds_read_b64_tr_b16 a[208:209], v3 offset:36864
v_cvt_pk_bf16_f32 v194, v196, v197
v_mfma_f32_16x16x32_bf16 v[80:83], a[176:179], a[164:167], v[80:83]
ds_read_b64_tr_b16 a[210:211], v3 offset:37376
s_add_u32 m0, s25, 98304
v_mfma_f32_16x16x32_bf16 v[96:99], a[176:179], a[168:171], v[96:99]
buffer_load_dwordx4 v10, s[44:47], s29 offen offset:0 lds
v_add_u32 v20, 65536, v3
s_waitcnt lgkmcnt(4)
v_mfma_f32_16x16x32_bf16 v[112:115], a[176:179], a[172:175], v[112:115]
ds_read_b128 a[192:195], v7 offset:33792
v_add_u32 v2, 65536, v7
v_mfma_f32_16x16x32_bf16 v[116:119], a[180:183], a[172:175], v[116:119]
ds_read_b128 a[196:199], v7 offset:35840
s_add_u32 s31, s31, 1
v_mfma_f32_16x16x32_bf16 v[100:103], a[180:183], a[168:171], v[100:103]
ds_read_b128 a[200:203], v7 offset:37888
v_cvt_pk_bf16_f32 v195, v198, v199
v_mfma_f32_16x16x32_bf16 v[84:87], a[180:183], a[164:167], v[84:87]
buffer_load_dwordx4 v11, s[44:47], s29 offen offset:1024 lds
v_add_u32 v21, 65536, v15
v_mfma_f32_16x16x32_bf16 v[68:71], a[180:183], a[160:163], v[68:71]
ds_read_b128 a[204:207], v7 offset:39936
v_cvt_pk_bf16_f32 v200, v200, v201
v_mfma_f32_16x16x32_bf16 v[72:75], a[184:187], a[160:163], v[72:75]
ds_read_b64_tr_b16 a[212:213], v15 offset:36864
v_readlane_b32 s28, v14, s31
v_mfma_f32_16x16x32_bf16 v[88:91], a[184:187], a[164:167], v[88:91]
ds_read_b64_tr_b16 a[214:215], v15 offset:37376
v_cvt_pk_bf16_f32 v201, v202, v203
v_mfma_f32_16x16x32_bf16 v[104:107], a[184:187], a[168:171], v[104:107]
buffer_load_dwordx4 v12, s[44:47], s29 offen offset:2048 lds
v_add_u32 v22, 65536, v5
v_mfma_f32_16x16x32_bf16 v[120:123], a[184:187], a[172:175], v[120:123]
ds_read_b64_tr_b16 a[216:217], v5 offset:36864
v_cvt_pk_bf16_f32 v202, v204, v205
s_waitcnt lgkmcnt(4)
v_mfma_f32_16x16x32_bf16 v[124:127], a[188:191], a[172:175], v[124:127]
ds_read_b64_tr_b16 a[218:219], v5 offset:37376
v_cvt_pk_bf16_f32 v203, v206, v207
v_mfma_f32_16x16x32_bf16 v[244:247], v[240:243], v[224:227], 0
v_cvt_pk_bf16_f32 v160, v160, v161
v_cvt_pk_bf16_f32 v161, v162, v163
v_mfma_f32_16x16x32_bf16 v[228:231], v[208:211], v[224:227], 0
v_cvt_pk_bf16_f32 v162, v164, v165
v_cvt_pk_bf16_f32 v163, v166, v167
v_mfma_f32_16x16x32_bf16 v[252:255], v[248:251], v[232:235], 0
v_cvt_pk_bf16_f32 v168, v168, v169
v_cvt_pk_bf16_f32 v169, v170, v171
v_mfma_f32_16x16x32_bf16 v[236:239], v[216:219], v[232:235], 0
v_cvt_pk_bf16_f32 v170, v172, v173
v_cvt_pk_bf16_f32 v171, v174, v175
v_mfma_f32_16x16x32_bf16 v[212:215], v[208:211], v[192:195], 0
v_cvt_pk_bf16_f32 v128, v128, v129
v_cvt_pk_bf16_f32 v129, v130, v131
v_mfma_f32_16x16x32_bf16 v[196:199], v[176:179], v[192:195], 0
v_cvt_pk_bf16_f32 v130, v132, v133
v_cvt_pk_bf16_f32 v131, v134, v135
v_mfma_f32_16x16x32_bf16 v[220:223], v[216:219], v[200:203], 0
v_cvt_pk_bf16_f32 v136, v136, v137
v_cvt_pk_bf16_f32 v137, v138, v139
v_mfma_f32_16x16x32_bf16 v[204:207], v[184:187], v[200:203], 0
v_cvt_pk_bf16_f32 v138, v140, v141
v_cvt_pk_bf16_f32 v139, v142, v143
v_mfma_f32_16x16x32_bf16 v[108:111], a[188:191], a[168:171], v[108:111]
ds_read_b64_tr_b16 a[220:221], v6 offset:36864
v_mov_b32 v132, s33
v_mfma_f32_16x16x32_bf16 v[92:95], a[188:191], a[164:167], v[92:95]
buffer_load_dwordx4 v13, s[44:47], s29 offen offset:3072 lds
v_add_u32 v23, 65536, v6
v_mfma_f32_16x16x32_bf16 v[76:79], a[188:191], a[160:163], v[76:79]
ds_read_b64_tr_b16 a[222:223], v6 offset:37376
v_mov_b32 v133, s33
s_waitcnt vmcnt(8)
v_mfma_f32_16x16x32_bf16 v[64:67], a[208:211], a[192:195], v[64:67]
s_barrier
ds_read_b64_tr_b16 a[176:177], v20 offset:0
v_mfma_f32_16x16x32_bf16 v[80:83], a[208:211], a[196:199], v[80:83]
ds_read_b64_tr_b16 a[178:179], v20 offset:512
s_add_u32 m0, s24, 0
v_mfma_f32_16x16x32_bf16 v[96:99], a[208:211], a[200:203], v[96:99]
buffer_load_dwordx4 v8, s[8:11], s28 offen offset:0 sc1 lds
v_mov_b32 v134, s33
s_waitcnt lgkmcnt(3)
v_mfma_f32_16x16x32_bf16 v[112:115], a[208:211], a[204:207], v[112:115]
ds_read_b128 a[160:163], v2 offset:0
v_mov_b32 v135, s33
v_mfma_f32_16x16x32_bf16 v[116:119], a[212:215], a[204:207], v[116:119]
ds_read_b128 a[164:167], v2 offset:2048
v_mov_b32 v140, s33
v_mfma_f32_16x16x32_bf16 v[100:103], a[212:215], a[200:203], v[100:103]
ds_read_b128 a[168:171], v2 offset:4096
v_mov_b32 v141, s33
v_mfma_f32_16x16x32_bf16 v[84:87], a[212:215], a[196:199], v[84:87]
buffer_load_dwordx4 v8, s[8:11], s28 offen offset:1024 sc1 lds
v_mov_b32 v142, s33
v_mfma_f32_16x16x32_bf16 v[68:71], a[212:215], a[192:195], v[68:71]
ds_read_b128 a[172:175], v2 offset:6144
v_mov_b32 v143, s33
v_mfma_f32_16x16x32_bf16 v[72:75], a[216:219], a[192:195], v[72:75]
ds_read_b64_tr_b16 a[180:181], v21 offset:0
s_mul_i32 s29, s28, 224
v_mfma_f32_16x16x32_bf16 v[88:91], a[216:219], a[196:199], v[88:91]
ds_read_b64_tr_b16 a[182:183], v21 offset:512
v_cndmask_b32 v244, v244, v245, s[58:59]
v_mfma_f32_16x16x32_bf16 v[104:107], a[216:219], a[200:203], v[104:107]
buffer_load_dwordx4 v9, s[8:11], s28 offen offset:2048 sc1 lds
v_cndmask_b32 v246, v246, v247, s[58:59]
v_mfma_f32_16x16x32_bf16 v[120:123], a[216:219], a[204:207], v[120:123]
ds_read_b64_tr_b16 a[184:185], v22 offset:0
v_cndmask_b32 v228, v228, v229, s[58:59]
s_waitcnt lgkmcnt(4)
v_mfma_f32_16x16x32_bf16 v[124:127], a[220:223], a[204:207], v[124:127]
ds_read_b64_tr_b16 a[186:187], v22 offset:512
v_cndmask_b32 v230, v230, v231, s[58:59]
v_mfma_f32_16x16x32_bf16 v[108:111], a[220:223], a[200:203], v[108:111]
ds_read_b64_tr_b16 a[188:189], v23 offset:0
v_cndmask_b32 v228, v228, v244, s[64:65]
v_mfma_f32_16x16x32_bf16 v[92:95], a[220:223], a[196:199], v[92:95]
buffer_load_dwordx4 v9, s[8:11], s28 offen offset:3072 sc1 lds
v_cndmask_b32 v229, v230, v246, s[66:67]
v_mfma_f32_16x16x32_bf16 v[76:79], a[220:223], a[192:195], v[76:79]
ds_read_b64_tr_b16 a[190:191], v23 offset:512
v_cvt_pk_bf16_f32 v244, v228, v229
v_mfma_f32_16x16x32_bf16 v[64:67], a[176:179], a[160:163], v[64:67]
ds_read_b64_tr_b16 a[208:209], v20 offset:4096
v_lshlrev_b32 v228, 16, v244
v_mfma_f32_16x16x32_bf16 v[80:83], a[176:179], a[164:167], v[80:83]
ds_read_b64_tr_b16 a[210:211], v20 offset:4608
s_add_u32 m0, s25, 0
v_mfma_f32_16x16x32_bf16 v[96:99], a[176:179], a[168:171], v[96:99]
buffer_load_dwordx4 v10, s[44:47], s29 offen offset:0 lds
v_and_b32 v229, 0xffff0000, v244
s_waitcnt lgkmcnt(3)
v_mfma_f32_16x16x32_bf16 v[112:115], a[176:179], a[172:175], v[112:115]
ds_read_b128 a[192:195], v2 offset:1024
v_cndmask_b32 v252, v252, v253, s[58:59]
v_mfma_f32_16x16x32_bf16 v[116:119], a[180:183], a[172:175], v[116:119]
ds_read_b128 a[196:199], v2 offset:3072
s_add_u32 s31, s31, 1
v_mfma_f32_16x16x32_bf16 v[100:103], a[180:183], a[168:171], v[100:103]
ds_read_b128 a[200:203], v2 offset:5120
v_cndmask_b32 v254, v254, v255, s[58:59]
v_mfma_f32_16x16x32_bf16 v[84:87], a[180:183], a[164:167], v[84:87]
buffer_load_dwordx4 v11, s[44:47], s29 offen offset:1024 lds
v_cndmask_b32 v236, v236, v237, s[58:59]
v_mfma_f32_16x16x32_bf16 v[68:71], a[180:183], a[160:163], v[68:71]
ds_read_b128 a[204:207], v2 offset:7168
v_cndmask_b32 v238, v238, v239, s[58:59]
v_mfma_f32_16x16x32_bf16 v[72:75], a[184:187], a[160:163], v[72:75]
ds_read_b64_tr_b16 a[212:213], v21 offset:4096
v_readlane_b32 s28, v14, s31
v_mfma_f32_16x16x32_bf16 v[88:91], a[184:187], a[164:167], v[88:91]
ds_read_b64_tr_b16 a[214:215], v21 offset:4608
v_cndmask_b32 v236, v236, v252, s[64:65]
v_mfma_f32_16x16x32_bf16 v[104:107], a[184:187], a[168:171], v[104:107]
buffer_load_dwordx4 v12, s[44:47], s29 offen offset:2048 lds
v_cndmask_b32 v237, v238, v254, s[66:67]
v_mfma_f32_16x16x32_bf16 v[120:123], a[184:187], a[172:175], v[120:123]
ds_read_b64_tr_b16 a[216:217], v22 offset:4096
v_cvt_pk_bf16_f32 v252, v236, v237
s_waitcnt lgkmcnt(4)
v_mfma_f32_16x16x32_bf16 v[124:127], a[188:191], a[172:175], v[124:127]
ds_read_b64_tr_b16 a[218:219], v22 offset:4608
v_lshlrev_b32 v236, 16, v252
v_mfma_f32_16x16x32_bf16 v[108:111], a[188:191], a[168:171], v[108:111]
ds_read_b64_tr_b16 a[220:221], v23 offset:4096
v_and_b32 v237, 0xffff0000, v252
v_mfma_f32_16x16x32_bf16 v[92:95], a[188:191], a[164:167], v[92:95]
buffer_load_dwordx4 v13, s[44:47], s29 offen offset:3072 lds
v_cndmask_b32 v212, v212, v213, s[58:59]
v_mfma_f32_16x16x32_bf16 v[76:79], a[188:191], a[160:163], v[76:79]
ds_read_b64_tr_b16 a[222:223], v23 offset:4608
v_cndmask_b32 v214, v214, v215, s[58:59]
v_mfma_f32_16x16x32_bf16 v[180:183], v[176:179], v[160:163], 0
v_cndmask_b32 v196, v196, v197, s[58:59]
v_cndmask_b32 v198, v198, v199, s[58:59]
v_mfma_f32_16x16x32_bf16 v[164:167], v[144:147], v[160:163], 0
v_cndmask_b32 v196, v196, v212, s[64:65]
v_cndmask_b32 v197, v198, v214, s[66:67]
v_mfma_f32_16x16x32_bf16 v[188:191], v[184:187], v[168:171], 0
v_cvt_pk_bf16_f32 v212, v196, v197
v_lshlrev_b32 v196, 16, v212
v_mfma_f32_16x16x32_bf16 v[172:175], v[152:155], v[168:171], 0
v_and_b32 v197, 0xffff0000, v212
v_cndmask_b32 v220, v220, v221, s[58:59]
v_mfma_f32_16x16x32_bf16 v[148:151], v[144:147], v[128:131], 0
v_cndmask_b32 v222, v222, v223, s[58:59]
v_cndmask_b32 v204, v204, v205, s[58:59]
v_mfma_f32_16x16x32_bf16 v[132:135], a[100:103], v[128:131], v[132:135]
v_cndmask_b32 v206, v206, v207, s[58:59]
v_cndmask_b32 v204, v204, v220, s[64:65]
v_mfma_f32_16x16x32_bf16 v[156:159], v[152:155], v[136:139], 0
v_cndmask_b32 v205, v206, v222, s[66:67]
v_cvt_pk_bf16_f32 v220, v204, v205
v_mfma_f32_16x16x32_bf16 v[140:143], a[104:107], v[136:139], v[140:143]
v_lshlrev_b32 v204, 16, v220
v_and_b32 v205, 0xffff0000, v220
s_waitcnt vmcnt(8)
v_mfma_f32_16x16x32_bf16 v[64:67], a[208:211], a[192:195], v[64:67]
s_barrier
ds_read_b64_tr_b16 a[176:177], v20 offset:32768
v_mfma_f32_16x16x32_bf16 v[80:83], a[208:211], a[196:199], v[80:83]
ds_read_b64_tr_b16 a[178:179], v20 offset:33280
s_add_u32 m0, s24, 32768
v_mfma_f32_16x16x32_bf16 v[96:99], a[208:211], a[200:203], v[96:99]
buffer_load_dwordx4 v8, s[8:11], s28 offen offset:0 sc1 lds
v_mul_f32 v228, s32, v228
s_waitcnt lgkmcnt(2)
v_mfma_f32_16x16x32_bf16 v[112:115], a[208:211], a[204:207], v[112:115]
ds_read_b128 a[160:163], v2 offset:32768
v_mul_f32 v229, s32, v229
v_mfma_f32_16x16x32_bf16 v[116:119], a[212:215], a[204:207], v[116:119]
ds_read_b128 a[164:167], v2 offset:34816
v_cvt_pk_bf16_f32 v244, v228, v229
v_mfma_f32_16x16x32_bf16 v[100:103], a[212:215], a[200:203], v[100:103]
ds_read_b128 a[168:171], v2 offset:36864
v_lshlrev_b32 v228, 16, v244
v_mfma_f32_16x16x32_bf16 v[84:87], a[212:215], a[196:199], v[84:87]
buffer_load_dwordx4 v8, s[8:11], s28 offen offset:1024 sc1 lds
v_and_b32 v229, 0xffff0000, v244
v_mfma_f32_16x16x32_bf16 v[68:71], a[212:215], a[192:195], v[68:71]
ds_read_b128 a[172:175], v2 offset:38912
v_mul_f32 v236, s32, v236
v_mfma_f32_16x16x32_bf16 v[72:75], a[216:219], a[192:195], v[72:75]
ds_read_b64_tr_b16 a[180:181], v21 offset:32768
s_mul_i32 s29, s28, 224
v_mfma_f32_16x16x32_bf16 v[88:91], a[216:219], a[196:199], v[88:91]
ds_read_b64_tr_b16 a[182:183], v21 offset:33280
v_mul_f32 v237, s32, v237
v_mfma_f32_16x16x32_bf16 v[104:107], a[216:219], a[200:203], v[104:107]
buffer_load_dwordx4 v9, s[8:11], s28 offen offset:2048 sc1 lds
v_cvt_pk_bf16_f32 v252, v236, v237
v_mfma_f32_16x16x32_bf16 v[120:123], a[216:219], a[204:207], v[120:123]
ds_read_b64_tr_b16 a[184:185], v22 offset:32768
v_lshlrev_b32 v236, 16, v252
v_mfma_f32_16x16x32_bf16 v[124:127], a[220:223], a[204:207], v[124:127]
ds_read_b64_tr_b16 a[186:187], v22 offset:33280
v_and_b32 v237, 0xffff0000, v252
v_mfma_f32_16x16x32_bf16 v[108:111], a[220:223], a[200:203], v[108:111]
ds_read_b64_tr_b16 a[188:189], v23 offset:32768
v_mul_f32 v196, s32, v196
v_mfma_f32_16x16x32_bf16 v[92:95], a[220:223], a[196:199], v[92:95]
buffer_load_dwordx4 v9, s[8:11], s28 offen offset:3072 sc1 lds
v_mul_f32 v197, s32, v197
v_mfma_f32_16x16x32_bf16 v[76:79], a[220:223], a[192:195], v[76:79]
ds_read_b64_tr_b16 a[190:191], v23 offset:33280
v_cvt_pk_bf16_f32 v212, v196, v197
s_waitcnt lgkmcnt(4)
v_mfma_f32_16x16x32_bf16 v[64:67], a[176:179], a[160:163], v[64:67]
ds_read_b64_tr_b16 a[208:209], v20 offset:36864
v_lshlrev_b32 v196, 16, v212
v_mfma_f32_16x16x32_bf16 v[80:83], a[176:179], a[164:167], v[80:83]
ds_read_b64_tr_b16 a[210:211], v20 offset:37376
s_add_u32 m0, s25, 32768
v_mfma_f32_16x16x32_bf16 v[96:99], a[176:179], a[168:171], v[96:99]
buffer_load_dwordx4 v10, s[44:47], s29 offen offset:0 lds
v_and_b32 v197, 0xffff0000, v212
v_mfma_f32_16x16x32_bf16 v[112:115], a[176:179], a[172:175], v[112:115]
ds_read_b128 a[192:195], v2 offset:33792
v_mul_f32 v204, s32, v204
v_mfma_f32_16x16x32_bf16 v[116:119], a[180:183], a[172:175], v[116:119]
ds_read_b128 a[196:199], v2 offset:35840
s_add_u32 s31, s31, 1
v_mfma_f32_16x16x32_bf16 v[100:103], a[180:183], a[168:171], v[100:103]
ds_read_b128 a[200:203], v2 offset:37888
v_mul_f32 v205, s32, v205
v_mfma_f32_16x16x32_bf16 v[84:87], a[180:183], a[164:167], v[84:87]
buffer_load_dwordx4 v11, s[44:47], s29 offen offset:1024 lds
v_cvt_pk_bf16_f32 v220, v204, v205
v_mfma_f32_16x16x32_bf16 v[68:71], a[180:183], a[160:163], v[68:71]
ds_read_b128 a[204:207], v2 offset:39936
v_lshlrev_b32 v204, 16, v220
s_waitcnt lgkmcnt(4)
v_mfma_f32_16x16x32_bf16 v[72:75], a[184:187], a[160:163], v[72:75]
ds_read_b64_tr_b16 a[212:213], v21 offset:36864
v_readlane_b32 s28, v14, s31
v_mfma_f32_16x16x32_bf16 v[88:91], a[184:187], a[164:167], v[88:91]
ds_read_b64_tr_b16 a[214:215], v21 offset:37376
v_and_b32 v205, 0xffff0000, v220
v_mfma_f32_16x16x32_bf16 v[104:107], a[184:187], a[168:171], v[104:107]
buffer_load_dwordx4 v12, s[44:47], s29 offen offset:2048 lds
v_max_f32 v230, v228, v229
v_mfma_f32_16x16x32_bf16 v[120:123], a[184:187], a[172:175], v[120:123]
ds_read_b64_tr_b16 a[216:217], v22 offset:36864
v_max_f32 v238, v236, v237
v_mfma_f32_16x16x32_bf16 v[124:127], a[188:191], a[172:175], v[124:127]
ds_read_b64_tr_b16 a[218:219], v22 offset:37376
v_max_f32 v198, v196, v197
v_mfma_f32_16x16x32_bf16 v[108:111], a[188:191], a[168:171], v[108:111]
ds_read_b64_tr_b16 a[220:221], v23 offset:36864
v_max_f32 v206, v204, v205
v_mfma_f32_16x16x32_bf16 v[92:95], a[188:191], a[164:167], v[92:95]
buffer_load_dwordx4 v13, s[44:47], s29 offen offset:3072 lds
v_permlane16_swap_b32 v230, v238
v_mfma_f32_16x16x32_bf16 v[76:79], a[188:191], a[160:163], v[76:79]
ds_read_b64_tr_b16 a[222:223], v23 offset:37376
v_permlane16_swap_b32 v198, v206
s_waitcnt vmcnt(8) lgkmcnt(4)
v_mfma_f32_16x16x32_bf16 v[64:67], a[208:211], a[192:195], v[64:67]
s_barrier
ds_read_b64_tr_b16 a[176:177], v3 offset:0
v_mfma_f32_16x16x32_bf16 v[80:83], a[208:211], a[196:199], v[80:83]
ds_read_b64_tr_b16 a[178:179], v3 offset:512
s_add_u32 m0, s24, 65536
v_mfma_f32_16x16x32_bf16 v[96:99], a[208:211], a[200:203], v[96:99]
buffer_load_dwordx4 v8, s[8:11], s28 offen offset:0 sc1 lds
v_max_f32 v244, v230, v238
v_mfma_f32_16x16x32_bf16 v[112:115], a[208:211], a[204:207], v[112:115]
ds_read_b128 a[160:163], v7 offset:0
v_max_f32 v212, v198, v206
v_mfma_f32_16x16x32_bf16 v[116:119], a[212:215], a[204:207], v[116:119]
ds_read_b128 a[164:167], v7 offset:2048
v_permlane32_swap_b32 v244, v212
v_mfma_f32_16x16x32_bf16 v[100:103], a[212:215], a[200:203], v[100:103]
ds_read_b128 a[168:171], v7 offset:4096
v_max_f32 v244, v244, v212
v_mfma_f32_16x16x32_bf16 v[84:87], a[212:215], a[196:199], v[84:87]
buffer_load_dwordx4 v8, s[8:11], s28 offen offset:1024 sc1 lds
v_mul_f32 v230, s34, v244
v_mfma_f32_16x16x32_bf16 v[68:71], a[212:215], a[192:195], v[68:71]
ds_read_b128 a[172:175], v7 offset:6144
v_mul_f32 v198, s34, v244
s_waitcnt lgkmcnt(4)
v_mfma_f32_16x16x32_bf16 v[72:75], a[216:219], a[192:195], v[72:75]
ds_read_b64_tr_b16 a[180:181], v15 offset:0
s_mul_i32 s29, s28, 224
v_mfma_f32_16x16x32_bf16 v[88:91], a[216:219], a[196:199], v[88:91]
ds_read_b64_tr_b16 a[182:183], v15 offset:512
v_permlane32_swap_b32 v230, v198
v_mfma_f32_16x16x32_bf16 v[104:107], a[216:219], a[200:203], v[104:107]
buffer_load_dwordx4 v9, s[8:11], s28 offen offset:2048 sc1 lds
v_mov_b32 v238, v230
v_mfma_f32_16x16x32_bf16 v[120:123], a[216:219], a[204:207], v[120:123]
ds_read_b64_tr_b16 a[184:185], v5 offset:0
v_mov_b32 v206, v198
v_mfma_f32_16x16x32_bf16 v[124:127], a[220:223], a[204:207], v[124:127]
ds_read_b64_tr_b16 a[186:187], v5 offset:512
v_permlane16_swap_b32 v230, v238
v_mfma_f32_16x16x32_bf16 v[108:111], a[220:223], a[200:203], v[108:111]
ds_read_b64_tr_b16 a[188:189], v6 offset:0
v_permlane16_swap_b32 v198, v206
v_mfma_f32_16x16x32_bf16 v[92:95], a[220:223], a[196:199], v[92:95]
buffer_load_dwordx4 v9, s[8:11], s28 offen offset:3072 sc1 lds
v_fma_f32 v228, v228, s34, -v230
v_mfma_f32_16x16x32_bf16 v[76:79], a[220:223], a[192:195], v[76:79]
ds_read_b64_tr_b16 a[190:191], v6 offset:512
v_fma_f32 v229, v229, s34, -v230
s_waitcnt lgkmcnt(4)
v_mfma_f32_16x16x32_bf16 v[64:67], a[176:179], a[160:163], v[64:67]
ds_read_b64_tr_b16 a[208:209], v3 offset:4096
v_fma_f32 v236, v236, s34, -v238
v_mfma_f32_16x16x32_bf16 v[80:83], a[176:179], a[164:167], v[80:83]
ds_read_b64_tr_b16 a[210:211], v3 offset:4608
s_add_u32 m0, s25, 65536
v_mfma_f32_16x16x32_bf16 v[96:99], a[176:179], a[168:171], v[96:99]
buffer_load_dwordx4 v10, s[44:47], s29 offen offset:0 lds
v_fma_f32 v237, v237, s34, -v238
v_mfma_f32_16x16x32_bf16 v[112:115], a[176:179], a[172:175], v[112:115]
ds_read_b128 a[192:195], v7 offset:1024
v_fma_f32 v196, v196, s34, -v198
v_mfma_f32_16x16x32_bf16 v[116:119], a[180:183], a[172:175], v[116:119]
ds_read_b128 a[196:199], v7 offset:3072
s_add_u32 s31, s31, 1
v_mfma_f32_16x16x32_bf16 v[100:103], a[180:183], a[168:171], v[100:103]
ds_read_b128 a[200:203], v7 offset:5120
v_fma_f32 v197, v197, s34, -v198
v_mfma_f32_16x16x32_bf16 v[84:87], a[180:183], a[164:167], v[84:87]
buffer_load_dwordx4 v11, s[44:47], s29 offen offset:1024 lds
v_fma_f32 v204, v204, s34, -v206
v_mfma_f32_16x16x32_bf16 v[68:71], a[180:183], a[160:163], v[68:71]
ds_read_b128 a[204:207], v7 offset:7168
v_fma_f32 v205, v205, s34, -v206
s_waitcnt lgkmcnt(4)
v_mfma_f32_16x16x32_bf16 v[72:75], a[184:187], a[160:163], v[72:75]
ds_read_b64_tr_b16 a[212:213], v15 offset:4096
v_readlane_b32 s28, v14, s31
v_mfma_f32_16x16x32_bf16 v[88:91], a[184:187], a[164:167], v[88:91]
ds_read_b64_tr_b16 a[214:215], v15 offset:4608
v_exp_f32 v228, v228
v_mfma_f32_16x16x32_bf16 v[104:107], a[184:187], a[168:171], v[104:107]
buffer_load_dwordx4 v12, s[44:47], s29 offen offset:2048 lds
v_exp_f32 v229, v229
v_mfma_f32_16x16x32_bf16 v[120:123], a[184:187], a[172:175], v[120:123]
ds_read_b64_tr_b16 a[216:217], v5 offset:4096
v_exp_f32 v236, v236
v_mfma_f32_16x16x32_bf16 v[124:127], a[188:191], a[172:175], v[124:127]
ds_read_b64_tr_b16 a[218:219], v5 offset:4608
v_exp_f32 v237, v237
v_mfma_f32_16x16x32_bf16 v[108:111], a[188:191], a[168:171], v[108:111]
ds_read_b64_tr_b16 a[220:221], v6 offset:4096
v_exp_f32 v196, v196
v_mfma_f32_16x16x32_bf16 v[92:95], a[188:191], a[164:167], v[92:95]
buffer_load_dwordx4 v13, s[44:47], s29 offen offset:3072 lds
v_exp_f32 v197, v197
v_mfma_f32_16x16x32_bf16 v[76:79], a[188:191], a[160:163], v[76:79]
ds_read_b64_tr_b16 a[222:223], v6 offset:4608
v_exp_f32 v204, v204
s_waitcnt vmcnt(8) lgkmcnt(4)
v_mfma_f32_16x16x32_bf16 v[64:67], a[208:211], a[192:195], v[64:67]
s_barrier
ds_read_b64_tr_b16 a[176:177], v3 offset:32768
v_mfma_f32_16x16x32_bf16 v[80:83], a[208:211], a[196:199], v[80:83]
ds_read_b64_tr_b16 a[178:179], v3 offset:33280
s_add_u32 m0, s24, 98304
v_mfma_f32_16x16x32_bf16 v[96:99], a[208:211], a[200:203], v[96:99]
buffer_load_dwordx4 v8, s[8:11], s28 offen offset:0 sc1 lds
v_exp_f32 v205, v205
v_mfma_f32_16x16x32_bf16 v[112:115], a[208:211], a[204:207], v[112:115]
ds_read_b128 a[160:163], v7 offset:32768
v_add_f32 v230, v228, v229
v_mfma_f32_16x16x32_bf16 v[116:119], a[212:215], a[204:207], v[116:119]
ds_read_b128 a[164:167], v7 offset:34816
v_add_f32 v238, v236, v237
v_mfma_f32_16x16x32_bf16 v[100:103], a[212:215], a[200:203], v[100:103]
ds_read_b128 a[168:171], v7 offset:36864
v_add_f32 v198, v196, v197
v_mfma_f32_16x16x32_bf16 v[84:87], a[212:215], a[196:199], v[84:87]
buffer_load_dwordx4 v8, s[8:11], s28 offen offset:1024 sc1 lds
v_add_f32 v206, v204, v205
v_mfma_f32_16x16x32_bf16 v[68:71], a[212:215], a[192:195], v[68:71]
ds_read_b128 a[172:175], v7 offset:38912
v_permlane16_swap_b32 v230, v238
s_waitcnt lgkmcnt(4)
v_mfma_f32_16x16x32_bf16 v[72:75], a[216:219], a[192:195], v[72:75]
ds_read_b64_tr_b16 a[180:181], v15 offset:32768
s_mul_i32 s29, s28, 224
v_mfma_f32_16x16x32_bf16 v[88:91], a[216:219], a[196:199], v[88:91]
ds_read_b64_tr_b16 a[182:183], v15 offset:33280
v_permlane16_swap_b32 v198, v206
v_mfma_f32_16x16x32_bf16 v[104:107], a[216:219], a[200:203], v[104:107]
buffer_load_dwordx4 v9, s[8:11], s28 offen offset:2048 sc1 lds
v_add_f32 v244, v230, v238
v_mfma_f32_16x16x32_bf16 v[120:123], a[216:219], a[204:207], v[120:123]
ds_read_b64_tr_b16 a[184:185], v5 offset:32768
v_add_f32 v212, v198, v206
v_mfma_f32_16x16x32_bf16 v[124:127], a[220:223], a[204:207], v[124:127]
ds_read_b64_tr_b16 a[186:187], v5 offset:33280
v_permlane32_swap_b32 v244, v212
v_mfma_f32_16x16x32_bf16 v[108:111], a[220:223], a[200:203], v[108:111]
ds_read_b64_tr_b16 a[188:189], v6 offset:32768
v_add_f32 v244, v244, v212
v_mfma_f32_16x16x32_bf16 v[92:95], a[220:223], a[196:199], v[92:95]
buffer_load_dwordx4 v9, s[8:11], s28 offen offset:3072 sc1 lds
v_rcp_f32 v230, v244
v_mfma_f32_16x16x32_bf16 v[76:79], a[220:223], a[192:195], v[76:79]
ds_read_b64_tr_b16 a[190:191], v6 offset:33280
v_mov_b32 v198, v230
s_waitcnt lgkmcnt(4)
v_mfma_f32_16x16x32_bf16 v[64:67], a[176:179], a[160:163], v[64:67]
ds_read_b64_tr_b16 a[208:209], v3 offset:36864
v_permlane32_swap_b32 v230, v198
v_mfma_f32_16x16x32_bf16 v[80:83], a[176:179], a[164:167], v[80:83]
ds_read_b64_tr_b16 a[210:211], v3 offset:37376
s_add_u32 m0, s25, 98304
v_mfma_f32_16x16x32_bf16 v[96:99], a[176:179], a[168:171], v[96:99]
buffer_load_dwordx4 v10, s[44:47], s29 offen offset:0 lds
v_mov_b32 v238, v230
v_mfma_f32_16x16x32_bf16 v[112:115], a[176:179], a[172:175], v[112:115]
ds_read_b128 a[192:195], v7 offset:33792
v_mov_b32 v206, v198
v_mfma_f32_16x16x32_bf16 v[116:119], a[180:183], a[172:175], v[116:119]
ds_read_b128 a[196:199], v7 offset:35840
s_add_u32 s31, s31, 1
v_mfma_f32_16x16x32_bf16 v[100:103], a[180:183], a[168:171], v[100:103]
ds_read_b128 a[200:203], v7 offset:37888
v_permlane16_swap_b32 v230, v238
v_mfma_f32_16x16x32_bf16 v[84:87], a[180:183], a[164:167], v[84:87]
buffer_load_dwordx4 v11, s[44:47], s29 offen offset:1024 lds
v_permlane16_swap_b32 v198, v206
v_mfma_f32_16x16x32_bf16 v[68:71], a[180:183], a[160:163], v[68:71]
ds_read_b128 a[204:207], v7 offset:39936
v_mul_f32 v228, v228, v230
s_waitcnt lgkmcnt(4)
v_mfma_f32_16x16x32_bf16 v[72:75], a[184:187], a[160:163], v[72:75]
ds_read_b64_tr_b16 a[212:213], v15 offset:36864
v_readlane_b32 s28, v14, s31
v_mfma_f32_16x16x32_bf16 v[88:91], a[184:187], a[164:167], v[88:91]
ds_read_b64_tr_b16 a[214:215], v15 offset:37376
v_mul_f32 v229, v229, v230
v_mfma_f32_16x16x32_bf16 v[104:107], a[184:187], a[168:171], v[104:107]
buffer_load_dwordx4 v12, s[44:47], s29 offen offset:2048 lds
v_cvt_pk_bf16_f32 v228, v228, v229
v_mfma_f32_16x16x32_bf16 v[120:123], a[184:187], a[172:175], v[120:123]
ds_read_b64_tr_b16 a[216:217], v5 offset:36864
v_mul_f32 v236, v236, v238
v_mfma_f32_16x16x32_bf16 v[124:127], a[188:191], a[172:175], v[124:127]
ds_read_b64_tr_b16 a[218:219], v5 offset:37376
v_mul_f32 v237, v237, v238
v_mfma_f32_16x16x32_bf16 v[108:111], a[188:191], a[168:171], v[108:111]
ds_read_b64_tr_b16 a[220:221], v6 offset:36864
v_cvt_pk_bf16_f32 v236, v236, v237
v_mfma_f32_16x16x32_bf16 v[92:95], a[188:191], a[164:167], v[92:95]
buffer_load_dwordx4 v13, s[44:47], s29 offen offset:3072 lds
v_mul_f32 v196, v196, v198
v_mfma_f32_16x16x32_bf16 v[76:79], a[188:191], a[160:163], v[76:79]
ds_read_b64_tr_b16 a[222:223], v6 offset:37376
v_mul_f32 v197, v197, v198
s_waitcnt vmcnt(8) lgkmcnt(4)
v_mfma_f32_16x16x32_bf16 v[64:67], a[208:211], a[192:195], v[64:67]
s_barrier
ds_read_b64_tr_b16 a[176:177], v20 offset:0
v_mfma_f32_16x16x32_bf16 v[80:83], a[208:211], a[196:199], v[80:83]
ds_read_b64_tr_b16 a[178:179], v20 offset:512
s_add_u32 m0, s24, 0
v_mfma_f32_16x16x32_bf16 v[96:99], a[208:211], a[200:203], v[96:99]
buffer_load_dwordx4 v8, s[8:11], s28 offen offset:0 sc1 lds
v_cvt_pk_bf16_f32 v196, v196, v197
v_mfma_f32_16x16x32_bf16 v[112:115], a[208:211], a[204:207], v[112:115]
ds_read_b128 a[160:163], v2 offset:0
v_mul_f32 v204, v204, v206
v_mfma_f32_16x16x32_bf16 v[116:119], a[212:215], a[204:207], v[116:119]
ds_read_b128 a[164:167], v2 offset:2048
v_mul_f32 v205, v205, v206
v_mfma_f32_16x16x32_bf16 v[100:103], a[212:215], a[200:203], v[100:103]
ds_read_b128 a[168:171], v2 offset:4096
v_cvt_pk_bf16_f32 v204, v204, v205
v_mfma_f32_16x16x32_bf16 v[84:87], a[212:215], a[196:199], v[84:87]
buffer_load_dwordx4 v8, s[8:11], s28 offen offset:1024 sc1 lds
v_perm_b32 v244, v228, v228, v16
v_mfma_f32_16x16x32_bf16 v[68:71], a[212:215], a[192:195], v[68:71]
ds_read_b128 a[172:175], v2 offset:6144
v_perm_b32 v245, v228, v228, v17
s_waitcnt lgkmcnt(4)
v_mfma_f32_16x16x32_bf16 v[72:75], a[216:219], a[192:195], v[72:75]
ds_read_b64_tr_b16 a[180:181], v21 offset:0
s_mul_i32 s29, s28, 224
v_mfma_f32_16x16x32_bf16 v[88:91], a[216:219], a[196:199], v[88:91]
ds_read_b64_tr_b16 a[182:183], v21 offset:512
v_perm_b32 v246, v228, v228, v18
v_mfma_f32_16x16x32_bf16 v[104:107], a[216:219], a[200:203], v[104:107]
buffer_load_dwordx4 v9, s[8:11], s28 offen offset:2048 sc1 lds
v_perm_b32 v247, v228, v228, v19
v_mfma_f32_16x16x32_bf16 v[120:123], a[216:219], a[204:207], v[120:123]
ds_read_b64_tr_b16 a[184:185], v22 offset:0
v_perm_b32 v252, v236, v236, v16
v_mfma_f32_16x16x32_bf16 v[124:127], a[220:223], a[204:207], v[124:127]
ds_read_b64_tr_b16 a[186:187], v22 offset:512
v_perm_b32 v253, v236, v236, v17
v_mfma_f32_16x16x32_bf16 v[108:111], a[220:223], a[200:203], v[108:111]
ds_read_b64_tr_b16 a[188:189], v23 offset:0
v_perm_b32 v254, v236, v236, v18
v_mfma_f32_16x16x32_bf16 v[92:95], a[220:223], a[196:199], v[92:95]
buffer_load_dwordx4 v9, s[8:11], s28 offen offset:3072 sc1 lds
v_perm_b32 v255, v236, v236, v19
v_mfma_f32_16x16x32_bf16 v[224:227], v[30:33], v[244:247], 0
v_perm_b32 v212, v196, v196, v16
v_perm_b32 v213, v196, v196, v17
v_mfma_f32_16x16x32_bf16 v[228:231], v[40:43], v[244:247], 0
v_perm_b32 v214, v196, v196, v18
v_perm_b32 v215, v196, v196, v19
v_mfma_f32_16x16x32_bf16 v[232:235], v[50:53], v[252:255], 0
v_perm_b32 v220, v204, v204, v16
v_perm_b32 v221, v204, v204, v17
v_mfma_f32_16x16x32_bf16 v[236:239], v[60:63], v[252:255], 0
v_perm_b32 v222, v204, v204, v18
v_perm_b32 v223, v204, v204, v19
v_mfma_f32_16x16x32_bf16 v[192:195], v[28:31], v[212:215], 0
v_cvt_pk_bf16_f32 v224, v224, v225
v_cvt_pk_bf16_f32 v225, v226, v227
v_mfma_f32_16x16x32_bf16 v[196:199], v[38:41], v[212:215], 0
v_cvt_pk_bf16_f32 v226, v228, v229
v_cvt_pk_bf16_f32 v227, v230, v231
v_mfma_f32_16x16x32_bf16 v[200:203], v[48:51], v[220:223], 0
v_mfma_f32_16x16x32_bf16 v[204:207], v[58:61], v[220:223], 0
v_cvt_pk_bf16_f32 v232, v232, v233
v_cvt_pk_bf16_f32 v233, v234, v235
v_mfma_f32_16x16x32_bf16 v[76:79], a[220:223], a[192:195], v[76:79]
ds_read_b64_tr_b16 a[190:191], v23 offset:512
v_cvt_pk_bf16_f32 v234, v236, v237
s_waitcnt lgkmcnt(1)
v_mfma_f32_16x16x32_bf16 v[64:67], a[176:179], a[160:163], v[64:67]
ds_read_b64_tr_b16 a[208:209], v20 offset:4096
v_cvt_pk_bf16_f32 v235, v238, v239
v_mfma_f32_16x16x32_bf16 v[80:83], a[176:179], a[164:167], v[80:83]
ds_read_b64_tr_b16 a[210:211], v20 offset:4608
s_add_u32 m0, s25, 0
v_mfma_f32_16x16x32_bf16 v[96:99], a[176:179], a[168:171], v[96:99]
buffer_load_dwordx4 v10, s[44:47], s29 offen offset:0 lds
v_cvt_pk_bf16_f32 v192, v192, v193
v_mfma_f32_16x16x32_bf16 v[112:115], a[176:179], a[172:175], v[112:115]
ds_read_b128 a[192:195], v2 offset:1024
v_cvt_pk_bf16_f32 v193, v194, v195
v_mfma_f32_16x16x32_bf16 v[116:119], a[180:183], a[172:175], v[116:119]
ds_read_b128 a[196:199], v2 offset:3072
s_add_u32 s31, s31, 1
v_mfma_f32_16x16x32_bf16 v[100:103], a[180:183], a[168:171], v[100:103]
ds_read_b128 a[200:203], v2 offset:5120
v_cvt_pk_bf16_f32 v194, v196, v197
v_mfma_f32_16x16x32_bf16 v[84:87], a[180:183], a[164:167], v[84:87]
buffer_load_dwordx4 v11, s[44:47], s29 offen offset:1024 lds
v_cvt_pk_bf16_f32 v195, v198, v199
v_mfma_f32_16x16x32_bf16 v[68:71], a[180:183], a[160:163], v[68:71]
ds_read_b128 a[204:207], v2 offset:7168
v_cvt_pk_bf16_f32 v200, v200, v201
v_mfma_f32_16x16x32_bf16 v[72:75], a[184:187], a[160:163], v[72:75]
ds_read_b64_tr_b16 a[212:213], v21 offset:4096
v_readlane_b32 s28, v14, s31
v_mfma_f32_16x16x32_bf16 v[88:91], a[184:187], a[164:167], v[88:91]
ds_read_b64_tr_b16 a[214:215], v21 offset:4608
v_cvt_pk_bf16_f32 v201, v202, v203
v_mfma_f32_16x16x32_bf16 v[104:107], a[184:187], a[168:171], v[104:107]
buffer_load_dwordx4 v12, s[44:47], s29 offen offset:2048 lds
v_cvt_pk_bf16_f32 v202, v204, v205
v_mfma_f32_16x16x32_bf16 v[120:123], a[184:187], a[172:175], v[120:123]
ds_read_b64_tr_b16 a[216:217], v22 offset:4096
v_cvt_pk_bf16_f32 v203, v206, v207
s_waitcnt lgkmcnt(4)
v_mfma_f32_16x16x32_bf16 v[124:127], a[188:191], a[172:175], v[124:127]
ds_read_b64_tr_b16 a[218:219], v22 offset:4608
v_cndmask_b32 v180, v180, v181, s[58:59]
v_mfma_f32_16x16x32_bf16 v[108:111], a[188:191], a[168:171], v[108:111]
ds_read_b64_tr_b16 a[220:221], v23 offset:4096
v_cndmask_b32 v182, v182, v183, s[58:59]
v_mfma_f32_16x16x32_bf16 v[92:95], a[188:191], a[164:167], v[92:95]
buffer_load_dwordx4 v13, s[44:47], s29 offen offset:3072 lds
v_cndmask_b32 v164, v164, v165, s[58:59]
v_mfma_f32_16x16x32_bf16 v[76:79], a[188:191], a[160:163], v[76:79]
ds_read_b64_tr_b16 a[222:223], v23 offset:4608
v_cndmask_b32 v166, v166, v167, s[58:59]
s_waitcnt vmcnt(8)
v_mfma_f32_16x16x32_bf16 v[64:67], a[208:211], a[192:195], v[64:67]
s_barrier
ds_read_b64_tr_b16 a[176:177], v20 offset:32768
v_mfma_f32_16x16x32_bf16 v[80:83], a[208:211], a[196:199], v[80:83]
ds_read_b64_tr_b16 a[178:179], v20 offset:33280
s_add_u32 m0, s24, 32768
v_mfma_f32_16x16x32_bf16 v[96:99], a[208:211], a[200:203], v[96:99]
buffer_load_dwordx4 v8, s[8:11], s28 offen offset:0 sc1 lds
v_cndmask_b32 v164, v164, v180, s[64:65]
s_waitcnt lgkmcnt(3)
v_mfma_f32_16x16x32_bf16 v[112:115], a[208:211], a[204:207], v[112:115]
ds_read_b128 a[160:163], v2 offset:32768
v_cndmask_b32 v165, v166, v182, s[66:67]
v_mfma_f32_16x16x32_bf16 v[116:119], a[212:215], a[204:207], v[116:119]
ds_read_b128 a[164:167], v2 offset:34816
v_cvt_pk_bf16_f32 v180, v164, v165
v_mfma_f32_16x16x32_bf16 v[100:103], a[212:215], a[200:203], v[100:103]
ds_read_b128 a[168:171], v2 offset:36864
v_lshlrev_b32 v164, 16, v180
v_mfma_f32_16x16x32_bf16 v[84:87], a[212:215], a[196:199], v[84:87]
buffer_load_dwordx4 v8, s[8:11], s28 offen offset:1024 sc1 lds
v_and_b32 v165, 0xffff0000, v180
v_mfma_f32_16x16x32_bf16 v[68:71], a[212:215], a[192:195], v[68:71]
ds_read_b128 a[172:175], v2 offset:38912
v_cndmask_b32 v188, v188, v189, s[58:59]
v_mfma_f32_16x16x32_bf16 v[72:75], a[216:219], a[192:195], v[72:75]
ds_read_b64_tr_b16 a[180:181], v21 offset:32768
s_mul_i32 s29, s28, 224
v_mfma_f32_16x16x32_bf16 v[88:91], a[216:219], a[196:199], v[88:91]
ds_read_b64_tr_b16 a[182:183], v21 offset:33280
v_cndmask_b32 v190, v190, v191, s[58:59]
v_mfma_f32_16x16x32_bf16 v[104:107], a[216:219], a[200:203], v[104:107]
buffer_load_dwordx4 v9, s[8:11], s28 offen offset:2048 sc1 lds
v_cndmask_b32 v172, v172, v173, s[58:59]
v_mfma_f32_16x16x32_bf16 v[120:123], a[216:219], a[204:207], v[120:123]
ds_read_b64_tr_b16 a[184:185], v22 offset:32768
v_cndmask_b32 v174, v174, v175, s[58:59]
s_waitcnt lgkmcnt(4)
v_mfma_f32_16x16x32_bf16 v[124:127], a[220:223], a[204:207], v[124:127]
ds_read_b64_tr_b16 a[186:187], v22 offset:33280
v_cndmask_b32 v172, v172, v188, s[64:65]
v_mfma_f32_16x16x32_bf16 v[108:111], a[220:223], a[200:203], v[108:111]
ds_read_b64_tr_b16 a[188:189], v23 offset:32768
v_cndmask_b32 v173, v174, v190, s[66:67]
v_mfma_f32_16x16x32_bf16 v[92:95], a[220:223], a[196:199], v[92:95]
buffer_load_dwordx4 v9, s[8:11], s28 offen offset:3072 sc1 lds
v_cvt_pk_bf16_f32 v188, v172, v173
v_mfma_f32_16x16x32_bf16 v[76:79], a[220:223], a[192:195], v[76:79]
ds_read_b64_tr_b16 a[190:191], v23 offset:33280
v_lshlrev_b32 v172, 16, v188
v_mfma_f32_16x16x32_bf16 v[64:67], a[176:179], a[160:163], v[64:67]
ds_read_b64_tr_b16 a[208:209], v20 offset:36864
v_and_b32 v173, 0xffff0000, v188
v_mfma_f32_16x16x32_bf16 v[80:83], a[176:179], a[164:167], v[80:83]
ds_read_b64_tr_b16 a[210:211], v20 offset:37376
s_add_u32 m0, s25, 32768
v_mfma_f32_16x16x32_bf16 v[96:99], a[176:179], a[168:171], v[96:99]
buffer_load_dwordx4 v10, s[44:47], s29 offen offset:0 lds
v_cndmask_b32 v148, v148, v149, s[58:59]
s_waitcnt lgkmcnt(3)
v_mfma_f32_16x16x32_bf16 v[112:115], a[176:179], a[172:175], v[112:115]
ds_read_b128 a[192:195], v2 offset:33792
v_cndmask_b32 v150, v150, v151, s[58:59]
v_mfma_f32_16x16x32_bf16 v[116:119], a[180:183], a[172:175], v[116:119]
ds_read_b128 a[196:199], v2 offset:35840
s_add_u32 s31, s31, 1
v_mfma_f32_16x16x32_bf16 v[100:103], a[180:183], a[168:171], v[100:103]
ds_read_b128 a[200:203], v2 offset:37888
v_cndmask_b32 v132, v132, v133, s[58:59]
v_mfma_f32_16x16x32_bf16 v[84:87], a[180:183], a[164:167], v[84:87]
buffer_load_dwordx4 v11, s[44:47], s29 offen offset:1024 lds
v_cndmask_b32 v134, v134, v135, s[58:59]
v_mfma_f32_16x16x32_bf16 v[68:71], a[180:183], a[160:163], v[68:71]
ds_read_b128 a[204:207], v2 offset:39936
v_cndmask_b32 v132, v132, v148, s[64:65]
v_mfma_f32_16x16x32_bf16 v[72:75], a[184:187], a[160:163], v[72:75]
ds_read_b64_tr_b16 a[212:213], v21 offset:36864
v_readlane_b32 s28, v14, s31
v_mfma_f32_16x16x32_bf16 v[88:91], a[184:187], a[164:167], v[88:91]
ds_read_b64_tr_b16 a[214:215], v21 offset:37376
v_cndmask_b32 v133, v134, v150, s[66:67]
v_mfma_f32_16x16x32_bf16 v[104:107], a[184:187], a[168:171], v[104:107]
buffer_load_dwordx4 v12, s[44:47], s29 offen offset:2048 lds
v_cvt_pk_bf16_f32 v148, v132, v133
v_mfma_f32_16x16x32_bf16 v[120:123], a[184:187], a[172:175], v[120:123]
ds_read_b64_tr_b16 a[216:217], v22 offset:36864
v_lshlrev_b32 v132, 16, v148
s_waitcnt lgkmcnt(4)
v_mfma_f32_16x16x32_bf16 v[124:127], a[188:191], a[172:175], v[124:127]
ds_read_b64_tr_b16 a[218:219], v22 offset:37376
v_and_b32 v133, 0xffff0000, v148
v_mfma_f32_16x16x32_bf16 v[108:111], a[188:191], a[168:171], v[108:111]
ds_read_b64_tr_b16 a[220:221], v23 offset:36864
v_cndmask_b32 v156, v156, v157, s[58:59]
v_mfma_f32_16x16x32_bf16 v[92:95], a[188:191], a[164:167], v[92:95]
buffer_load_dwordx4 v13, s[44:47], s29 offen offset:3072 lds
v_cndmask_b32 v158, v158, v159, s[58:59]
v_mfma_f32_16x16x32_bf16 v[76:79], a[188:191], a[160:163], v[76:79]
ds_read_b64_tr_b16 a[222:223], v23 offset:37376
v_cndmask_b32 v140, v140, v141, s[58:59]
s_waitcnt vmcnt(8)
v_mfma_f32_16x16x32_bf16 v[64:67], a[208:211], a[192:195], v[64:67]
s_barrier
ds_read_b64_tr_b16 a[176:177], v3 offset:0
v_mfma_f32_16x16x32_bf16 v[80:83], a[208:211], a[196:199], v[80:83]
ds_read_b64_tr_b16 a[178:179], v3 offset:512
s_add_u32 m0, s24, 65536
v_mfma_f32_16x16x32_bf16 v[96:99], a[208:211], a[200:203], v[96:99]
buffer_load_dwordx4 v8, s[8:11], s28 offen offset:0 sc1 lds
v_cndmask_b32 v142, v142, v143, s[58:59]
s_waitcnt lgkmcnt(3)
v_mfma_f32_16x16x32_bf16 v[112:115], a[208:211], a[204:207], v[112:115]
ds_read_b128 a[160:163], v7 offset:0
v_cndmask_b32 v140, v140, v156, s[64:65]
v_mfma_f32_16x16x32_bf16 v[116:119], a[212:215], a[204:207], v[116:119]
ds_read_b128 a[164:167], v7 offset:2048
v_cndmask_b32 v141, v142, v158, s[66:67]
v_mfma_f32_16x16x32_bf16 v[100:103], a[212:215], a[200:203], v[100:103]
ds_read_b128 a[168:171], v7 offset:4096
v_cvt_pk_bf16_f32 v156, v140, v141
v_mfma_f32_16x16x32_bf16 v[84:87], a[212:215], a[196:199], v[84:87]
buffer_load_dwordx4 v8, s[8:11], s28 offen offset:1024 sc1 lds
v_lshlrev_b32 v140, 16, v156
v_mfma_f32_16x16x32_bf16 v[68:71], a[212:215], a[192:195], v[68:71]
ds_read_b128 a[172:175], v7 offset:6144
v_and_b32 v141, 0xffff0000, v156
v_mfma_f32_16x16x32_bf16 v[72:75], a[216:219], a[192:195], v[72:75]
ds_read_b64_tr_b16 a[180:181], v15 offset:0
s_mul_i32 s29, s28, 224
v_mfma_f32_16x16x32_bf16 v[88:91], a[216:219], a[196:199], v[88:91]
ds_read_b64_tr_b16 a[182:183], v15 offset:512
v_mul_f32 v164, s32, v164
v_mfma_f32_16x16x32_bf16 v[104:107], a[216:219], a[200:203], v[104:107]
buffer_load_dwordx4 v9, s[8:11], s28 offen offset:2048 sc1 lds
v_mul_f32 v165, s32, v165
v_mfma_f32_16x16x32_bf16 v[120:123], a[216:219], a[204:207], v[120:123]
ds_read_b64_tr_b16 a[184:185], v5 offset:0
v_cvt_pk_bf16_f32 v180, v164, v165
s_waitcnt lgkmcnt(4)
v_mfma_f32_16x16x32_bf16 v[124:127], a[220:223], a[204:207], v[124:127]
ds_read_b64_tr_b16 a[186:187], v5 offset:512
v_lshlrev_b32 v164, 16, v180
v_mfma_f32_16x16x32_bf16 v[108:111], a[220:223], a[200:203], v[108:111]
ds_read_b64_tr_b16 a[188:189], v6 offset:0
v_and_b32 v165, 0xffff0000, v180
v_mfma_f32_16x16x32_bf16 v[92:95], a[220:223], a[196:199], v[92:95]
buffer_load_dwordx4 v9, s[8:11], s28 offen offset:3072 sc1 lds
v_mul_f32 v172, s32, v172
v_mfma_f32_16x16x32_bf16 v[76:79], a[220:223], a[192:195], v[76:79]
ds_read_b64_tr_b16 a[190:191], v6 offset:512
v_mul_f32 v173, s32, v173
v_mfma_f32_16x16x32_bf16 v[64:67], a[176:179], a[160:163], v[64:67]
ds_read_b64_tr_b16 a[208:209], v3 offset:4096
v_cvt_pk_bf16_f32 v188, v172, v173
v_mfma_f32_16x16x32_bf16 v[80:83], a[176:179], a[164:167], v[80:83]
ds_read_b64_tr_b16 a[210:211], v3 offset:4608
s_add_u32 m0, s25, 65536
v_mfma_f32_16x16x32_bf16 v[96:99], a[176:179], a[168:171], v[96:99]
buffer_load_dwordx4 v10, s[44:47], s29 offen offset:0 lds
v_lshlrev_b32 v172, 16, v188
s_waitcnt lgkmcnt(3)
v_mfma_f32_16x16x32_bf16 v[112:115], a[176:179], a[172:175], v[112:115]
ds_read_b128 a[192:195], v7 offset:1024
v_and_b32 v173, 0xffff0000, v188
v_mfma_f32_16x16x32_bf16 v[116:119], a[180:183], a[172:175], v[116:119]
ds_read_b128 a[196:199], v7 offset:3072
s_add_u32 s31, s31, 1
v_mfma_f32_16x16x32_bf16 v[100:103], a[180:183], a[168:171], v[100:103]
ds_read_b128 a[200:203], v7 offset:5120
v_mul_f32 v132, s32, v132
v_mfma_f32_16x16x32_bf16 v[84:87], a[180:183], a[164:167], v[84:87]
buffer_load_dwordx4 v11, s[44:47], s29 offen offset:1024 lds
v_mul_f32 v133, s32, v133
v_mfma_f32_16x16x32_bf16 v[68:71], a[180:183], a[160:163], v[68:71]
ds_read_b128 a[204:207], v7 offset:7168
v_cvt_pk_bf16_f32 v148, v132, v133
v_mfma_f32_16x16x32_bf16 v[72:75], a[184:187], a[160:163], v[72:75]
ds_read_b64_tr_b16 a[212:213], v15 offset:4096
v_readlane_b32 s28, v14, s31
v_mfma_f32_16x16x32_bf16 v[88:91], a[184:187], a[164:167], v[88:91]
ds_read_b64_tr_b16 a[214:215], v15 offset:4608
v_lshlrev_b32 v132, 16, v148
v_mfma_f32_16x16x32_bf16 v[104:107], a[184:187], a[168:171], v[104:107]
buffer_load_dwordx4 v12, s[44:47], s29 offen offset:2048 lds
buffer_store_dwordx4 v[224:227], v4, s[16:19], s23 offen offset:0 sc1
v_mfma_f32_16x16x32_bf16 v[120:123], a[184:187], a[172:175], v[120:123]
ds_read_b64_tr_b16 a[216:217], v5 offset:4096
v_and_b32 v133, 0xffff0000, v148
s_waitcnt lgkmcnt(4)
v_mfma_f32_16x16x32_bf16 v[124:127], a[188:191], a[172:175], v[124:127]
ds_read_b64_tr_b16 a[218:219], v5 offset:4608
v_mul_f32 v140, s32, v140
v_mfma_f32_16x16x32_bf16 v[108:111], a[188:191], a[168:171], v[108:111]
ds_read_b64_tr_b16 a[220:221], v6 offset:4096
v_mul_f32 v141, s32, v141
v_mfma_f32_16x16x32_bf16 v[92:95], a[188:191], a[164:167], v[92:95]
buffer_load_dwordx4 v13, s[44:47], s29 offen offset:3072 lds
v_cvt_pk_bf16_f32 v156, v140, v141
v_mfma_f32_16x16x32_bf16 v[76:79], a[188:191], a[160:163], v[76:79]
ds_read_b64_tr_b16 a[222:223], v6 offset:4608
v_lshlrev_b32 v140, 16, v156
s_waitcnt vmcnt(9)
v_mfma_f32_16x16x32_bf16 v[64:67], a[208:211], a[192:195], v[64:67]
s_barrier
ds_read_b64_tr_b16 a[176:177], v3 offset:32768
v_mfma_f32_16x16x32_bf16 v[80:83], a[208:211], a[196:199], v[80:83]
ds_read_b64_tr_b16 a[178:179], v3 offset:33280
s_add_u32 m0, s24, 98304
v_mfma_f32_16x16x32_bf16 v[96:99], a[208:211], a[200:203], v[96:99]
buffer_load_dwordx4 v8, s[8:11], s28 offen offset:0 sc1 lds
v_and_b32 v141, 0xffff0000, v156
s_waitcnt lgkmcnt(3)
v_mfma_f32_16x16x32_bf16 v[112:115], a[208:211], a[204:207], v[112:115]
ds_read_b128 a[160:163], v7 offset:32768
v_max_f32 v166, v164, v165
v_mfma_f32_16x16x32_bf16 v[116:119], a[212:215], a[204:207], v[116:119]
ds_read_b128 a[164:167], v7 offset:34816
v_max_f32 v174, v172, v173
v_mfma_f32_16x16x32_bf16 v[100:103], a[212:215], a[200:203], v[100:103]
ds_read_b128 a[168:171], v7 offset:36864
v_max_f32 v134, v132, v133
v_mfma_f32_16x16x32_bf16 v[84:87], a[212:215], a[196:199], v[84:87]
buffer_load_dwordx4 v8, s[8:11], s28 offen offset:1024 sc1 lds
v_max_f32 v142, v140, v141
v_mfma_f32_16x16x32_bf16 v[68:71], a[212:215], a[192:195], v[68:71]
ds_read_b128 a[172:175], v7 offset:38912
v_permlane16_swap_b32 v166, v174
v_mfma_f32_16x16x32_bf16 v[72:75], a[216:219], a[192:195], v[72:75]
ds_read_b64_tr_b16 a[180:181], v15 offset:32768
s_mul_i32 s29, s28, 224
v_mfma_f32_16x16x32_bf16 v[88:91], a[216:219], a[196:199], v[88:91]
ds_read_b64_tr_b16 a[182:183], v15 offset:33280
v_permlane16_swap_b32 v134, v142
v_mfma_f32_16x16x32_bf16 v[104:107], a[216:219], a[200:203], v[104:107]
buffer_load_dwordx4 v9, s[8:11], s28 offen offset:2048 sc1 lds
v_max_f32 v180, v166, v174
v_mfma_f32_16x16x32_bf16 v[120:123], a[216:219], a[204:207], v[120:123]
ds_read_b64_tr_b16 a[184:185], v5 offset:32768
v_max_f32 v148, v134, v142
s_waitcnt lgkmcnt(4)
v_mfma_f32_16x16x32_bf16 v[124:127], a[220:223], a[204:207], v[124:127]
ds_read_b64_tr_b16 a[186:187], v5 offset:33280
v_permlane32_swap_b32 v180, v148
v_mfma_f32_16x16x32_bf16 v[108:111], a[220:223], a[200:203], v[108:111]
ds_read_b64_tr_b16 a[188:189], v6 offset:32768
v_max_f32 v180, v180, v148
v_mfma_f32_16x16x32_bf16 v[92:95], a[220:223], a[196:199], v[92:95]
buffer_load_dwordx4 v9, s[8:11], s28 offen offset:3072 sc1 lds
v_mul_f32 v166, s34, v180
v_mfma_f32_16x16x32_bf16 v[76:79], a[220:223], a[192:195], v[76:79]
ds_read_b64_tr_b16 a[190:191], v6 offset:33280
v_mul_f32 v134, s34, v180
v_mfma_f32_16x16x32_bf16 v[64:67], a[176:179], a[160:163], v[64:67]
ds_read_b64_tr_b16 a[208:209], v3 offset:36864
v_permlane32_swap_b32 v166, v134
v_mfma_f32_16x16x32_bf16 v[80:83], a[176:179], a[164:167], v[80:83]
ds_read_b64_tr_b16 a[210:211], v3 offset:37376
s_add_u32 m0, s25, 98304
v_mfma_f32_16x16x32_bf16 v[96:99], a[176:179], a[168:171], v[96:99]
buffer_load_dwordx4 v10, s[44:47], s29 offen offset:0 lds
v_mov_b32 v174, v166
s_waitcnt lgkmcnt(3)
v_mfma_f32_16x16x32_bf16 v[112:115], a[176:179], a[172:175], v[112:115]
ds_read_b128 a[192:195], v7 offset:33792
v_mov_b32 v142, v134
v_mfma_f32_16x16x32_bf16 v[116:119], a[180:183], a[172:175], v[116:119]
ds_read_b128 a[196:199], v7 offset:35840
s_add_u32 s31, s31, 1
v_mfma_f32_16x16x32_bf16 v[100:103], a[180:183], a[168:171], v[100:103]
ds_read_b128 a[200:203], v7 offset:37888
v_permlane16_swap_b32 v166, v174
v_mfma_f32_16x16x32_bf16 v[84:87], a[180:183], a[164:167], v[84:87]
buffer_load_dwordx4 v11, s[44:47], s29 offen offset:1024 lds
buffer_store_dwordx4 v[232:235], v4, s[16:19], s23 offen offset:1024 sc1
v_mfma_f32_16x16x32_bf16 v[68:71], a[180:183], a[160:163], v[68:71]
ds_read_b128 a[204:207], v7 offset:39936
v_permlane16_swap_b32 v134, v142
v_mfma_f32_16x16x32_bf16 v[72:75], a[184:187], a[160:163], v[72:75]
ds_read_b64_tr_b16 a[212:213], v15 offset:36864
v_readlane_b32 s28, v14, s31
v_mfma_f32_16x16x32_bf16 v[88:91], a[184:187], a[164:167], v[88:91]
ds_read_b64_tr_b16 a[214:215], v15 offset:37376
v_fma_f32 v164, v164, s34, -v166
v_mfma_f32_16x16x32_bf16 v[104:107], a[184:187], a[168:171], v[104:107]
buffer_load_dwordx4 v12, s[44:47], s29 offen offset:2048 lds
v_fma_f32 v165, v165, s34, -v166
v_mfma_f32_16x16x32_bf16 v[120:123], a[184:187], a[172:175], v[120:123]
ds_read_b64_tr_b16 a[216:217], v5 offset:36864
v_fma_f32 v172, v172, s34, -v174
s_waitcnt lgkmcnt(4)
v_mfma_f32_16x16x32_bf16 v[124:127], a[188:191], a[172:175], v[124:127]
ds_read_b64_tr_b16 a[218:219], v5 offset:37376
v_fma_f32 v173, v173, s34, -v174
v_mfma_f32_16x16x32_bf16 v[108:111], a[188:191], a[168:171], v[108:111]
ds_read_b64_tr_b16 a[220:221], v6 offset:36864
v_fma_f32 v132, v132, s34, -v134
v_mfma_f32_16x16x32_bf16 v[92:95], a[188:191], a[164:167], v[92:95]
buffer_load_dwordx4 v13, s[44:47], s29 offen offset:3072 lds
v_fma_f32 v133, v133, s34, -v134
v_mfma_f32_16x16x32_bf16 v[76:79], a[188:191], a[160:163], v[76:79]
ds_read_b64_tr_b16 a[222:223], v6 offset:37376
v_fma_f32 v140, v140, s34, -v142
s_waitcnt vmcnt(9)
v_mfma_f32_16x16x32_bf16 v[64:67], a[208:211], a[192:195], v[64:67]
s_barrier
ds_read_b64_tr_b16 a[176:177], v20 offset:0
v_mfma_f32_16x16x32_bf16 v[80:83], a[208:211], a[196:199], v[80:83]
ds_read_b64_tr_b16 a[178:179], v20 offset:512
s_add_u32 m0, s24, 0
v_mfma_f32_16x16x32_bf16 v[96:99], a[208:211], a[200:203], v[96:99]
buffer_load_dwordx4 v8, s[8:11], s28 offen offset:0 sc1 lds
v_fma_f32 v141, v141, s34, -v142
s_waitcnt lgkmcnt(3)
v_mfma_f32_16x16x32_bf16 v[112:115], a[208:211], a[204:207], v[112:115]
ds_read_b128 a[160:163], v2 offset:0
v_exp_f32 v164, v164
v_mfma_f32_16x16x32_bf16 v[116:119], a[212:215], a[204:207], v[116:119]
ds_read_b128 a[164:167], v2 offset:2048
v_exp_f32 v165, v165
v_mfma_f32_16x16x32_bf16 v[100:103], a[212:215], a[200:203], v[100:103]
ds_read_b128 a[168:171], v2 offset:4096
v_exp_f32 v172, v172
v_mfma_f32_16x16x32_bf16 v[84:87], a[212:215], a[196:199], v[84:87]
buffer_load_dwordx4 v8, s[8:11], s28 offen offset:1024 sc1 lds
v_exp_f32 v173, v173
v_mfma_f32_16x16x32_bf16 v[68:71], a[212:215], a[192:195], v[68:71]
ds_read_b128 a[172:175], v2 offset:6144
v_exp_f32 v132, v132
v_mfma_f32_16x16x32_bf16 v[72:75], a[216:219], a[192:195], v[72:75]
ds_read_b64_tr_b16 a[180:181], v21 offset:0
s_mul_i32 s29, s28, 224
v_mfma_f32_16x16x32_bf16 v[88:91], a[216:219], a[196:199], v[88:91]
ds_read_b64_tr_b16 a[182:183], v21 offset:512
v_exp_f32 v133, v133
v_mfma_f32_16x16x32_bf16 v[104:107], a[216:219], a[200:203], v[104:107]
buffer_load_dwordx4 v9, s[8:11], s28 offen offset:2048 sc1 lds
v_exp_f32 v140, v140
v_mfma_f32_16x16x32_bf16 v[120:123], a[216:219], a[204:207], v[120:123]
ds_read_b64_tr_b16 a[184:185], v22 offset:0
v_exp_f32 v141, v141
s_waitcnt lgkmcnt(4)
v_mfma_f32_16x16x32_bf16 v[124:127], a[220:223], a[204:207], v[124:127]
ds_read_b64_tr_b16 a[186:187], v22 offset:512
v_add_f32 v166, v164, v165
v_mfma_f32_16x16x32_bf16 v[108:111], a[220:223], a[200:203], v[108:111]
ds_read_b64_tr_b16 a[188:189], v23 offset:0
v_add_f32 v174, v172, v173
v_mfma_f32_16x16x32_bf16 v[92:95], a[220:223], a[196:199], v[92:95]
buffer_load_dwordx4 v9, s[8:11], s28 offen offset:3072 sc1 lds
v_add_f32 v134, v132, v133
v_mfma_f32_16x16x32_bf16 v[76:79], a[220:223], a[192:195], v[76:79]
ds_read_b64_tr_b16 a[190:191], v23 offset:512
v_add_f32 v142, v140, v141
v_mfma_f32_16x16x32_bf16 v[64:67], a[176:179], a[160:163], v[64:67]
ds_read_b64_tr_b16 a[208:209], v20 offset:4096
v_permlane16_swap_b32 v166, v174
v_mfma_f32_16x16x32_bf16 v[80:83], a[176:179], a[164:167], v[80:83]
ds_read_b64_tr_b16 a[210:211], v20 offset:4608
s_add_u32 m0, s25, 0
v_mfma_f32_16x16x32_bf16 v[96:99], a[176:179], a[168:171], v[96:99]
buffer_load_dwordx4 v10, s[44:47], s29 offen offset:0 lds
buffer_store_dwordx4 v[192:195], v4, s[16:19], s22 offen offset:0 sc1
s_waitcnt lgkmcnt(3)
v_mfma_f32_16x16x32_bf16 v[112:115], a[176:179], a[172:175], v[112:115]
ds_read_b128 a[192:195], v2 offset:1024
v_permlane16_swap_b32 v134, v142
v_mfma_f32_16x16x32_bf16 v[116:119], a[180:183], a[172:175], v[116:119]
ds_read_b128 a[196:199], v2 offset:3072
s_add_u32 s31, s31, 1
v_mfma_f32_16x16x32_bf16 v[100:103], a[180:183], a[168:171], v[100:103]
ds_read_b128 a[200:203], v2 offset:5120
v_add_f32 v180, v166, v174
v_mfma_f32_16x16x32_bf16 v[84:87], a[180:183], a[164:167], v[84:87]
buffer_load_dwordx4 v11, s[44:47], s29 offen offset:1024 lds
v_add_f32 v148, v134, v142
v_mfma_f32_16x16x32_bf16 v[68:71], a[180:183], a[160:163], v[68:71]
ds_read_b128 a[204:207], v2 offset:7168
v_permlane32_swap_b32 v180, v148
v_mfma_f32_16x16x32_bf16 v[72:75], a[184:187], a[160:163], v[72:75]
ds_read_b64_tr_b16 a[212:213], v21 offset:4096
v_readlane_b32 s28, v14, s31
v_mfma_f32_16x16x32_bf16 v[88:91], a[184:187], a[164:167], v[88:91]
ds_read_b64_tr_b16 a[214:215], v21 offset:4608
v_add_f32 v180, v180, v148
v_mfma_f32_16x16x32_bf16 v[104:107], a[184:187], a[168:171], v[104:107]
buffer_load_dwordx4 v12, s[44:47], s29 offen offset:2048 lds
v_rcp_f32 v166, v180
v_mfma_f32_16x16x32_bf16 v[120:123], a[184:187], a[172:175], v[120:123]
ds_read_b64_tr_b16 a[216:217], v22 offset:4096
v_mov_b32 v134, v166
s_waitcnt lgkmcnt(4)
v_mfma_f32_16x16x32_bf16 v[124:127], a[188:191], a[172:175], v[124:127]
ds_read_b64_tr_b16 a[218:219], v22 offset:4608
v_permlane32_swap_b32 v166, v134
v_mfma_f32_16x16x32_bf16 v[108:111], a[188:191], a[168:171], v[108:111]
ds_read_b64_tr_b16 a[220:221], v23 offset:4096
v_mov_b32 v174, v166
v_mfma_f32_16x16x32_bf16 v[92:95], a[188:191], a[164:167], v[92:95]
buffer_load_dwordx4 v13, s[44:47], s29 offen offset:3072 lds
v_mov_b32 v142, v134
v_mfma_f32_16x16x32_bf16 v[76:79], a[188:191], a[160:163], v[76:79]
ds_read_b64_tr_b16 a[222:223], v23 offset:4608
v_permlane16_swap_b32 v166, v174
s_waitcnt vmcnt(9)
v_mfma_f32_16x16x32_bf16 v[64:67], a[208:211], a[192:195], v[64:67]
s_barrier
ds_read_b64_tr_b16 a[176:177], v20 offset:32768
v_mfma_f32_16x16x32_bf16 v[80:83], a[208:211], a[196:199], v[80:83]
ds_read_b64_tr_b16 a[178:179], v20 offset:33280
s_add_u32 m0, s24, 32768
v_mfma_f32_16x16x32_bf16 v[96:99], a[208:211], a[200:203], v[96:99]
buffer_load_dwordx4 v8, s[8:11], s28 offen offset:0 sc1 lds
v_permlane16_swap_b32 v134, v142
s_waitcnt lgkmcnt(3)
v_mfma_f32_16x16x32_bf16 v[112:115], a[208:211], a[204:207], v[112:115]
ds_read_b128 a[160:163], v2 offset:32768
v_mul_f32 v164, v164, v166
v_mfma_f32_16x16x32_bf16 v[116:119], a[212:215], a[204:207], v[116:119]
ds_read_b128 a[164:167], v2 offset:34816
v_mul_f32 v165, v165, v166
v_mfma_f32_16x16x32_bf16 v[100:103], a[212:215], a[200:203], v[100:103]
ds_read_b128 a[168:171], v2 offset:36864
v_cvt_pk_bf16_f32 v164, v164, v165
v_mfma_f32_16x16x32_bf16 v[84:87], a[212:215], a[196:199], v[84:87]
buffer_load_dwordx4 v8, s[8:11], s28 offen offset:1024 sc1 lds
v_mul_f32 v172, v172, v174
v_mfma_f32_16x16x32_bf16 v[68:71], a[212:215], a[192:195], v[68:71]
ds_read_b128 a[172:175], v2 offset:38912
v_mul_f32 v173, v173, v174
v_mfma_f32_16x16x32_bf16 v[72:75], a[216:219], a[192:195], v[72:75]
ds_read_b64_tr_b16 a[180:181], v21 offset:32768
s_mul_i32 s29, s28, 224
v_mfma_f32_16x16x32_bf16 v[88:91], a[216:219], a[196:199], v[88:91]
ds_read_b64_tr_b16 a[182:183], v21 offset:33280
v_cvt_pk_bf16_f32 v172, v172, v173
v_mfma_f32_16x16x32_bf16 v[104:107], a[216:219], a[200:203], v[104:107]
buffer_load_dwordx4 v9, s[8:11], s28 offen offset:2048 sc1 lds
v_mul_f32 v132, v132, v134
v_mfma_f32_16x16x32_bf16 v[120:123], a[216:219], a[204:207], v[120:123]
ds_read_b64_tr_b16 a[184:185], v22 offset:32768
v_mul_f32 v133, v133, v134
s_waitcnt lgkmcnt(4)
v_mfma_f32_16x16x32_bf16 v[124:127], a[220:223], a[204:207], v[124:127]
ds_read_b64_tr_b16 a[186:187], v22 offset:33280
v_cvt_pk_bf16_f32 v132, v132, v133
v_mfma_f32_16x16x32_bf16 v[108:111], a[220:223], a[200:203], v[108:111]
ds_read_b64_tr_b16 a[188:189], v23 offset:32768
v_mul_f32 v140, v140, v142
v_mfma_f32_16x16x32_bf16 v[92:95], a[220:223], a[196:199], v[92:95]
buffer_load_dwordx4 v9, s[8:11], s28 offen offset:3072 sc1 lds
buffer_store_dwordx4 v[200:203], v4, s[16:19], s22 offen offset:1024 sc1
v_mfma_f32_16x16x32_bf16 v[76:79], a[220:223], a[192:195], v[76:79]
ds_read_b64_tr_b16 a[190:191], v23 offset:33280
v_mul_f32 v141, v141, v142
v_mfma_f32_16x16x32_bf16 v[64:67], a[176:179], a[160:163], v[64:67]
ds_read_b64_tr_b16 a[208:209], v20 offset:36864
v_cvt_pk_bf16_f32 v140, v140, v141
v_mfma_f32_16x16x32_bf16 v[80:83], a[176:179], a[164:167], v[80:83]
ds_read_b64_tr_b16 a[210:211], v20 offset:37376
s_add_u32 m0, s25, 32768
v_mfma_f32_16x16x32_bf16 v[96:99], a[176:179], a[168:171], v[96:99]
buffer_load_dwordx4 v10, s[44:47], s29 offen offset:0 lds
v_perm_b32 v180, v164, v164, v16
s_waitcnt lgkmcnt(3)
v_mfma_f32_16x16x32_bf16 v[112:115], a[176:179], a[172:175], v[112:115]
ds_read_b128 a[192:195], v2 offset:33792
v_perm_b32 v181, v164, v164, v17
v_mfma_f32_16x16x32_bf16 v[116:119], a[180:183], a[172:175], v[116:119]
ds_read_b128 a[196:199], v2 offset:35840
s_add_u32 s31, s31, 1
v_mfma_f32_16x16x32_bf16 v[100:103], a[180:183], a[168:171], v[100:103]
ds_read_b128 a[200:203], v2 offset:37888
v_perm_b32 v182, v164, v164, v18
v_mfma_f32_16x16x32_bf16 v[84:87], a[180:183], a[164:167], v[84:87]
buffer_load_dwordx4 v11, s[44:47], s29 offen offset:1024 lds
v_perm_b32 v183, v164, v164, v19
v_mfma_f32_16x16x32_bf16 v[68:71], a[180:183], a[160:163], v[68:71]
ds_read_b128 a[204:207], v2 offset:39936
v_perm_b32 v188, v172, v172, v16
v_mfma_f32_16x16x32_bf16 v[72:75], a[184:187], a[160:163], v[72:75]
ds_read_b64_tr_b16 a[212:213], v21 offset:36864
v_readlane_b32 s28, v14, s31
v_mfma_f32_16x16x32_bf16 v[88:91], a[184:187], a[164:167], v[88:91]
ds_read_b64_tr_b16 a[214:215], v21 offset:37376
v_perm_b32 v189, v172, v172, v17
v_mfma_f32_16x16x32_bf16 v[104:107], a[184:187], a[168:171], v[104:107]
buffer_load_dwordx4 v12, s[44:47], s29 offen offset:2048 lds
v_perm_b32 v190, v172, v172, v18
v_mfma_f32_16x16x32_bf16 v[120:123], a[184:187], a[172:175], v[120:123]
ds_read_b64_tr_b16 a[216:217], v22 offset:36864
v_perm_b32 v191, v172, v172, v19
v_mfma_f32_16x16x32_bf16 v[160:163], v[26:29], v[180:183], 0
v_perm_b32 v148, v132, v132, v16
v_perm_b32 v149, v132, v132, v17
v_mfma_f32_16x16x32_bf16 v[164:167], v[36:39], v[180:183], 0
v_perm_b32 v150, v132, v132, v18
v_perm_b32 v151, v132, v132, v19
v_mfma_f32_16x16x32_bf16 v[168:171], v[46:49], v[188:191], 0
v_perm_b32 v156, v140, v140, v16
v_perm_b32 v157, v140, v140, v17
v_mfma_f32_16x16x32_bf16 v[172:175], v[56:59], v[188:191], 0
v_perm_b32 v158, v140, v140, v18
v_perm_b32 v159, v140, v140, v19
v_mfma_f32_16x16x32_bf16 v[128:131], v[24:27], v[148:151], 0
v_cvt_pk_bf16_f32 v160, v160, v161
v_cvt_pk_bf16_f32 v161, v162, v163
v_mfma_f32_16x16x32_bf16 v[132:135], v[34:37], v[148:151], 0
v_cvt_pk_bf16_f32 v162, v164, v165
v_cvt_pk_bf16_f32 v163, v166, v167
v_mfma_f32_16x16x32_bf16 v[136:139], v[44:47], v[156:159], 0
buffer_store_dwordx4 v[160:163], v4, s[16:19], s21 offen offset:0 sc1
v_mfma_f32_16x16x32_bf16 v[140:143], v[54:57], v[156:159], 0
v_cvt_pk_bf16_f32 v168, v168, v169
v_cvt_pk_bf16_f32 v169, v170, v171
s_waitcnt lgkmcnt(0)
v_mfma_f32_16x16x32_bf16 v[124:127], a[188:191], a[172:175], v[124:127]
ds_read_b64_tr_b16 a[218:219], v22 offset:37376
v_cvt_pk_bf16_f32 v170, v172, v173
v_mfma_f32_16x16x32_bf16 v[108:111], a[188:191], a[168:171], v[108:111]
ds_read_b64_tr_b16 a[220:221], v23 offset:36864
v_cvt_pk_bf16_f32 v171, v174, v175
v_mfma_f32_16x16x32_bf16 v[92:95], a[188:191], a[164:167], v[92:95]
buffer_load_dwordx4 v13, s[44:47], s29 offen offset:3072 lds
buffer_store_dwordx4 v[168:171], v4, s[16:19], s21 offen offset:1024 sc1
v_mfma_f32_16x16x32_bf16 v[76:79], a[188:191], a[160:163], v[76:79]
ds_read_b64_tr_b16 a[222:223], v23 offset:37376
v_cvt_pk_bf16_f32 v128, v128, v129
s_waitcnt vmcnt(11)
v_mfma_f32_16x16x32_bf16 v[64:67], a[208:211], a[192:195], v[64:67]
s_barrier
ds_read_b64_tr_b16 a[176:177], v3 offset:0
v_mfma_f32_16x16x32_bf16 v[80:83], a[208:211], a[196:199], v[80:83]
ds_read_b64_tr_b16 a[178:179], v3 offset:512
s_add_u32 m0, s24, 65536
v_mfma_f32_16x16x32_bf16 v[96:99], a[208:211], a[200:203], v[96:99]
buffer_load_dwordx4 v8, s[8:11], s28 offen offset:0 sc1 lds
v_cvt_pk_bf16_f32 v129, v130, v131
v_mfma_f32_16x16x32_bf16 v[112:115], a[208:211], a[204:207], v[112:115]
ds_read_b128 a[160:163], v7 offset:0
v_cvt_pk_bf16_f32 v130, v132, v133
v_mfma_f32_16x16x32_bf16 v[116:119], a[212:215], a[204:207], v[116:119]
ds_read_b128 a[164:167], v7 offset:2048
v_cvt_pk_bf16_f32 v131, v134, v135
v_mfma_f32_16x16x32_bf16 v[100:103], a[212:215], a[200:203], v[100:103]
ds_read_b128 a[168:171], v7 offset:4096
buffer_store_dwordx4 v[128:131], v4, s[16:19], s20 offen offset:0 sc1
v_mfma_f32_16x16x32_bf16 v[84:87], a[212:215], a[196:199], v[84:87]
buffer_load_dwordx4 v8, s[8:11], s28 offen offset:1024 sc1 lds
v_cvt_pk_bf16_f32 v136, v136, v137
v_mfma_f32_16x16x32_bf16 v[68:71], a[212:215], a[192:195], v[68:71]
ds_read_b128 a[172:175], v7 offset:6144
v_cvt_pk_bf16_f32 v137, v138, v139
s_waitcnt lgkmcnt(4)
v_mfma_f32_16x16x32_bf16 v[72:75], a[216:219], a[192:195], v[72:75]
ds_read_b64_tr_b16 a[180:181], v15 offset:0
s_mul_i32 s29, s28, 224
v_mfma_f32_16x16x32_bf16 v[88:91], a[216:219], a[196:199], v[88:91]
ds_read_b64_tr_b16 a[182:183], v15 offset:512
v_cvt_pk_bf16_f32 v138, v140, v141
v_mfma_f32_16x16x32_bf16 v[104:107], a[216:219], a[200:203], v[104:107]
buffer_load_dwordx4 v9, s[8:11], s28 offen offset:2048 sc1 lds
v_cvt_pk_bf16_f32 v139, v142, v143
v_mfma_f32_16x16x32_bf16 v[120:123], a[216:219], a[204:207], v[120:123]
ds_read_b64_tr_b16 a[184:185], v5 offset:0
buffer_store_dwordx4 v[136:139], v4, s[16:19], s20 offen offset:1024 sc1
v_mfma_f32_16x16x32_bf16 v[124:127], a[220:223], a[204:207], v[124:127]
ds_read_b64_tr_b16 a[186:187], v5 offset:512
v_mfma_f32_16x16x32_bf16 v[108:111], a[220:223], a[200:203], v[108:111]
ds_read_b64_tr_b16 a[188:189], v6 offset:0
v_mfma_f32_16x16x32_bf16 v[92:95], a[220:223], a[196:199], v[92:95]
buffer_load_dwordx4 v9, s[8:11], s28 offen offset:3072 sc1 lds
v_mfma_f32_16x16x32_bf16 v[76:79], a[220:223], a[192:195], v[76:79]
ds_read_b64_tr_b16 a[190:191], v6 offset:512
v_accvgpr_read_b32 v22, a230
v_accvgpr_read_b32 v23, a231
v_accvgpr_read_b32 v24, a232
v_accvgpr_read_b32 v25, a233
v_accvgpr_read_b32 v26, a234
s_branch L_p2
Lq_loop1a:
ds_read_b64_tr_b16 a[48:49], v16 offset:4096
ds_read_b64_tr_b16 a[50:51], v16 offset:4608
v_mfma_f32_16x16x32_bf16 v[192:195], a[0:3], a[104:107], v[192:195]
buffer_load_dwordx4 a[144:147], v4, s[8:11], s21 offen offset:1024 sc1
v_mfma_f32_16x16x32_bf16 v[224:227], a[0:3], a[108:111], v[224:227]
v_mfma_f32_16x16x32_bf16 v[228:231], a[4:7], a[108:111], v[228:231]
ds_read_b64_tr_b16 a[52:53], v17 offset:4096
v_mfma_f32_16x16x32_bf16 v[196:199], a[4:7], a[104:107], v[196:199]
ds_read_b64_tr_b16 a[54:55], v17 offset:4608
ds_read_b64_tr_b16 a[56:57], v18 offset:4096
buffer_load_dwordx4 a[148:151], v5, s[8:11], s21 offen offset:1024 sc1
ds_read_b64_tr_b16 a[58:59], v18 offset:4608
v_mfma_f32_16x16x32_bf16 v[200:203], a[8:11], a[104:107], v[200:203]
v_mfma_f32_16x16x32_bf16 v[232:235], a[8:11], a[108:111], v[232:235]
ds_read_b64_tr_b16 a[60:61], v19 offset:4096
v_mfma_f32_16x16x32_bf16 v[236:239], a[12:15], a[108:111], v[236:239]
ds_read_b64_tr_b16 a[62:63], v19 offset:4608
v_mfma_f32_16x16x32_bf16 v[204:207], a[12:15], a[104:107], v[204:207]
buffer_load_dwordx4 a[152:155], v6, s[8:11], s21 offen offset:1024 sc1
ds_read_b64_tr_b16 a[64:65], v16 offset:12288
s_waitcnt lgkmcnt(3)
ds_read_b64_tr_b16 a[66:67], v16 offset:12800
v_mfma_f32_16x16x32_bf16 v[176:179], a[16:19], a[100:103], v[176:179]
v_mfma_f32_16x16x32_bf16 v[208:211], a[16:19], a[104:107], v[208:211]
ds_read_b64_tr_b16 a[68:69], v17 offset:12288
v_mfma_f32_16x16x32_bf16 v[240:243], a[16:19], a[108:111], v[240:243]
ds_read_b64_tr_b16 a[70:71], v17 offset:12800
v_mfma_f32_16x16x32_bf16 v[244:247], a[20:23], a[108:111], v[244:247]
buffer_load_dwordx4 a[156:159], v7, s[8:11], s21 offen offset:1024 sc1
v_mfma_f32_16x16x32_bf16 v[212:215], a[20:23], a[104:107], v[212:215]
v_mfma_f32_16x16x32_bf16 v[180:183], a[20:23], a[100:103], v[180:183]
ds_read_b64_tr_b16 a[72:73], v18 offset:12288
ds_read_b64_tr_b16 a[74:75], v18 offset:12800
v_mfma_f32_16x16x32_bf16 v[184:187], a[24:27], a[100:103], v[184:187]
ds_read_b64_tr_b16 a[76:77], v19 offset:12288
v_mfma_f32_16x16x32_bf16 v[216:219], a[24:27], a[104:107], v[216:219]
buffer_load_dwordx4 v11, s[12:15], s22 offen offset:1024 lds
v_mfma_f32_16x16x32_bf16 v[248:251], a[24:27], a[108:111], v[248:251]
ds_read_b64_tr_b16 a[78:79], v19 offset:12800
v_mfma_f32_16x16x32_bf16 v[252:255], a[28:31], a[108:111], v[252:255]
v_mfma_f32_16x16x32_bf16 v[220:223], a[28:31], a[104:107], v[220:223]
ds_read_b64_tr_b16 a[80:81], v16 offset:20480
v_mfma_f32_16x16x32_bf16 v[188:191], a[28:31], a[100:103], v[188:191]
ds_read_b64_tr_b16 a[82:83], v16 offset:20992
s_add_u32 m0, s23, 81920
s_nop 0
buffer_load_dwordx4 v12, s[12:15], s22 offen offset:0 lds
v_mfma_f32_16x16x32_bf16 v[80:83], a[100:103], a[32:35], v[80:83]
v_mfma_f32_16x16x32_bf16 v[96:99], a[104:107], a[32:35], v[96:99]
ds_read_b64_tr_b16 a[84:85], v17 offset:20480
v_mfma_f32_16x16x32_bf16 v[112:115], a[108:111], a[32:35], v[112:115]
ds_read_b64_tr_b16 a[86:87], v17 offset:20992
v_mfma_f32_16x16x32_bf16 v[116:119], a[108:111], a[36:39], v[116:119]
v_mfma_f32_16x16x32_bf16 v[100:103], a[104:107], a[36:39], v[100:103]
ds_read_b64_tr_b16 a[88:89], v18 offset:20480
v_mfma_f32_16x16x32_bf16 v[84:87], a[100:103], a[36:39], v[84:87]
buffer_load_dwordx4 v13, s[12:15], s22 offen offset:1024 lds
v_readlane_b32 s21, v14, s20
ds_read_b64_tr_b16 a[90:91], v18 offset:20992
v_mfma_f32_16x16x32_bf16 v[88:91], a[100:103], a[40:43], v[88:91]
s_add_u32 s20, s20, 1
v_mfma_f32_16x16x32_bf16 v[104:107], a[104:107], a[40:43], v[104:107]
v_mfma_f32_16x16x32_bf16 v[120:123], a[108:111], a[40:43], v[120:123]
v_readlane_b32 s22, v15, s20
v_mfma_f32_16x16x32_bf16 v[124:127], a[108:111], a[44:47], v[124:127]
ds_read_b64_tr_b16 a[92:93], v19 offset:20480
v_mfma_f32_16x16x32_bf16 v[108:111], a[104:107], a[44:47], v[108:111]
ds_read_b64_tr_b16 a[94:95], v19 offset:20992
v_mfma_f32_16x16x32_bf16 v[92:95], a[100:103], a[44:47], v[92:95]
s_waitcnt vmcnt(14)
s_barrier
ds_read_b64_tr_b16 a[0:1], v16 offset:32768
v_mfma_f32_16x16x32_bf16 v[192:195], a[48:51], a[120:123], v[192:195]
buffer_load_dwordx4 a[96:99], v4, s[8:11], s21 offen offset:0 sc1
v_mfma_f32_16x16x32_bf16 v[224:227], a[48:51], a[124:127], v[224:227]
ds_read_b64_tr_b16 a[2:3], v16 offset:33280
v_mfma_f32_16x16x32_bf16 v[228:231], a[52:55], a[124:127], v[228:231]
v_mfma_f32_16x16x32_bf16 v[196:199], a[52:55], a[120:123], v[196:199]
ds_read_b64_tr_b16 a[4:5], v17 offset:32768
ds_read_b64_tr_b16 a[6:7], v17 offset:33280
buffer_load_dwordx4 a[100:103], v5, s[8:11], s21 offen offset:0 sc1
ds_read_b64_tr_b16 a[8:9], v18 offset:32768
v_mfma_f32_16x16x32_bf16 v[200:203], a[56:59], a[120:123], v[200:203]
ds_read_b64_tr_b16 a[10:11], v18 offset:33280
v_mfma_f32_16x16x32_bf16 v[232:235], a[56:59], a[124:127], v[232:235]
s_waitcnt lgkmcnt(2)
v_mfma_f32_16x16x32_bf16 v[236:239], a[60:63], a[124:127], v[236:239]
ds_read_b64_tr_b16 a[12:13], v19 offset:32768
v_mfma_f32_16x16x32_bf16 v[204:207], a[60:63], a[120:123], v[204:207]
ds_read_b64_tr_b16 a[14:15], v19 offset:33280
buffer_load_dwordx4 a[104:107], v6, s[8:11], s21 offen offset:0 sc1
ds_read_b64_tr_b16 a[16:17], v16 offset:40960
v_mfma_f32_16x16x32_bf16 v[176:179], a[64:67], a[116:119], v[176:179]
ds_read_b64_tr_b16 a[18:19], v16 offset:41472
v_mfma_f32_16x16x32_bf16 v[208:211], a[64:67], a[120:123], v[208:211]
v_mfma_f32_16x16x32_bf16 v[240:243], a[64:67], a[124:127], v[240:243]
ds_read_b64_tr_b16 a[20:21], v17 offset:40960
v_mfma_f32_16x16x32_bf16 v[244:247], a[68:71], a[124:127], v[244:247]
buffer_load_dwordx4 a[108:111], v7, s[8:11], s21 offen offset:0 sc1
v_mfma_f32_16x16x32_bf16 v[212:215], a[68:71], a[120:123], v[212:215]
ds_read_b64_tr_b16 a[22:23], v17 offset:41472
v_mfma_f32_16x16x32_bf16 v[180:183], a[68:71], a[116:119], v[180:183]
ds_read_b64_tr_b16 a[24:25], v18 offset:40960
v_mfma_f32_16x16x32_bf16 v[184:187], a[72:75], a[116:119], v[184:187]
s_add_u32 m0, s23, 98304
v_mfma_f32_16x16x32_bf16 v[216:219], a[72:75], a[120:123], v[216:219]
buffer_load_dwordx4 v8, s[12:15], s22 offen offset:0 lds
v_mfma_f32_16x16x32_bf16 v[248:251], a[72:75], a[124:127], v[248:251]
ds_read_b64_tr_b16 a[26:27], v18 offset:41472
v_mfma_f32_16x16x32_bf16 v[252:255], a[76:79], a[124:127], v[252:255]
ds_read_b64_tr_b16 a[28:29], v19 offset:40960
v_mfma_f32_16x16x32_bf16 v[220:223], a[76:79], a[120:123], v[220:223]
v_mfma_f32_16x16x32_bf16 v[188:191], a[76:79], a[116:119], v[188:191]
ds_read_b64_tr_b16 a[30:31], v19 offset:41472
ds_read_b64_tr_b16 a[32:33], v16 offset:49152
buffer_load_dwordx4 v9, s[12:15], s22 offen offset:1024 lds
v_mfma_f32_16x16x32_bf16 v[80:83], a[116:119], a[80:83], v[80:83]
v_mfma_f32_16x16x32_bf16 v[96:99], a[120:123], a[80:83], v[96:99]
ds_read_b64_tr_b16 a[34:35], v16 offset:49664
v_mfma_f32_16x16x32_bf16 v[112:115], a[124:127], a[80:83], v[112:115]
ds_read_b64_tr_b16 a[36:37], v17 offset:49152
v_mfma_f32_16x16x32_bf16 v[116:119], a[124:127], a[84:87], v[116:119]
v_mfma_f32_16x16x32_bf16 v[100:103], a[120:123], a[84:87], v[100:103]
s_add_u32 m0, s23, 106496
v_mfma_f32_16x16x32_bf16 v[84:87], a[116:119], a[84:87], v[84:87]
buffer_load_dwordx4 v10, s[12:15], s22 offen offset:0 lds
ds_read_b64_tr_b16 a[38:39], v17 offset:49664
ds_read_b64_tr_b16 a[40:41], v18 offset:49152
v_mfma_f32_16x16x32_bf16 v[88:91], a[116:119], a[88:91], v[88:91]
v_mfma_f32_16x16x32_bf16 v[104:107], a[120:123], a[88:91], v[104:107]
ds_read_b64_tr_b16 a[42:43], v18 offset:49664
v_mfma_f32_16x16x32_bf16 v[120:123], a[124:127], a[88:91], v[120:123]
ds_read_b64_tr_b16 a[44:45], v19 offset:49152
v_mfma_f32_16x16x32_bf16 v[124:127], a[124:127], a[92:95], v[124:127]
v_mfma_f32_16x16x32_bf16 v[108:111], a[120:123], a[92:95], v[108:111]
ds_read_b64_tr_b16 a[46:47], v19 offset:49664
v_mfma_f32_16x16x32_bf16 v[92:95], a[116:119], a[92:95], v[92:95]
s_waitcnt vmcnt(17)
ds_read_b64_tr_b16 a[48:49], v16 offset:36864
ds_read_b64_tr_b16 a[50:51], v16 offset:37376
v_mfma_f32_16x16x32_bf16 v[192:195], a[0:3], a[136:139], v[192:195]
buffer_load_dwordx4 a[112:115], v4, s[8:11], s21 offen offset:1024 sc1
v_mfma_f32_16x16x32_bf16 v[224:227], a[0:3], a[140:143], v[224:227]
v_mfma_f32_16x16x32_bf16 v[228:231], a[4:7], a[140:143], v[228:231]
ds_read_b64_tr_b16 a[52:53], v17 offset:36864
v_mfma_f32_16x16x32_bf16 v[196:199], a[4:7], a[136:139], v[196:199]
ds_read_b64_tr_b16 a[54:55], v17 offset:37376
ds_read_b64_tr_b16 a[56:57], v18 offset:36864
s_waitcnt lgkmcnt(3)
buffer_load_dwordx4 a[116:119], v5, s[8:11], s21 offen offset:1024 sc1
ds_read_b64_tr_b16 a[58:59], v18 offset:37376
v_mfma_f32_16x16x32_bf16 v[200:203], a[8:11], a[136:139], v[200:203]
v_mfma_f32_16x16x32_bf16 v[232:235], a[8:11], a[140:143], v[232:235]
ds_read_b64_tr_b16 a[60:61], v19 offset:36864
v_mfma_f32_16x16x32_bf16 v[236:239], a[12:15], a[140:143], v[236:239]
ds_read_b64_tr_b16 a[62:63], v19 offset:37376
v_mfma_f32_16x16x32_bf16 v[204:207], a[12:15], a[136:139], v[204:207]
buffer_load_dwordx4 a[120:123], v6, s[8:11], s21 offen offset:1024 sc1
ds_read_b64_tr_b16 a[64:65], v16 offset:45056
ds_read_b64_tr_b16 a[66:67], v16 offset:45568
v_mfma_f32_16x16x32_bf16 v[176:179], a[16:19], a[132:135], v[176:179]
v_mfma_f32_16x16x32_bf16 v[208:211], a[16:19], a[136:139], v[208:211]
ds_read_b64_tr_b16 a[68:69], v17 offset:45056
v_mfma_f32_16x16x32_bf16 v[240:243], a[16:19], a[140:143], v[240:243]
ds_read_b64_tr_b16 a[70:71], v17 offset:45568
v_mfma_f32_16x16x32_bf16 v[244:247], a[20:23], a[140:143], v[244:247]
buffer_load_dwordx4 a[124:127], v7, s[8:11], s21 offen offset:1024 sc1
v_mfma_f32_16x16x32_bf16 v[212:215], a[20:23], a[136:139], v[212:215]
v_mfma_f32_16x16x32_bf16 v[180:183], a[20:23], a[132:135], v[180:183]
ds_read_b64_tr_b16 a[72:73], v18 offset:45056
ds_read_b64_tr_b16 a[74:75], v18 offset:45568
v_mfma_f32_16x16x32_bf16 v[184:187], a[24:27], a[132:135], v[184:187]
ds_read_b64_tr_b16 a[76:77], v19 offset:45056
v_mfma_f32_16x16x32_bf16 v[216:219], a[24:27], a[136:139], v[216:219]
buffer_load_dwordx4 v11, s[12:15], s22 offen offset:1024 lds
v_mfma_f32_16x16x32_bf16 v[248:251], a[24:27], a[140:143], v[248:251]
ds_read_b64_tr_b16 a[78:79], v19 offset:45568
v_mfma_f32_16x16x32_bf16 v[252:255], a[28:31], a[140:143], v[252:255]
v_mfma_f32_16x16x32_bf16 v[220:223], a[28:31], a[136:139], v[220:223]
ds_read_b64_tr_b16 a[80:81], v16 offset:53248
v_mfma_f32_16x16x32_bf16 v[188:191], a[28:31], a[132:135], v[188:191]
ds_read_b64_tr_b16 a[82:83], v16 offset:53760
s_add_u32 m0, s23, 114688
s_nop 0
buffer_load_dwordx4 v12, s[12:15], s22 offen offset:0 lds
v_mfma_f32_16x16x32_bf16 v[80:83], a[132:135], a[32:35], v[80:83]
v_mfma_f32_16x16x32_bf16 v[96:99], a[136:139], a[32:35], v[96:99]
ds_read_b64_tr_b16 a[84:85], v17 offset:53248
v_mfma_f32_16x16x32_bf16 v[112:115], a[140:143], a[32:35], v[112:115]
ds_read_b64_tr_b16 a[86:87], v17 offset:53760
v_mfma_f32_16x16x32_bf16 v[116:119], a[140:143], a[36:39], v[116:119]
v_mfma_f32_16x16x32_bf16 v[100:103], a[136:139], a[36:39], v[100:103]
ds_read_b64_tr_b16 a[88:89], v18 offset:53248
v_mfma_f32_16x16x32_bf16 v[84:87], a[132:135], a[36:39], v[84:87]
buffer_load_dwordx4 v13, s[12:15], s22 offen offset:1024 lds
v_readlane_b32 s21, v14, s20
ds_read_b64_tr_b16 a[90:91], v18 offset:53760
v_mfma_f32_16x16x32_bf16 v[88:91], a[132:135], a[40:43], v[88:91]
s_add_u32 s20, s20, 1
v_mfma_f32_16x16x32_bf16 v[104:107], a[136:139], a[40:43], v[104:107]
v_mfma_f32_16x16x32_bf16 v[120:123], a[140:143], a[40:43], v[120:123]
v_readlane_b32 s22, v15, s20
v_mfma_f32_16x16x32_bf16 v[124:127], a[140:143], a[44:47], v[124:127]
ds_read_b64_tr_b16 a[92:93], v19 offset:53248
v_mfma_f32_16x16x32_bf16 v[108:111], a[136:139], a[44:47], v[108:111]
ds_read_b64_tr_b16 a[94:95], v19 offset:53760
v_mfma_f32_16x16x32_bf16 v[92:95], a[132:135], a[44:47], v[92:95]
s_waitcnt vmcnt(14)
s_barrier
ds_read_b64_tr_b16 a[0:1], v20 offset:0
v_mfma_f32_16x16x32_bf16 v[192:195], a[48:51], a[152:155], v[192:195]
buffer_load_dwordx4 a[128:131], v4, s[8:11], s21 offen offset:0 sc1
v_mfma_f32_16x16x32_bf16 v[224:227], a[48:51], a[156:159], v[224:227]
ds_read_b64_tr_b16 a[2:3], v20 offset:512
s_waitcnt lgkmcnt(2)
v_mfma_f32_16x16x32_bf16 v[228:231], a[52:55], a[156:159], v[228:231]
v_mfma_f32_16x16x32_bf16 v[196:199], a[52:55], a[152:155], v[196:199]
ds_read_b64_tr_b16 a[4:5], v21 offset:0
ds_read_b64_tr_b16 a[6:7], v21 offset:512
buffer_load_dwordx4 a[132:135], v5, s[8:11], s21 offen offset:0 sc1
ds_read_b64_tr_b16 a[8:9], v22 offset:0
v_mfma_f32_16x16x32_bf16 v[200:203], a[56:59], a[152:155], v[200:203]
ds_read_b64_tr_b16 a[10:11], v22 offset:512
v_mfma_f32_16x16x32_bf16 v[232:235], a[56:59], a[156:159], v[232:235]
v_mfma_f32_16x16x32_bf16 v[236:239], a[60:63], a[156:159], v[236:239]
ds_read_b64_tr_b16 a[12:13], v23 offset:0
v_mfma_f32_16x16x32_bf16 v[204:207], a[60:63], a[152:155], v[204:207]
ds_read_b64_tr_b16 a[14:15], v23 offset:512
buffer_load_dwordx4 a[136:139], v6, s[8:11], s21 offen offset:0 sc1
ds_read_b64_tr_b16 a[16:17], v20 offset:8192
v_mfma_f32_16x16x32_bf16 v[176:179], a[64:67], a[148:151], v[176:179]
ds_read_b64_tr_b16 a[18:19], v20 offset:8704
v_mfma_f32_16x16x32_bf16 v[208:211], a[64:67], a[152:155], v[208:211]
v_mfma_f32_16x16x32_bf16 v[240:243], a[64:67], a[156:159], v[240:243]
ds_read_b64_tr_b16 a[20:21], v21 offset:8192
v_mfma_f32_16x16x32_bf16 v[244:247], a[68:71], a[156:159], v[244:247]
buffer_load_dwordx4 a[140:143], v7, s[8:11], s21 offen offset:0 sc1
v_mfma_f32_16x16x32_bf16 v[212:215], a[68:71], a[152:155], v[212:215]
ds_read_b64_tr_b16 a[22:23], v21 offset:8704
v_mfma_f32_16x16x32_bf16 v[180:183], a[68:71], a[148:151], v[180:183]
ds_read_b64_tr_b16 a[24:25], v22 offset:8192
v_mfma_f32_16x16x32_bf16 v[184:187], a[72:75], a[148:151], v[184:187]
s_add_u32 m0, s23, 0
v_mfma_f32_16x16x32_bf16 v[216:219], a[72:75], a[152:155], v[216:219]
buffer_load_dwordx4 v8, s[12:15], s22 offen offset:0 lds
v_mfma_f32_16x16x32_bf16 v[248:251], a[72:75], a[156:159], v[248:251]
ds_read_b64_tr_b16 a[26:27], v22 offset:8704
v_mfma_f32_16x16x32_bf16 v[252:255], a[76:79], a[156:159], v[252:255]
ds_read_b64_tr_b16 a[28:29], v23 offset:8192
v_mfma_f32_16x16x32_bf16 v[220:223], a[76:79], a[152:155], v[220:223]
v_mfma_f32_16x16x32_bf16 v[188:191], a[76:79], a[148:151], v[188:191]
ds_read_b64_tr_b16 a[30:31], v23 offset:8704
ds_read_b64_tr_b16 a[32:33], v20 offset:16384
buffer_load_dwordx4 v9, s[12:15], s22 offen offset:1024 lds
v_mfma_f32_16x16x32_bf16 v[80:83], a[148:151], a[80:83], v[80:83]
v_mfma_f32_16x16x32_bf16 v[96:99], a[152:155], a[80:83], v[96:99]
ds_read_b64_tr_b16 a[34:35], v20 offset:16896
v_mfma_f32_16x16x32_bf16 v[112:115], a[156:159], a[80:83], v[112:115]
ds_read_b64_tr_b16 a[36:37], v21 offset:16384
v_mfma_f32_16x16x32_bf16 v[116:119], a[156:159], a[84:87], v[116:119]
v_mfma_f32_16x16x32_bf16 v[100:103], a[152:155], a[84:87], v[100:103]
s_add_u32 m0, s23, 8192
v_mfma_f32_16x16x32_bf16 v[84:87], a[148:151], a[84:87], v[84:87]
buffer_load_dwordx4 v10, s[12:15], s22 offen offset:0 lds
ds_read_b64_tr_b16 a[38:39], v21 offset:16896
ds_read_b64_tr_b16 a[40:41], v22 offset:16384
v_mfma_f32_16x16x32_bf16 v[88:91], a[148:151], a[88:91], v[88:91]
v_mfma_f32_16x16x32_bf16 v[104:107], a[152:155], a[88:91], v[104:107]
ds_read_b64_tr_b16 a[42:43], v22 offset:16896
v_mfma_f32_16x16x32_bf16 v[120:123], a[156:159], a[88:91], v[120:123]
ds_read_b64_tr_b16 a[44:45], v23 offset:16384
v_mfma_f32_16x16x32_bf16 v[124:127], a[156:159], a[92:95], v[124:127]
v_mfma_f32_16x16x32_bf16 v[108:111], a[152:155], a[92:95], v[108:111]
ds_read_b64_tr_b16 a[46:47], v23 offset:16896
v_mfma_f32_16x16x32_bf16 v[92:95], a[148:151], a[92:95], v[92:95]
s_waitcnt vmcnt(17) lgkmcnt(2)
ds_read_b64_tr_b16 a[48:49], v20 offset:4096
ds_read_b64_tr_b16 a[50:51], v20 offset:4608
v_mfma_f32_16x16x32_bf16 v[192:195], a[0:3], a[104:107], v[192:195]
buffer_load_dwordx4 a[144:147], v4, s[8:11], s21 offen offset:1024 sc1
v_mfma_f32_16x16x32_bf16 v[224:227], a[0:3], a[108:111], v[224:227]
v_mfma_f32_16x16x32_bf16 v[228:231], a[4:7], a[108:111], v[228:231]
ds_read_b64_tr_b16 a[52:53], v21 offset:4096
v_mfma_f32_16x16x32_bf16 v[196:199], a[4:7], a[104:107], v[196:199]
ds_read_b64_tr_b16 a[54:55], v21 offset:4608
ds_read_b64_tr_b16 a[56:57], v22 offset:4096
buffer_load_dwordx4 a[148:151], v5, s[8:11], s21 offen offset:1024 sc1
ds_read_b64_tr_b16 a[58:59], v22 offset:4608
v_mfma_f32_16x16x32_bf16 v[200:203], a[8:11], a[104:107], v[200:203]
v_mfma_f32_16x16x32_bf16 v[232:235], a[8:11], a[108:111], v[232:235]
ds_read_b64_tr_b16 a[60:61], v23 offset:4096
v_mfma_f32_16x16x32_bf16 v[236:239], a[12:15], a[108:111], v[236:239]
ds_read_b64_tr_b16 a[62:63], v23 offset:4608
v_mfma_f32_16x16x32_bf16 v[204:207], a[12:15], a[104:107], v[204:207]
buffer_load_dwordx4 a[152:155], v6, s[8:11], s21 offen offset:1024 sc1
ds_read_b64_tr_b16 a[64:65], v20 offset:12288
ds_read_b64_tr_b16 a[66:67], v20 offset:12800
v_mfma_f32_16x16x32_bf16 v[176:179], a[16:19], a[100:103], v[176:179]
v_mfma_f32_16x16x32_bf16 v[208:211], a[16:19], a[104:107], v[208:211]
ds_read_b64_tr_b16 a[68:69], v21 offset:12288
v_mfma_f32_16x16x32_bf16 v[240:243], a[16:19], a[108:111], v[240:243]
ds_read_b64_tr_b16 a[70:71], v21 offset:12800
v_mfma_f32_16x16x32_bf16 v[244:247], a[20:23], a[108:111], v[244:247]
buffer_load_dwordx4 a[156:159], v7, s[8:11], s21 offen offset:1024 sc1
v_mfma_f32_16x16x32_bf16 v[212:215], a[20:23], a[104:107], v[212:215]
v_mfma_f32_16x16x32_bf16 v[180:183], a[20:23], a[100:103], v[180:183]
ds_read_b64_tr_b16 a[72:73], v22 offset:12288
ds_read_b64_tr_b16 a[74:75], v22 offset:12800
v_mfma_f32_16x16x32_bf16 v[184:187], a[24:27], a[100:103], v[184:187]
ds_read_b64_tr_b16 a[76:77], v23 offset:12288
v_mfma_f32_16x16x32_bf16 v[216:219], a[24:27], a[104:107], v[216:219]
buffer_load_dwordx4 v11, s[12:15], s22 offen offset:1024 lds
v_mfma_f32_16x16x32_bf16 v[248:251], a[24:27], a[108:111], v[248:251]
ds_read_b64_tr_b16 a[78:79], v23 offset:12800
v_mfma_f32_16x16x32_bf16 v[252:255], a[28:31], a[108:111], v[252:255]
v_mfma_f32_16x16x32_bf16 v[220:223], a[28:31], a[104:107], v[220:223]
ds_read_b64_tr_b16 a[80:81], v20 offset:20480
v_mfma_f32_16x16x32_bf16 v[188:191], a[28:31], a[100:103], v[188:191]
ds_read_b64_tr_b16 a[82:83], v20 offset:20992
s_add_u32 m0, s23, 16384
s_nop 0
buffer_load_dwordx4 v12, s[12:15], s22 offen offset:0 lds
v_mfma_f32_16x16x32_bf16 v[80:83], a[100:103], a[32:35], v[80:83]
v_mfma_f32_16x16x32_bf16 v[96:99], a[104:107], a[32:35], v[96:99]
ds_read_b64_tr_b16 a[84:85], v21 offset:20480
v_mfma_f32_16x16x32_bf16 v[112:115], a[108:111], a[32:35], v[112:115]
ds_read_b64_tr_b16 a[86:87], v21 offset:20992
v_mfma_f32_16x16x32_bf16 v[116:119], a[108:111], a[36:39], v[116:119]
v_mfma_f32_16x16x32_bf16 v[100:103], a[104:107], a[36:39], v[100:103]
ds_read_b64_tr_b16 a[88:89], v22 offset:20480
v_mfma_f32_16x16x32_bf16 v[84:87], a[100:103], a[36:39], v[84:87]
buffer_load_dwordx4 v13, s[12:15], s22 offen offset:1024 lds
v_readlane_b32 s21, v14, s20
ds_read_b64_tr_b16 a[90:91], v22 offset:20992
v_mfma_f32_16x16x32_bf16 v[88:91], a[100:103], a[40:43], v[88:91]
s_add_u32 s20, s20, 1
v_mfma_f32_16x16x32_bf16 v[104:107], a[104:107], a[40:43], v[104:107]
v_mfma_f32_16x16x32_bf16 v[120:123], a[108:111], a[40:43], v[120:123]
v_readlane_b32 s22, v15, s20
s_waitcnt lgkmcnt(1)
v_mfma_f32_16x16x32_bf16 v[124:127], a[108:111], a[44:47], v[124:127]
ds_read_b64_tr_b16 a[92:93], v23 offset:20480
v_mfma_f32_16x16x32_bf16 v[108:111], a[104:107], a[44:47], v[108:111]
ds_read_b64_tr_b16 a[94:95], v23 offset:20992
v_mfma_f32_16x16x32_bf16 v[92:95], a[100:103], a[44:47], v[92:95]
s_waitcnt vmcnt(14)
s_barrier
ds_read_b64_tr_b16 a[0:1], v20 offset:32768
v_mfma_f32_16x16x32_bf16 v[192:195], a[48:51], a[120:123], v[192:195]
buffer_load_dwordx4 a[96:99], v4, s[8:11], s21 offen offset:0 sc1
v_mfma_f32_16x16x32_bf16 v[224:227], a[48:51], a[124:127], v[224:227]
ds_read_b64_tr_b16 a[2:3], v20 offset:33280
v_mfma_f32_16x16x32_bf16 v[228:231], a[52:55], a[124:127], v[228:231]
v_mfma_f32_16x16x32_bf16 v[196:199], a[52:55], a[120:123], v[196:199]
ds_read_b64_tr_b16 a[4:5], v21 offset:32768
ds_read_b64_tr_b16 a[6:7], v21 offset:33280
buffer_load_dwordx4 a[100:103], v5, s[8:11], s21 offen offset:0 sc1
ds_read_b64_tr_b16 a[8:9], v22 offset:32768
v_mfma_f32_16x16x32_bf16 v[200:203], a[56:59], a[120:123], v[200:203]
ds_read_b64_tr_b16 a[10:11], v22 offset:33280
v_mfma_f32_16x16x32_bf16 v[232:235], a[56:59], a[124:127], v[232:235]
v_mfma_f32_16x16x32_bf16 v[236:239], a[60:63], a[124:127], v[236:239]
ds_read_b64_tr_b16 a[12:13], v23 offset:32768
v_mfma_f32_16x16x32_bf16 v[204:207], a[60:63], a[120:123], v[204:207]
ds_read_b64_tr_b16 a[14:15], v23 offset:33280
buffer_load_dwordx4 a[104:107], v6, s[8:11], s21 offen offset:0 sc1
ds_read_b64_tr_b16 a[16:17], v20 offset:40960
v_mfma_f32_16x16x32_bf16 v[176:179], a[64:67], a[116:119], v[176:179]
ds_read_b64_tr_b16 a[18:19], v20 offset:41472
v_mfma_f32_16x16x32_bf16 v[208:211], a[64:67], a[120:123], v[208:211]
v_mfma_f32_16x16x32_bf16 v[240:243], a[64:67], a[124:127], v[240:243]
ds_read_b64_tr_b16 a[20:21], v21 offset:40960
v_mfma_f32_16x16x32_bf16 v[244:247], a[68:71], a[124:127], v[244:247]
buffer_load_dwordx4 a[108:111], v7, s[8:11], s21 offen offset:0 sc1
v_mfma_f32_16x16x32_bf16 v[212:215], a[68:71], a[120:123], v[212:215]
ds_read_b64_tr_b16 a[22:23], v21 offset:41472
v_mfma_f32_16x16x32_bf16 v[180:183], a[68:71], a[116:119], v[180:183]
ds_read_b64_tr_b16 a[24:25], v22 offset:40960
v_mfma_f32_16x16x32_bf16 v[184:187], a[72:75], a[116:119], v[184:187]
s_add_u32 m0, s23, 32768
v_mfma_f32_16x16x32_bf16 v[216:219], a[72:75], a[120:123], v[216:219]
buffer_load_dwordx4 v8, s[12:15], s22 offen offset:0 lds
v_mfma_f32_16x16x32_bf16 v[248:251], a[72:75], a[124:127], v[248:251]
ds_read_b64_tr_b16 a[26:27], v22 offset:41472
v_mfma_f32_16x16x32_bf16 v[252:255], a[76:79], a[124:127], v[252:255]
ds_read_b64_tr_b16 a[28:29], v23 offset:40960
v_mfma_f32_16x16x32_bf16 v[220:223], a[76:79], a[120:123], v[220:223]
v_mfma_f32_16x16x32_bf16 v[188:191], a[76:79], a[116:119], v[188:191]
ds_read_b64_tr_b16 a[30:31], v23 offset:41472
ds_read_b64_tr_b16 a[32:33], v20 offset:49152
buffer_load_dwordx4 v9, s[12:15], s22 offen offset:1024 lds
v_mfma_f32_16x16x32_bf16 v[80:83], a[116:119], a[80:83], v[80:83]
v_mfma_f32_16x16x32_bf16 v[96:99], a[120:123], a[80:83], v[96:99]
ds_read_b64_tr_b16 a[34:35], v20 offset:49664
v_mfma_f32_16x16x32_bf16 v[112:115], a[124:127], a[80:83], v[112:115]
ds_read_b64_tr_b16 a[36:37], v21 offset:49152
v_mfma_f32_16x16x32_bf16 v[116:119], a[124:127], a[84:87], v[116:119]
v_mfma_f32_16x16x32_bf16 v[100:103], a[120:123], a[84:87], v[100:103]
s_add_u32 m0, s23, 40960
v_mfma_f32_16x16x32_bf16 v[84:87], a[116:119], a[84:87], v[84:87]
buffer_load_dwordx4 v10, s[12:15], s22 offen offset:0 lds
ds_read_b64_tr_b16 a[38:39], v21 offset:49664
s_waitcnt lgkmcnt(2)
ds_read_b64_tr_b16 a[40:41], v22 offset:49152
v_mfma_f32_16x16x32_bf16 v[88:91], a[116:119], a[88:91], v[88:91]
v_mfma_f32_16x16x32_bf16 v[104:107], a[120:123], a[88:91], v[104:107]
ds_read_b64_tr_b16 a[42:43], v22 offset:49664
v_mfma_f32_16x16x32_bf16 v[120:123], a[124:127], a[88:91], v[120:123]
ds_read_b64_tr_b16 a[44:45], v23 offset:49152
v_mfma_f32_16x16x32_bf16 v[124:127], a[124:127], a[92:95], v[124:127]
v_mfma_f32_16x16x32_bf16 v[108:111], a[120:123], a[92:95], v[108:111]
ds_read_b64_tr_b16 a[46:47], v23 offset:49664
v_mfma_f32_16x16x32_bf16 v[92:95], a[116:119], a[92:95], v[92:95]
s_waitcnt vmcnt(17)
ds_read_b64_tr_b16 a[48:49], v20 offset:36864
ds_read_b64_tr_b16 a[50:51], v20 offset:37376
v_mfma_f32_16x16x32_bf16 v[192:195], a[0:3], a[136:139], v[192:195]
buffer_load_dwordx4 a[112:115], v4, s[8:11], s21 offen offset:1024 sc1
v_mfma_f32_16x16x32_bf16 v[224:227], a[0:3], a[140:143], v[224:227]
v_mfma_f32_16x16x32_bf16 v[228:231], a[4:7], a[140:143], v[228:231]
ds_read_b64_tr_b16 a[52:53], v21 offset:36864
v_mfma_f32_16x16x32_bf16 v[196:199], a[4:7], a[136:139], v[196:199]
ds_read_b64_tr_b16 a[54:55], v21 offset:37376
ds_read_b64_tr_b16 a[56:57], v22 offset:36864
buffer_load_dwordx4 a[116:119], v5, s[8:11], s21 offen offset:1024 sc1
ds_read_b64_tr_b16 a[58:59], v22 offset:37376
v_mfma_f32_16x16x32_bf16 v[200:203], a[8:11], a[136:139], v[200:203]
v_mfma_f32_16x16x32_bf16 v[232:235], a[8:11], a[140:143], v[232:235]
ds_read_b64_tr_b16 a[60:61], v23 offset:36864
v_mfma_f32_16x16x32_bf16 v[236:239], a[12:15], a[140:143], v[236:239]
ds_read_b64_tr_b16 a[62:63], v23 offset:37376
v_mfma_f32_16x16x32_bf16 v[204:207], a[12:15], a[136:139], v[204:207]
buffer_load_dwordx4 a[120:123], v6, s[8:11], s21 offen offset:1024 sc1
ds_read_b64_tr_b16 a[64:65], v20 offset:45056
ds_read_b64_tr_b16 a[66:67], v20 offset:45568
v_mfma_f32_16x16x32_bf16 v[176:179], a[16:19], a[132:135], v[176:179]
v_mfma_f32_16x16x32_bf16 v[208:211], a[16:19], a[136:139], v[208:211]
ds_read_b64_tr_b16 a[68:69], v21 offset:45056
v_mfma_f32_16x16x32_bf16 v[240:243], a[16:19], a[140:143], v[240:243]
ds_read_b64_tr_b16 a[70:71], v21 offset:45568
v_mfma_f32_16x16x32_bf16 v[244:247], a[20:23], a[140:143], v[244:247]
buffer_load_dwordx4 a[124:127], v7, s[8:11], s21 offen offset:1024 sc1
v_mfma_f32_16x16x32_bf16 v[212:215], a[20:23], a[136:139], v[212:215]
v_mfma_f32_16x16x32_bf16 v[180:183], a[20:23], a[132:135], v[180:183]
ds_read_b64_tr_b16 a[72:73], v22 offset:45056
ds_read_b64_tr_b16 a[74:75], v22 offset:45568
v_mfma_f32_16x16x32_bf16 v[184:187], a[24:27], a[132:135], v[184:187]
ds_read_b64_tr_b16 a[76:77], v23 offset:45056
v_mfma_f32_16x16x32_bf16 v[216:219], a[24:27], a[136:139], v[216:219]
buffer_load_dwordx4 v11, s[12:15], s22 offen offset:1024 lds
v_mfma_f32_16x16x32_bf16 v[248:251], a[24:27], a[140:143], v[248:251]
ds_read_b64_tr_b16 a[78:79], v23 offset:45568
v_mfma_f32_16x16x32_bf16 v[252:255], a[28:31], a[140:143], v[252:255]
v_mfma_f32_16x16x32_bf16 v[220:223], a[28:31], a[136:139], v[220:223]
ds_read_b64_tr_b16 a[80:81], v20 offset:53248
v_mfma_f32_16x16x32_bf16 v[188:191], a[28:31], a[132:135], v[188:191]
ds_read_b64_tr_b16 a[82:83], v20 offset:53760
s_add_u32 m0, s23, 49152
s_nop 0
buffer_load_dwordx4 v12, s[12:15], s22 offen offset:0 lds
v_mfma_f32_16x16x32_bf16 v[80:83], a[132:135], a[32:35], v[80:83]
v_mfma_f32_16x16x32_bf16 v[96:99], a[136:139], a[32:35], v[96:99]
ds_read_b64_tr_b16 a[84:85], v21 offset:53248
v_mfma_f32_16x16x32_bf16 v[112:115], a[140:143], a[32:35], v[112:115]
ds_read_b64_tr_b16 a[86:87], v21 offset:53760
s_waitcnt lgkmcnt(2)
v_mfma_f32_16x16x32_bf16 v[116:119], a[140:143], a[36:39], v[116:119]
v_mfma_f32_16x16x32_bf16 v[100:103], a[136:139], a[36:39], v[100:103]
ds_read_b64_tr_b16 a[88:89], v22 offset:53248
v_mfma_f32_16x16x32_bf16 v[84:87], a[132:135], a[36:39], v[84:87]
buffer_load_dwordx4 v13, s[12:15], s22 offen offset:1024 lds
v_readlane_b32 s21, v14, s20
ds_read_b64_tr_b16 a[90:91], v22 offset:53760
v_mfma_f32_16x16x32_bf16 v[88:91], a[132:135], a[40:43], v[88:91]
s_add_u32 s20, s20, 1
v_mfma_f32_16x16x32_bf16 v[104:107], a[136:139], a[40:43], v[104:107]
v_mfma_f32_16x16x32_bf16 v[120:123], a[140:143], a[40:43], v[120:123]
v_readlane_b32 s22, v15, s20
v_mfma_f32_16x16x32_bf16 v[124:127], a[140:143], a[44:47], v[124:127]
ds_read_b64_tr_b16 a[92:93], v23 offset:53248
v_mfma_f32_16x16x32_bf16 v[108:111], a[136:139], a[44:47], v[108:111]
ds_read_b64_tr_b16 a[94:95], v23 offset:53760
v_mfma_f32_16x16x32_bf16 v[92:95], a[132:135], a[44:47], v[92:95]
s_waitcnt vmcnt(14)
s_barrier
ds_read_b64_tr_b16 a[0:1], v16 offset:0
v_mfma_f32_16x16x32_bf16 v[192:195], a[48:51], a[152:155], v[192:195]
buffer_load_dwordx4 a[128:131], v4, s[8:11], s21 offen offset:0 sc1
v_mfma_f32_16x16x32_bf16 v[224:227], a[48:51], a[156:159], v[224:227]
ds_read_b64_tr_b16 a[2:3], v16 offset:512
v_mfma_f32_16x16x32_bf16 v[228:231], a[52:55], a[156:159], v[228:231]
v_mfma_f32_16x16x32_bf16 v[196:199], a[52:55], a[152:155], v[196:199]
ds_read_b64_tr_b16 a[4:5], v17 offset:0
ds_read_b64_tr_b16 a[6:7], v17 offset:512
buffer_load_dwordx4 a[132:135], v5, s[8:11], s21 offen offset:0 sc1
ds_read_b64_tr_b16 a[8:9], v18 offset:0
v_mfma_f32_16x16x32_bf16 v[200:203], a[56:59], a[152:155], v[200:203]
ds_read_b64_tr_b16 a[10:11], v18 offset:512
v_mfma_f32_16x16x32_bf16 v[232:235], a[56:59], a[156:159], v[232:235]
v_mfma_f32_16x16x32_bf16 v[236:239], a[60:63], a[156:159], v[236:239]
ds_read_b64_tr_b16 a[12:13], v19 offset:0
v_mfma_f32_16x16x32_bf16 v[204:207], a[60:63], a[152:155], v[204:207]
ds_read_b64_tr_b16 a[14:15], v19 offset:512
buffer_load_dwordx4 a[136:139], v6, s[8:11], s21 offen offset:0 sc1
ds_read_b64_tr_b16 a[16:17], v16 offset:8192
v_mfma_f32_16x16x32_bf16 v[176:179], a[64:67], a[148:151], v[176:179]
ds_read_b64_tr_b16 a[18:19], v16 offset:8704
v_mfma_f32_16x16x32_bf16 v[208:211], a[64:67], a[152:155], v[208:211]
v_mfma_f32_16x16x32_bf16 v[240:243], a[64:67], a[156:159], v[240:243]
ds_read_b64_tr_b16 a[20:21], v17 offset:8192
v_mfma_f32_16x16x32_bf16 v[244:247], a[68:71], a[156:159], v[244:247]
buffer_load_dwordx4 a[140:143], v7, s[8:11], s21 offen offset:0 sc1
v_mfma_f32_16x16x32_bf16 v[212:215], a[68:71], a[152:155], v[212:215]
ds_read_b64_tr_b16 a[22:23], v17 offset:8704
v_mfma_f32_16x16x32_bf16 v[180:183], a[68:71], a[148:151], v[180:183]
ds_read_b64_tr_b16 a[24:25], v18 offset:8192
v_mfma_f32_16x16x32_bf16 v[184:187], a[72:75], a[148:151], v[184:187]
s_add_u32 m0, s23, 65536
v_mfma_f32_16x16x32_bf16 v[216:219], a[72:75], a[152:155], v[216:219]
buffer_load_dwordx4 v8, s[12:15], s22 offen offset:0 lds
v_mfma_f32_16x16x32_bf16 v[248:251], a[72:75], a[156:159], v[248:251]
ds_read_b64_tr_b16 a[26:27], v18 offset:8704
v_mfma_f32_16x16x32_bf16 v[252:255], a[76:79], a[156:159], v[252:255]
ds_read_b64_tr_b16 a[28:29], v19 offset:8192
v_mfma_f32_16x16x32_bf16 v[220:223], a[76:79], a[152:155], v[220:223]
v_mfma_f32_16x16x32_bf16 v[188:191], a[76:79], a[148:151], v[188:191]
ds_read_b64_tr_b16 a[30:31], v19 offset:8704
ds_read_b64_tr_b16 a[32:33], v16 offset:16384
buffer_load_dwordx4 v9, s[12:15], s22 offen offset:1024 lds
v_mfma_f32_16x16x32_bf16 v[80:83], a[148:151], a[80:83], v[80:83]
v_mfma_f32_16x16x32_bf16 v[96:99], a[152:155], a[80:83], v[96:99]
ds_read_b64_tr_b16 a[34:35], v16 offset:16896
v_mfma_f32_16x16x32_bf16 v[112:115], a[156:159], a[80:83], v[112:115]
ds_read_b64_tr_b16 a[36:37], v17 offset:16384
s_waitcnt lgkmcnt(3)
v_mfma_f32_16x16x32_bf16 v[116:119], a[156:159], a[84:87], v[116:119]
v_mfma_f32_16x16x32_bf16 v[100:103], a[152:155], a[84:87], v[100:103]
s_add_u32 m0, s23, 73728
v_mfma_f32_16x16x32_bf16 v[84:87], a[148:151], a[84:87], v[84:87]
buffer_load_dwordx4 v10, s[12:15], s22 offen offset:0 lds
ds_read_b64_tr_b16 a[38:39], v17 offset:16896
ds_read_b64_tr_b16 a[40:41], v18 offset:16384
v_mfma_f32_16x16x32_bf16 v[88:91], a[148:151], a[88:91], v[88:91]
v_mfma_f32_16x16x32_bf16 v[104:107], a[152:155], a[88:91], v[104:107]
ds_read_b64_tr_b16 a[42:43], v18 offset:16896
v_mfma_f32_16x16x32_bf16 v[120:123], a[156:159], a[88:91], v[120:123]
ds_read_b64_tr_b16 a[44:45], v19 offset:16384
v_mfma_f32_16x16x32_bf16 v[124:127], a[156:159], a[92:95], v[124:127]
v_mfma_f32_16x16x32_bf16 v[108:111], a[152:155], a[92:95], v[108:111]
ds_read_b64_tr_b16 a[46:47], v19 offset:16896
v_mfma_f32_16x16x32_bf16 v[92:95], a[148:151], a[92:95], v[92:95]
s_sub_u32 s30, s30, 1
s_waitcnt vmcnt(17)
s_cbranch_scc0 Lq_loop1a
s_waitcnt lgkmcnt(2)
ds_read_b64_tr_b16 a[48:49], v16 offset:4096
ds_read_b64_tr_b16 a[50:51], v16 offset:4608
v_mfma_f32_16x16x32_bf16 v[192:195], a[0:3], a[104:107], v[192:195]
buffer_load_dwordx4 a[144:147], v4, s[8:11], s21 offen offset:1024 sc1
v_mfma_f32_16x16x32_bf16 v[224:227], a[0:3], a[108:111], v[224:227]
ds_read_b64_tr_b16 a[52:53], v17 offset:4096
v_mfma_f32_16x16x32_bf16 v[228:231], a[4:7], a[108:111], v[228:231]
v_mfma_f32_16x16x32_bf16 v[196:199], a[4:7], a[104:107], v[196:199]
ds_read_b64_tr_b16 a[54:55], v17 offset:4608
ds_read_b64_tr_b16 a[56:57], v18 offset:4096
buffer_load_dwordx4 a[148:151], v5, s[8:11], s21 offen offset:1024 sc1
ds_read_b64_tr_b16 a[58:59], v18 offset:4608
v_mfma_f32_16x16x32_bf16 v[200:203], a[8:11], a[104:107], v[200:203]
ds_read_b64_tr_b16 a[60:61], v19 offset:4096
v_mfma_f32_16x16x32_bf16 v[232:235], a[8:11], a[108:111], v[232:235]
v_mfma_f32_16x16x32_bf16 v[236:239], a[12:15], a[108:111], v[236:239]
buffer_load_dwordx4 a[152:155], v6, s[8:11], s21 offen offset:1024 sc1
v_mfma_f32_16x16x32_bf16 v[204:207], a[12:15], a[104:107], v[204:207]
ds_read_b64_tr_b16 a[62:63], v19 offset:4608
ds_read_b64_tr_b16 a[64:65], v16 offset:12288
ds_read_b64_tr_b16 a[66:67], v16 offset:12800
v_mfma_f32_16x16x32_bf16 v[176:179], a[16:19], a[100:103], v[176:179]
buffer_load_dwordx4 a[156:159], v7, s[8:11], s21 offen offset:1024 sc1
v_mfma_f32_16x16x32_bf16 v[208:211], a[16:19], a[104:107], v[208:211]
ds_read_b64_tr_b16 a[68:69], v17 offset:12288
v_mfma_f32_16x16x32_bf16 v[240:243], a[16:19], a[108:111], v[240:243]
v_mfma_f32_16x16x32_bf16 v[244:247], a[20:23], a[108:111], v[244:247]
ds_read_b64_tr_b16 a[70:71], v17 offset:12800
v_mfma_f32_16x16x32_bf16 v[212:215], a[20:23], a[104:107], v[212:215]
ds_read_b64_tr_b16 a[72:73], v18 offset:12288
v_mfma_f32_16x16x32_bf16 v[180:183], a[20:23], a[100:103], v[180:183]
buffer_load_dwordx4 v11, s[12:15], s22 offen offset:1024 lds
ds_read_b64_tr_b16 a[74:75], v18 offset:12800
v_mfma_f32_16x16x32_bf16 v[184:187], a[24:27], a[100:103], v[184:187]
ds_read_b64_tr_b16 a[76:77], v19 offset:12288
v_mfma_f32_16x16x32_bf16 v[216:219], a[24:27], a[104:107], v[216:219]
s_add_u32 m0, s23, 81920
v_mfma_f32_16x16x32_bf16 v[248:251], a[24:27], a[108:111], v[248:251]
buffer_load_dwordx4 v12, s[12:15], s22 offen offset:0 lds
v_mfma_f32_16x16x32_bf16 v[252:255], a[28:31], a[108:111], v[252:255]
ds_read_b64_tr_b16 a[78:79], v19 offset:12800
v_mfma_f32_16x16x32_bf16 v[220:223], a[28:31], a[104:107], v[220:223]
v_mfma_f32_16x16x32_bf16 v[188:191], a[28:31], a[100:103], v[188:191]
ds_read_b64_tr_b16 a[80:81], v16 offset:20480
ds_read_b64_tr_b16 a[82:83], v16 offset:20992
buffer_load_dwordx4 v13, s[12:15], s22 offen offset:1024 lds
v_mfma_f32_16x16x32_bf16 v[80:83], a[100:103], a[32:35], v[80:83]
v_mfma_f32_16x16x32_bf16 v[96:99], a[104:107], a[32:35], v[96:99]
ds_read_b64_tr_b16 a[84:85], v17 offset:20480
v_mfma_f32_16x16x32_bf16 v[112:115], a[108:111], a[32:35], v[112:115]
ds_read_b64_tr_b16 a[86:87], v17 offset:20992
v_mfma_f32_16x16x32_bf16 v[116:119], a[108:111], a[36:39], v[116:119]
v_mfma_f32_16x16x32_bf16 v[100:103], a[104:107], a[36:39], v[100:103]
buffer_load_dword v28, v29, s[40:43], 0 offen sc1
v_mfma_f32_16x16x32_bf16 v[84:87], a[100:103], a[36:39], v[84:87]
v_readlane_b32 s21, v14, s20
ds_read_b64_tr_b16 a[88:89], v18 offset:20480
s_add_u32 s20, s20, 1
v_mfma_f32_16x16x32_bf16 v[88:91], a[100:103], a[40:43], v[88:91]
ds_read_b64_tr_b16 a[90:91], v18 offset:20992
v_mfma_f32_16x16x32_bf16 v[104:107], a[104:107], a[40:43], v[104:107]
v_readlane_b32 s22, v15, s20
v_mfma_f32_16x16x32_bf16 v[120:123], a[108:111], a[40:43], v[120:123]
s_waitcnt lgkmcnt(2)
v_mfma_f32_16x16x32_bf16 v[124:127], a[108:111], a[44:47], v[124:127]
ds_read_b64_tr_b16 a[92:93], v19 offset:20480
v_mfma_f32_16x16x32_bf16 v[108:111], a[104:107], a[44:47], v[108:111]
ds_read_b64_tr_b16 a[94:95], v19 offset:20992
v_mfma_f32_16x16x32_bf16 v[92:95], a[100:103], a[44:47], v[92:95]
s_waitcnt vmcnt(15)
s_barrier
ds_read_b64_tr_b16 a[0:1], v16 offset:32768
v_mfma_f32_16x16x32_bf16 v[192:195], a[48:51], a[120:123], v[192:195]
buffer_load_dwordx4 a[96:99], v4, s[8:11], s21 offen offset:0 sc1
v_mfma_f32_16x16x32_bf16 v[224:227], a[48:51], a[124:127], v[224:227]
ds_read_b64_tr_b16 a[2:3], v16 offset:33280
v_mfma_f32_16x16x32_bf16 v[228:231], a[52:55], a[124:127], v[228:231]
v_mfma_f32_16x16x32_bf16 v[196:199], a[52:55], a[120:123], v[196:199]
ds_read_b64_tr_b16 a[4:5], v17 offset:32768
ds_read_b64_tr_b16 a[6:7], v17 offset:33280
buffer_load_dwordx4 a[100:103], v5, s[8:11], s21 offen offset:0 sc1
ds_read_b64_tr_b16 a[8:9], v18 offset:32768
v_mfma_f32_16x16x32_bf16 v[200:203], a[56:59], a[120:123], v[200:203]
ds_read_b64_tr_b16 a[10:11], v18 offset:33280
v_mfma_f32_16x16x32_bf16 v[232:235], a[56:59], a[124:127], v[232:235]
v_mfma_f32_16x16x32_bf16 v[236:239], a[60:63], a[124:127], v[236:239]
ds_read_b64_tr_b16 a[12:13], v19 offset:32768
v_mfma_f32_16x16x32_bf16 v[204:207], a[60:63], a[120:123], v[204:207]
ds_read_b64_tr_b16 a[14:15], v19 offset:33280
buffer_load_dwordx4 a[104:107], v6, s[8:11], s21 offen offset:0 sc1
ds_read_b64_tr_b16 a[16:17], v16 offset:40960
v_mfma_f32_16x16x32_bf16 v[176:179], a[64:67], a[116:119], v[176:179]
ds_read_b64_tr_b16 a[18:19], v16 offset:41472
v_mfma_f32_16x16x32_bf16 v[208:211], a[64:67], a[120:123], v[208:211]
v_mfma_f32_16x16x32_bf16 v[240:243], a[64:67], a[124:127], v[240:243]
ds_read_b64_tr_b16 a[20:21], v17 offset:40960
v_mfma_f32_16x16x32_bf16 v[244:247], a[68:71], a[124:127], v[244:247]
buffer_load_dwordx4 a[108:111], v7, s[8:11], s21 offen offset:0 sc1
v_mfma_f32_16x16x32_bf16 v[212:215], a[68:71], a[120:123], v[212:215]
ds_read_b64_tr_b16 a[22:23], v17 offset:41472
v_mfma_f32_16x16x32_bf16 v[180:183], a[68:71], a[116:119], v[180:183]
ds_read_b64_tr_b16 a[24:25], v18 offset:40960
v_mfma_f32_16x16x32_bf16 v[184:187], a[72:75], a[116:119], v[184:187]
s_add_u32 m0, s23, 98304
v_mfma_f32_16x16x32_bf16 v[216:219], a[72:75], a[120:123], v[216:219]
buffer_load_dwordx4 v8, s[12:15], s22 offen offset:0 lds
v_mfma_f32_16x16x32_bf16 v[248:251], a[72:75], a[124:127], v[248:251]
ds_read_b64_tr_b16 a[26:27], v18 offset:41472
v_mfma_f32_16x16x32_bf16 v[252:255], a[76:79], a[124:127], v[252:255]
ds_read_b64_tr_b16 a[28:29], v19 offset:40960
v_mfma_f32_16x16x32_bf16 v[220:223], a[76:79], a[120:123], v[220:223]
v_mfma_f32_16x16x32_bf16 v[188:191], a[76:79], a[116:119], v[188:191]
ds_read_b64_tr_b16 a[30:31], v19 offset:41472
ds_read_b64_tr_b16 a[32:33], v16 offset:49152
buffer_load_dwordx4 v9, s[12:15], s22 offen offset:1024 lds
v_mfma_f32_16x16x32_bf16 v[80:83], a[116:119], a[80:83], v[80:83]
v_mfma_f32_16x16x32_bf16 v[96:99], a[120:123], a[80:83], v[96:99]
ds_read_b64_tr_b16 a[34:35], v16 offset:49664
v_mfma_f32_16x16x32_bf16 v[112:115], a[124:127], a[80:83], v[112:115]
ds_read_b64_tr_b16 a[36:37], v17 offset:49152
v_mfma_f32_16x16x32_bf16 v[116:119], a[124:127], a[84:87], v[116:119]
v_mfma_f32_16x16x32_bf16 v[100:103], a[120:123], a[84:87], v[100:103]
s_add_u32 m0, s23, 106496
v_mfma_f32_16x16x32_bf16 v[84:87], a[116:119], a[84:87], v[84:87]
buffer_load_dwordx4 v10, s[12:15], s22 offen offset:0 lds
ds_read_b64_tr_b16 a[38:39], v17 offset:49664
s_waitcnt lgkmcnt(2)
ds_read_b64_tr_b16 a[40:41], v18 offset:49152
v_mfma_f32_16x16x32_bf16 v[88:91], a[116:119], a[88:91], v[88:91]
v_mfma_f32_16x16x32_bf16 v[104:107], a[120:123], a[88:91], v[104:107]
ds_read_b64_tr_b16 a[42:43], v18 offset:49664
v_mfma_f32_16x16x32_bf16 v[120:123], a[124:127], a[88:91], v[120:123]
ds_read_b64_tr_b16 a[44:45], v19 offset:49152
v_mfma_f32_16x16x32_bf16 v[124:127], a[124:127], a[92:95], v[124:127]
v_mfma_f32_16x16x32_bf16 v[108:111], a[120:123], a[92:95], v[108:111]
ds_read_b64_tr_b16 a[46:47], v19 offset:49664
v_mfma_f32_16x16x32_bf16 v[92:95], a[116:119], a[92:95], v[92:95]
s_waitcnt vmcnt(18)
ds_read_b64_tr_b16 a[48:49], v16 offset:36864
ds_read_b64_tr_b16 a[50:51], v16 offset:37376
s_mov_b32 s31, 16
v_mfma_f32_16x16x32_bf16 v[192:195], a[0:3], a[136:139], v[192:195]
buffer_load_dwordx4 a[112:115], v4, s[8:11], s21 offen offset:1024 sc1
v_readlane_b32 s28, v14, s31
v_mfma_f32_16x16x32_bf16 v[224:227], a[0:3], a[140:143], v[224:227]
ds_read_b64_tr_b16 a[52:53], v17 offset:36864
v_mfma_f32_16x16x32_bf16 v[228:231], a[4:7], a[140:143], v[228:231]
v_mfma_f32_16x16x32_bf16 v[196:199], a[4:7], a[136:139], v[196:199]
ds_read_b64_tr_b16 a[54:55], v17 offset:37376
ds_read_b64_tr_b16 a[56:57], v18 offset:36864
buffer_load_dwordx4 a[116:119], v5, s[8:11], s21 offen offset:1024 sc1
ds_read_b64_tr_b16 a[58:59], v18 offset:37376
v_mfma_f32_16x16x32_bf16 v[200:203], a[8:11], a[136:139], v[200:203]
ds_read_b64_tr_b16 a[60:61], v19 offset:36864
s_waitcnt vmcnt(9)
v_cmp_ne_u32 vcc, s78, v28
v_mfma_f32_16x16x32_bf16 v[232:235], a[8:11], a[140:143], v[232:235]
v_mfma_f32_16x16x32_bf16 v[236:239], a[12:15], a[140:143], v[236:239]
ds_read_b64_tr_b16 a[62:63], v19 offset:37376
v_mfma_f32_16x16x32_bf16 v[204:207], a[12:15], a[136:139], v[204:207]
ds_read_b64_tr_b16 a[64:65], v16 offset:45056
s_cbranch_vccz Lok_6a
s_mov_b32 s79, 32768
Lspin_5a:
buffer_load_dword v28, v29, s[40:43], 0 offen sc1
s_waitcnt vmcnt(0)
v_cmp_ne_u32 vcc, s78, v28
s_sub_u32 s79, s79, 1
s_cbranch_scc1 Lok_6a
s_cbranch_vccnz Lspin_5a
Lok_6a:
buffer_load_dwordx4 a[120:123], v6, s[8:11], s21 offen offset:1024 sc1
ds_read_b64_tr_b16 a[66:67], v16 offset:45568
v_mfma_f32_16x16x32_bf16 v[176:179], a[16:19], a[132:135], v[176:179]
ds_read_b64_tr_b16 a[68:69], v17 offset:45056
v_mfma_f32_16x16x32_bf16 v[208:211], a[16:19], a[136:139], v[208:211]
v_mfma_f32_16x16x32_bf16 v[240:243], a[16:19], a[140:143], v[240:243]
ds_read_b64_tr_b16 a[70:71], v17 offset:45568
v_mfma_f32_16x16x32_bf16 v[244:247], a[20:23], a[140:143], v[244:247]
buffer_load_dwordx4 a[124:127], v7, s[8:11], s21 offen offset:1024 sc1
v_mfma_f32_16x16x32_bf16 v[212:215], a[20:23], a[136:139], v[212:215]
ds_read_b64_tr_b16 a[72:73], v18 offset:45056
v_mfma_f32_16x16x32_bf16 v[180:183], a[20:23], a[132:135], v[180:183]
ds_read_b64_tr_b16 a[74:75], v18 offset:45568
ds_read_b64_tr_b16 a[76:77], v19 offset:45056
v_mfma_f32_16x16x32_bf16 v[184:187], a[24:27], a[132:135], v[184:187]
ds_read_b64_tr_b16 a[78:79], v19 offset:45568
v_mfma_f32_16x16x32_bf16 v[216:219], a[24:27], a[136:139], v[216:219]
buffer_load_dwordx4 v11, s[12:15], s22 offen offset:1024 lds
v_mfma_f32_16x16x32_bf16 v[248:251], a[24:27], a[140:143], v[248:251]
v_mfma_f32_16x16x32_bf16 v[252:255], a[28:31], a[140:143], v[252:255]
ds_read_b64_tr_b16 a[80:81], v16 offset:53248
v_mfma_f32_16x16x32_bf16 v[220:223], a[28:31], a[136:139], v[220:223]
ds_read_b64_tr_b16 a[82:83], v16 offset:53760
v_mfma_f32_16x16x32_bf16 v[188:191], a[28:31], a[132:135], v[188:191]
s_add_u32 m0, s23, 114688
s_nop 0
buffer_load_dwordx4 v12, s[12:15], s22 offen offset:0 lds
v_mfma_f32_16x16x32_bf16 v[80:83], a[132:135], a[32:35], v[80:83]
ds_read_b64_tr_b16 a[84:85], v17 offset:53248
v_mfma_f32_16x16x32_bf16 v[96:99], a[136:139], a[32:35], v[96:99]
ds_read_b64_tr_b16 a[86:87], v17 offset:53760
v_mfma_f32_16x16x32_bf16 v[112:115], a[140:143], a[32:35], v[112:115]
s_waitcnt lgkmcnt(2)
v_mfma_f32_16x16x32_bf16 v[116:119], a[140:143], a[36:39], v[116:119]
ds_read_b64_tr_b16 a[88:89], v18 offset:53248
v_mfma_f32_16x16x32_bf16 v[100:103], a[136:139], a[36:39], v[100:103]
ds_read_b64_tr_b16 a[90:91], v18 offset:53760
v_mfma_f32_16x16x32_bf16 v[84:87], a[132:135], a[36:39], v[84:87]
buffer_load_dwordx4 v13, s[12:15], s22 offen offset:1024 lds
v_readlane_b32 s21, v14, s20
v_mfma_f32_16x16x32_bf16 v[88:91], a[132:135], a[40:43], v[88:91]
v_accvgpr_read_b32 v8, a208
v_accvgpr_read_b32 v9, a209
v_mfma_f32_16x16x32_bf16 v[104:107], a[136:139], a[40:43], v[104:107]
ds_read_b64_tr_b16 a[92:93], v19 offset:53248
v_mfma_f32_16x16x32_bf16 v[120:123], a[140:143], a[40:43], v[120:123]
v_accvgpr_read_b32 v10, a210
v_accvgpr_read_b32 v11, a211
v_mfma_f32_16x16x32_bf16 v[124:127], a[140:143], a[44:47], v[124:127]
ds_read_b64_tr_b16 a[94:95], v19 offset:53760
v_mfma_f32_16x16x32_bf16 v[108:111], a[136:139], a[44:47], v[108:111]
v_accvgpr_read_b32 v12, a212
v_accvgpr_read_b32 v13, a213
v_mfma_f32_16x16x32_bf16 v[92:95], a[132:135], a[44:47], v[92:95]
s_barrier
ds_read_b64_tr_b16 a[0:1], v20 offset:0
v_mfma_f32_16x16x32_bf16 v[192:195], a[48:51], a[152:155], v[192:195]
buffer_load_dwordx4 a[128:131], v4, s[8:11], s21 offen offset:0 sc1
v_mfma_f32_16x16x32_bf16 v[224:227], a[48:51], a[156:159], v[224:227]
ds_read_b64_tr_b16 a[2:3], v20 offset:512
v_mfma_f32_16x16x32_bf16 v[228:231], a[52:55], a[156:159], v[228:231]
ds_read_b64_tr_b16 a[4:5], v21 offset:0
v_mfma_f32_16x16x32_bf16 v[196:199], a[52:55], a[152:155], v[196:199]
buffer_load_dwordx4 a[132:135], v5, s[8:11], s21 offen offset:0 sc1
ds_read_b64_tr_b16 a[6:7], v21 offset:512
buffer_load_dwordx4 a[136:139], v6, s[8:11], s21 offen offset:0 sc1
ds_read_b64_tr_b16 a[8:9], v22 offset:0
v_mfma_f32_16x16x32_bf16 v[200:203], a[56:59], a[152:155], v[200:203]
ds_read_b64_tr_b16 a[10:11], v22 offset:512
v_mfma_f32_16x16x32_bf16 v[232:235], a[56:59], a[156:159], v[232:235]
buffer_load_dwordx4 a[140:143], v7, s[8:11], s21 offen offset:0 sc1
v_mfma_f32_16x16x32_bf16 v[236:239], a[60:63], a[156:159], v[236:239]
v_mfma_f32_16x16x32_bf16 v[204:207], a[60:63], a[152:155], v[204:207]
s_add_u32 m0, s24, 0
s_nop 0
buffer_load_dwordx4 v8, s[8:11], s28 offen offset:0 sc1 lds
ds_read_b64_tr_b16 a[12:13], v23 offset:0
ds_read_b64_tr_b16 a[14:15], v23 offset:512
v_mfma_f32_16x16x32_bf16 v[176:179], a[64:67], a[148:151], v[176:179]
buffer_load_dwordx4 v8, s[8:11], s28 offen offset:1024 sc1 lds
v_mfma_f32_16x16x32_bf16 v[208:211], a[64:67], a[152:155], v[208:211]
ds_read_b64_tr_b16 a[16:17], v20 offset:8192
v_mfma_f32_16x16x32_bf16 v[240:243], a[64:67], a[156:159], v[240:243]
v_mfma_f32_16x16x32_bf16 v[244:247], a[68:71], a[156:159], v[244:247]
buffer_load_dwordx4 v9, s[8:11], s28 offen offset:2048 sc1 lds
v_mfma_f32_16x16x32_bf16 v[212:215], a[68:71], a[152:155], v[212:215]
ds_read_b64_tr_b16 a[18:19], v20 offset:8704
v_mfma_f32_16x16x32_bf16 v[180:183], a[68:71], a[148:151], v[180:183]
ds_read_b64_tr_b16 a[20:21], v21 offset:8192
buffer_load_dwordx4 v9, s[8:11], s28 offen offset:3072 sc1 lds
ds_read_b64_tr_b16 a[22:23], v21 offset:8704
s_mul_i32 s29, s28, 224
v_mfma_f32_16x16x32_bf16 v[184:187], a[72:75], a[148:151], v[184:187]
s_add_u32 m0, s24, 147456
v_mfma_f32_16x16x32_bf16 v[216:219], a[72:75], a[152:155], v[216:219]
buffer_load_dwordx4 v33, s[48:51], 0 offen offset:0 lds
v_mfma_f32_16x16x32_bf16 v[248:251], a[72:75], a[156:159], v[248:251]
v_mfma_f32_16x16x32_bf16 v[252:255], a[76:79], a[156:159], v[252:255]
ds_read_b64_tr_b16 a[24:25], v22 offset:8192
v_mfma_f32_16x16x32_bf16 v[220:223], a[76:79], a[152:155], v[220:223]
buffer_load_dwordx4 v34, s[48:51], 0 offen offset:1024 lds
v_mfma_f32_16x16x32_bf16 v[188:191], a[76:79], a[148:151], v[188:191]
ds_read_b64_tr_b16 a[26:27], v22 offset:8704
ds_read_b64_tr_b16 a[28:29], v23 offset:8192
buffer_load_dwordx4 v35, s[48:51], 0 offen offset:2048 lds
v_mfma_f32_16x16x32_bf16 v[80:83], a[148:151], a[80:83], v[80:83]
v_mfma_f32_16x16x32_bf16 v[96:99], a[152:155], a[80:83], v[96:99]
ds_read_b64_tr_b16 a[30:31], v23 offset:8704
v_mfma_f32_16x16x32_bf16 v[112:115], a[156:159], a[80:83], v[112:115]
buffer_load_dwordx4 v36, s[48:51], 0 offen offset:3072 lds
s_waitcnt lgkmcnt(2)
v_mfma_f32_16x16x32_bf16 v[116:119], a[156:159], a[84:87], v[116:119]
ds_read_b64_tr_b16 a[32:33], v20 offset:16384
v_mfma_f32_16x16x32_bf16 v[100:103], a[152:155], a[84:87], v[100:103]
ds_read_b64_tr_b16 a[34:35], v20 offset:16896
v_mfma_f32_16x16x32_bf16 v[84:87], a[148:151], a[84:87], v[84:87]
ds_read_b64_tr_b16 a[36:37], v21 offset:16384
ds_read_b64_tr_b16 a[38:39], v21 offset:16896
v_mfma_f32_16x16x32_bf16 v[88:91], a[148:151], a[88:91], v[88:91]
ds_read_b64_tr_b16 a[40:41], v22 offset:16384
v_mfma_f32_16x16x32_bf16 v[104:107], a[152:155], a[88:91], v[104:107]
v_mfma_f32_16x16x32_bf16 v[120:123], a[156:159], a[88:91], v[120:123]
ds_read_b64_tr_b16 a[42:43], v22 offset:16896
v_mfma_f32_16x16x32_bf16 v[124:127], a[156:159], a[92:95], v[124:127]
ds_read_b64_tr_b16 a[44:45], v23 offset:16384
v_mfma_f32_16x16x32_bf16 v[108:111], a[152:155], a[92:95], v[108:111]
ds_read_b64_tr_b16 a[46:47], v23 offset:16896
v_mfma_f32_16x16x32_bf16 v[92:95], a[148:151], a[92:95], v[92:95]
s_waitcnt vmcnt(22)
ds_read_b64_tr_b16 a[48:49], v20 offset:4096
ds_read_b64_tr_b16 a[50:51], v20 offset:4608
s_add_u32 s31, s31, 1
v_mfma_f32_16x16x32_bf16 v[192:195], a[0:3], a[104:107], v[192:195]
buffer_load_dwordx4 a[144:147], v4, s[8:11], s21 offen offset:1024 sc1
v_readlane_b32 s28, v14, s31
v_mfma_f32_16x16x32_bf16 v[224:227], a[0:3], a[108:111], v[224:227]
ds_read_b64_tr_b16 a[52:53], v21 offset:4096
v_mfma_f32_16x16x32_bf16 v[228:231], a[4:7], a[108:111], v[228:231]
v_mfma_f32_16x16x32_bf16 v[196:199], a[4:7], a[104:107], v[196:199]
ds_read_b64_tr_b16 a[54:55], v21 offset:4608
ds_read_b64_tr_b16 a[56:57], v22 offset:4096
buffer_load_dwordx4 a[148:151], v5, s[8:11], s21 offen offset:1024 sc1
ds_read_b64_tr_b16 a[58:59], v22 offset:4608
v_mfma_f32_16x16x32_bf16 v[200:203], a[8:11], a[104:107], v[200:203]
ds_read_b64_tr_b16 a[60:61], v23 offset:4096
v_mfma_f32_16x16x32_bf16 v[232:235], a[8:11], a[108:111], v[232:235]
v_mfma_f32_16x16x32_bf16 v[236:239], a[12:15], a[108:111], v[236:239]
buffer_load_dwordx4 a[152:155], v6, s[8:11], s21 offen offset:1024 sc1
v_mfma_f32_16x16x32_bf16 v[204:207], a[12:15], a[104:107], v[204:207]
ds_read_b64_tr_b16 a[62:63], v23 offset:4608
ds_read_b64_tr_b16 a[64:65], v20 offset:12288
ds_read_b64_tr_b16 a[66:67], v20 offset:12800
v_mfma_f32_16x16x32_bf16 v[176:179], a[16:19], a[100:103], v[176:179]
buffer_load_dwordx4 a[156:159], v7, s[8:11], s21 offen offset:1024 sc1
v_mfma_f32_16x16x32_bf16 v[208:211], a[16:19], a[104:107], v[208:211]
ds_read_b64_tr_b16 a[68:69], v21 offset:12288
v_mfma_f32_16x16x32_bf16 v[240:243], a[16:19], a[108:111], v[240:243]
v_mfma_f32_16x16x32_bf16 v[244:247], a[20:23], a[108:111], v[244:247]
ds_read_b64_tr_b16 a[70:71], v21 offset:12800
v_mfma_f32_16x16x32_bf16 v[212:215], a[20:23], a[104:107], v[212:215]
s_add_u32 m0, s25, 0
v_mfma_f32_16x16x32_bf16 v[180:183], a[20:23], a[100:103], v[180:183]
buffer_load_dwordx4 v10, s[44:47], s29 offen offset:0 lds
ds_read_b64_tr_b16 a[72:73], v22 offset:12288
ds_read_b64_tr_b16 a[74:75], v22 offset:12800
v_mfma_f32_16x16x32_bf16 v[184:187], a[24:27], a[100:103], v[184:187]
v_mfma_f32_16x16x32_bf16 v[216:219], a[24:27], a[104:107], v[216:219]
ds_read_b64_tr_b16 a[76:77], v23 offset:12288
v_mfma_f32_16x16x32_bf16 v[248:251], a[24:27], a[108:111], v[248:251]
buffer_load_dwordx4 v11, s[44:47], s29 offen offset:1024 lds
s_waitcnt lgkmcnt(3)
v_mfma_f32_16x16x32_bf16 v[252:255], a[28:31], a[108:111], v[252:255]
ds_read_b64_tr_b16 a[78:79], v23 offset:12800
v_mfma_f32_16x16x32_bf16 v[220:223], a[28:31], a[104:107], v[220:223]
v_mfma_f32_16x16x32_bf16 v[188:191], a[28:31], a[100:103], v[188:191]
ds_read_b64_tr_b16 a[80:81], v20 offset:20480
ds_read_b64_tr_b16 a[82:83], v20 offset:20992
buffer_load_dwordx4 v12, s[44:47], s29 offen offset:2048 lds
v_mfma_f32_16x16x32_bf16 v[80:83], a[100:103], a[32:35], v[80:83]
v_mfma_f32_16x16x32_bf16 v[96:99], a[104:107], a[32:35], v[96:99]
ds_read_b64_tr_b16 a[84:85], v21 offset:20480
v_mfma_f32_16x16x32_bf16 v[112:115], a[108:111], a[32:35], v[112:115]
ds_read_b64_tr_b16 a[86:87], v21 offset:20992
v_mfma_f32_16x16x32_bf16 v[116:119], a[108:111], a[36:39], v[116:119]
v_mfma_f32_16x16x32_bf16 v[100:103], a[104:107], a[36:39], v[100:103]
buffer_load_dwordx4 v13, s[44:47], s29 offen offset:3072 lds
v_mfma_f32_16x16x32_bf16 v[84:87], a[100:103], a[36:39], v[84:87]
s_mov_b32 s48, s66
ds_read_b64_tr_b16 a[88:89], v22 offset:20480
s_mov_b32 s49, s67
v_mfma_f32_16x16x32_bf16 v[88:91], a[100:103], a[40:43], v[88:91]
ds_read_b64_tr_b16 a[90:91], v22 offset:20992
v_mfma_f32_16x16x32_bf16 v[104:107], a[104:107], a[40:43], v[104:107]
s_mov_b32 s50, 8388608
v_mfma_f32_16x16x32_bf16 v[120:123], a[108:111], a[40:43], v[120:123]
v_mfma_f32_16x16x32_bf16 v[124:127], a[108:111], a[44:47], v[124:127]
ds_read_b64_tr_b16 a[92:93], v23 offset:20480
v_mfma_f32_16x16x32_bf16 v[108:111], a[104:107], a[44:47], v[108:111]
ds_read_b64_tr_b16 a[94:95], v23 offset:20992
v_mfma_f32_16x16x32_bf16 v[92:95], a[100:103], a[44:47], v[92:95]
s_waitcnt vmcnt(20)
s_barrier
s_add_u32 m0, s24, 32768
v_mfma_f32_16x16x32_bf16 v[192:195], a[48:51], a[120:123], v[192:195]
buffer_load_dwordx4 v8, s[8:11], s28 offen offset:0 sc1 lds
v_mfma_f32_16x16x32_bf16 v[224:227], a[48:51], a[124:127], v[224:227]
ds_read_b64_tr_b16 a[0:1], v20 offset:32768
v_mfma_f32_16x16x32_bf16 v[228:231], a[52:55], a[124:127], v[228:231]
ds_read_b64_tr_b16 a[2:3], v20 offset:33280
v_mfma_f32_16x16x32_bf16 v[196:199], a[52:55], a[120:123], v[196:199]
ds_read_b64_tr_b16 a[4:5], v21 offset:32768
ds_read_b64_tr_b16 a[6:7], v21 offset:33280
ds_read_b64_tr_b16 a[8:9], v22 offset:32768
v_mfma_f32_16x16x32_bf16 v[200:203], a[56:59], a[120:123], v[200:203]
v_mfma_f32_16x16x32_bf16 v[232:235], a[56:59], a[124:127], v[232:235]
ds_read_b64_tr_b16 a[10:11], v22 offset:33280
v_mfma_f32_16x16x32_bf16 v[236:239], a[60:63], a[124:127], v[236:239]
v_mfma_f32_16x16x32_bf16 v[204:207], a[60:63], a[120:123], v[204:207]
buffer_load_dwordx4 v8, s[8:11], s28 offen offset:1024 sc1 lds
ds_read_b64_tr_b16 a[12:13], v23 offset:32768
ds_read_b64_tr_b16 a[14:15], v23 offset:33280
v_mfma_f32_16x16x32_bf16 v[176:179], a[64:67], a[116:119], v[176:179]
ds_read_b64_tr_b16 a[16:17], v20 offset:40960
v_mfma_f32_16x16x32_bf16 v[208:211], a[64:67], a[120:123], v[208:211]
v_mfma_f32_16x16x32_bf16 v[240:243], a[64:67], a[124:127], v[240:243]
ds_read_b64_tr_b16 a[18:19], v20 offset:41472
v_mfma_f32_16x16x32_bf16 v[244:247], a[68:71], a[124:127], v[244:247]
v_mfma_f32_16x16x32_bf16 v[212:215], a[68:71], a[120:123], v[212:215]
ds_read_b64_tr_b16 a[20:21], v21 offset:40960
v_mfma_f32_16x16x32_bf16 v[180:183], a[68:71], a[116:119], v[180:183]
ds_read_b64_tr_b16 a[22:23], v21 offset:41472
s_waitcnt lgkmcnt(3)
buffer_load_dwordx4 v9, s[8:11], s28 offen offset:2048 sc1 lds
s_mul_i32 s29, s28, 224
v_mfma_f32_16x16x32_bf16 v[184:187], a[72:75], a[116:119], v[184:187]
ds_read_b64_tr_b16 a[24:25], v22 offset:40960
v_mfma_f32_16x16x32_bf16 v[216:219], a[72:75], a[120:123], v[216:219]
v_mfma_f32_16x16x32_bf16 v[248:251], a[72:75], a[124:127], v[248:251]
ds_read_b64_tr_b16 a[26:27], v22 offset:41472
v_mfma_f32_16x16x32_bf16 v[252:255], a[76:79], a[124:127], v[252:255]
ds_read_b64_tr_b16 a[28:29], v23 offset:40960
v_mfma_f32_16x16x32_bf16 v[220:223], a[76:79], a[120:123], v[220:223]
v_mfma_f32_16x16x32_bf16 v[188:191], a[76:79], a[116:119], v[188:191]
ds_read_b64_tr_b16 a[30:31], v23 offset:41472
ds_read_b64_tr_b16 a[32:33], v20 offset:49152
v_mfma_f32_16x16x32_bf16 v[80:83], a[116:119], a[80:83], v[80:83]
v_mfma_f32_16x16x32_bf16 v[96:99], a[120:123], a[80:83], v[96:99]
ds_read_b64_tr_b16 a[34:35], v20 offset:49664
v_mfma_f32_16x16x32_bf16 v[112:115], a[124:127], a[80:83], v[112:115]
buffer_load_dwordx4 v9, s[8:11], s28 offen offset:3072 sc1 lds
v_mfma_f32_16x16x32_bf16 v[116:119], a[124:127], a[84:87], v[116:119]
ds_read_b64_tr_b16 a[36:37], v21 offset:49152
v_mfma_f32_16x16x32_bf16 v[100:103], a[120:123], a[84:87], v[100:103]
v_mfma_f32_16x16x32_bf16 v[84:87], a[116:119], a[84:87], v[84:87]
ds_read_b64_tr_b16 a[38:39], v21 offset:49664
ds_read_b64_tr_b16 a[40:41], v22 offset:49152
v_mfma_f32_16x16x32_bf16 v[88:91], a[116:119], a[88:91], v[88:91]
ds_read_b64_tr_b16 a[42:43], v22 offset:49664
v_mfma_f32_16x16x32_bf16 v[104:107], a[120:123], a[88:91], v[104:107]
v_mfma_f32_16x16x32_bf16 v[120:123], a[124:127], a[88:91], v[120:123]
ds_read_b64_tr_b16 a[44:45], v23 offset:49152
v_mfma_f32_16x16x32_bf16 v[124:127], a[124:127], a[92:95], v[124:127]
v_mfma_f32_16x16x32_bf16 v[108:111], a[120:123], a[92:95], v[108:111]
ds_read_b64_tr_b16 a[46:47], v23 offset:49664
v_mfma_f32_16x16x32_bf16 v[92:95], a[116:119], a[92:95], v[92:95]
s_waitcnt vmcnt(20)
s_branch Lq_join
L_z:
v_mov_b32 v24, v0
v_add_u32 v24, s62, v24
v_and_b32 v24, 15, v24
v_subrev_u32 v25, 16, v0
v_subrev_u32 v1, 1, v25
v_and_b32 v2, 3, v1
v_cmp_eq_u32 vcc, s63, v2
v_add_u32 v2, 4, v25
v_min_u32 v2, 16, v2
v_subrev_u32 v2, 1, v2
v_cndmask_b32 v1, v1, v2, vcc
v_cmp_eq_u32 vcc, 0, v25
v_mov_b32 v2, s63
s_nop 0
v_cndmask_b32 v25, v1, v2, vcc
v_subrev_u32 v26, 32, v0
v_lshrrev_b32 v26, 1, v26
v_subrev_u32 v1, 1, v26
v_and_b32 v2, 3, v1
v_cmp_eq_u32 vcc, s63, v2
v_add_u32 v2, 4, v26
v_min_u32 v2, 16, v2
v_subrev_u32 v2, 1, v2
v_cndmask_b32 v1, v1, v2, vcc
v_cmp_eq_u32 vcc, 0, v26
v_mov_b32 v2, s63
s_nop 0
v_cndmask_b32 v26, v1, v2, vcc
v_and_b32 v1, 1, v0
v_lshl_add_u32 v26, v26, 1, v1
v_cmp_gt_u32 vcc, 16, v0
v_mul_u32_u24 v15, 458752, v24
v_lshlrev_b32 v14, 7, v26
v_cndmask_b32 v25, v25, v24, vcc
v_cmp_gt_u32 vcc, 32, v0
v_lshlrev_b32 v27, 11, v25
s_nop 0
v_cndmask_b32 v14, v14, v27, vcc
s_mov_b32 vcc_lo, 0
s_mov_b32 vcc_hi, 2863311530
v_mul_u32_u24 v1, 16, v14
v_cndmask_b32 v14, v14, v1, vcc
s_lshl_b32 s27, s3, 2
s_add_u32 s27, s27, s85
s_mul_i32 s31, s27, 32768
v_lshl_add_u32 v4, v0, 4, s31
v_add_u32 v5, 32768, v4
v_add_u32 v6, 65536, v4
v_add_u32 v7, 98304, v4
s_lshl_b32 s27, s27, 10
v_lshrrev_b32 v1, 3, v0
v_lshl_add_u32 v24, v1, 9, s27
s_lshl_b32 s27, s80, 13
v_lshrrev_b32 v1, 2, v0
v_lshl_add_u32 v29, v1, 9, s27
s_waitcnt vmcnt(0)
v_readfirstlane_b32 s78, v56
s_nop 0
s_cmp_lg_u32 s78, 0
s_cbranch_scc1 Lnok_8
s_mov_b32 s79, 32768
Lnon_7:
buffer_load_dword v56, off, s[36:39], 0 sc1
s_waitcnt vmcnt(0)
v_readfirstlane_b32 s78, v56
s_sub_u32 s79, s79, 1
s_cbranch_scc1 Lnok_8
s_cmp_eq_u32 s78, 0
s_cbranch_scc1 Lnon_7
Lnok_8:
s_barrier
v_mov_b32 v56, s78
buffer_store_dword v56, off, s[40:43], s1 offset:0 sc1
s_add_u32 m0, s23, 32768
s_nop 0
buffer_load_dwordx4 v8, s[12:15], s22 offen offset:0 lds
buffer_load_dwordx4 v9, s[12:15], s22 offen offset:1024 lds
s_add_u32 m0, s23, 40960
s_nop 0
buffer_load_dwordx4 v10, s[12:15], s22 offen offset:0 lds
buffer_load_dwordx4 v11, s[12:15], s22 offen offset:1024 lds
ds_read_b64_tr_b16 a[0:1], v16 offset:0
ds_read_b64_tr_b16 a[2:3], v16 offset:512
ds_read_b64_tr_b16 a[4:5], v17 offset:0
ds_read_b64_tr_b16 a[6:7], v17 offset:512
ds_read_b64_tr_b16 a[8:9], v18 offset:0
ds_read_b64_tr_b16 a[10:11], v18 offset:512
ds_read_b64_tr_b16 a[12:13], v19 offset:0
ds_read_b64_tr_b16 a[14:15], v19 offset:512
ds_read_b64_tr_b16 a[16:17], v16 offset:8192
ds_read_b64_tr_b16 a[18:19], v16 offset:8704
ds_read_b64_tr_b16 a[20:21], v17 offset:8192
ds_read_b64_tr_b16 a[22:23], v17 offset:8704
ds_read_b64_tr_b16 a[24:25], v18 offset:8192
ds_read_b64_tr_b16 a[26:27], v18 offset:8704
ds_read_b64_tr_b16 a[28:29], v19 offset:8192
ds_read_b64_tr_b16 a[30:31], v19 offset:8704
s_mul_i32 s31, s80, 262144
s_mul_i32 s27, s3, 65536
s_add_u32 s27, s27, s31
v_lshl_add_u32 v32, v0, 4, s27
v_add_u32 v33, 30720, v32
v_lshrrev_b32 v1, 3, v0
s_lshl_b32 s27, s84, 5
v_add_u32 v1, s27, v1
v_mul_u32_u24 v1, 7168, v1
s_lshl_b32 s27, s81, 8
s_lshl_b32 s31, s83, 7
s_add_u32 s27, s27, s31
v_add_u32 v1, s27, v1
v_bfe_u32 v2, v0, 4, 1
v_lshlrev_b32 v2, 1, v2
v_and_b32 v3, 7, v0
v_xor_b32 v2, v2, v3
v_xor_b32 v3, 0, v2
v_lshl_add_u32 v34, v3, 4, v1
v_xor_b32 v3, 4, v2
v_lshl_add_u32 v35, v3, 4, v1
v_add_u32 v35, 56320, v35
v_xor_b32 v3, 0, v2
v_lshl_add_u32 v36, v3, 4, v1
v_add_u32 v36, 112640, v36
v_xor_b32 v3, 4, v2
v_lshl_add_u32 v37, v3, 4, v1
v_add_u32 v37, 168960, v37
s_cmp_ge_u32 s5, 28
s_cselect_b32 s27, 2147483648, 0
v_or_b32 v32, s27, v32
v_or_b32 v33, s27, v33
v_or_b32 v34, s27, v34
v_or_b32 v35, s27, v35
v_or_b32 v36, s27, v36
v_or_b32 v37, s27, v37
v_accvgpr_write_b32 a208, v32
v_accvgpr_write_b32 a209, v33
v_accvgpr_write_b32 a210, v34
v_accvgpr_write_b32 a211, v35
v_accvgpr_write_b32 a212, v36
v_accvgpr_write_b32 a213, v37
s_mul_i32 s31, s80, 720896
s_mul_i32 s27, s3, 180224
s_add_u32 s27, s27, s31
v_lshl_add_u32 v32, v0, 4, s27
v_add_u32 v33, 88064, v32
v_lshrrev_b32 v1, 5, v0
v_bfe_u32 v3, v0, 3, 2
v_lshl_add_u32 v1, v1, 4, v3
v_lshlrev_b32 v1, 11, v1
v_lshl_add_u32 v1, v2, 4, v1
v_xor_b32 v3, 64, v1
v_add_u32 v3, 7168, v3
s_xor_b32 s27, s82, s83
s_lshl_b32 s27, s27, 7
s_lshl_b32 s31, s84, 16
s_add_u32 s27, s27, s31
v_add_u32 v34, s27, v1
v_add_u32 v35, s27, v3
v_add_u32 v36, 14336, v34
v_add_u32 v37, 14336, v35
s_lshl_b32 s27, s82, 7
s_lshl_b32 s31, s83, 16
s_add_u32 s27, s27, s31
s_lshl_b32 s31, s84, 14
s_add_u32 s27, s27, s31
v_add_u32 v38, s27, v1
v_add_u32 v39, s27, v3
v_accvgpr_write_b32 a238, v32
v_accvgpr_write_b32 a239, v33
v_accvgpr_write_b32 a240, v34
v_accvgpr_write_b32 a241, v35
v_accvgpr_write_b32 a242, v36
v_accvgpr_write_b32 a243, v37
v_accvgpr_write_b32 a244, v38
v_accvgpr_write_b32 a245, v39
s_lshl_b32 s27, s84, 6
v_xor_b32 v1, s27, v16
v_xor_b32 v3, s27, v17
v_add_u32 v32, 16384, v1
v_add_u32 v33, 16384, v3
v_accvgpr_write_b32 a252, v32
v_accvgpr_write_b32 a253, v33
v_lshrrev_b32 v1, 3, v0
s_lshl_b32 s27, s80, 7
s_lshl_b32 s31, s3, 5
s_add_u32 s27, s27, s31
v_add_u32 v1, s27, v1
v_lshlrev_b32 v1, 12, v1
v_lshrrev_b32 v2, 4, v0
v_and_b32 v3, 7, v0
v_xor_b32 v2, v2, v3
v_xor_b32 v3, 0, v2
v_lshl_add_u32 v32, v3, 4, v1
v_xor_b32 v3, 4, v2
v_lshl_add_u32 v33, v3, 4, v1
v_add_u32 v33, 31744, v33
v_xor_b32 v3, 0, v2
v_lshl_add_u32 v34, v3, 4, v1
v_add_u32 v34, 63488, v34
v_xor_b32 v3, 4, v2
v_lshl_add_u32 v35, v3, 4, v1
v_add_u32 v35, 95232, v35
s_mul_i32 s31, s81, 524288
s_mul_i32 s27, s3, 131072
s_add_u32 s27, s27, s31
v_lshl_add_u32 v36, v0, 4, s27
v_add_u32 v37, 63488, v36
v_accvgpr_write_b32 a224, v32
v_accvgpr_write_b32 a225, v33
v_accvgpr_write_b32 a226, v34
v_accvgpr_write_b32 a227, v35
v_accvgpr_write_b32 a228, v36
v_accvgpr_write_b32 a229, v37
s_lshl_b32 s27, s84, 13
s_add_u32 s27, s27, 16384
v_add_u32 v32, s27, v16
v_add_u32 v33, s27, v17
v_add_u32 v34, s27, v18
v_add_u32 v35, s27, v19
v_lshl_add_u32 v39, v0, 4, s27
s_lshl_b32 s27, s83, 13
v_lshl_add_u32 v36, v0, 4, s27
v_and_b32 v1, 15, v0
v_lshrrev_b32 v2, 1, v1
v_lshrrev_b32 v3, 4, v0
v_xor_b32 v2, v2, v3
v_lshl_add_u32 v1, v1, 7, s27
v_lshl_add_u32 v37, v2, 4, v1
v_xor_b32 v2, 4, v2
v_lshl_add_u32 v38, v2, 4, v1
v_accvgpr_write_b32 a230, v32
v_accvgpr_write_b32 a231, v33
v_accvgpr_write_b32 a232, v34
v_accvgpr_write_b32 a233, v35
v_accvgpr_write_b32 a234, v36
v_accvgpr_write_b32 a235, v37
v_accvgpr_write_b32 a236, v38
v_accvgpr_write_b32 a237, v39
v_mov_b32 v32, v0
v_subrev_u32 v1, 1, v32
v_and_b32 v2, 3, v1
v_cmp_eq_u32 vcc, s63, v2
v_add_u32 v2, 4, v32
v_min_u32 v2, 8, v2
v_subrev_u32 v2, 1, v2
v_cndmask_b32 v1, v1, v2, vcc
v_cmp_eq_u32 vcc, 0, v32
v_mov_b32 v2, s63
s_nop 0
v_cndmask_b32 v32, v1, v2, vcc
v_subrev_u32 v33, 8, v0
v_subrev_u32 v1, 1, v33
v_and_b32 v2, 3, v1
v_cmp_eq_u32 vcc, s63, v2
v_add_u32 v2, 4, v33
v_min_u32 v2, 12, v2
v_subrev_u32 v2, 1, v2
v_cndmask_b32 v1, v1, v2, vcc
v_cmp_eq_u32 vcc, 0, v33
v_mov_b32 v2, s63
s_nop 0
v_cndmask_b32 v33, v1, v2, vcc
v_subrev_u32 v34, 20, v0
v_subrev_u32 v1, 1, v34
v_and_b32 v2, 3, v1
v_cmp_eq_u32 vcc, s63, v2
v_add_u32 v2, 4, v34
v_min_u32 v2, 4, v2
v_subrev_u32 v2, 1, v2
v_cndmask_b32 v1, v1, v2, vcc
v_cmp_eq_u32 vcc, 0, v34
v_mov_b32 v2, s63
s_nop 0
v_cndmask_b32 v34, v1, v2, vcc
s_lshl_b32 s27, s0, 3
v_add_u32 v32, s27, v32
s_mul_i32 s27, s0, 14
s_add_u32 s27, s27, 2
v_add_u32 v33, s27, v33
v_add_u32 v1, 12, v34
v_cmp_gt_u32 vcc, 2, v34
s_nop 1
v_cndmask_b32 v34, v1, v34, vcc
v_cmp_gt_u32 vcc, 20, v0
s_nop 1
v_cndmask_b32 v33, v34, v33, vcc
v_cmp_gt_u32 vcc, 8, v0
s_nop 1
v_cndmask_b32 v32, v33, v32, vcc
v_lshlrev_b32 v32, 11, v32
s_mov_b32 vcc_lo, 16777215
s_mov_b32 vcc_hi, 0
v_mul_u32_u24 v1, 64, v32
v_cndmask_b32 v32, v32, v1, vcc
v_accvgpr_write_b32 a246, v32
s_lshl_b32 s27, s81, 3
v_lshrrev_b32 v1, 3, v0
v_add_u32 v1, s27, v1
v_mul_u32_u24 v2, 4682, v1
v_lshrrev_b32 v2, 16, v2
v_mul_u32_u24 v32, 14, v2
v_sub_u32 v32, v1, v32
v_add_u32 v32, 18, v32
v_lshl_add_u32 v32, v32, 3, v2
s_lshl_b32 s27, s80, 3
v_lshrrev_b32 v1, 5, v0
v_mul_u32_u24 v1, 7, v1
v_add_u32 v1, s27, v1
v_max_u32 v1, 2, v1
v_subrev_u32 v1, 2, v1
v_mul_u32_u24 v1, 4682, v1
v_lshrrev_b32 v1, 16, v1
v_bfe_u32 v2, v0, 1, 1
v_mul_u32_u24 v2, 9, v2
v_add_u32 v1, v1, v2
v_bfe_u32 v2, v0, 2, 3
v_lshl_add_u32 v33, v1, 3, v2
s_and_b32 s27, s2, 31
v_lshrrev_b32 v1, 3, v0
v_min_u32 v1, 5, v1
v_add_u32 v1, 1, v1
v_lshl_add_u32 v34, v1, 5, s27
s_and_b32 s27, s2, 27
v_bfe_u32 v1, v0, 3, 2
v_min_u32 v1, 0, v1
v_lshl_add_u32 v1, v1, 5, s27
v_lshrrev_b32 v2, 5, v0
v_lshl_add_u32 v35, v2, 2, v1
s_movk_i32 s27, 128
s_movk_i32 s31, 256
v_lshl_add_u32 v32, v32, 9, s27
v_lshl_add_u32 v33, v33, 9, s27
v_lshl_add_u32 v34, v34, 9, s31
v_lshl_add_u32 v35, v35, 9, s31
s_xor_b32 s27, s2, 4
s_lshl_b32 s27, s27, 9
s_add_u32 s27, s27, 384
v_mov_b32 v36, s27
v_accvgpr_write_b32 a247, v32
v_accvgpr_write_b32 a248, v33
v_accvgpr_write_b32 a249, v34
v_accvgpr_write_b32 a250, v35
v_accvgpr_write_b32 a251, v36
v_lshrrev_b32 v1, 3, v0
v_and_b32 v2, 7, v0
v_xor_b32 v2, v1, v2
s_lshl2_add_u32 s27, s80, s3
s_lshl_b32 s27, s27, 16
s_lshl_b32 s31, s82, 7
s_add_u32 s27, s27, s31
v_lshl_add_u32 v1, v1, 11, s27
v_lshl_add_u32 v33, v2, 4, v1
v_add_u32 v34, 15360, v33
v_add_u32 v35, 30720, v33
v_add_u32 v36, 46080, v33
s_sub_u32 s31, s2, 144
s_lshl2_add_u32 s31, s31, s3
s_mul_i32 s27, s31, 7168
v_lshl_add_u32 v32, v0, 7, s27
v_mov_b32 v1, 2147483648
v_cmp_gt_u32 vcc, 28, v0
s_nop 1
v_cndmask_b32 v32, v1, v32, vcc
s_mov_b32 s36, s60
s_mov_b32 s37, s61
s_mov_b32 s38, 2097152
s_mov_b32 s39, 0x20000
s_mul_i32 s27, s31, 4736
v_lshl_add_u32 v31, v0, 7, s27
v_mov_b32 v1, 2147483648
v_cmp_gt_u32 vcc, 37, v0
s_nop 1
v_cndmask_b32 v31, v1, v31, vcc
v_readlane_b32 s21, v14, 0
v_readlane_b32 s22, v15, 2
s_mov_b32 s79, 32768
Lspin_9:
buffer_load_dword v28, v24, s[40:43], 0 offen sc1
s_waitcnt vmcnt(0)
v_cmp_ne_u32 vcc, s78, v28
s_sub_u32 s79, s79, 1
s_cbranch_scc1 Lok_10
s_cbranch_vccnz Lspin_9
Lok_10:
buffer_load_dwordx4 a[96:99], v4, s[8:11], s21 offen offset:0 sc1
buffer_load_dwordx4 a[100:103], v5, s[8:11], s21 offen offset:0 sc1
buffer_load_dwordx4 a[104:107], v6, s[8:11], s21 offen offset:0 sc1
buffer_load_dwordx4 a[108:111], v7, s[8:11], s21 offen offset:0 sc1
buffer_load_dwordx4 a[112:115], v4, s[8:11], s21 offen offset:1024 sc1
buffer_load_dwordx4 a[116:119], v5, s[8:11], s21 offen offset:1024 sc1
buffer_load_dwordx4 a[120:123], v6, s[8:11], s21 offen offset:1024 sc1
buffer_load_dwordx4 a[124:127], v7, s[8:11], s21 offen offset:1024 sc1
v_readlane_b32 s21, v14, 1
s_mov_b32 s20, 2
s_nop 3
buffer_load_dwordx4 a[128:131], v4, s[8:11], s21 offen offset:0 sc1
buffer_load_dwordx4 a[132:135], v5, s[8:11], s21 offen offset:0 sc1
buffer_load_dwordx4 a[136:139], v6, s[8:11], s21 offen offset:0 sc1
buffer_load_dwordx4 a[140:143], v7, s[8:11], s21 offen offset:0 sc1
s_add_u32 m0, s23, 65536
s_nop 0
buffer_load_dwordx4 v8, s[12:15], s22 offen offset:0 lds
buffer_load_dwordx4 v9, s[12:15], s22 offen offset:1024 lds
s_waitcnt vmcnt(10) lgkmcnt(0)
s_mov_b32 s30, 2
Lz_loop1:
v_mfma_f32_16x16x32_bf16 v[128:131], a[96:99], a[0:3], v[128:131]
ds_read_b64_tr_b16 a[32:33], v16 offset:4096
v_mfma_f32_16x16x32_bf16 v[160:163], a[100:103], a[0:3], v[160:163]
ds_read_b64_tr_b16 a[34:35], v16 offset:4608
v_mfma_f32_16x16x32_bf16 v[192:195], a[104:107], a[0:3], v[192:195]
buffer_load_dwordx4 a[144:147], v4, s[8:11], s21 offen offset:1024 sc1
v_mfma_f32_16x16x32_bf16 v[224:227], a[108:111], a[0:3], v[224:227]
ds_read_b64_tr_b16 a[36:37], v17 offset:4096
v_mfma_f32_16x16x32_bf16 v[228:231], a[108:111], a[4:7], v[228:231]
ds_read_b64_tr_b16 a[38:39], v17 offset:4608
v_mfma_f32_16x16x32_bf16 v[196:199], a[104:107], a[4:7], v[196:199]
v_mfma_f32_16x16x32_bf16 v[164:167], a[100:103], a[4:7], v[164:167]
ds_read_b64_tr_b16 a[40:41], v18 offset:4096
v_mfma_f32_16x16x32_bf16 v[132:135], a[96:99], a[4:7], v[132:135]
buffer_load_dwordx4 a[148:151], v5, s[8:11], s21 offen offset:1024 sc1
s_waitcnt lgkmcnt(3)
v_mfma_f32_16x16x32_bf16 v[136:139], a[96:99], a[8:11], v[136:139]
ds_read_b64_tr_b16 a[42:43], v18 offset:4608
v_mfma_f32_16x16x32_bf16 v[168:171], a[100:103], a[8:11], v[168:171]
ds_read_b64_tr_b16 a[44:45], v19 offset:4096
v_mfma_f32_16x16x32_bf16 v[200:203], a[104:107], a[8:11], v[200:203]
v_mfma_f32_16x16x32_bf16 v[232:235], a[108:111], a[8:11], v[232:235]
ds_read_b64_tr_b16 a[46:47], v19 offset:4608
v_mfma_f32_16x16x32_bf16 v[236:239], a[108:111], a[12:15], v[236:239]
buffer_load_dwordx4 a[152:155], v6, s[8:11], s21 offen offset:1024 sc1
v_mfma_f32_16x16x32_bf16 v[204:207], a[104:107], a[12:15], v[204:207]
ds_read_b64_tr_b16 a[48:49], v16 offset:12288
v_mfma_f32_16x16x32_bf16 v[172:175], a[100:103], a[12:15], v[172:175]
ds_read_b64_tr_b16 a[50:51], v16 offset:12800
v_mfma_f32_16x16x32_bf16 v[140:143], a[96:99], a[12:15], v[140:143]
v_mfma_f32_16x16x32_bf16 v[144:147], a[96:99], a[16:19], v[144:147]
ds_read_b64_tr_b16 a[52:53], v17 offset:12288
v_mfma_f32_16x16x32_bf16 v[176:179], a[100:103], a[16:19], v[176:179]
buffer_load_dwordx4 a[156:159], v7, s[8:11], s21 offen offset:1024 sc1
v_mfma_f32_16x16x32_bf16 v[208:211], a[104:107], a[16:19], v[208:211]
ds_read_b64_tr_b16 a[54:55], v17 offset:12800
v_mfma_f32_16x16x32_bf16 v[240:243], a[108:111], a[16:19], v[240:243]
ds_read_b64_tr_b16 a[56:57], v18 offset:12288
v_mfma_f32_16x16x32_bf16 v[244:247], a[108:111], a[20:23], v[244:247]
v_mfma_f32_16x16x32_bf16 v[212:215], a[104:107], a[20:23], v[212:215]
s_add_u32 m0, s23, 73728
v_mfma_f32_16x16x32_bf16 v[180:183], a[100:103], a[20:23], v[180:183]
buffer_load_dwordx4 v10, s[12:15], s22 offen offset:0 lds
v_mfma_f32_16x16x32_bf16 v[148:151], a[96:99], a[20:23], v[148:151]
ds_read_b64_tr_b16 a[58:59], v18 offset:12800
v_mfma_f32_16x16x32_bf16 v[152:155], a[96:99], a[24:27], v[152:155]
ds_read_b64_tr_b16 a[60:61], v19 offset:12288
v_mfma_f32_16x16x32_bf16 v[184:187], a[100:103], a[24:27], v[184:187]
ds_read_b64_tr_b16 a[62:63], v19 offset:12800
v_mfma_f32_16x16x32_bf16 v[216:219], a[104:107], a[24:27], v[216:219]
v_mfma_f32_16x16x32_bf16 v[248:251], a[108:111], a[24:27], v[248:251]
buffer_load_dwordx4 v11, s[12:15], s22 offen offset:1024 lds
v_mfma_f32_16x16x32_bf16 v[252:255], a[108:111], a[28:31], v[252:255]
v_readlane_b32 s21, v14, s20
v_mfma_f32_16x16x32_bf16 v[220:223], a[104:107], a[28:31], v[220:223]
s_add_u32 s20, s20, 1
v_mfma_f32_16x16x32_bf16 v[188:191], a[100:103], a[28:31], v[188:191]
v_readlane_b32 s22, v15, s20
v_mfma_f32_16x16x32_bf16 v[156:159], a[96:99], a[28:31], v[156:159]
s_waitcnt vmcnt(12)
v_mfma_f32_16x16x32_bf16 v[128:131], a[112:115], a[32:35], v[128:131]
s_barrier
v_mfma_f32_16x16x32_bf16 v[160:163], a[116:119], a[32:35], v[160:163]
ds_read_b64_tr_b16 a[0:1], v16 offset:32768
v_mfma_f32_16x16x32_bf16 v[192:195], a[120:123], a[32:35], v[192:195]
buffer_load_dwordx4 a[96:99], v4, s[8:11], s21 offen offset:0 sc1
v_mfma_f32_16x16x32_bf16 v[224:227], a[124:127], a[32:35], v[224:227]
ds_read_b64_tr_b16 a[2:3], v16 offset:33280
s_waitcnt lgkmcnt(2)
v_mfma_f32_16x16x32_bf16 v[228:231], a[124:127], a[36:39], v[228:231]
ds_read_b64_tr_b16 a[4:5], v17 offset:32768
v_mfma_f32_16x16x32_bf16 v[196:199], a[120:123], a[36:39], v[196:199]
v_mfma_f32_16x16x32_bf16 v[164:167], a[116:119], a[36:39], v[164:167]
ds_read_b64_tr_b16 a[6:7], v17 offset:33280
v_mfma_f32_16x16x32_bf16 v[132:135], a[112:115], a[36:39], v[132:135]
buffer_load_dwordx4 a[100:103], v5, s[8:11], s21 offen offset:0 sc1
v_mfma_f32_16x16x32_bf16 v[136:139], a[112:115], a[40:43], v[136:139]
ds_read_b64_tr_b16 a[8:9], v18 offset:32768
v_mfma_f32_16x16x32_bf16 v[168:171], a[116:119], a[40:43], v[168:171]
v_mfma_f32_16x16x32_bf16 v[200:203], a[120:123], a[40:43], v[200:203]
ds_read_b64_tr_b16 a[10:11], v18 offset:33280
v_mfma_f32_16x16x32_bf16 v[232:235], a[124:127], a[40:43], v[232:235]
ds_read_b64_tr_b16 a[12:13], v19 offset:32768
v_mfma_f32_16x16x32_bf16 v[236:239], a[124:127], a[44:47], v[236:239]
buffer_load_dwordx4 a[104:107], v6, s[8:11], s21 offen offset:0 sc1
v_mfma_f32_16x16x32_bf16 v[204:207], a[120:123], a[44:47], v[204:207]
v_mfma_f32_16x16x32_bf16 v[172:175], a[116:119], a[44:47], v[172:175]
ds_read_b64_tr_b16 a[14:15], v19 offset:33280
v_mfma_f32_16x16x32_bf16 v[140:143], a[112:115], a[44:47], v[140:143]
ds_read_b64_tr_b16 a[16:17], v16 offset:40960
v_mfma_f32_16x16x32_bf16 v[144:147], a[112:115], a[48:51], v[144:147]
ds_read_b64_tr_b16 a[18:19], v16 offset:41472
v_mfma_f32_16x16x32_bf16 v[176:179], a[116:119], a[48:51], v[176:179]
buffer_load_dwordx4 a[108:111], v7, s[8:11], s21 offen offset:0 sc1
v_mfma_f32_16x16x32_bf16 v[208:211], a[120:123], a[48:51], v[208:211]
v_mfma_f32_16x16x32_bf16 v[240:243], a[124:127], a[48:51], v[240:243]
ds_read_b64_tr_b16 a[20:21], v17 offset:40960
v_mfma_f32_16x16x32_bf16 v[244:247], a[124:127], a[52:55], v[244:247]
ds_read_b64_tr_b16 a[22:23], v17 offset:41472
v_mfma_f32_16x16x32_bf16 v[212:215], a[120:123], a[52:55], v[212:215]
s_add_u32 m0, s23, 98304
v_mfma_f32_16x16x32_bf16 v[180:183], a[116:119], a[52:55], v[180:183]
buffer_load_dwordx4 v8, s[12:15], s22 offen offset:0 lds
v_mfma_f32_16x16x32_bf16 v[148:151], a[112:115], a[52:55], v[148:151]
v_mfma_f32_16x16x32_bf16 v[152:155], a[112:115], a[56:59], v[152:155]
ds_read_b64_tr_b16 a[24:25], v18 offset:40960
v_mfma_f32_16x16x32_bf16 v[184:187], a[116:119], a[56:59], v[184:187]
ds_read_b64_tr_b16 a[26:27], v18 offset:41472
v_mfma_f32_16x16x32_bf16 v[216:219], a[120:123], a[56:59], v[216:219]
v_mfma_f32_16x16x32_bf16 v[248:251], a[124:127], a[56:59], v[248:251]
buffer_load_dwordx4 v9, s[12:15], s22 offen offset:1024 lds
v_mfma_f32_16x16x32_bf16 v[252:255], a[124:127], a[60:63], v[252:255]
ds_read_b64_tr_b16 a[28:29], v19 offset:40960
v_mfma_f32_16x16x32_bf16 v[220:223], a[120:123], a[60:63], v[220:223]
ds_read_b64_tr_b16 a[30:31], v19 offset:41472
v_mfma_f32_16x16x32_bf16 v[188:191], a[116:119], a[60:63], v[188:191]
v_mfma_f32_16x16x32_bf16 v[156:159], a[112:115], a[60:63], v[156:159]
s_waitcnt vmcnt(14) lgkmcnt(2)
v_mfma_f32_16x16x32_bf16 v[128:131], a[128:131], a[0:3], v[128:131]
ds_read_b64_tr_b16 a[32:33], v16 offset:36864
v_mfma_f32_16x16x32_bf16 v[160:163], a[132:135], a[0:3], v[160:163]
ds_read_b64_tr_b16 a[34:35], v16 offset:37376
v_mfma_f32_16x16x32_bf16 v[192:195], a[136:139], a[0:3], v[192:195]
buffer_load_dwordx4 a[112:115], v4, s[8:11], s21 offen offset:1024 sc1
v_mfma_f32_16x16x32_bf16 v[224:227], a[140:143], a[0:3], v[224:227]
ds_read_b64_tr_b16 a[36:37], v17 offset:36864
v_mfma_f32_16x16x32_bf16 v[228:231], a[140:143], a[4:7], v[228:231]
ds_read_b64_tr_b16 a[38:39], v17 offset:37376
v_mfma_f32_16x16x32_bf16 v[196:199], a[136:139], a[4:7], v[196:199]
v_mfma_f32_16x16x32_bf16 v[164:167], a[132:135], a[4:7], v[164:167]
ds_read_b64_tr_b16 a[40:41], v18 offset:36864
v_mfma_f32_16x16x32_bf16 v[132:135], a[128:131], a[4:7], v[132:135]
buffer_load_dwordx4 a[116:119], v5, s[8:11], s21 offen offset:1024 sc1
v_mfma_f32_16x16x32_bf16 v[136:139], a[128:131], a[8:11], v[136:139]
ds_read_b64_tr_b16 a[42:43], v18 offset:37376
v_mfma_f32_16x16x32_bf16 v[168:171], a[132:135], a[8:11], v[168:171]
ds_read_b64_tr_b16 a[44:45], v19 offset:36864
v_mfma_f32_16x16x32_bf16 v[200:203], a[136:139], a[8:11], v[200:203]
v_mfma_f32_16x16x32_bf16 v[232:235], a[140:143], a[8:11], v[232:235]
ds_read_b64_tr_b16 a[46:47], v19 offset:37376
v_mfma_f32_16x16x32_bf16 v[236:239], a[140:143], a[12:15], v[236:239]
buffer_load_dwordx4 a[120:123], v6, s[8:11], s21 offen offset:1024 sc1
v_mfma_f32_16x16x32_bf16 v[204:207], a[136:139], a[12:15], v[204:207]
ds_read_b64_tr_b16 a[48:49], v16 offset:45056
v_mfma_f32_16x16x32_bf16 v[172:175], a[132:135], a[12:15], v[172:175]
ds_read_b64_tr_b16 a[50:51], v16 offset:45568
v_mfma_f32_16x16x32_bf16 v[140:143], a[128:131], a[12:15], v[140:143]
v_mfma_f32_16x16x32_bf16 v[144:147], a[128:131], a[16:19], v[144:147]
ds_read_b64_tr_b16 a[52:53], v17 offset:45056
v_mfma_f32_16x16x32_bf16 v[176:179], a[132:135], a[16:19], v[176:179]
buffer_load_dwordx4 a[124:127], v7, s[8:11], s21 offen offset:1024 sc1
v_mfma_f32_16x16x32_bf16 v[208:211], a[136:139], a[16:19], v[208:211]
ds_read_b64_tr_b16 a[54:55], v17 offset:45568
v_mfma_f32_16x16x32_bf16 v[240:243], a[140:143], a[16:19], v[240:243]
ds_read_b64_tr_b16 a[56:57], v18 offset:45056
v_mfma_f32_16x16x32_bf16 v[244:247], a[140:143], a[20:23], v[244:247]
v_mfma_f32_16x16x32_bf16 v[212:215], a[136:139], a[20:23], v[212:215]
s_add_u32 m0, s23, 106496
v_mfma_f32_16x16x32_bf16 v[180:183], a[132:135], a[20:23], v[180:183]
buffer_load_dwordx4 v10, s[12:15], s22 offen offset:0 lds
v_mfma_f32_16x16x32_bf16 v[148:151], a[128:131], a[20:23], v[148:151]
ds_read_b64_tr_b16 a[58:59], v18 offset:45568
v_mfma_f32_16x16x32_bf16 v[152:155], a[128:131], a[24:27], v[152:155]
ds_read_b64_tr_b16 a[60:61], v19 offset:45056
v_mfma_f32_16x16x32_bf16 v[184:187], a[132:135], a[24:27], v[184:187]
ds_read_b64_tr_b16 a[62:63], v19 offset:45568
v_mfma_f32_16x16x32_bf16 v[216:219], a[136:139], a[24:27], v[216:219]
v_mfma_f32_16x16x32_bf16 v[248:251], a[140:143], a[24:27], v[248:251]
buffer_load_dwordx4 v11, s[12:15], s22 offen offset:1024 lds
s_waitcnt lgkmcnt(3)
v_mfma_f32_16x16x32_bf16 v[252:255], a[140:143], a[28:31], v[252:255]
v_readlane_b32 s21, v14, s20
v_mfma_f32_16x16x32_bf16 v[220:223], a[136:139], a[28:31], v[220:223]
s_add_u32 s20, s20, 1
v_mfma_f32_16x16x32_bf16 v[188:191], a[132:135], a[28:31], v[188:191]
v_readlane_b32 s22, v15, s20
v_mfma_f32_16x16x32_bf16 v[156:159], a[128:131], a[28:31], v[156:159]
s_waitcnt vmcnt(12)
v_mfma_f32_16x16x32_bf16 v[128:131], a[144:147], a[32:35], v[128:131]
s_barrier
v_mfma_f32_16x16x32_bf16 v[160:163], a[148:151], a[32:35], v[160:163]
ds_read_b64_tr_b16 a[0:1], v20 offset:0
v_mfma_f32_16x16x32_bf16 v[192:195], a[152:155], a[32:35], v[192:195]
buffer_load_dwordx4 a[128:131], v4, s[8:11], s21 offen offset:0 sc1
v_mfma_f32_16x16x32_bf16 v[224:227], a[156:159], a[32:35], v[224:227]
ds_read_b64_tr_b16 a[2:3], v20 offset:512
v_mfma_f32_16x16x32_bf16 v[228:231], a[156:159], a[36:39], v[228:231]
ds_read_b64_tr_b16 a[4:5], v21 offset:0
v_mfma_f32_16x16x32_bf16 v[196:199], a[152:155], a[36:39], v[196:199]
v_mfma_f32_16x16x32_bf16 v[164:167], a[148:151], a[36:39], v[164:167]
ds_read_b64_tr_b16 a[6:7], v21 offset:512
v_mfma_f32_16x16x32_bf16 v[132:135], a[144:147], a[36:39], v[132:135]
buffer_load_dwordx4 a[132:135], v5, s[8:11], s21 offen offset:0 sc1
v_mfma_f32_16x16x32_bf16 v[136:139], a[144:147], a[40:43], v[136:139]
ds_read_b64_tr_b16 a[8:9], v22 offset:0
v_mfma_f32_16x16x32_bf16 v[168:171], a[148:151], a[40:43], v[168:171]
v_mfma_f32_16x16x32_bf16 v[200:203], a[152:155], a[40:43], v[200:203]
ds_read_b64_tr_b16 a[10:11], v22 offset:512
v_mfma_f32_16x16x32_bf16 v[232:235], a[156:159], a[40:43], v[232:235]
ds_read_b64_tr_b16 a[12:13], v23 offset:0
v_mfma_f32_16x16x32_bf16 v[236:239], a[156:159], a[44:47], v[236:239]
buffer_load_dwordx4 a[136:139], v6, s[8:11], s21 offen offset:0 sc1
v_mfma_f32_16x16x32_bf16 v[204:207], a[152:155], a[44:47], v[204:207]
v_mfma_f32_16x16x32_bf16 v[172:175], a[148:151], a[44:47], v[172:175]
ds_read_b64_tr_b16 a[14:15], v23 offset:512
v_mfma_f32_16x16x32_bf16 v[140:143], a[144:147], a[44:47], v[140:143]
ds_read_b64_tr_b16 a[16:17], v20 offset:8192
v_mfma_f32_16x16x32_bf16 v[144:147], a[144:147], a[48:51], v[144:147]
ds_read_b64_tr_b16 a[18:19], v20 offset:8704
v_mfma_f32_16x16x32_bf16 v[176:179], a[148:151], a[48:51], v[176:179]
buffer_load_dwordx4 a[140:143], v7, s[8:11], s21 offen offset:0 sc1
v_mfma_f32_16x16x32_bf16 v[208:211], a[152:155], a[48:51], v[208:211]
v_mfma_f32_16x16x32_bf16 v[240:243], a[156:159], a[48:51], v[240:243]
ds_read_b64_tr_b16 a[20:21], v21 offset:8192
v_mfma_f32_16x16x32_bf16 v[244:247], a[156:159], a[52:55], v[244:247]
ds_read_b64_tr_b16 a[22:23], v21 offset:8704
v_mfma_f32_16x16x32_bf16 v[212:215], a[152:155], a[52:55], v[212:215]
s_add_u32 m0, s23, 0
v_mfma_f32_16x16x32_bf16 v[180:183], a[148:151], a[52:55], v[180:183]
buffer_load_dwordx4 v8, s[12:15], s22 offen offset:0 lds
v_mfma_f32_16x16x32_bf16 v[148:151], a[144:147], a[52:55], v[148:151]
s_waitcnt lgkmcnt(2)
v_mfma_f32_16x16x32_bf16 v[152:155], a[144:147], a[56:59], v[152:155]
ds_read_b64_tr_b16 a[24:25], v22 offset:8192
v_mfma_f32_16x16x32_bf16 v[184:187], a[148:151], a[56:59], v[184:187]
ds_read_b64_tr_b16 a[26:27], v22 offset:8704
v_mfma_f32_16x16x32_bf16 v[216:219], a[152:155], a[56:59], v[216:219]
v_mfma_f32_16x16x32_bf16 v[248:251], a[156:159], a[56:59], v[248:251]
buffer_load_dwordx4 v9, s[12:15], s22 offen offset:1024 lds
v_mfma_f32_16x16x32_bf16 v[252:255], a[156:159], a[60:63], v[252:255]
ds_read_b64_tr_b16 a[28:29], v23 offset:8192
v_mfma_f32_16x16x32_bf16 v[220:223], a[152:155], a[60:63], v[220:223]
ds_read_b64_tr_b16 a[30:31], v23 offset:8704
v_mfma_f32_16x16x32_bf16 v[188:191], a[148:151], a[60:63], v[188:191]
v_mfma_f32_16x16x32_bf16 v[156:159], a[144:147], a[60:63], v[156:159]
s_waitcnt vmcnt(14)
v_mfma_f32_16x16x32_bf16 v[128:131], a[96:99], a[0:3], v[128:131]
ds_read_b64_tr_b16 a[32:33], v20 offset:4096
v_mfma_f32_16x16x32_bf16 v[160:163], a[100:103], a[0:3], v[160:163]
ds_read_b64_tr_b16 a[34:35], v20 offset:4608
v_mfma_f32_16x16x32_bf16 v[192:195], a[104:107], a[0:3], v[192:195]
buffer_load_dwordx4 a[144:147], v4, s[8:11], s21 offen offset:1024 sc1
v_mfma_f32_16x16x32_bf16 v[224:227], a[108:111], a[0:3], v[224:227]
ds_read_b64_tr_b16 a[36:37], v21 offset:4096
v_mfma_f32_16x16x32_bf16 v[228:231], a[108:111], a[4:7], v[228:231]
ds_read_b64_tr_b16 a[38:39], v21 offset:4608
v_mfma_f32_16x16x32_bf16 v[196:199], a[104:107], a[4:7], v[196:199]
v_mfma_f32_16x16x32_bf16 v[164:167], a[100:103], a[4:7], v[164:167]
ds_read_b64_tr_b16 a[40:41], v22 offset:4096
v_mfma_f32_16x16x32_bf16 v[132:135], a[96:99], a[4:7], v[132:135]
buffer_load_dwordx4 a[148:151], v5, s[8:11], s21 offen offset:1024 sc1
v_mfma_f32_16x16x32_bf16 v[136:139], a[96:99], a[8:11], v[136:139]
ds_read_b64_tr_b16 a[42:43], v22 offset:4608
v_mfma_f32_16x16x32_bf16 v[168:171], a[100:103], a[8:11], v[168:171]
ds_read_b64_tr_b16 a[44:45], v23 offset:4096
v_mfma_f32_16x16x32_bf16 v[200:203], a[104:107], a[8:11], v[200:203]
v_mfma_f32_16x16x32_bf16 v[232:235], a[108:111], a[8:11], v[232:235]
ds_read_b64_tr_b16 a[46:47], v23 offset:4608
v_mfma_f32_16x16x32_bf16 v[236:239], a[108:111], a[12:15], v[236:239]
buffer_load_dwordx4 a[152:155], v6, s[8:11], s21 offen offset:1024 sc1
v_mfma_f32_16x16x32_bf16 v[204:207], a[104:107], a[12:15], v[204:207]
ds_read_b64_tr_b16 a[48:49], v20 offset:12288
v_mfma_f32_16x16x32_bf16 v[172:175], a[100:103], a[12:15], v[172:175]
ds_read_b64_tr_b16 a[50:51], v20 offset:12800
v_mfma_f32_16x16x32_bf16 v[140:143], a[96:99], a[12:15], v[140:143]
v_mfma_f32_16x16x32_bf16 v[144:147], a[96:99], a[16:19], v[144:147]
ds_read_b64_tr_b16 a[52:53], v21 offset:12288
v_mfma_f32_16x16x32_bf16 v[176:179], a[100:103], a[16:19], v[176:179]
buffer_load_dwordx4 a[156:159], v7, s[8:11], s21 offen offset:1024 sc1
v_mfma_f32_16x16x32_bf16 v[208:211], a[104:107], a[16:19], v[208:211]
ds_read_b64_tr_b16 a[54:55], v21 offset:12800
v_mfma_f32_16x16x32_bf16 v[240:243], a[108:111], a[16:19], v[240:243]
ds_read_b64_tr_b16 a[56:57], v22 offset:12288
s_waitcnt lgkmcnt(3)
v_mfma_f32_16x16x32_bf16 v[244:247], a[108:111], a[20:23], v[244:247]
v_mfma_f32_16x16x32_bf16 v[212:215], a[104:107], a[20:23], v[212:215]
s_add_u32 m0, s23, 8192
v_mfma_f32_16x16x32_bf16 v[180:183], a[100:103], a[20:23], v[180:183]
buffer_load_dwordx4 v10, s[12:15], s22 offen offset:0 lds
v_mfma_f32_16x16x32_bf16 v[148:151], a[96:99], a[20:23], v[148:151]
ds_read_b64_tr_b16 a[58:59], v22 offset:12800
v_mfma_f32_16x16x32_bf16 v[152:155], a[96:99], a[24:27], v[152:155]
ds_read_b64_tr_b16 a[60:61], v23 offset:12288
v_mfma_f32_16x16x32_bf16 v[184:187], a[100:103], a[24:27], v[184:187]
ds_read_b64_tr_b16 a[62:63], v23 offset:12800
v_mfma_f32_16x16x32_bf16 v[216:219], a[104:107], a[24:27], v[216:219]
v_mfma_f32_16x16x32_bf16 v[248:251], a[108:111], a[24:27], v[248:251]
buffer_load_dwordx4 v11, s[12:15], s22 offen offset:1024 lds
v_mfma_f32_16x16x32_bf16 v[252:255], a[108:111], a[28:31], v[252:255]
v_readlane_b32 s21, v14, s20
v_mfma_f32_16x16x32_bf16 v[220:223], a[104:107], a[28:31], v[220:223]
s_add_u32 s20, s20, 1
v_mfma_f32_16x16x32_bf16 v[188:191], a[100:103], a[28:31], v[188:191]
v_readlane_b32 s22, v15, s20
v_mfma_f32_16x16x32_bf16 v[156:159], a[96:99], a[28:31], v[156:159]
s_waitcnt vmcnt(12)
v_mfma_f32_16x16x32_bf16 v[128:131], a[112:115], a[32:35], v[128:131]
s_barrier
v_mfma_f32_16x16x32_bf16 v[160:163], a[116:119], a[32:35], v[160:163]
ds_read_b64_tr_b16 a[0:1], v20 offset:32768
v_mfma_f32_16x16x32_bf16 v[192:195], a[120:123], a[32:35], v[192:195]
buffer_load_dwordx4 a[96:99], v4, s[8:11], s21 offen offset:0 sc1
v_mfma_f32_16x16x32_bf16 v[224:227], a[124:127], a[32:35], v[224:227]
ds_read_b64_tr_b16 a[2:3], v20 offset:33280
v_mfma_f32_16x16x32_bf16 v[228:231], a[124:127], a[36:39], v[228:231]
ds_read_b64_tr_b16 a[4:5], v21 offset:32768
v_mfma_f32_16x16x32_bf16 v[196:199], a[120:123], a[36:39], v[196:199]
v_mfma_f32_16x16x32_bf16 v[164:167], a[116:119], a[36:39], v[164:167]
ds_read_b64_tr_b16 a[6:7], v21 offset:33280
v_mfma_f32_16x16x32_bf16 v[132:135], a[112:115], a[36:39], v[132:135]
buffer_load_dwordx4 a[100:103], v5, s[8:11], s21 offen offset:0 sc1
v_mfma_f32_16x16x32_bf16 v[136:139], a[112:115], a[40:43], v[136:139]
ds_read_b64_tr_b16 a[8:9], v22 offset:32768
v_mfma_f32_16x16x32_bf16 v[168:171], a[116:119], a[40:43], v[168:171]
v_mfma_f32_16x16x32_bf16 v[200:203], a[120:123], a[40:43], v[200:203]
ds_read_b64_tr_b16 a[10:11], v22 offset:33280
v_mfma_f32_16x16x32_bf16 v[232:235], a[124:127], a[40:43], v[232:235]
ds_read_b64_tr_b16 a[12:13], v23 offset:32768
v_mfma_f32_16x16x32_bf16 v[236:239], a[124:127], a[44:47], v[236:239]
buffer_load_dwordx4 a[104:107], v6, s[8:11], s21 offen offset:0 sc1
v_mfma_f32_16x16x32_bf16 v[204:207], a[120:123], a[44:47], v[204:207]
v_mfma_f32_16x16x32_bf16 v[172:175], a[116:119], a[44:47], v[172:175]
ds_read_b64_tr_b16 a[14:15], v23 offset:33280
v_mfma_f32_16x16x32_bf16 v[140:143], a[112:115], a[44:47], v[140:143]
ds_read_b64_tr_b16 a[16:17], v20 offset:40960
v_mfma_f32_16x16x32_bf16 v[144:147], a[112:115], a[48:51], v[144:147]
ds_read_b64_tr_b16 a[18:19], v20 offset:41472
v_mfma_f32_16x16x32_bf16 v[176:179], a[116:119], a[48:51], v[176:179]
buffer_load_dwordx4 a[108:111], v7, s[8:11], s21 offen offset:0 sc1
v_mfma_f32_16x16x32_bf16 v[208:211], a[120:123], a[48:51], v[208:211]
v_mfma_f32_16x16x32_bf16 v[240:243], a[124:127], a[48:51], v[240:243]
ds_read_b64_tr_b16 a[20:21], v21 offset:40960
s_waitcnt lgkmcnt(3)
v_mfma_f32_16x16x32_bf16 v[244:247], a[124:127], a[52:55], v[244:247]
ds_read_b64_tr_b16 a[22:23], v21 offset:41472
v_mfma_f32_16x16x32_bf16 v[212:215], a[120:123], a[52:55], v[212:215]
s_add_u32 m0, s23, 32768
v_mfma_f32_16x16x32_bf16 v[180:183], a[116:119], a[52:55], v[180:183]
buffer_load_dwordx4 v8, s[12:15], s22 offen offset:0 lds
v_mfma_f32_16x16x32_bf16 v[148:151], a[112:115], a[52:55], v[148:151]
v_mfma_f32_16x16x32_bf16 v[152:155], a[112:115], a[56:59], v[152:155]
ds_read_b64_tr_b16 a[24:25], v22 offset:40960
v_mfma_f32_16x16x32_bf16 v[184:187], a[116:119], a[56:59], v[184:187]
ds_read_b64_tr_b16 a[26:27], v22 offset:41472
v_mfma_f32_16x16x32_bf16 v[216:219], a[120:123], a[56:59], v[216:219]
v_mfma_f32_16x16x32_bf16 v[248:251], a[124:127], a[56:59], v[248:251]
buffer_load_dwordx4 v9, s[12:15], s22 offen offset:1024 lds
v_mfma_f32_16x16x32_bf16 v[252:255], a[124:127], a[60:63], v[252:255]
ds_read_b64_tr_b16 a[28:29], v23 offset:40960
v_mfma_f32_16x16x32_bf16 v[220:223], a[120:123], a[60:63], v[220:223]
ds_read_b64_tr_b16 a[30:31], v23 offset:41472
v_mfma_f32_16x16x32_bf16 v[188:191], a[116:119], a[60:63], v[188:191]
v_mfma_f32_16x16x32_bf16 v[156:159], a[112:115], a[60:63], v[156:159]
s_waitcnt vmcnt(14)
v_mfma_f32_16x16x32_bf16 v[128:131], a[128:131], a[0:3], v[128:131]
ds_read_b64_tr_b16 a[32:33], v20 offset:36864
v_mfma_f32_16x16x32_bf16 v[160:163], a[132:135], a[0:3], v[160:163]
ds_read_b64_tr_b16 a[34:35], v20 offset:37376
v_mfma_f32_16x16x32_bf16 v[192:195], a[136:139], a[0:3], v[192:195]
buffer_load_dwordx4 a[112:115], v4, s[8:11], s21 offen offset:1024 sc1
v_mfma_f32_16x16x32_bf16 v[224:227], a[140:143], a[0:3], v[224:227]
ds_read_b64_tr_b16 a[36:37], v21 offset:36864
v_mfma_f32_16x16x32_bf16 v[228:231], a[140:143], a[4:7], v[228:231]
ds_read_b64_tr_b16 a[38:39], v21 offset:37376
v_mfma_f32_16x16x32_bf16 v[196:199], a[136:139], a[4:7], v[196:199]
v_mfma_f32_16x16x32_bf16 v[164:167], a[132:135], a[4:7], v[164:167]
ds_read_b64_tr_b16 a[40:41], v22 offset:36864
v_mfma_f32_16x16x32_bf16 v[132:135], a[128:131], a[4:7], v[132:135]
buffer_load_dwordx4 a[116:119], v5, s[8:11], s21 offen offset:1024 sc1
v_mfma_f32_16x16x32_bf16 v[136:139], a[128:131], a[8:11], v[136:139]
ds_read_b64_tr_b16 a[42:43], v22 offset:37376
v_mfma_f32_16x16x32_bf16 v[168:171], a[132:135], a[8:11], v[168:171]
ds_read_b64_tr_b16 a[44:45], v23 offset:36864
v_mfma_f32_16x16x32_bf16 v[200:203], a[136:139], a[8:11], v[200:203]
v_mfma_f32_16x16x32_bf16 v[232:235], a[140:143], a[8:11], v[232:235]
ds_read_b64_tr_b16 a[46:47], v23 offset:37376
v_mfma_f32_16x16x32_bf16 v[236:239], a[140:143], a[12:15], v[236:239]
buffer_load_dwordx4 a[120:123], v6, s[8:11], s21 offen offset:1024 sc1
v_mfma_f32_16x16x32_bf16 v[204:207], a[136:139], a[12:15], v[204:207]
ds_read_b64_tr_b16 a[48:49], v20 offset:45056
v_mfma_f32_16x16x32_bf16 v[172:175], a[132:135], a[12:15], v[172:175]
ds_read_b64_tr_b16 a[50:51], v20 offset:45568
v_mfma_f32_16x16x32_bf16 v[140:143], a[128:131], a[12:15], v[140:143]
s_waitcnt lgkmcnt(3)
v_mfma_f32_16x16x32_bf16 v[144:147], a[128:131], a[16:19], v[144:147]
ds_read_b64_tr_b16 a[52:53], v21 offset:45056
v_mfma_f32_16x16x32_bf16 v[176:179], a[132:135], a[16:19], v[176:179]
buffer_load_dwordx4 a[124:127], v7, s[8:11], s21 offen offset:1024 sc1
v_mfma_f32_16x16x32_bf16 v[208:211], a[136:139], a[16:19], v[208:211]
ds_read_b64_tr_b16 a[54:55], v21 offset:45568
v_mfma_f32_16x16x32_bf16 v[240:243], a[140:143], a[16:19], v[240:243]
ds_read_b64_tr_b16 a[56:57], v22 offset:45056
v_mfma_f32_16x16x32_bf16 v[244:247], a[140:143], a[20:23], v[244:247]
v_mfma_f32_16x16x32_bf16 v[212:215], a[136:139], a[20:23], v[212:215]
s_add_u32 m0, s23, 40960
v_mfma_f32_16x16x32_bf16 v[180:183], a[132:135], a[20:23], v[180:183]
buffer_load_dwordx4 v10, s[12:15], s22 offen offset:0 lds
v_mfma_f32_16x16x32_bf16 v[148:151], a[128:131], a[20:23], v[148:151]
ds_read_b64_tr_b16 a[58:59], v22 offset:45568
v_mfma_f32_16x16x32_bf16 v[152:155], a[128:131], a[24:27], v[152:155]
ds_read_b64_tr_b16 a[60:61], v23 offset:45056
v_mfma_f32_16x16x32_bf16 v[184:187], a[132:135], a[24:27], v[184:187]
ds_read_b64_tr_b16 a[62:63], v23 offset:45568
v_mfma_f32_16x16x32_bf16 v[216:219], a[136:139], a[24:27], v[216:219]
v_mfma_f32_16x16x32_bf16 v[248:251], a[140:143], a[24:27], v[248:251]
buffer_load_dwordx4 v11, s[12:15], s22 offen offset:1024 lds
v_mfma_f32_16x16x32_bf16 v[252:255], a[140:143], a[28:31], v[252:255]
v_readlane_b32 s21, v14, s20
v_mfma_f32_16x16x32_bf16 v[220:223], a[136:139], a[28:31], v[220:223]
s_add_u32 s20, s20, 1
v_mfma_f32_16x16x32_bf16 v[188:191], a[132:135], a[28:31], v[188:191]
v_readlane_b32 s22, v15, s20
v_mfma_f32_16x16x32_bf16 v[156:159], a[128:131], a[28:31], v[156:159]
s_waitcnt vmcnt(12)
v_mfma_f32_16x16x32_bf16 v[128:131], a[144:147], a[32:35], v[128:131]
s_barrier
v_mfma_f32_16x16x32_bf16 v[160:163], a[148:151], a[32:35], v[160:163]
ds_read_b64_tr_b16 a[0:1], v16 offset:0
v_mfma_f32_16x16x32_bf16 v[192:195], a[152:155], a[32:35], v[192:195]
buffer_load_dwordx4 a[128:131], v4, s[8:11], s21 offen offset:0 sc1
v_mfma_f32_16x16x32_bf16 v[224:227], a[156:159], a[32:35], v[224:227]
ds_read_b64_tr_b16 a[2:3], v16 offset:512
v_mfma_f32_16x16x32_bf16 v[228:231], a[156:159], a[36:39], v[228:231]
ds_read_b64_tr_b16 a[4:5], v17 offset:0
v_mfma_f32_16x16x32_bf16 v[196:199], a[152:155], a[36:39], v[196:199]
v_mfma_f32_16x16x32_bf16 v[164:167], a[148:151], a[36:39], v[164:167]
ds_read_b64_tr_b16 a[6:7], v17 offset:512
v_mfma_f32_16x16x32_bf16 v[132:135], a[144:147], a[36:39], v[132:135]
buffer_load_dwordx4 a[132:135], v5, s[8:11], s21 offen offset:0 sc1
v_mfma_f32_16x16x32_bf16 v[136:139], a[144:147], a[40:43], v[136:139]
ds_read_b64_tr_b16 a[8:9], v18 offset:0
v_mfma_f32_16x16x32_bf16 v[168:171], a[148:151], a[40:43], v[168:171]
v_mfma_f32_16x16x32_bf16 v[200:203], a[152:155], a[40:43], v[200:203]
ds_read_b64_tr_b16 a[10:11], v18 offset:512
v_mfma_f32_16x16x32_bf16 v[232:235], a[156:159], a[40:43], v[232:235]
ds_read_b64_tr_b16 a[12:13], v19 offset:0
s_waitcnt lgkmcnt(3)
v_mfma_f32_16x16x32_bf16 v[236:239], a[156:159], a[44:47], v[236:239]
buffer_load_dwordx4 a[136:139], v6, s[8:11], s21 offen offset:0 sc1
v_mfma_f32_16x16x32_bf16 v[204:207], a[152:155], a[44:47], v[204:207]
v_mfma_f32_16x16x32_bf16 v[172:175], a[148:151], a[44:47], v[172:175]
ds_read_b64_tr_b16 a[14:15], v19 offset:512
v_mfma_f32_16x16x32_bf16 v[140:143], a[144:147], a[44:47], v[140:143]
ds_read_b64_tr_b16 a[16:17], v16 offset:8192
v_mfma_f32_16x16x32_bf16 v[144:147], a[144:147], a[48:51], v[144:147]
ds_read_b64_tr_b16 a[18:19], v16 offset:8704
v_mfma_f32_16x16x32_bf16 v[176:179], a[148:151], a[48:51], v[176:179]
buffer_load_dwordx4 a[140:143], v7, s[8:11], s21 offen offset:0 sc1
v_mfma_f32_16x16x32_bf16 v[208:211], a[152:155], a[48:51], v[208:211]
v_mfma_f32_16x16x32_bf16 v[240:243], a[156:159], a[48:51], v[240:243]
ds_read_b64_tr_b16 a[20:21], v17 offset:8192
v_mfma_f32_16x16x32_bf16 v[244:247], a[156:159], a[52:55], v[244:247]
ds_read_b64_tr_b16 a[22:23], v17 offset:8704
v_mfma_f32_16x16x32_bf16 v[212:215], a[152:155], a[52:55], v[212:215]
s_add_u32 m0, s23, 65536
v_mfma_f32_16x16x32_bf16 v[180:183], a[148:151], a[52:55], v[180:183]
buffer_load_dwordx4 v8, s[12:15], s22 offen offset:0 lds
v_mfma_f32_16x16x32_bf16 v[148:151], a[144:147], a[52:55], v[148:151]
v_mfma_f32_16x16x32_bf16 v[152:155], a[144:147], a[56:59], v[152:155]
ds_read_b64_tr_b16 a[24:25], v18 offset:8192
v_mfma_f32_16x16x32_bf16 v[184:187], a[148:151], a[56:59], v[184:187]
ds_read_b64_tr_b16 a[26:27], v18 offset:8704
v_mfma_f32_16x16x32_bf16 v[216:219], a[152:155], a[56:59], v[216:219]
v_mfma_f32_16x16x32_bf16 v[248:251], a[156:159], a[56:59], v[248:251]
buffer_load_dwordx4 v9, s[12:15], s22 offen offset:1024 lds
v_mfma_f32_16x16x32_bf16 v[252:255], a[156:159], a[60:63], v[252:255]
ds_read_b64_tr_b16 a[28:29], v19 offset:8192
v_mfma_f32_16x16x32_bf16 v[220:223], a[152:155], a[60:63], v[220:223]
ds_read_b64_tr_b16 a[30:31], v19 offset:8704
v_mfma_f32_16x16x32_bf16 v[188:191], a[148:151], a[60:63], v[188:191]
s_sub_u32 s30, s30, 1
v_mfma_f32_16x16x32_bf16 v[156:159], a[144:147], a[60:63], v[156:159]
s_waitcnt vmcnt(14)
s_cbranch_scc0 Lz_loop1
v_mfma_f32_16x16x32_bf16 v[128:131], a[96:99], a[0:3], v[128:131]
ds_read_b64_tr_b16 a[32:33], v16 offset:4096
v_mfma_f32_16x16x32_bf16 v[160:163], a[100:103], a[0:3], v[160:163]
ds_read_b64_tr_b16 a[34:35], v16 offset:4608
v_mfma_f32_16x16x32_bf16 v[192:195], a[104:107], a[0:3], v[192:195]
buffer_load_dwordx4 a[144:147], v4, s[8:11], s21 offen offset:1024 sc1
v_mfma_f32_16x16x32_bf16 v[224:227], a[108:111], a[0:3], v[224:227]
ds_read_b64_tr_b16 a[36:37], v17 offset:4096
v_mfma_f32_16x16x32_bf16 v[228:231], a[108:111], a[4:7], v[228:231]
ds_read_b64_tr_b16 a[38:39], v17 offset:4608
v_mfma_f32_16x16x32_bf16 v[196:199], a[104:107], a[4:7], v[196:199]
v_mfma_f32_16x16x32_bf16 v[164:167], a[100:103], a[4:7], v[164:167]
buffer_load_dwordx4 a[148:151], v5, s[8:11], s21 offen offset:1024 sc1
v_mfma_f32_16x16x32_bf16 v[132:135], a[96:99], a[4:7], v[132:135]
ds_read_b64_tr_b16 a[40:41], v18 offset:4096
s_waitcnt lgkmcnt(3)
v_mfma_f32_16x16x32_bf16 v[136:139], a[96:99], a[8:11], v[136:139]
ds_read_b64_tr_b16 a[42:43], v18 offset:4608
v_mfma_f32_16x16x32_bf16 v[168:171], a[100:103], a[8:11], v[168:171]
ds_read_b64_tr_b16 a[44:45], v19 offset:4096
v_mfma_f32_16x16x32_bf16 v[200:203], a[104:107], a[8:11], v[200:203]
buffer_load_dwordx4 a[152:155], v6, s[8:11], s21 offen offset:1024 sc1
v_mfma_f32_16x16x32_bf16 v[232:235], a[108:111], a[8:11], v[232:235]
ds_read_b64_tr_b16 a[46:47], v19 offset:4608
v_mfma_f32_16x16x32_bf16 v[236:239], a[108:111], a[12:15], v[236:239]
v_mfma_f32_16x16x32_bf16 v[204:207], a[104:107], a[12:15], v[204:207]
ds_read_b64_tr_b16 a[48:49], v16 offset:12288
v_mfma_f32_16x16x32_bf16 v[172:175], a[100:103], a[12:15], v[172:175]
buffer_load_dwordx4 a[156:159], v7, s[8:11], s21 offen offset:1024 sc1
v_mfma_f32_16x16x32_bf16 v[140:143], a[96:99], a[12:15], v[140:143]
ds_read_b64_tr_b16 a[50:51], v16 offset:12800
v_mfma_f32_16x16x32_bf16 v[144:147], a[96:99], a[16:19], v[144:147]
ds_read_b64_tr_b16 a[52:53], v17 offset:12288
v_mfma_f32_16x16x32_bf16 v[176:179], a[100:103], a[16:19], v[176:179]
s_add_u32 m0, s23, 73728
v_mfma_f32_16x16x32_bf16 v[208:211], a[104:107], a[16:19], v[208:211]
buffer_load_dwordx4 v10, s[12:15], s22 offen offset:0 lds
v_mfma_f32_16x16x32_bf16 v[240:243], a[108:111], a[16:19], v[240:243]
ds_read_b64_tr_b16 a[54:55], v17 offset:12800
v_mfma_f32_16x16x32_bf16 v[244:247], a[108:111], a[20:23], v[244:247]
v_mfma_f32_16x16x32_bf16 v[212:215], a[104:107], a[20:23], v[212:215]
ds_read_b64_tr_b16 a[56:57], v18 offset:12288
v_mfma_f32_16x16x32_bf16 v[180:183], a[100:103], a[20:23], v[180:183]
buffer_load_dwordx4 v11, s[12:15], s22 offen offset:1024 lds
v_mfma_f32_16x16x32_bf16 v[148:151], a[96:99], a[20:23], v[148:151]
ds_read_b64_tr_b16 a[58:59], v18 offset:12800
v_mfma_f32_16x16x32_bf16 v[152:155], a[96:99], a[24:27], v[152:155]
ds_read_b64_tr_b16 a[60:61], v19 offset:12288
v_mfma_f32_16x16x32_bf16 v[184:187], a[100:103], a[24:27], v[184:187]
ds_read_b64_tr_b16 a[62:63], v19 offset:12800
v_mfma_f32_16x16x32_bf16 v[216:219], a[104:107], a[24:27], v[216:219]
buffer_load_dword v28, v29, s[40:43], 0 offen sc1
v_mfma_f32_16x16x32_bf16 v[248:251], a[108:111], a[24:27], v[248:251]
v_readlane_b32 s21, v14, s20
v_mfma_f32_16x16x32_bf16 v[252:255], a[108:111], a[28:31], v[252:255]
s_add_u32 s20, s20, 1
v_mfma_f32_16x16x32_bf16 v[220:223], a[104:107], a[28:31], v[220:223]
v_readlane_b32 s22, v15, s20
v_mfma_f32_16x16x32_bf16 v[188:191], a[100:103], a[28:31], v[188:191]
v_mfma_f32_16x16x32_bf16 v[156:159], a[96:99], a[28:31], v[156:159]
s_waitcnt vmcnt(13)
v_mfma_f32_16x16x32_bf16 v[128:131], a[112:115], a[32:35], v[128:131]
s_barrier
v_mfma_f32_16x16x32_bf16 v[160:163], a[116:119], a[32:35], v[160:163]
ds_read_b64_tr_b16 a[0:1], v16 offset:32768
v_mfma_f32_16x16x32_bf16 v[192:195], a[120:123], a[32:35], v[192:195]
buffer_load_dwordx4 a[96:99], v4, s[8:11], s21 offen offset:0 sc1
v_mfma_f32_16x16x32_bf16 v[224:227], a[124:127], a[32:35], v[224:227]
ds_read_b64_tr_b16 a[2:3], v16 offset:33280
s_waitcnt lgkmcnt(2)
v_mfma_f32_16x16x32_bf16 v[228:231], a[124:127], a[36:39], v[228:231]
ds_read_b64_tr_b16 a[4:5], v17 offset:32768
v_mfma_f32_16x16x32_bf16 v[196:199], a[120:123], a[36:39], v[196:199]
v_mfma_f32_16x16x32_bf16 v[164:167], a[116:119], a[36:39], v[164:167]
ds_read_b64_tr_b16 a[6:7], v17 offset:33280
v_mfma_f32_16x16x32_bf16 v[132:135], a[112:115], a[36:39], v[132:135]
buffer_load_dwordx4 a[100:103], v5, s[8:11], s21 offen offset:0 sc1
v_mfma_f32_16x16x32_bf16 v[136:139], a[112:115], a[40:43], v[136:139]
ds_read_b64_tr_b16 a[8:9], v18 offset:32768
v_mfma_f32_16x16x32_bf16 v[168:171], a[116:119], a[40:43], v[168:171]
v_mfma_f32_16x16x32_bf16 v[200:203], a[120:123], a[40:43], v[200:203]
ds_read_b64_tr_b16 a[10:11], v18 offset:33280
v_mfma_f32_16x16x32_bf16 v[232:235], a[124:127], a[40:43], v[232:235]
ds_read_b64_tr_b16 a[12:13], v19 offset:32768
v_mfma_f32_16x16x32_bf16 v[236:239], a[124:127], a[44:47], v[236:239]
buffer_load_dwordx4 a[104:107], v6, s[8:11], s21 offen offset:0 sc1
v_mfma_f32_16x16x32_bf16 v[204:207], a[120:123], a[44:47], v[204:207]
v_mfma_f32_16x16x32_bf16 v[172:175], a[116:119], a[44:47], v[172:175]
ds_read_b64_tr_b16 a[14:15], v19 offset:33280
v_mfma_f32_16x16x32_bf16 v[140:143], a[112:115], a[44:47], v[140:143]
ds_read_b64_tr_b16 a[16:17], v16 offset:40960
v_mfma_f32_16x16x32_bf16 v[144:147], a[112:115], a[48:51], v[144:147]
ds_read_b64_tr_b16 a[18:19], v16 offset:41472
v_mfma_f32_16x16x32_bf16 v[176:179], a[116:119], a[48:51], v[176:179]
buffer_load_dwordx4 a[108:111], v7, s[8:11], s21 offen offset:0 sc1
v_mfma_f32_16x16x32_bf16 v[208:211], a[120:123], a[48:51], v[208:211]
v_mfma_f32_16x16x32_bf16 v[240:243], a[124:127], a[48:51], v[240:243]
ds_read_b64_tr_b16 a[20:21], v17 offset:40960
v_mfma_f32_16x16x32_bf16 v[244:247], a[124:127], a[52:55], v[244:247]
ds_read_b64_tr_b16 a[22:23], v17 offset:41472
v_mfma_f32_16x16x32_bf16 v[212:215], a[120:123], a[52:55], v[212:215]
s_add_u32 m0, s23, 98304
v_mfma_f32_16x16x32_bf16 v[180:183], a[116:119], a[52:55], v[180:183]
buffer_load_dwordx4 v8, s[12:15], s22 offen offset:0 lds
v_mfma_f32_16x16x32_bf16 v[148:151], a[112:115], a[52:55], v[148:151]
v_mfma_f32_16x16x32_bf16 v[152:155], a[112:115], a[56:59], v[152:155]
ds_read_b64_tr_b16 a[24:25], v18 offset:40960
v_mfma_f32_16x16x32_bf16 v[184:187], a[116:119], a[56:59], v[184:187]
ds_read_b64_tr_b16 a[26:27], v18 offset:41472
v_mfma_f32_16x16x32_bf16 v[216:219], a[120:123], a[56:59], v[216:219]
v_mfma_f32_16x16x32_bf16 v[248:251], a[124:127], a[56:59], v[248:251]
buffer_load_dwordx4 v9, s[12:15], s22 offen offset:1024 lds
v_mfma_f32_16x16x32_bf16 v[252:255], a[124:127], a[60:63], v[252:255]
ds_read_b64_tr_b16 a[28:29], v19 offset:40960
v_mfma_f32_16x16x32_bf16 v[220:223], a[120:123], a[60:63], v[220:223]
ds_read_b64_tr_b16 a[30:31], v19 offset:41472
v_mfma_f32_16x16x32_bf16 v[188:191], a[116:119], a[60:63], v[188:191]
v_mfma_f32_16x16x32_bf16 v[156:159], a[112:115], a[60:63], v[156:159]
s_waitcnt vmcnt(15) lgkmcnt(2)
v_mfma_f32_16x16x32_bf16 v[128:131], a[128:131], a[0:3], v[128:131]
ds_read_b64_tr_b16 a[32:33], v16 offset:36864
v_mfma_f32_16x16x32_bf16 v[160:163], a[132:135], a[0:3], v[160:163]
ds_read_b64_tr_b16 a[34:35], v16 offset:37376
s_mov_b32 s31, 16
v_mfma_f32_16x16x32_bf16 v[192:195], a[136:139], a[0:3], v[192:195]
buffer_load_dwordx4 a[112:115], v4, s[8:11], s21 offen offset:1024 sc1
v_readlane_b32 s28, v14, s31
v_mfma_f32_16x16x32_bf16 v[224:227], a[140:143], a[0:3], v[224:227]
ds_read_b64_tr_b16 a[36:37], v17 offset:36864
v_mfma_f32_16x16x32_bf16 v[228:231], a[140:143], a[4:7], v[228:231]
ds_read_b64_tr_b16 a[38:39], v17 offset:37376
v_mfma_f32_16x16x32_bf16 v[196:199], a[136:139], a[4:7], v[196:199]
v_mfma_f32_16x16x32_bf16 v[164:167], a[132:135], a[4:7], v[164:167]
ds_read_b64_tr_b16 a[40:41], v18 offset:36864
v_mfma_f32_16x16x32_bf16 v[132:135], a[128:131], a[4:7], v[132:135]
buffer_load_dwordx4 a[116:119], v5, s[8:11], s21 offen offset:1024 sc1
v_mfma_f32_16x16x32_bf16 v[136:139], a[128:131], a[8:11], v[136:139]
ds_read_b64_tr_b16 a[42:43], v18 offset:37376
v_mfma_f32_16x16x32_bf16 v[168:171], a[132:135], a[8:11], v[168:171]
ds_read_b64_tr_b16 a[44:45], v19 offset:36864
v_mfma_f32_16x16x32_bf16 v[200:203], a[136:139], a[8:11], v[200:203]
s_waitcnt vmcnt(8)
v_cmp_ne_u32 vcc, s78, v28
v_mfma_f32_16x16x32_bf16 v[232:235], a[140:143], a[8:11], v[232:235]
ds_read_b64_tr_b16 a[46:47], v19 offset:37376
v_mfma_f32_16x16x32_bf16 v[236:239], a[140:143], a[12:15], v[236:239]
buffer_load_dwordx4 a[120:123], v6, s[8:11], s21 offen offset:1024 sc1
v_mfma_f32_16x16x32_bf16 v[204:207], a[136:139], a[12:15], v[204:207]
ds_read_b64_tr_b16 a[48:49], v16 offset:45056
s_cbranch_vccz Lok_12
s_mov_b32 s79, 32768
Lspin_11:
buffer_load_dword v28, v29, s[40:43], 0 offen sc1
s_waitcnt vmcnt(0)
v_cmp_ne_u32 vcc, s78, v28
s_sub_u32 s79, s79, 1
s_cbranch_scc1 Lok_12
s_cbranch_vccnz Lspin_11
Lok_12:
v_mfma_f32_16x16x32_bf16 v[172:175], a[132:135], a[12:15], v[172:175]
ds_read_b64_tr_b16 a[50:51], v16 offset:45568
v_mfma_f32_16x16x32_bf16 v[140:143], a[128:131], a[12:15], v[140:143]
v_mfma_f32_16x16x32_bf16 v[144:147], a[128:131], a[16:19], v[144:147]
ds_read_b64_tr_b16 a[52:53], v17 offset:45056
v_mfma_f32_16x16x32_bf16 v[176:179], a[132:135], a[16:19], v[176:179]
buffer_load_dwordx4 a[124:127], v7, s[8:11], s21 offen offset:1024 sc1
v_mfma_f32_16x16x32_bf16 v[208:211], a[136:139], a[16:19], v[208:211]
ds_read_b64_tr_b16 a[54:55], v17 offset:45568
v_mfma_f32_16x16x32_bf16 v[240:243], a[140:143], a[16:19], v[240:243]
ds_read_b64_tr_b16 a[56:57], v18 offset:45056
v_mfma_f32_16x16x32_bf16 v[244:247], a[140:143], a[20:23], v[244:247]
v_mfma_f32_16x16x32_bf16 v[212:215], a[136:139], a[20:23], v[212:215]
s_add_u32 m0, s23, 106496
v_mfma_f32_16x16x32_bf16 v[180:183], a[132:135], a[20:23], v[180:183]
buffer_load_dwordx4 v10, s[12:15], s22 offen offset:0 lds
v_mfma_f32_16x16x32_bf16 v[148:151], a[128:131], a[20:23], v[148:151]
ds_read_b64_tr_b16 a[58:59], v18 offset:45568
v_mfma_f32_16x16x32_bf16 v[152:155], a[128:131], a[24:27], v[152:155]
ds_read_b64_tr_b16 a[60:61], v19 offset:45056
v_mfma_f32_16x16x32_bf16 v[184:187], a[132:135], a[24:27], v[184:187]
ds_read_b64_tr_b16 a[62:63], v19 offset:45568
v_mfma_f32_16x16x32_bf16 v[216:219], a[136:139], a[24:27], v[216:219]
v_mfma_f32_16x16x32_bf16 v[248:251], a[140:143], a[24:27], v[248:251]
buffer_load_dwordx4 v11, s[12:15], s22 offen offset:1024 lds
s_waitcnt lgkmcnt(3)
v_mfma_f32_16x16x32_bf16 v[252:255], a[140:143], a[28:31], v[252:255]
v_readlane_b32 s21, v14, s20
v_mfma_f32_16x16x32_bf16 v[220:223], a[136:139], a[28:31], v[220:223]
v_accvgpr_read_b32 v8, a208
v_accvgpr_read_b32 v9, a209
v_mfma_f32_16x16x32_bf16 v[188:191], a[132:135], a[28:31], v[188:191]
v_accvgpr_read_b32 v10, a210
v_accvgpr_read_b32 v11, a211
v_accvgpr_read_b32 v12, a212
v_accvgpr_read_b32 v13, a213
v_mfma_f32_16x16x32_bf16 v[156:159], a[128:131], a[28:31], v[156:159]
v_mfma_f32_16x16x32_bf16 v[128:131], a[144:147], a[32:35], v[128:131]
s_barrier
v_mfma_f32_16x16x32_bf16 v[160:163], a[148:151], a[32:35], v[160:163]
ds_read_b64_tr_b16 a[0:1], v20 offset:0
v_mfma_f32_16x16x32_bf16 v[192:195], a[152:155], a[32:35], v[192:195]
buffer_load_dwordx4 a[128:131], v4, s[8:11], s21 offen offset:0 sc1
v_mfma_f32_16x16x32_bf16 v[224:227], a[156:159], a[32:35], v[224:227]
ds_read_b64_tr_b16 a[2:3], v20 offset:512
v_mfma_f32_16x16x32_bf16 v[228:231], a[156:159], a[36:39], v[228:231]
buffer_load_dwordx4 a[132:135], v5, s[8:11], s21 offen offset:0 sc1
v_mfma_f32_16x16x32_bf16 v[196:199], a[152:155], a[36:39], v[196:199]
ds_read_b64_tr_b16 a[4:5], v21 offset:0
v_mfma_f32_16x16x32_bf16 v[164:167], a[148:151], a[36:39], v[164:167]
buffer_load_dwordx4 a[136:139], v6, s[8:11], s21 offen offset:0 sc1
v_mfma_f32_16x16x32_bf16 v[132:135], a[144:147], a[36:39], v[132:135]
ds_read_b64_tr_b16 a[6:7], v21 offset:512
v_mfma_f32_16x16x32_bf16 v[136:139], a[144:147], a[40:43], v[136:139]
buffer_load_dwordx4 a[140:143], v7, s[8:11], s21 offen offset:0 sc1
v_mfma_f32_16x16x32_bf16 v[168:171], a[148:151], a[40:43], v[168:171]
s_add_u32 m0, s24, 0
v_mfma_f32_16x16x32_bf16 v[200:203], a[152:155], a[40:43], v[200:203]
buffer_load_dwordx4 v8, s[8:11], s28 offen offset:0 sc1 lds
v_mfma_f32_16x16x32_bf16 v[232:235], a[156:159], a[40:43], v[232:235]
ds_read_b64_tr_b16 a[8:9], v22 offset:0
v_mfma_f32_16x16x32_bf16 v[236:239], a[156:159], a[44:47], v[236:239]
buffer_load_dwordx4 v8, s[8:11], s28 offen offset:1024 sc1 lds
v_mfma_f32_16x16x32_bf16 v[204:207], a[152:155], a[44:47], v[204:207]
ds_read_b64_tr_b16 a[10:11], v22 offset:512
v_mfma_f32_16x16x32_bf16 v[172:175], a[148:151], a[44:47], v[172:175]
buffer_load_dwordx4 v9, s[8:11], s28 offen offset:2048 sc1 lds
v_mfma_f32_16x16x32_bf16 v[140:143], a[144:147], a[44:47], v[140:143]
ds_read_b64_tr_b16 a[12:13], v23 offset:0
v_mfma_f32_16x16x32_bf16 v[144:147], a[144:147], a[48:51], v[144:147]
buffer_load_dwordx4 v9, s[8:11], s28 offen offset:3072 sc1 lds
s_mul_i32 s29, s28, 224
v_mfma_f32_16x16x32_bf16 v[176:179], a[148:151], a[48:51], v[176:179]
s_add_u32 m0, s24, 147456
v_mfma_f32_16x16x32_bf16 v[208:211], a[152:155], a[48:51], v[208:211]
buffer_load_dwordx4 v33, s[48:51], 0 offen offset:0 lds
v_mfma_f32_16x16x32_bf16 v[240:243], a[156:159], a[48:51], v[240:243]
ds_read_b64_tr_b16 a[14:15], v23 offset:512
v_mfma_f32_16x16x32_bf16 v[244:247], a[156:159], a[52:55], v[244:247]
buffer_load_dwordx4 v34, s[48:51], 0 offen offset:1024 lds
v_mfma_f32_16x16x32_bf16 v[212:215], a[152:155], a[52:55], v[212:215]
ds_read_b64_tr_b16 a[16:17], v20 offset:8192
v_mfma_f32_16x16x32_bf16 v[180:183], a[148:151], a[52:55], v[180:183]
buffer_load_dwordx4 v35, s[48:51], 0 offen offset:2048 lds
v_mfma_f32_16x16x32_bf16 v[148:151], a[144:147], a[52:55], v[148:151]
ds_read_b64_tr_b16 a[18:19], v20 offset:8704
s_waitcnt lgkmcnt(3)
v_mfma_f32_16x16x32_bf16 v[152:155], a[144:147], a[56:59], v[152:155]
buffer_load_dwordx4 v36, s[48:51], 0 offen offset:3072 lds
v_mfma_f32_16x16x32_bf16 v[184:187], a[148:151], a[56:59], v[184:187]
ds_read_b64_tr_b16 a[20:21], v21 offset:8192
v_mfma_f32_16x16x32_bf16 v[216:219], a[152:155], a[56:59], v[216:219]
ds_read_b64_tr_b16 a[22:23], v21 offset:8704
v_mfma_f32_16x16x32_bf16 v[248:251], a[156:159], a[56:59], v[248:251]
ds_read_b64_tr_b16 a[24:25], v22 offset:8192
v_mfma_f32_16x16x32_bf16 v[252:255], a[156:159], a[60:63], v[252:255]
ds_read_b64_tr_b16 a[26:27], v22 offset:8704
v_mfma_f32_16x16x32_bf16 v[220:223], a[152:155], a[60:63], v[220:223]
ds_read_b64_tr_b16 a[28:29], v23 offset:8192
v_mfma_f32_16x16x32_bf16 v[188:191], a[148:151], a[60:63], v[188:191]
ds_read_b64_tr_b16 a[30:31], v23 offset:8704
v_mfma_f32_16x16x32_bf16 v[156:159], a[144:147], a[60:63], v[156:159]
s_waitcnt vmcnt(20)
v_mfma_f32_16x16x32_bf16 v[128:131], a[96:99], a[0:3], v[128:131]
ds_read_b64_tr_b16 a[32:33], v20 offset:4096
v_mfma_f32_16x16x32_bf16 v[160:163], a[100:103], a[0:3], v[160:163]
ds_read_b64_tr_b16 a[34:35], v20 offset:4608
s_add_u32 s31, s31, 1
v_mfma_f32_16x16x32_bf16 v[192:195], a[104:107], a[0:3], v[192:195]
buffer_load_dwordx4 a[144:147], v4, s[8:11], s21 offen offset:1024 sc1
v_readlane_b32 s28, v14, s31
v_mfma_f32_16x16x32_bf16 v[224:227], a[108:111], a[0:3], v[224:227]
ds_read_b64_tr_b16 a[36:37], v21 offset:4096
v_mfma_f32_16x16x32_bf16 v[228:231], a[108:111], a[4:7], v[228:231]
ds_read_b64_tr_b16 a[38:39], v21 offset:4608
v_mfma_f32_16x16x32_bf16 v[196:199], a[104:107], a[4:7], v[196:199]
buffer_load_dwordx4 a[148:151], v5, s[8:11], s21 offen offset:1024 sc1
v_mfma_f32_16x16x32_bf16 v[164:167], a[100:103], a[4:7], v[164:167]
ds_read_b64_tr_b16 a[40:41], v22 offset:4096
v_mfma_f32_16x16x32_bf16 v[132:135], a[96:99], a[4:7], v[132:135]
ds_read_b64_tr_b16 a[42:43], v22 offset:4608
v_mfma_f32_16x16x32_bf16 v[136:139], a[96:99], a[8:11], v[136:139]
buffer_load_dwordx4 a[152:155], v6, s[8:11], s21 offen offset:1024 sc1
v_mfma_f32_16x16x32_bf16 v[168:171], a[100:103], a[8:11], v[168:171]
v_mfma_f32_16x16x32_bf16 v[200:203], a[104:107], a[8:11], v[200:203]
ds_read_b64_tr_b16 a[44:45], v23 offset:4096
v_mfma_f32_16x16x32_bf16 v[232:235], a[108:111], a[8:11], v[232:235]
buffer_load_dwordx4 a[156:159], v7, s[8:11], s21 offen offset:1024 sc1
s_waitcnt lgkmcnt(2)
v_mfma_f32_16x16x32_bf16 v[236:239], a[108:111], a[12:15], v[236:239]
ds_read_b64_tr_b16 a[46:47], v23 offset:4608
v_mfma_f32_16x16x32_bf16 v[204:207], a[104:107], a[12:15], v[204:207]
s_add_u32 m0, s25, 0
v_mfma_f32_16x16x32_bf16 v[172:175], a[100:103], a[12:15], v[172:175]
buffer_load_dwordx4 v10, s[44:47], s29 offen offset:0 lds
v_mfma_f32_16x16x32_bf16 v[140:143], a[96:99], a[12:15], v[140:143]
ds_read_b64_tr_b16 a[48:49], v20 offset:12288
v_mfma_f32_16x16x32_bf16 v[144:147], a[96:99], a[16:19], v[144:147]
ds_read_b64_tr_b16 a[50:51], v20 offset:12800
v_mfma_f32_16x16x32_bf16 v[176:179], a[100:103], a[16:19], v[176:179]
buffer_load_dwordx4 v11, s[44:47], s29 offen offset:1024 lds
v_mfma_f32_16x16x32_bf16 v[208:211], a[104:107], a[16:19], v[208:211]
ds_read_b64_tr_b16 a[52:53], v21 offset:12288
v_mfma_f32_16x16x32_bf16 v[240:243], a[108:111], a[16:19], v[240:243]
v_mfma_f32_16x16x32_bf16 v[244:247], a[108:111], a[20:23], v[244:247]
buffer_load_dwordx4 v12, s[44:47], s29 offen offset:2048 lds
v_mfma_f32_16x16x32_bf16 v[212:215], a[104:107], a[20:23], v[212:215]
ds_read_b64_tr_b16 a[54:55], v21 offset:12800
v_mfma_f32_16x16x32_bf16 v[180:183], a[100:103], a[20:23], v[180:183]
ds_read_b64_tr_b16 a[56:57], v22 offset:12288
v_mfma_f32_16x16x32_bf16 v[148:151], a[96:99], a[20:23], v[148:151]
buffer_load_dwordx4 v13, s[44:47], s29 offen offset:3072 lds
v_mfma_f32_16x16x32_bf16 v[152:155], a[96:99], a[24:27], v[152:155]
s_mov_b32 s48, s66
v_mfma_f32_16x16x32_bf16 v[184:187], a[100:103], a[24:27], v[184:187]
ds_read_b64_tr_b16 a[58:59], v22 offset:12800
v_mfma_f32_16x16x32_bf16 v[216:219], a[104:107], a[24:27], v[216:219]
s_mov_b32 s49, s67
v_mfma_f32_16x16x32_bf16 v[248:251], a[108:111], a[24:27], v[248:251]
ds_read_b64_tr_b16 a[60:61], v23 offset:12288
v_mfma_f32_16x16x32_bf16 v[252:255], a[108:111], a[28:31], v[252:255]
s_mov_b32 s50, 8388608
v_mfma_f32_16x16x32_bf16 v[220:223], a[104:107], a[28:31], v[220:223]
ds_read_b64_tr_b16 a[62:63], v23 offset:12800
v_mfma_f32_16x16x32_bf16 v[188:191], a[100:103], a[28:31], v[188:191]
v_mfma_f32_16x16x32_bf16 v[156:159], a[96:99], a[28:31], v[156:159]
s_waitcnt vmcnt(20)
v_mfma_f32_16x16x32_bf16 v[128:131], a[112:115], a[32:35], v[128:131]
s_barrier
v_mfma_f32_16x16x32_bf16 v[160:163], a[116:119], a[32:35], v[160:163]
s_add_u32 m0, s24, 32768
v_mfma_f32_16x16x32_bf16 v[192:195], a[120:123], a[32:35], v[192:195]
buffer_load_dwordx4 v8, s[8:11], s28 offen offset:0 sc1 lds
v_mfma_f32_16x16x32_bf16 v[224:227], a[124:127], a[32:35], v[224:227]
ds_read_b64_tr_b16 a[0:1], v20 offset:32768
v_mfma_f32_16x16x32_bf16 v[228:231], a[124:127], a[36:39], v[228:231]
ds_read_b64_tr_b16 a[2:3], v20 offset:33280
v_mfma_f32_16x16x32_bf16 v[196:199], a[120:123], a[36:39], v[196:199]
v_mfma_f32_16x16x32_bf16 v[164:167], a[116:119], a[36:39], v[164:167]
ds_read_b64_tr_b16 a[4:5], v21 offset:32768
v_mfma_f32_16x16x32_bf16 v[132:135], a[112:115], a[36:39], v[132:135]
ds_read_b64_tr_b16 a[6:7], v21 offset:33280
s_waitcnt lgkmcnt(4)
v_mfma_f32_16x16x32_bf16 v[136:139], a[112:115], a[40:43], v[136:139]
v_mfma_f32_16x16x32_bf16 v[168:171], a[116:119], a[40:43], v[168:171]
buffer_load_dwordx4 v8, s[8:11], s28 offen offset:1024 sc1 lds
v_mfma_f32_16x16x32_bf16 v[200:203], a[120:123], a[40:43], v[200:203]
ds_read_b64_tr_b16 a[8:9], v22 offset:32768
v_mfma_f32_16x16x32_bf16 v[232:235], a[124:127], a[40:43], v[232:235]
ds_read_b64_tr_b16 a[10:11], v22 offset:33280
v_mfma_f32_16x16x32_bf16 v[236:239], a[124:127], a[44:47], v[236:239]
v_mfma_f32_16x16x32_bf16 v[204:207], a[120:123], a[44:47], v[204:207]
ds_read_b64_tr_b16 a[12:13], v23 offset:32768
v_mfma_f32_16x16x32_bf16 v[172:175], a[116:119], a[44:47], v[172:175]
ds_read_b64_tr_b16 a[14:15], v23 offset:33280
v_mfma_f32_16x16x32_bf16 v[140:143], a[112:115], a[44:47], v[140:143]
v_mfma_f32_16x16x32_bf16 v[144:147], a[112:115], a[48:51], v[144:147]
buffer_load_dwordx4 v9, s[8:11], s28 offen offset:2048 sc1 lds
s_mul_i32 s29, s28, 224
v_mfma_f32_16x16x32_bf16 v[176:179], a[116:119], a[48:51], v[176:179]
ds_read_b64_tr_b16 a[16:17], v20 offset:40960
v_mfma_f32_16x16x32_bf16 v[208:211], a[120:123], a[48:51], v[208:211]
v_mfma_f32_16x16x32_bf16 v[240:243], a[124:127], a[48:51], v[240:243]
ds_read_b64_tr_b16 a[18:19], v20 offset:41472
v_mfma_f32_16x16x32_bf16 v[244:247], a[124:127], a[52:55], v[244:247]
ds_read_b64_tr_b16 a[20:21], v21 offset:40960
v_mfma_f32_16x16x32_bf16 v[212:215], a[120:123], a[52:55], v[212:215]
v_mfma_f32_16x16x32_bf16 v[180:183], a[116:119], a[52:55], v[180:183]
ds_read_b64_tr_b16 a[22:23], v21 offset:41472
v_mfma_f32_16x16x32_bf16 v[148:151], a[112:115], a[52:55], v[148:151]
buffer_load_dwordx4 v9, s[8:11], s28 offen offset:3072 sc1 lds
v_mfma_f32_16x16x32_bf16 v[152:155], a[112:115], a[56:59], v[152:155]
ds_read_b64_tr_b16 a[24:25], v22 offset:40960
v_mfma_f32_16x16x32_bf16 v[184:187], a[116:119], a[56:59], v[184:187]
v_mfma_f32_16x16x32_bf16 v[216:219], a[120:123], a[56:59], v[216:219]
ds_read_b64_tr_b16 a[26:27], v22 offset:41472
v_mfma_f32_16x16x32_bf16 v[248:251], a[124:127], a[56:59], v[248:251]
ds_read_b64_tr_b16 a[28:29], v23 offset:40960
v_mfma_f32_16x16x32_bf16 v[252:255], a[124:127], a[60:63], v[252:255]
v_mfma_f32_16x16x32_bf16 v[220:223], a[120:123], a[60:63], v[220:223]
ds_read_b64_tr_b16 a[30:31], v23 offset:41472
v_mfma_f32_16x16x32_bf16 v[188:191], a[116:119], a[60:63], v[188:191]
v_mfma_f32_16x16x32_bf16 v[156:159], a[112:115], a[60:63], v[156:159]
s_waitcnt vmcnt(20) lgkmcnt(2)
v_mfma_f32_16x16x32_bf16 v[128:131], a[128:131], a[0:3], v[128:131]
ds_read_b64_tr_b16 a[32:33], v20 offset:36864
v_mfma_f32_16x16x32_bf16 v[160:163], a[132:135], a[0:3], v[160:163]
s_add_u32 m0, s25, 32768
s_add_u32 s31, s31, 1
v_mfma_f32_16x16x32_bf16 v[192:195], a[136:139], a[0:3], v[192:195]
buffer_load_dwordx4 v10, s[44:47], s29 offen offset:0 lds
v_readlane_b32 s28, v14, s31
v_mfma_f32_16x16x32_bf16 v[224:227], a[140:143], a[0:3], v[224:227]
ds_read_b64_tr_b16 a[34:35], v20 offset:37376
v_mfma_f32_16x16x32_bf16 v[228:231], a[140:143], a[4:7], v[228:231]
v_mfma_f32_16x16x32_bf16 v[196:199], a[136:139], a[4:7], v[196:199]
ds_read_b64_tr_b16 a[36:37], v21 offset:36864
v_mfma_f32_16x16x32_bf16 v[164:167], a[132:135], a[4:7], v[164:167]
ds_read_b64_tr_b16 a[38:39], v21 offset:37376
v_mfma_f32_16x16x32_bf16 v[132:135], a[128:131], a[4:7], v[132:135]
v_mfma_f32_16x16x32_bf16 v[136:139], a[128:131], a[8:11], v[136:139]
ds_read_b64_tr_b16 a[40:41], v22 offset:36864
v_mfma_f32_16x16x32_bf16 v[168:171], a[132:135], a[8:11], v[168:171]
buffer_load_dwordx4 v11, s[44:47], s29 offen offset:1024 lds
v_mfma_f32_16x16x32_bf16 v[200:203], a[136:139], a[8:11], v[200:203]
v_mfma_f32_16x16x32_bf16 v[232:235], a[140:143], a[8:11], v[232:235]
ds_read_b64_tr_b16 a[42:43], v22 offset:37376
v_mfma_f32_16x16x32_bf16 v[236:239], a[140:143], a[12:15], v[236:239]
ds_read_b64_tr_b16 a[44:45], v23 offset:36864
v_mfma_f32_16x16x32_bf16 v[204:207], a[136:139], a[12:15], v[204:207]
v_mfma_f32_16x16x32_bf16 v[172:175], a[132:135], a[12:15], v[172:175]
ds_read_b64_tr_b16 a[46:47], v23 offset:37376
v_mfma_f32_16x16x32_bf16 v[140:143], a[128:131], a[12:15], v[140:143]
v_mfma_f32_16x16x32_bf16 v[144:147], a[128:131], a[16:19], v[144:147]
buffer_load_dwordx4 v12, s[44:47], s29 offen offset:2048 lds
v_mfma_f32_16x16x32_bf16 v[176:179], a[132:135], a[16:19], v[176:179]
ds_read_b64_tr_b16 a[48:49], v20 offset:45056
v_mfma_f32_16x16x32_bf16 v[208:211], a[136:139], a[16:19], v[208:211]
ds_read_b64_tr_b16 a[50:51], v20 offset:45568
v_mfma_f32_16x16x32_bf16 v[240:243], a[140:143], a[16:19], v[240:243]
v_mfma_f32_16x16x32_bf16 v[244:247], a[140:143], a[20:23], v[244:247]
ds_read_b64_tr_b16 a[52:53], v21 offset:45056
v_mfma_f32_16x16x32_bf16 v[212:215], a[136:139], a[20:23], v[212:215]
ds_read_b64_tr_b16 a[54:55], v21 offset:45568
v_mfma_f32_16x16x32_bf16 v[180:183], a[132:135], a[20:23], v[180:183]
v_mfma_f32_16x16x32_bf16 v[148:151], a[128:131], a[20:23], v[148:151]
buffer_load_dwordx4 v13, s[44:47], s29 offen offset:3072 lds
v_mfma_f32_16x16x32_bf16 v[152:155], a[128:131], a[24:27], v[152:155]
ds_read_b64_tr_b16 a[56:57], v22 offset:45056
v_mfma_f32_16x16x32_bf16 v[184:187], a[132:135], a[24:27], v[184:187]
v_mfma_f32_16x16x32_bf16 v[216:219], a[136:139], a[24:27], v[216:219]
ds_read_b64_tr_b16 a[58:59], v22 offset:45568
v_mfma_f32_16x16x32_bf16 v[248:251], a[140:143], a[24:27], v[248:251]
ds_read_b64_tr_b16 a[60:61], v23 offset:45056
s_waitcnt lgkmcnt(3)
v_mfma_f32_16x16x32_bf16 v[252:255], a[140:143], a[28:31], v[252:255]
v_mfma_f32_16x16x32_bf16 v[220:223], a[136:139], a[28:31], v[220:223]
ds_read_b64_tr_b16 a[62:63], v23 offset:45568
v_mfma_f32_16x16x32_bf16 v[188:191], a[132:135], a[28:31], v[188:191]
v_mfma_f32_16x16x32_bf16 v[156:159], a[128:131], a[28:31], v[156:159]
s_waitcnt vmcnt(12)
v_mfma_f32_16x16x32_bf16 v[128:131], a[144:147], a[32:35], v[128:131]
s_barrier
v_mfma_f32_16x16x32_bf16 v[160:163], a[148:151], a[32:35], v[160:163]
s_add_u32 m0, s24, 65536
v_mfma_f32_16x16x32_bf16 v[192:195], a[152:155], a[32:35], v[192:195]
buffer_load_dwordx4 v8, s[8:11], s28 offen offset:0 sc1 lds
v_mfma_f32_16x16x32_bf16 v[224:227], a[156:159], a[32:35], v[224:227]
v_mfma_f32_16x16x32_bf16 v[228:231], a[156:159], a[36:39], v[228:231]
v_mfma_f32_16x16x32_bf16 v[196:199], a[152:155], a[36:39], v[196:199]
v_mfma_f32_16x16x32_bf16 v[164:167], a[148:151], a[36:39], v[164:167]
v_mfma_f32_16x16x32_bf16 v[132:135], a[144:147], a[36:39], v[132:135]
v_mfma_f32_16x16x32_bf16 v[136:139], a[144:147], a[40:43], v[136:139]
buffer_load_dwordx4 v8, s[8:11], s28 offen offset:1024 sc1 lds
v_mfma_f32_16x16x32_bf16 v[168:171], a[148:151], a[40:43], v[168:171]
v_mfma_f32_16x16x32_bf16 v[200:203], a[152:155], a[40:43], v[200:203]
v_mfma_f32_16x16x32_bf16 v[232:235], a[156:159], a[40:43], v[232:235]
v_mfma_f32_16x16x32_bf16 v[236:239], a[156:159], a[44:47], v[236:239]
v_mfma_f32_16x16x32_bf16 v[204:207], a[152:155], a[44:47], v[204:207]
v_mfma_f32_16x16x32_bf16 v[172:175], a[148:151], a[44:47], v[172:175]
buffer_load_dwordx4 v9, s[8:11], s28 offen offset:2048 sc1 lds
v_mfma_f32_16x16x32_bf16 v[140:143], a[144:147], a[44:47], v[140:143]
v_mfma_f32_16x16x32_bf16 v[144:147], a[144:147], a[48:51], v[144:147]
s_mul_i32 s29, s28, 224
v_mfma_f32_16x16x32_bf16 v[176:179], a[148:151], a[48:51], v[176:179]
v_mfma_f32_16x16x32_bf16 v[208:211], a[152:155], a[48:51], v[208:211]
v_mfma_f32_16x16x32_bf16 v[240:243], a[156:159], a[48:51], v[240:243]
v_mfma_f32_16x16x32_bf16 v[244:247], a[156:159], a[52:55], v[244:247]
buffer_load_dwordx4 v9, s[8:11], s28 offen offset:3072 sc1 lds
v_mfma_f32_16x16x32_bf16 v[212:215], a[152:155], a[52:55], v[212:215]
v_mfma_f32_16x16x32_bf16 v[180:183], a[148:151], a[52:55], v[180:183]
v_mfma_f32_16x16x32_bf16 v[148:151], a[144:147], a[52:55], v[148:151]
s_waitcnt lgkmcnt(0)
v_mfma_f32_16x16x32_bf16 v[152:155], a[144:147], a[56:59], v[152:155]
v_mfma_f32_16x16x32_bf16 v[184:187], a[148:151], a[56:59], v[184:187]
v_mfma_f32_16x16x32_bf16 v[216:219], a[152:155], a[56:59], v[216:219]
buffer_load_dword a96, v31, s[36:39], 0 offen
v_mfma_f32_16x16x32_bf16 v[248:251], a[156:159], a[56:59], v[248:251]
v_mfma_f32_16x16x32_bf16 v[252:255], a[156:159], a[60:63], v[252:255]
v_mfma_f32_16x16x32_bf16 v[220:223], a[152:155], a[60:63], v[220:223]
v_mfma_f32_16x16x32_bf16 v[188:191], a[148:151], a[60:63], v[188:191]
v_mfma_f32_16x16x32_bf16 v[156:159], a[144:147], a[60:63], v[156:159]
s_barrier
s_mov_b32 s36, 0xbdd2d3e8
s_mov_b32 s37, 0xbdd2d3e8
v_mov_b32 v72, 0xc0135761
v_mov_b32 v73, 0xc0135761
s_lshl2_add_u32 s38, s5, s3
s_sub_u32 s38, s38, 72
s_mul_i32 s38, s38, 1792
v_mul_u32_u24 v2, 28, v0
buffer_load_dword a97, v2, s[32:35], s38 offen
s_cmp_lt_u32 s5, 28
s_cbranch_scc1 Lz_nq
v_and_b32 v2, 31, v0
v_lshrrev_b32 v3, 5, v0
v_mul_u32_u24 v3, 7168, v3
v_min_u32 v2, 27, v2
v_lshl_add_u32 v15, v2, 7, v3
s_sub_u32 s38, s2, 224
s_lshl2_add_u32 s38, s38, s3
s_mul_i32 s38, s38, 14336
s_add_u32 s38, s38, 917504
buffer_load_dword a97, v15, s[44:47], s38 offen
s_add_u32 s38, s38, 1835008
buffer_load_dword a97, v15, s[44:47], s38 offen
s_add_u32 s38, s38, 1835008
buffer_load_dword a97, v15, s[44:47], s38 offen
s_add_u32 s38, s38, 1835008
Lz_nq:
v_pk_mul_f32 v[64:65], v[128:129], v[128:129]
v_pk_mul_f32 v[66:67], v[130:131], v[130:131]
v_pk_mul_f32 v[68:69], v[160:161], v[160:161]
v_pk_mul_f32 v[70:71], v[162:163], v[162:163]
v_pk_fma_f32 v[64:65], v[64:65], s[36:37], v[72:73]
v_pk_fma_f32 v[66:67], v[66:67], s[36:37], v[72:73]
v_pk_fma_f32 v[68:69], v[68:69], s[36:37], v[72:73]
v_pk_fma_f32 v[70:71], v[70:71], s[36:37], v[72:73]
v_pk_mul_f32 v[64:65], v[64:65], v[128:129]
v_pk_mul_f32 v[66:67], v[66:67], v[130:131]
v_pk_mul_f32 v[68:69], v[68:69], v[160:161]
v_pk_mul_f32 v[70:71], v[70:71], v[162:163]
v_exp_f32 v64, v64
v_exp_f32 v65, v65
v_exp_f32 v66, v66
v_exp_f32 v67, v67
v_exp_f32 v68, v68
v_exp_f32 v69, v69
v_exp_f32 v70, v70
v_exp_f32 v71, v71
v_pk_add_f32 v[64:65], v[64:65], 1.0 op_sel_hi:[1,0]
v_pk_add_f32 v[66:67], v[66:67], 1.0 op_sel_hi:[1,0]
v_pk_add_f32 v[68:69], v[68:69], 1.0 op_sel_hi:[1,0]
v_pk_add_f32 v[70:71], v[70:71], 1.0 op_sel_hi:[1,0]
v_rcp_f32 v64, v64
v_rcp_f32 v65, v65
v_rcp_f32 v66, v66
v_rcp_f32 v67, v67
v_rcp_f32 v68, v68
v_rcp_f32 v69, v69
v_rcp_f32 v70, v70
v_rcp_f32 v71, v71
v_pk_mul_f32 v[128:129], v[128:129], v[64:65]
v_pk_mul_f32 v[130:131], v[130:131], v[66:67]
v_pk_mul_f32 v[160:161], v[160:161], v[68:69]
v_pk_mul_f32 v[162:163], v[162:163], v[70:71]
v_pk_mov_b32 v[32:33], v[128:129], v[128:129] op_sel:[0,1]
v_pk_mul_f32 v[48:49], v[128:129], v[128:129]
v_pk_mov_b32 v[34:35], v[130:131], v[130:131] op_sel:[0,1]
v_pk_mul_f32 v[50:51], v[130:131], v[130:131]
v_pk_mov_b32 v[36:37], v[160:161], v[160:161] op_sel:[0,1]
v_pk_mul_f32 v[52:53], v[160:161], v[160:161]
v_pk_mov_b32 v[38:39], v[162:163], v[162:163] op_sel:[0,1]
v_pk_mul_f32 v[54:55], v[162:163], v[162:163]
v_pk_mul_f32 v[64:65], v[192:193], v[192:193]
v_pk_mul_f32 v[66:67], v[194:195], v[194:195]
v_pk_mul_f32 v[68:69], v[224:225], v[224:225]
v_pk_mul_f32 v[70:71], v[226:227], v[226:227]
v_pk_fma_f32 v[64:65], v[64:65], s[36:37], v[72:73]
v_pk_fma_f32 v[66:67], v[66:67], s[36:37], v[72:73]
v_pk_fma_f32 v[68:69], v[68:69], s[36:37], v[72:73]
v_pk_fma_f32 v[70:71], v[70:71], s[36:37], v[72:73]
v_pk_mul_f32 v[64:65], v[64:65], v[192:193]
v_pk_mul_f32 v[66:67], v[66:67], v[194:195]
v_pk_mul_f32 v[68:69], v[68:69], v[224:225]
v_pk_mul_f32 v[70:71], v[70:71], v[226:227]
v_exp_f32 v64, v64
v_exp_f32 v65, v65
v_exp_f32 v66, v66
v_exp_f32 v67, v67
v_exp_f32 v68, v68
v_exp_f32 v69, v69
v_exp_f32 v70, v70
v_exp_f32 v71, v71
v_pk_add_f32 v[64:65], v[64:65], 1.0 op_sel_hi:[1,0]
v_pk_add_f32 v[66:67], v[66:67], 1.0 op_sel_hi:[1,0]
v_pk_add_f32 v[68:69], v[68:69], 1.0 op_sel_hi:[1,0]
v_pk_add_f32 v[70:71], v[70:71], 1.0 op_sel_hi:[1,0]
v_rcp_f32 v64, v64
v_rcp_f32 v65, v65
v_rcp_f32 v66, v66
v_rcp_f32 v67, v67
v_rcp_f32 v68, v68
v_rcp_f32 v69, v69
v_rcp_f32 v70, v70
v_rcp_f32 v71, v71
v_pk_mul_f32 v[192:193], v[192:193], v[64:65]
v_pk_mul_f32 v[194:195], v[194:195], v[66:67]
v_pk_mul_f32 v[224:225], v[224:225], v[68:69]
v_pk_mul_f32 v[226:227], v[226:227], v[70:71]
v_pk_mov_b32 v[40:41], v[192:193], v[192:193] op_sel:[0,1]
v_pk_mul_f32 v[56:57], v[192:193], v[192:193]
v_pk_mov_b32 v[42:43], v[194:195], v[194:195] op_sel:[0,1]
v_pk_mul_f32 v[58:59], v[194:195], v[194:195]
v_pk_mov_b32 v[44:45], v[224:225], v[224:225] op_sel:[0,1]
v_pk_mul_f32 v[60:61], v[224:225], v[224:225]
v_pk_mov_b32 v[46:47], v[226:227], v[226:227] op_sel:[0,1]
v_pk_mul_f32 v[62:63], v[226:227], v[226:227]
v_pk_mul_f32 v[64:65], v[132:133], v[132:133]
v_pk_mul_f32 v[66:67], v[134:135], v[134:135]
v_pk_mul_f32 v[68:69], v[164:165], v[164:165]
v_pk_mul_f32 v[70:71], v[166:167], v[166:167]
v_pk_fma_f32 v[64:65], v[64:65], s[36:37], v[72:73]
v_pk_fma_f32 v[66:67], v[66:67], s[36:37], v[72:73]
v_pk_fma_f32 v[68:69], v[68:69], s[36:37], v[72:73]
v_pk_fma_f32 v[70:71], v[70:71], s[36:37], v[72:73]
v_pk_mul_f32 v[64:65], v[64:65], v[132:133]
v_pk_mul_f32 v[66:67], v[66:67], v[134:135]
v_pk_mul_f32 v[68:69], v[68:69], v[164:165]
v_pk_mul_f32 v[70:71], v[70:71], v[166:167]
v_exp_f32 v64, v64
v_exp_f32 v65, v65
v_exp_f32 v66, v66
v_exp_f32 v67, v67
v_exp_f32 v68, v68
v_exp_f32 v69, v69
v_exp_f32 v70, v70
v_exp_f32 v71, v71
v_pk_add_f32 v[64:65], v[64:65], 1.0 op_sel_hi:[1,0]
v_pk_add_f32 v[66:67], v[66:67], 1.0 op_sel_hi:[1,0]
v_pk_add_f32 v[68:69], v[68:69], 1.0 op_sel_hi:[1,0]
v_pk_add_f32 v[70:71], v[70:71], 1.0 op_sel_hi:[1,0]
v_rcp_f32 v64, v64
v_rcp_f32 v65, v65
v_rcp_f32 v66, v66
v_rcp_f32 v67, v67
v_rcp_f32 v68, v68
v_rcp_f32 v69, v69
v_rcp_f32 v70, v70
v_rcp_f32 v71, v71
v_pk_mul_f32 v[132:133], v[132:133], v[64:65]
v_pk_mul_f32 v[134:135], v[134:135], v[66:67]
v_pk_mul_f32 v[164:165], v[164:165], v[68:69]
v_pk_mul_f32 v[166:167], v[166:167], v[70:71]
v_pk_add_f32 v[32:33], v[32:33], v[132:133]
v_pk_fma_f32 v[48:49], v[132:133], v[132:133], v[48:49]
v_pk_add_f32 v[34:35], v[34:35], v[134:135]
v_pk_fma_f32 v[50:51], v[134:135], v[134:135], v[50:51]
v_pk_add_f32 v[36:37], v[36:37], v[164:165]
v_pk_fma_f32 v[52:53], v[164:165], v[164:165], v[52:53]
v_pk_add_f32 v[38:39], v[38:39], v[166:167]
v_pk_fma_f32 v[54:55], v[166:167], v[166:167], v[54:55]
v_pk_mul_f32 v[64:65], v[196:197], v[196:197]
v_pk_mul_f32 v[66:67], v[198:199], v[198:199]
v_pk_mul_f32 v[68:69], v[228:229], v[228:229]
v_pk_mul_f32 v[70:71], v[230:231], v[230:231]
v_pk_fma_f32 v[64:65], v[64:65], s[36:37], v[72:73]
v_pk_fma_f32 v[66:67], v[66:67], s[36:37], v[72:73]
v_pk_fma_f32 v[68:69], v[68:69], s[36:37], v[72:73]
v_pk_fma_f32 v[70:71], v[70:71], s[36:37], v[72:73]
v_pk_mul_f32 v[64:65], v[64:65], v[196:197]
v_pk_mul_f32 v[66:67], v[66:67], v[198:199]
v_pk_mul_f32 v[68:69], v[68:69], v[228:229]
v_pk_mul_f32 v[70:71], v[70:71], v[230:231]
v_exp_f32 v64, v64
v_exp_f32 v65, v65
v_exp_f32 v66, v66
v_exp_f32 v67, v67
v_exp_f32 v68, v68
v_exp_f32 v69, v69
v_exp_f32 v70, v70
v_exp_f32 v71, v71
v_pk_add_f32 v[64:65], v[64:65], 1.0 op_sel_hi:[1,0]
v_pk_add_f32 v[66:67], v[66:67], 1.0 op_sel_hi:[1,0]
v_pk_add_f32 v[68:69], v[68:69], 1.0 op_sel_hi:[1,0]
v_pk_add_f32 v[70:71], v[70:71], 1.0 op_sel_hi:[1,0]
v_rcp_f32 v64, v64
v_rcp_f32 v65, v65
v_rcp_f32 v66, v66
v_rcp_f32 v67, v67
v_rcp_f32 v68, v68
v_rcp_f32 v69, v69
v_rcp_f32 v70, v70
v_rcp_f32 v71, v71
v_pk_mul_f32 v[196:197], v[196:197], v[64:65]
v_pk_mul_f32 v[198:199], v[198:199], v[66:67]
v_pk_mul_f32 v[228:229], v[228:229], v[68:69]
v_pk_mul_f32 v[230:231], v[230:231], v[70:71]
v_pk_add_f32 v[40:41], v[40:41], v[196:197]
v_pk_fma_f32 v[56:57], v[196:197], v[196:197], v[56:57]
v_pk_add_f32 v[42:43], v[42:43], v[198:199]
v_pk_fma_f32 v[58:59], v[198:199], v[198:199], v[58:59]
v_pk_add_f32 v[44:45], v[44:45], v[228:229]
v_pk_fma_f32 v[60:61], v[228:229], v[228:229], v[60:61]
v_pk_add_f32 v[46:47], v[46:47], v[230:231]
v_pk_fma_f32 v[62:63], v[230:231], v[230:231], v[62:63]
v_pk_mul_f32 v[64:65], v[136:137], v[136:137]
v_pk_mul_f32 v[66:67], v[138:139], v[138:139]
v_pk_mul_f32 v[68:69], v[168:169], v[168:169]
v_pk_mul_f32 v[70:71], v[170:171], v[170:171]
v_pk_fma_f32 v[64:65], v[64:65], s[36:37], v[72:73]
v_pk_fma_f32 v[66:67], v[66:67], s[36:37], v[72:73]
v_pk_fma_f32 v[68:69], v[68:69], s[36:37], v[72:73]
v_pk_fma_f32 v[70:71], v[70:71], s[36:37], v[72:73]
v_pk_mul_f32 v[64:65], v[64:65], v[136:137]
v_pk_mul_f32 v[66:67], v[66:67], v[138:139]
v_pk_mul_f32 v[68:69], v[68:69], v[168:169]
v_pk_mul_f32 v[70:71], v[70:71], v[170:171]
v_exp_f32 v64, v64
v_exp_f32 v65, v65
v_exp_f32 v66, v66
v_exp_f32 v67, v67
v_exp_f32 v68, v68
v_exp_f32 v69, v69
v_exp_f32 v70, v70
v_exp_f32 v71, v71
v_pk_add_f32 v[64:65], v[64:65], 1.0 op_sel_hi:[1,0]
v_pk_add_f32 v[66:67], v[66:67], 1.0 op_sel_hi:[1,0]
v_pk_add_f32 v[68:69], v[68:69], 1.0 op_sel_hi:[1,0]
v_pk_add_f32 v[70:71], v[70:71], 1.0 op_sel_hi:[1,0]
v_rcp_f32 v64, v64
v_rcp_f32 v65, v65
v_rcp_f32 v66, v66
v_rcp_f32 v67, v67
v_rcp_f32 v68, v68
v_rcp_f32 v69, v69
v_rcp_f32 v70, v70
v_rcp_f32 v71, v71
v_pk_mul_f32 v[136:137], v[136:137], v[64:65]
v_pk_mul_f32 v[138:139], v[138:139], v[66:67]
v_pk_mul_f32 v[168:169], v[168:169], v[68:69]
v_pk_mul_f32 v[170:171], v[170:171], v[70:71]
v_pk_add_f32 v[32:33], v[32:33], v[136:137]
v_pk_fma_f32 v[48:49], v[136:137], v[136:137], v[48:49]
v_pk_add_f32 v[34:35], v[34:35], v[138:139]
v_pk_fma_f32 v[50:51], v[138:139], v[138:139], v[50:51]
v_pk_add_f32 v[36:37], v[36:37], v[168:169]
v_pk_fma_f32 v[52:53], v[168:169], v[168:169], v[52:53]
v_pk_add_f32 v[38:39], v[38:39], v[170:171]
v_pk_fma_f32 v[54:55], v[170:171], v[170:171], v[54:55]
v_pk_mul_f32 v[64:65], v[200:201], v[200:201]
v_pk_mul_f32 v[66:67], v[202:203], v[202:203]
v_pk_mul_f32 v[68:69], v[232:233], v[232:233]
v_pk_mul_f32 v[70:71], v[234:235], v[234:235]
v_pk_fma_f32 v[64:65], v[64:65], s[36:37], v[72:73]
v_pk_fma_f32 v[66:67], v[66:67], s[36:37], v[72:73]
v_pk_fma_f32 v[68:69], v[68:69], s[36:37], v[72:73]
v_pk_fma_f32 v[70:71], v[70:71], s[36:37], v[72:73]
v_pk_mul_f32 v[64:65], v[64:65], v[200:201]
v_pk_mul_f32 v[66:67], v[66:67], v[202:203]
v_pk_mul_f32 v[68:69], v[68:69], v[232:233]
v_pk_mul_f32 v[70:71], v[70:71], v[234:235]
v_exp_f32 v64, v64
v_exp_f32 v65, v65
v_exp_f32 v66, v66
v_exp_f32 v67, v67
v_exp_f32 v68, v68
v_exp_f32 v69, v69
v_exp_f32 v70, v70
v_exp_f32 v71, v71
v_pk_add_f32 v[64:65], v[64:65], 1.0 op_sel_hi:[1,0]
v_pk_add_f32 v[66:67], v[66:67], 1.0 op_sel_hi:[1,0]
v_pk_add_f32 v[68:69], v[68:69], 1.0 op_sel_hi:[1,0]
v_pk_add_f32 v[70:71], v[70:71], 1.0 op_sel_hi:[1,0]
v_rcp_f32 v64, v64
v_rcp_f32 v65, v65
v_rcp_f32 v66, v66
v_rcp_f32 v67, v67
v_rcp_f32 v68, v68
v_rcp_f32 v69, v69
v_rcp_f32 v70, v70
v_rcp_f32 v71, v71
v_pk_mul_f32 v[200:201], v[200:201], v[64:65]
v_pk_mul_f32 v[202:203], v[202:203], v[66:67]
v_pk_mul_f32 v[232:233], v[232:233], v[68:69]
v_pk_mul_f32 v[234:235], v[234:235], v[70:71]
v_pk_add_f32 v[40:41], v[40:41], v[200:201]
v_pk_fma_f32 v[56:57], v[200:201], v[200:201], v[56:57]
v_pk_add_f32 v[42:43], v[42:43], v[202:203]
v_pk_fma_f32 v[58:59], v[202:203], v[202:203], v[58:59]
v_pk_add_f32 v[44:45], v[44:45], v[232:233]
v_pk_fma_f32 v[60:61], v[232:233], v[232:233], v[60:61]
v_pk_add_f32 v[46:47], v[46:47], v[234:235]
v_pk_fma_f32 v[62:63], v[234:235], v[234:235], v[62:63]
v_pk_mul_f32 v[64:65], v[140:141], v[140:141]
v_pk_mul_f32 v[66:67], v[142:143], v[142:143]
v_pk_mul_f32 v[68:69], v[172:173], v[172:173]
v_pk_mul_f32 v[70:71], v[174:175], v[174:175]
v_pk_fma_f32 v[64:65], v[64:65], s[36:37], v[72:73]
v_pk_fma_f32 v[66:67], v[66:67], s[36:37], v[72:73]
v_pk_fma_f32 v[68:69], v[68:69], s[36:37], v[72:73]
v_pk_fma_f32 v[70:71], v[70:71], s[36:37], v[72:73]
v_pk_mul_f32 v[64:65], v[64:65], v[140:141]
v_pk_mul_f32 v[66:67], v[66:67], v[142:143]
v_pk_mul_f32 v[68:69], v[68:69], v[172:173]
v_pk_mul_f32 v[70:71], v[70:71], v[174:175]
v_exp_f32 v64, v64
v_exp_f32 v65, v65
v_exp_f32 v66, v66
v_exp_f32 v67, v67
v_exp_f32 v68, v68
v_exp_f32 v69, v69
v_exp_f32 v70, v70
v_exp_f32 v71, v71
v_pk_add_f32 v[64:65], v[64:65], 1.0 op_sel_hi:[1,0]
v_pk_add_f32 v[66:67], v[66:67], 1.0 op_sel_hi:[1,0]
v_pk_add_f32 v[68:69], v[68:69], 1.0 op_sel_hi:[1,0]
v_pk_add_f32 v[70:71], v[70:71], 1.0 op_sel_hi:[1,0]
v_rcp_f32 v64, v64
v_rcp_f32 v65, v65
v_rcp_f32 v66, v66
v_rcp_f32 v67, v67
v_rcp_f32 v68, v68
v_rcp_f32 v69, v69
v_rcp_f32 v70, v70
v_rcp_f32 v71, v71
v_pk_mul_f32 v[140:141], v[140:141], v[64:65]
v_pk_mul_f32 v[142:143], v[142:143], v[66:67]
v_pk_mul_f32 v[172:173], v[172:173], v[68:69]
v_pk_mul_f32 v[174:175], v[174:175], v[70:71]
v_pk_add_f32 v[32:33], v[32:33], v[140:141]
v_pk_fma_f32 v[48:49], v[140:141], v[140:141], v[48:49]
v_pk_add_f32 v[34:35], v[34:35], v[142:143]
v_pk_fma_f32 v[50:51], v[142:143], v[142:143], v[50:51]
v_pk_add_f32 v[36:37], v[36:37], v[172:173]
v_pk_fma_f32 v[52:53], v[172:173], v[172:173], v[52:53]
v_pk_add_f32 v[38:39], v[38:39], v[174:175]
v_pk_fma_f32 v[54:55], v[174:175], v[174:175], v[54:55]
v_pk_mul_f32 v[64:65], v[204:205], v[204:205]
v_pk_mul_f32 v[66:67], v[206:207], v[206:207]
v_pk_mul_f32 v[68:69], v[236:237], v[236:237]
v_pk_mul_f32 v[70:71], v[238:239], v[238:239]
v_pk_fma_f32 v[64:65], v[64:65], s[36:37], v[72:73]
v_pk_fma_f32 v[66:67], v[66:67], s[36:37], v[72:73]
v_pk_fma_f32 v[68:69], v[68:69], s[36:37], v[72:73]
v_pk_fma_f32 v[70:71], v[70:71], s[36:37], v[72:73]
v_pk_mul_f32 v[64:65], v[64:65], v[204:205]
v_pk_mul_f32 v[66:67], v[66:67], v[206:207]
v_pk_mul_f32 v[68:69], v[68:69], v[236:237]
v_pk_mul_f32 v[70:71], v[70:71], v[238:239]
v_exp_f32 v64, v64
v_exp_f32 v65, v65
v_exp_f32 v66, v66
v_exp_f32 v67, v67
v_exp_f32 v68, v68
v_exp_f32 v69, v69
v_exp_f32 v70, v70
v_exp_f32 v71, v71
v_pk_add_f32 v[64:65], v[64:65], 1.0 op_sel_hi:[1,0]
v_pk_add_f32 v[66:67], v[66:67], 1.0 op_sel_hi:[1,0]
v_pk_add_f32 v[68:69], v[68:69], 1.0 op_sel_hi:[1,0]
v_pk_add_f32 v[70:71], v[70:71], 1.0 op_sel_hi:[1,0]
v_rcp_f32 v64, v64
v_rcp_f32 v65, v65
v_rcp_f32 v66, v66
v_rcp_f32 v67, v67
v_rcp_f32 v68, v68
v_rcp_f32 v69, v69
v_rcp_f32 v70, v70
v_rcp_f32 v71, v71
s_add_u32 s31, s31, 1
v_readlane_b32 s28, v14, s31
s_add_u32 m0, s25, 65536
s_nop 0
buffer_load_dwordx4 v10, s[44:47], s29 offen offset:0 lds
v_pk_mul_f32 v[204:205], v[204:205], v[64:65]
v_pk_mul_f32 v[206:207], v[206:207], v[66:67]
v_pk_mul_f32 v[236:237], v[236:237], v[68:69]
v_pk_mul_f32 v[238:239], v[238:239], v[70:71]
v_pk_add_f32 v[40:41], v[40:41], v[204:205]
v_pk_fma_f32 v[56:57], v[204:205], v[204:205], v[56:57]
v_pk_add_f32 v[42:43], v[42:43], v[206:207]
v_pk_fma_f32 v[58:59], v[206:207], v[206:207], v[58:59]
v_pk_add_f32 v[44:45], v[44:45], v[236:237]
v_pk_fma_f32 v[60:61], v[236:237], v[236:237], v[60:61]
v_pk_add_f32 v[46:47], v[46:47], v[238:239]
v_pk_fma_f32 v[62:63], v[238:239], v[238:239], v[62:63]
v_pk_mul_f32 v[64:65], v[144:145], v[144:145]
v_pk_mul_f32 v[66:67], v[146:147], v[146:147]
v_pk_mul_f32 v[68:69], v[176:177], v[176:177]
v_pk_mul_f32 v[70:71], v[178:179], v[178:179]
v_pk_fma_f32 v[64:65], v[64:65], s[36:37], v[72:73]
v_pk_fma_f32 v[66:67], v[66:67], s[36:37], v[72:73]
v_pk_fma_f32 v[68:69], v[68:69], s[36:37], v[72:73]
v_pk_fma_f32 v[70:71], v[70:71], s[36:37], v[72:73]
v_pk_mul_f32 v[64:65], v[64:65], v[144:145]
v_pk_mul_f32 v[66:67], v[66:67], v[146:147]
v_pk_mul_f32 v[68:69], v[68:69], v[176:177]
v_pk_mul_f32 v[70:71], v[70:71], v[178:179]
v_exp_f32 v64, v64
v_exp_f32 v65, v65
v_exp_f32 v66, v66
v_exp_f32 v67, v67
v_exp_f32 v68, v68
v_exp_f32 v69, v69
buffer_load_dwordx4 v11, s[44:47], s29 offen offset:1024 lds
v_exp_f32 v70, v70
v_exp_f32 v71, v71
v_pk_add_f32 v[64:65], v[64:65], 1.0 op_sel_hi:[1,0]
v_pk_add_f32 v[66:67], v[66:67], 1.0 op_sel_hi:[1,0]
v_pk_add_f32 v[68:69], v[68:69], 1.0 op_sel_hi:[1,0]
v_pk_add_f32 v[70:71], v[70:71], 1.0 op_sel_hi:[1,0]
v_rcp_f32 v64, v64
v_rcp_f32 v65, v65
v_rcp_f32 v66, v66
v_rcp_f32 v67, v67
v_rcp_f32 v68, v68
v_rcp_f32 v69, v69
v_rcp_f32 v70, v70
v_rcp_f32 v71, v71
v_pk_mul_f32 v[144:145], v[144:145], v[64:65]
v_pk_mul_f32 v[146:147], v[146:147], v[66:67]
v_pk_mul_f32 v[176:177], v[176:177], v[68:69]
v_pk_mul_f32 v[178:179], v[178:179], v[70:71]
v_pk_add_f32 v[32:33], v[32:33], v[144:145]
v_pk_fma_f32 v[48:49], v[144:145], v[144:145], v[48:49]
v_pk_add_f32 v[34:35], v[34:35], v[146:147]
v_pk_fma_f32 v[50:51], v[146:147], v[146:147], v[50:51]
v_pk_add_f32 v[36:37], v[36:37], v[176:177]
v_pk_fma_f32 v[52:53], v[176:177], v[176:177], v[52:53]
v_pk_add_f32 v[38:39], v[38:39], v[178:179]
v_pk_fma_f32 v[54:55], v[178:179], v[178:179], v[54:55]
v_pk_mul_f32 v[64:65], v[208:209], v[208:209]
v_pk_mul_f32 v[66:67], v[210:211], v[210:211]
v_pk_mul_f32 v[68:69], v[240:241], v[240:241]
v_pk_mul_f32 v[70:71], v[242:243], v[242:243]
buffer_load_dwordx4 v12, s[44:47], s29 offen offset:2048 lds
v_pk_fma_f32 v[64:65], v[64:65], s[36:37], v[72:73]
v_pk_fma_f32 v[66:67], v[66:67], s[36:37], v[72:73]
v_pk_fma_f32 v[68:69], v[68:69], s[36:37], v[72:73]
v_pk_fma_f32 v[70:71], v[70:71], s[36:37], v[72:73]
v_pk_mul_f32 v[64:65], v[64:65], v[208:209]
v_pk_mul_f32 v[66:67], v[66:67], v[210:211]
v_pk_mul_f32 v[68:69], v[68:69], v[240:241]
v_pk_mul_f32 v[70:71], v[70:71], v[242:243]
v_exp_f32 v64, v64
v_exp_f32 v65, v65
v_exp_f32 v66, v66
v_exp_f32 v67, v67
v_exp_f32 v68, v68
v_exp_f32 v69, v69
v_exp_f32 v70, v70
v_exp_f32 v71, v71
v_pk_add_f32 v[64:65], v[64:65], 1.0 op_sel_hi:[1,0]
v_pk_add_f32 v[66:67], v[66:67], 1.0 op_sel_hi:[1,0]
v_pk_add_f32 v[68:69], v[68:69], 1.0 op_sel_hi:[1,0]
v_pk_add_f32 v[70:71], v[70:71], 1.0 op_sel_hi:[1,0]
v_rcp_f32 v64, v64
v_rcp_f32 v65, v65
v_rcp_f32 v66, v66
v_rcp_f32 v67, v67
v_rcp_f32 v68, v68
v_rcp_f32 v69, v69
v_rcp_f32 v70, v70
v_rcp_f32 v71, v71
v_pk_mul_f32 v[208:209], v[208:209], v[64:65]
v_pk_mul_f32 v[210:211], v[210:211], v[66:67]
buffer_load_dwordx4 v13, s[44:47], s29 offen offset:3072 lds
v_pk_mul_f32 v[240:241], v[240:241], v[68:69]
v_pk_mul_f32 v[242:243], v[242:243], v[70:71]
v_pk_add_f32 v[40:41], v[40:41], v[208:209]
v_pk_fma_f32 v[56:57], v[208:209], v[208:209], v[56:57]
v_pk_add_f32 v[42:43], v[42:43], v[210:211]
v_pk_fma_f32 v[58:59], v[210:211], v[210:211], v[58:59]
v_pk_add_f32 v[44:45], v[44:45], v[240:241]
v_pk_fma_f32 v[60:61], v[240:241], v[240:241], v[60:61]
v_pk_add_f32 v[46:47], v[46:47], v[242:243]
v_pk_fma_f32 v[62:63], v[242:243], v[242:243], v[62:63]
v_pk_mul_f32 v[64:65], v[148:149], v[148:149]
v_pk_mul_f32 v[66:67], v[150:151], v[150:151]
v_pk_mul_f32 v[68:69], v[180:181], v[180:181]
v_pk_mul_f32 v[70:71], v[182:183], v[182:183]
v_pk_fma_f32 v[64:65], v[64:65], s[36:37], v[72:73]
v_pk_fma_f32 v[66:67], v[66:67], s[36:37], v[72:73]
v_pk_fma_f32 v[68:69], v[68:69], s[36:37], v[72:73]
v_pk_fma_f32 v[70:71], v[70:71], s[36:37], v[72:73]
v_pk_mul_f32 v[64:65], v[64:65], v[148:149]
v_pk_mul_f32 v[66:67], v[66:67], v[150:151]
v_pk_mul_f32 v[68:69], v[68:69], v[180:181]
v_pk_mul_f32 v[70:71], v[70:71], v[182:183]
v_exp_f32 v64, v64
v_exp_f32 v65, v65
v_exp_f32 v66, v66
v_exp_f32 v67, v67
v_exp_f32 v68, v68
v_exp_f32 v69, v69
v_exp_f32 v70, v70
v_exp_f32 v71, v71
s_mul_i32 s29, s28, 224
s_add_u32 m0, s24, 98304
s_nop 0
buffer_load_dwordx4 v8, s[8:11], s28 offen offset:0 sc1 lds
v_pk_add_f32 v[64:65], v[64:65], 1.0 op_sel_hi:[1,0]
v_pk_add_f32 v[66:67], v[66:67], 1.0 op_sel_hi:[1,0]
v_pk_add_f32 v[68:69], v[68:69], 1.0 op_sel_hi:[1,0]
v_pk_add_f32 v[70:71], v[70:71], 1.0 op_sel_hi:[1,0]
v_rcp_f32 v64, v64
v_rcp_f32 v65, v65
v_rcp_f32 v66, v66
v_rcp_f32 v67, v67
v_rcp_f32 v68, v68
v_rcp_f32 v69, v69
v_rcp_f32 v70, v70
v_rcp_f32 v71, v71
v_pk_mul_f32 v[148:149], v[148:149], v[64:65]
v_pk_mul_f32 v[150:151], v[150:151], v[66:67]
v_pk_mul_f32 v[180:181], v[180:181], v[68:69]
v_pk_mul_f32 v[182:183], v[182:183], v[70:71]
v_pk_add_f32 v[32:33], v[32:33], v[148:149]
v_pk_fma_f32 v[48:49], v[148:149], v[148:149], v[48:49]
v_pk_add_f32 v[34:35], v[34:35], v[150:151]
v_pk_fma_f32 v[50:51], v[150:151], v[150:151], v[50:51]
v_pk_add_f32 v[36:37], v[36:37], v[180:181]
v_pk_fma_f32 v[52:53], v[180:181], v[180:181], v[52:53]
v_pk_add_f32 v[38:39], v[38:39], v[182:183]
v_pk_fma_f32 v[54:55], v[182:183], v[182:183], v[54:55]
v_pk_mul_f32 v[64:65], v[212:213], v[212:213]
v_pk_mul_f32 v[66:67], v[214:215], v[214:215]
v_pk_mul_f32 v[68:69], v[244:245], v[244:245]
v_pk_mul_f32 v[70:71], v[246:247], v[246:247]
v_pk_fma_f32 v[64:65], v[64:65], s[36:37], v[72:73]
v_pk_fma_f32 v[66:67], v[66:67], s[36:37], v[72:73]
buffer_load_dwordx4 v8, s[8:11], s28 offen offset:1024 sc1 lds
v_pk_fma_f32 v[68:69], v[68:69], s[36:37], v[72:73]
v_pk_fma_f32 v[70:71], v[70:71], s[36:37], v[72:73]
v_pk_mul_f32 v[64:65], v[64:65], v[212:213]
v_pk_mul_f32 v[66:67], v[66:67], v[214:215]
v_pk_mul_f32 v[68:69], v[68:69], v[244:245]
v_pk_mul_f32 v[70:71], v[70:71], v[246:247]
v_exp_f32 v64, v64
v_exp_f32 v65, v65
v_exp_f32 v66, v66
v_exp_f32 v67, v67
v_exp_f32 v68, v68
v_exp_f32 v69, v69
v_exp_f32 v70, v70
v_exp_f32 v71, v71
v_pk_add_f32 v[64:65], v[64:65], 1.0 op_sel_hi:[1,0]
v_pk_add_f32 v[66:67], v[66:67], 1.0 op_sel_hi:[1,0]
v_pk_add_f32 v[68:69], v[68:69], 1.0 op_sel_hi:[1,0]
v_pk_add_f32 v[70:71], v[70:71], 1.0 op_sel_hi:[1,0]
v_rcp_f32 v64, v64
v_rcp_f32 v65, v65
v_rcp_f32 v66, v66
v_rcp_f32 v67, v67
v_rcp_f32 v68, v68
v_rcp_f32 v69, v69
v_rcp_f32 v70, v70
v_rcp_f32 v71, v71
v_pk_mul_f32 v[212:213], v[212:213], v[64:65]
v_pk_mul_f32 v[214:215], v[214:215], v[66:67]
v_pk_mul_f32 v[244:245], v[244:245], v[68:69]
v_pk_mul_f32 v[246:247], v[246:247], v[70:71]
buffer_load_dwordx4 v9, s[8:11], s28 offen offset:2048 sc1 lds
v_pk_add_f32 v[40:41], v[40:41], v[212:213]
v_pk_fma_f32 v[56:57], v[212:213], v[212:213], v[56:57]
v_pk_add_f32 v[42:43], v[42:43], v[214:215]
v_pk_fma_f32 v[58:59], v[214:215], v[214:215], v[58:59]
v_pk_add_f32 v[44:45], v[44:45], v[244:245]
v_pk_fma_f32 v[60:61], v[244:245], v[244:245], v[60:61]
v_pk_add_f32 v[46:47], v[46:47], v[246:247]
v_pk_fma_f32 v[62:63], v[246:247], v[246:247], v[62:63]
v_pk_mul_f32 v[64:65], v[152:153], v[152:153]
v_pk_mul_f32 v[66:67], v[154:155], v[154:155]
v_pk_mul_f32 v[68:69], v[184:185], v[184:185]
v_pk_mul_f32 v[70:71], v[186:187], v[186:187]
v_pk_fma_f32 v[64:65], v[64:65], s[36:37], v[72:73]
v_pk_fma_f32 v[66:67], v[66:67], s[36:37], v[72:73]
v_pk_fma_f32 v[68:69], v[68:69], s[36:37], v[72:73]
v_pk_fma_f32 v[70:71], v[70:71], s[36:37], v[72:73]
v_pk_mul_f32 v[64:65], v[64:65], v[152:153]
v_pk_mul_f32 v[66:67], v[66:67], v[154:155]
v_pk_mul_f32 v[68:69], v[68:69], v[184:185]
v_pk_mul_f32 v[70:71], v[70:71], v[186:187]
v_exp_f32 v64, v64
v_exp_f32 v65, v65
v_exp_f32 v66, v66
v_exp_f32 v67, v67
v_exp_f32 v68, v68
v_exp_f32 v69, v69
v_exp_f32 v70, v70
v_exp_f32 v71, v71
v_pk_add_f32 v[64:65], v[64:65], 1.0 op_sel_hi:[1,0]
v_pk_add_f32 v[66:67], v[66:67], 1.0 op_sel_hi:[1,0]
buffer_load_dwordx4 v9, s[8:11], s28 offen offset:3072 sc1 lds
v_pk_add_f32 v[68:69], v[68:69], 1.0 op_sel_hi:[1,0]
v_pk_add_f32 v[70:71], v[70:71], 1.0 op_sel_hi:[1,0]
v_rcp_f32 v64, v64
v_rcp_f32 v65, v65
v_rcp_f32 v66, v66
v_rcp_f32 v67, v67
v_rcp_f32 v68, v68
v_rcp_f32 v69, v69
v_rcp_f32 v70, v70
v_rcp_f32 v71, v71
v_pk_mul_f32 v[152:153], v[152:153], v[64:65]
v_pk_mul_f32 v[154:155], v[154:155], v[66:67]
v_pk_mul_f32 v[184:185], v[184:185], v[68:69]
v_pk_mul_f32 v[186:187], v[186:187], v[70:71]
v_pk_add_f32 v[32:33], v[32:33], v[152:153]
v_pk_fma_f32 v[48:49], v[152:153], v[152:153], v[48:49]
v_pk_add_f32 v[34:35], v[34:35], v[154:155]
v_pk_fma_f32 v[50:51], v[154:155], v[154:155], v[50:51]
v_pk_add_f32 v[36:37], v[36:37], v[184:185]
v_pk_fma_f32 v[52:53], v[184:185], v[184:185], v[52:53]
v_pk_add_f32 v[38:39], v[38:39], v[186:187]
v_pk_fma_f32 v[54:55], v[186:187], v[186:187], v[54:55]
v_pk_mul_f32 v[64:65], v[216:217], v[216:217]
v_pk_mul_f32 v[66:67], v[218:219], v[218:219]
v_pk_mul_f32 v[68:69], v[248:249], v[248:249]
v_pk_mul_f32 v[70:71], v[250:251], v[250:251]
v_pk_fma_f32 v[64:65], v[64:65], s[36:37], v[72:73]
v_pk_fma_f32 v[66:67], v[66:67], s[36:37], v[72:73]
v_pk_fma_f32 v[68:69], v[68:69], s[36:37], v[72:73]
v_pk_fma_f32 v[70:71], v[70:71], s[36:37], v[72:73]
s_add_u32 m0, s25, 98304
s_nop 0
buffer_load_dwordx4 v10, s[44:47], s29 offen offset:0 lds
v_pk_mul_f32 v[64:65], v[64:65], v[216:217]
v_pk_mul_f32 v[66:67], v[66:67], v[218:219]
v_pk_mul_f32 v[68:69], v[68:69], v[248:249]
v_pk_mul_f32 v[70:71], v[70:71], v[250:251]
v_exp_f32 v64, v64
v_exp_f32 v65, v65
v_exp_f32 v66, v66
v_exp_f32 v67, v67
v_exp_f32 v68, v68
v_exp_f32 v69, v69
v_exp_f32 v70, v70
v_exp_f32 v71, v71
v_pk_add_f32 v[64:65], v[64:65], 1.0 op_sel_hi:[1,0]
v_pk_add_f32 v[66:67], v[66:67], 1.0 op_sel_hi:[1,0]
v_pk_add_f32 v[68:69], v[68:69], 1.0 op_sel_hi:[1,0]
v_pk_add_f32 v[70:71], v[70:71], 1.0 op_sel_hi:[1,0]
v_rcp_f32 v64, v64
v_rcp_f32 v65, v65
v_rcp_f32 v66, v66
v_rcp_f32 v67, v67
v_rcp_f32 v68, v68
v_rcp_f32 v69, v69
v_rcp_f32 v70, v70
v_rcp_f32 v71, v71
v_pk_mul_f32 v[216:217], v[216:217], v[64:65]
v_pk_mul_f32 v[218:219], v[218:219], v[66:67]
v_pk_mul_f32 v[248:249], v[248:249], v[68:69]
v_pk_mul_f32 v[250:251], v[250:251], v[70:71]
v_pk_add_f32 v[40:41], v[40:41], v[216:217]
v_pk_fma_f32 v[56:57], v[216:217], v[216:217], v[56:57]
buffer_load_dwordx4 v11, s[44:47], s29 offen offset:1024 lds
v_pk_add_f32 v[42:43], v[42:43], v[218:219]
v_pk_fma_f32 v[58:59], v[218:219], v[218:219], v[58:59]
v_pk_add_f32 v[44:45], v[44:45], v[248:249]
v_pk_fma_f32 v[60:61], v[248:249], v[248:249], v[60:61]
v_pk_add_f32 v[46:47], v[46:47], v[250:251]
v_pk_fma_f32 v[62:63], v[250:251], v[250:251], v[62:63]
v_pk_mul_f32 v[64:65], v[156:157], v[156:157]
v_pk_mul_f32 v[66:67], v[158:159], v[158:159]
v_pk_mul_f32 v[68:69], v[188:189], v[188:189]
v_pk_mul_f32 v[70:71], v[190:191], v[190:191]
v_pk_fma_f32 v[64:65], v[64:65], s[36:37], v[72:73]
v_pk_fma_f32 v[66:67], v[66:67], s[36:37], v[72:73]
v_pk_fma_f32 v[68:69], v[68:69], s[36:37], v[72:73]
v_pk_fma_f32 v[70:71], v[70:71], s[36:37], v[72:73]
v_pk_mul_f32 v[64:65], v[64:65], v[156:157]
v_pk_mul_f32 v[66:67], v[66:67], v[158:159]
v_pk_mul_f32 v[68:69], v[68:69], v[188:189]
v_pk_mul_f32 v[70:71], v[70:71], v[190:191]
v_exp_f32 v64, v64
v_exp_f32 v65, v65
v_exp_f32 v66, v66
v_exp_f32 v67, v67
v_exp_f32 v68, v68
v_exp_f32 v69, v69
v_exp_f32 v70, v70
v_exp_f32 v71, v71
v_pk_add_f32 v[64:65], v[64:65], 1.0 op_sel_hi:[1,0]
v_pk_add_f32 v[66:67], v[66:67], 1.0 op_sel_hi:[1,0]
v_pk_add_f32 v[68:69], v[68:69], 1.0 op_sel_hi:[1,0]
v_pk_add_f32 v[70:71], v[70:71], 1.0 op_sel_hi:[1,0]
buffer_load_dwordx4 v12, s[44:47], s29 offen offset:2048 lds
v_rcp_f32 v64, v64
v_rcp_f32 v65, v65
v_rcp_f32 v66, v66
v_rcp_f32 v67, v67
v_rcp_f32 v68, v68
v_rcp_f32 v69, v69
v_rcp_f32 v70, v70
v_rcp_f32 v71, v71
v_pk_mul_f32 v[156:157], v[156:157], v[64:65]
v_pk_mul_f32 v[158:159], v[158:159], v[66:67]
v_pk_mul_f32 v[188:189], v[188:189], v[68:69]
v_pk_mul_f32 v[190:191], v[190:191], v[70:71]
v_pk_add_f32 v[32:33], v[32:33], v[156:157]
v_pk_fma_f32 v[48:49], v[156:157], v[156:157], v[48:49]
v_pk_add_f32 v[34:35], v[34:35], v[158:159]
v_pk_fma_f32 v[50:51], v[158:159], v[158:159], v[50:51]
v_pk_add_f32 v[36:37], v[36:37], v[188:189]
v_pk_fma_f32 v[52:53], v[188:189], v[188:189], v[52:53]
v_pk_add_f32 v[38:39], v[38:39], v[190:191]
v_pk_fma_f32 v[54:55], v[190:191], v[190:191], v[54:55]
v_pk_mul_f32 v[64:65], v[220:221], v[220:221]
v_pk_mul_f32 v[66:67], v[222:223], v[222:223]
v_pk_mul_f32 v[68:69], v[252:253], v[252:253]
v_pk_mul_f32 v[70:71], v[254:255], v[254:255]
v_pk_fma_f32 v[64:65], v[64:65], s[36:37], v[72:73]
v_pk_fma_f32 v[66:67], v[66:67], s[36:37], v[72:73]
v_pk_fma_f32 v[68:69], v[68:69], s[36:37], v[72:73]
v_pk_fma_f32 v[70:71], v[70:71], s[36:37], v[72:73]
v_pk_mul_f32 v[64:65], v[64:65], v[220:221]
v_pk_mul_f32 v[66:67], v[66:67], v[222:223]
buffer_load_dwordx4 v13, s[44:47], s29 offen offset:3072 lds
v_pk_mul_f32 v[68:69], v[68:69], v[252:253]
v_pk_mul_f32 v[70:71], v[70:71], v[254:255]
v_exp_f32 v64, v64
v_exp_f32 v65, v65
v_exp_f32 v66, v66
v_exp_f32 v67, v67
v_exp_f32 v68, v68
v_exp_f32 v69, v69
v_exp_f32 v70, v70
v_exp_f32 v71, v71
v_pk_add_f32 v[64:65], v[64:65], 1.0 op_sel_hi:[1,0]
v_pk_add_f32 v[66:67], v[66:67], 1.0 op_sel_hi:[1,0]
v_pk_add_f32 v[68:69], v[68:69], 1.0 op_sel_hi:[1,0]
v_pk_add_f32 v[70:71], v[70:71], 1.0 op_sel_hi:[1,0]
v_rcp_f32 v64, v64
v_rcp_f32 v65, v65
v_rcp_f32 v66, v66
v_rcp_f32 v67, v67
v_rcp_f32 v68, v68
v_rcp_f32 v69, v69
v_rcp_f32 v70, v70
v_rcp_f32 v71, v71
v_pk_mul_f32 v[220:221], v[220:221], v[64:65]
v_pk_mul_f32 v[222:223], v[222:223], v[66:67]
v_pk_mul_f32 v[252:253], v[252:253], v[68:69]
v_pk_mul_f32 v[254:255], v[254:255], v[70:71]
v_pk_add_f32 v[40:41], v[40:41], v[220:221]
v_pk_fma_f32 v[56:57], v[220:221], v[220:221], v[56:57]
v_pk_add_f32 v[42:43], v[42:43], v[222:223]
v_pk_fma_f32 v[58:59], v[222:223], v[222:223], v[58:59]
v_pk_add_f32 v[44:45], v[44:45], v[252:253]
v_pk_fma_f32 v[60:61], v[252:253], v[252:253], v[60:61]
v_pk_add_f32 v[46:47], v[46:47], v[254:255]
v_pk_fma_f32 v[62:63], v[254:255], v[254:255], v[62:63]
v_add_f32_dpp v32, v32, v32 row_ror:8 row_mask:0xf bank_mask:0x3
v_add_f32_dpp v33, v33, v33 row_ror:8 row_mask:0xf bank_mask:0x3
v_add_f32_dpp v34, v34, v34 row_ror:8 row_mask:0xf bank_mask:0x3
v_add_f32_dpp v35, v35, v35 row_ror:8 row_mask:0xf bank_mask:0x3
v_add_f32_dpp v36, v36, v36 row_ror:8 row_mask:0xf bank_mask:0x3
v_add_f32_dpp v37, v37, v37 row_ror:8 row_mask:0xf bank_mask:0x3
v_add_f32_dpp v38, v38, v38 row_ror:8 row_mask:0xf bank_mask:0x3
v_add_f32_dpp v39, v39, v39 row_ror:8 row_mask:0xf bank_mask:0x3
v_add_f32_dpp v48, v48, v48 row_ror:8 row_mask:0xf bank_mask:0x3
v_add_f32_dpp v49, v49, v49 row_ror:8 row_mask:0xf bank_mask:0x3
v_add_f32_dpp v50, v50, v50 row_ror:8 row_mask:0xf bank_mask:0x3
v_add_f32_dpp v51, v51, v51 row_ror:8 row_mask:0xf bank_mask:0x3
v_add_f32_dpp v52, v52, v52 row_ror:8 row_mask:0xf bank_mask:0x3
v_add_f32_dpp v53, v53, v53 row_ror:8 row_mask:0xf bank_mask:0x3
v_add_f32_dpp v54, v54, v54 row_ror:8 row_mask:0xf bank_mask:0x3
v_add_f32_dpp v55, v55, v55 row_ror:8 row_mask:0xf bank_mask:0x3
v_add_f32_dpp v32, v40, v40 row_ror:8 row_mask:0xf bank_mask:0xc
v_add_f32_dpp v33, v41, v41 row_ror:8 row_mask:0xf bank_mask:0xc
v_add_f32_dpp v34, v42, v42 row_ror:8 row_mask:0xf bank_mask:0xc
v_add_f32_dpp v35, v43, v43 row_ror:8 row_mask:0xf bank_mask:0xc
v_add_f32_dpp v36, v44, v44 row_ror:8 row_mask:0xf bank_mask:0xc
v_add_f32_dpp v37, v45, v45 row_ror:8 row_mask:0xf bank_mask:0xc
v_add_f32_dpp v38, v46, v46 row_ror:8 row_mask:0xf bank_mask:0xc
v_add_f32_dpp v39, v47, v47 row_ror:8 row_mask:0xf bank_mask:0xc
v_add_f32_dpp v48, v56, v56 row_ror:8 row_mask:0xf bank_mask:0xc
v_add_f32_dpp v49, v57, v57 row_ror:8 row_mask:0xf bank_mask:0xc
v_add_f32_dpp v50, v58, v58 row_ror:8 row_mask:0xf bank_mask:0xc
v_add_f32_dpp v51, v59, v59 row_ror:8 row_mask:0xf bank_mask:0xc
v_add_f32_dpp v52, v60, v60 row_ror:8 row_mask:0xf bank_mask:0xc
v_add_f32_dpp v53, v61, v61 row_ror:8 row_mask:0xf bank_mask:0xc
v_add_f32_dpp v54, v62, v62 row_ror:8 row_mask:0xf bank_mask:0xc
v_add_f32_dpp v55, v63, v63 row_ror:8 row_mask:0xf bank_mask:0xc
v_add_f32_dpp v32, v32, v32 row_shl:4 row_mask:0xf bank_mask:0x5
v_add_f32_dpp v33, v33, v33 row_shl:4 row_mask:0xf bank_mask:0x5
v_add_f32_dpp v34, v34, v34 row_shl:4 row_mask:0xf bank_mask:0x5
v_add_f32_dpp v35, v35, v35 row_shl:4 row_mask:0xf bank_mask:0x5
v_add_f32_dpp v48, v48, v48 row_shl:4 row_mask:0xf bank_mask:0x5
v_add_f32_dpp v49, v49, v49 row_shl:4 row_mask:0xf bank_mask:0x5
v_add_f32_dpp v50, v50, v50 row_shl:4 row_mask:0xf bank_mask:0x5
v_add_f32_dpp v51, v51, v51 row_shl:4 row_mask:0xf bank_mask:0x5
v_add_f32_dpp v32, v36, v36 row_shr:4 row_mask:0xf bank_mask:0xa
v_add_f32_dpp v33, v37, v37 row_shr:4 row_mask:0xf bank_mask:0xa
v_add_f32_dpp v34, v38, v38 row_shr:4 row_mask:0xf bank_mask:0xa
v_add_f32_dpp v35, v39, v39 row_shr:4 row_mask:0xf bank_mask:0xa
v_add_f32_dpp v48, v52, v52 row_shr:4 row_mask:0xf bank_mask:0xa
v_add_f32_dpp v49, v53, v53 row_shr:4 row_mask:0xf bank_mask:0xa
v_add_f32_dpp v50, v54, v54 row_shr:4 row_mask:0xf bank_mask:0xa
v_add_f32_dpp v51, v55, v55 row_shr:4 row_mask:0xf bank_mask:0xa
v_add_f32_dpp v32, v32, v32 quad_perm:[1,0,3,2] row_mask:0xf bank_mask:0xf
v_add_f32_dpp v33, v33, v33 quad_perm:[1,0,3,2] row_mask:0xf bank_mask:0xf
v_add_f32_dpp v34, v34, v34 quad_perm:[1,0,3,2] row_mask:0xf bank_mask:0xf
v_add_f32_dpp v35, v35, v35 quad_perm:[1,0,3,2] row_mask:0xf bank_mask:0xf
v_add_f32_dpp v48, v48, v48 quad_perm:[1,0,3,2] row_mask:0xf bank_mask:0xf
v_add_f32_dpp v49, v49, v49 quad_perm:[1,0,3,2] row_mask:0xf bank_mask:0xf
v_add_f32_dpp v50, v50, v50 quad_perm:[1,0,3,2] row_mask:0xf bank_mask:0xf
v_add_f32_dpp v51, v51, v51 quad_perm:[1,0,3,2] row_mask:0xf bank_mask:0xf
v_add_f32_dpp v32, v32, v32 quad_perm:[2,3,0,1] row_mask:0xf bank_mask:0xf
v_add_f32_dpp v33, v33, v33 quad_perm:[2,3,0,1] row_mask:0xf bank_mask:0xf
v_add_f32_dpp v34, v34, v34 quad_perm:[2,3,0,1] row_mask:0xf bank_mask:0xf
v_add_f32_dpp v35, v35, v35 quad_perm:[2,3,0,1] row_mask:0xf bank_mask:0xf
v_add_f32_dpp v48, v48, v48 quad_perm:[2,3,0,1] row_mask:0xf bank_mask:0xf
v_add_f32_dpp v49, v49, v49 quad_perm:[2,3,0,1] row_mask:0xf bank_mask:0xf
v_add_f32_dpp v50, v50, v50 quad_perm:[2,3,0,1] row_mask:0xf bank_mask:0xf
v_add_f32_dpp v51, v51, v51 quad_perm:[2,3,0,1] row_mask:0xf bank_mask:0xf
s_mov_b32 s32, 0xaaaaaaaa
s_mov_b32 s33, 0xaaaaaaaa
s_mov_b32 s34, 0xcccccccc
s_mov_b32 s35, 0xcccccccc
v_cndmask_b32 v32, v32, v33, s[32:33]
v_cndmask_b32 v34, v34, v35, s[32:33]
v_cndmask_b32 v48, v48, v49, s[32:33]
v_cndmask_b32 v50, v50, v51, s[32:33]
v_cndmask_b32 v16, v32, v34, s[34:35]
v_cndmask_b32 v18, v48, v50, s[34:35]
v_mov_b32 v17, s78
v_mov_b32 v19, s78
s_lshl_b32 s27, s6, 16
s_lshl_b32 s38, s3, 14
s_add_u32 s27, s27, s38
s_add_u32 s38, s27, 131072
v_lshl_add_u32 v1, v0, 4, s38
s_lshl_b32 s27, s7, 10
buffer_store_dwordx4 v[16:19], v1, s[40:43], s27 offen sc1
v_add_u32 v2, 4096, v1
v_add_u32 v3, 8192, v1
v_add_u32 v4, 12288, v1
v_lshrrev_b32 v5, 2, v0
v_min_u32 v5, 13, v5
s_add_u32 s38, s38, 1012
v_lshl_add_u32 v5, v5, 10, s38
v_accvgpr_read_b32 v22, a230
v_accvgpr_read_b32 v23, a231
v_accvgpr_read_b32 v24, a232
v_accvgpr_read_b32 v25, a233
v_accvgpr_read_b32 v26, a234
v_add_u32 v27, 65536, v22
v_add_u32 v28, 65536, v23
v_add_u32 v29, 65536, v24
v_add_u32 v30, 65536, v25
v_add_u32 v31, 65536, v26
s_mov_b32 s79, 32768
s_cmp_ge_u32 s5, 28
s_cbranch_scc1 Lz_slow
s_waitcnt vmcnt(27)
s_barrier
ds_read_b64_tr_b16 a[176:177], v22 offset:0
ds_read_b64_tr_b16 a[178:179], v22 offset:512
ds_read_b128 a[160:163], v26 offset:0
ds_read_b128 a[164:167], v26 offset:2048
ds_read_b128 a[168:171], v26 offset:4096
ds_read_b128 a[172:175], v26 offset:6144
ds_read_b64_tr_b16 a[180:181], v23 offset:0
ds_read_b64_tr_b16 a[182:183], v23 offset:512
ds_read_b64_tr_b16 a[184:185], v24 offset:0
ds_read_b64_tr_b16 a[186:187], v24 offset:512
ds_read_b64_tr_b16 a[188:189], v25 offset:0
ds_read_b64_tr_b16 a[190:191], v25 offset:512
s_waitcnt lgkmcnt(9)
v_mfma_f32_16x16x32_bf16 v[64:67], a[176:179], a[160:163], 0
ds_read_b64_tr_b16 a[208:209], v22 offset:4096
s_waitcnt lgkmcnt(9)
v_mfma_f32_16x16x32_bf16 v[80:83], a[176:179], a[164:167], 0
ds_read_b64_tr_b16 a[210:211], v22 offset:4608
s_waitcnt lgkmcnt(9)
v_mfma_f32_16x16x32_bf16 v[96:99], a[176:179], a[168:171], 0
s_waitcnt lgkmcnt(8)
v_mfma_f32_16x16x32_bf16 v[112:115], a[176:179], a[172:175], 0
ds_read_b128 a[192:195], v26 offset:1024
s_waitcnt lgkmcnt(7)
v_mfma_f32_16x16x32_bf16 v[116:119], a[180:183], a[172:175], 0
ds_read_b128 a[196:199], v26 offset:3072
v_mfma_f32_16x16x32_bf16 v[100:103], a[180:183], a[168:171], 0
ds_read_b128 a[200:203], v26 offset:5120
v_mfma_f32_16x16x32_bf16 v[84:87], a[180:183], a[164:167], 0
v_mfma_f32_16x16x32_bf16 v[68:71], a[180:183], a[160:163], 0
ds_read_b128 a[204:207], v26 offset:7168
s_waitcnt lgkmcnt(4)
v_mfma_f32_16x16x32_bf16 v[72:75], a[184:187], a[160:163], 0
ds_read_b64_tr_b16 a[212:213], v23 offset:4096
v_mfma_f32_16x16x32_bf16 v[88:91], a[184:187], a[164:167], 0
ds_read_b64_tr_b16 a[214:215], v23 offset:4608
v_mfma_f32_16x16x32_bf16 v[104:107], a[184:187], a[168:171], 0
v_mfma_f32_16x16x32_bf16 v[120:123], a[184:187], a[172:175], 0
ds_read_b64_tr_b16 a[216:217], v24 offset:4096
v_mfma_f32_16x16x32_bf16 v[124:127], a[188:191], a[172:175], 0
ds_read_b64_tr_b16 a[218:219], v24 offset:4608
v_mfma_f32_16x16x32_bf16 v[108:111], a[188:191], a[168:171], 0
ds_read_b64_tr_b16 a[220:221], v25 offset:4096
v_mfma_f32_16x16x32_bf16 v[92:95], a[188:191], a[164:167], 0
v_mfma_f32_16x16x32_bf16 v[76:79], a[188:191], a[160:163], 0
ds_read_b64_tr_b16 a[222:223], v25 offset:4608
s_waitcnt vmcnt(19) lgkmcnt(4)
v_mfma_f32_16x16x32_bf16 v[64:67], a[208:211], a[192:195], v[64:67]
s_barrier
ds_read_b64_tr_b16 a[176:177], v22 offset:32768
v_mfma_f32_16x16x32_bf16 v[80:83], a[208:211], a[196:199], v[80:83]
ds_read_b64_tr_b16 a[178:179], v22 offset:33280
v_mfma_f32_16x16x32_bf16 v[96:99], a[208:211], a[200:203], v[96:99]
v_mfma_f32_16x16x32_bf16 v[112:115], a[208:211], a[204:207], v[112:115]
ds_read_b128 a[160:163], v26 offset:32768
v_mfma_f32_16x16x32_bf16 v[116:119], a[212:215], a[204:207], v[116:119]
ds_read_b128 a[164:167], v26 offset:34816
v_mfma_f32_16x16x32_bf16 v[100:103], a[212:215], a[200:203], v[100:103]
ds_read_b128 a[168:171], v26 offset:36864
v_mfma_f32_16x16x32_bf16 v[84:87], a[212:215], a[196:199], v[84:87]
v_mfma_f32_16x16x32_bf16 v[68:71], a[212:215], a[192:195], v[68:71]
ds_read_b128 a[172:175], v26 offset:38912
s_waitcnt lgkmcnt(4)
v_mfma_f32_16x16x32_bf16 v[72:75], a[216:219], a[192:195], v[72:75]
ds_read_b64_tr_b16 a[180:181], v23 offset:32768
v_mfma_f32_16x16x32_bf16 v[88:91], a[216:219], a[196:199], v[88:91]
ds_read_b64_tr_b16 a[182:183], v23 offset:33280
v_mfma_f32_16x16x32_bf16 v[104:107], a[216:219], a[200:203], v[104:107]
v_mfma_f32_16x16x32_bf16 v[120:123], a[216:219], a[204:207], v[120:123]
ds_read_b64_tr_b16 a[184:185], v24 offset:32768
v_mfma_f32_16x16x32_bf16 v[124:127], a[220:223], a[204:207], v[124:127]
ds_read_b64_tr_b16 a[186:187], v24 offset:33280
v_mfma_f32_16x16x32_bf16 v[108:111], a[220:223], a[200:203], v[108:111]
ds_read_b64_tr_b16 a[188:189], v25 offset:32768
v_mfma_f32_16x16x32_bf16 v[92:95], a[220:223], a[196:199], v[92:95]
v_mfma_f32_16x16x32_bf16 v[76:79], a[220:223], a[192:195], v[76:79]
ds_read_b64_tr_b16 a[190:191], v25 offset:33280
s_waitcnt lgkmcnt(4)
v_mfma_f32_16x16x32_bf16 v[64:67], a[176:179], a[160:163], v[64:67]
ds_read_b64_tr_b16 a[208:209], v22 offset:36864
v_mfma_f32_16x16x32_bf16 v[80:83], a[176:179], a[164:167], v[80:83]
ds_read_b64_tr_b16 a[210:211], v22 offset:37376
v_mfma_f32_16x16x32_bf16 v[96:99], a[176:179], a[168:171], v[96:99]
v_mfma_f32_16x16x32_bf16 v[112:115], a[176:179], a[172:175], v[112:115]
ds_read_b128 a[192:195], v26 offset:33792
v_mfma_f32_16x16x32_bf16 v[116:119], a[180:183], a[172:175], v[116:119]
ds_read_b128 a[196:199], v26 offset:35840
s_add_u32 s31, s31, 1
v_mfma_f32_16x16x32_bf16 v[100:103], a[180:183], a[168:171], v[100:103]
ds_read_b128 a[200:203], v26 offset:37888
v_mfma_f32_16x16x32_bf16 v[84:87], a[180:183], a[164:167], v[84:87]
v_mfma_f32_16x16x32_bf16 v[68:71], a[180:183], a[160:163], v[68:71]
ds_read_b128 a[204:207], v26 offset:39936
s_waitcnt lgkmcnt(4)
v_mfma_f32_16x16x32_bf16 v[72:75], a[184:187], a[160:163], v[72:75]
ds_read_b64_tr_b16 a[212:213], v23 offset:36864
v_readlane_b32 s28, v14, s31
v_mfma_f32_16x16x32_bf16 v[88:91], a[184:187], a[164:167], v[88:91]
ds_read_b64_tr_b16 a[214:215], v23 offset:37376
v_mfma_f32_16x16x32_bf16 v[104:107], a[184:187], a[168:171], v[104:107]
v_mfma_f32_16x16x32_bf16 v[120:123], a[184:187], a[172:175], v[120:123]
ds_read_b64_tr_b16 a[216:217], v24 offset:36864
v_mfma_f32_16x16x32_bf16 v[124:127], a[188:191], a[172:175], v[124:127]
ds_read_b64_tr_b16 a[218:219], v24 offset:37376
v_mfma_f32_16x16x32_bf16 v[108:111], a[188:191], a[168:171], v[108:111]
ds_read_b64_tr_b16 a[220:221], v25 offset:36864
v_mfma_f32_16x16x32_bf16 v[92:95], a[188:191], a[164:167], v[92:95]
v_mfma_f32_16x16x32_bf16 v[76:79], a[188:191], a[160:163], v[76:79]
ds_read_b64_tr_b16 a[222:223], v25 offset:37376
s_waitcnt vmcnt(9) lgkmcnt(4)
v_mfma_f32_16x16x32_bf16 v[64:67], a[208:211], a[192:195], v[64:67]
s_barrier
ds_read_b64_tr_b16 a[176:177], v27 offset:0
v_mfma_f32_16x16x32_bf16 v[80:83], a[208:211], a[196:199], v[80:83]
ds_read_b64_tr_b16 a[178:179], v27 offset:512
s_add_u32 m0, s24, 0
v_mfma_f32_16x16x32_bf16 v[96:99], a[208:211], a[200:203], v[96:99]
buffer_load_dwordx4 v8, s[8:11], s28 offen offset:0 sc1 lds
v_mfma_f32_16x16x32_bf16 v[112:115], a[208:211], a[204:207], v[112:115]
ds_read_b128 a[160:163], v31 offset:0
v_mfma_f32_16x16x32_bf16 v[116:119], a[212:215], a[204:207], v[116:119]
ds_read_b128 a[164:167], v31 offset:2048
v_mfma_f32_16x16x32_bf16 v[100:103], a[212:215], a[200:203], v[100:103]
ds_read_b128 a[168:171], v31 offset:4096
v_mfma_f32_16x16x32_bf16 v[84:87], a[212:215], a[196:199], v[84:87]
buffer_load_dwordx4 v8, s[8:11], s28 offen offset:1024 sc1 lds
v_mfma_f32_16x16x32_bf16 v[68:71], a[212:215], a[192:195], v[68:71]
ds_read_b128 a[172:175], v31 offset:6144
s_waitcnt lgkmcnt(4)
v_mfma_f32_16x16x32_bf16 v[72:75], a[216:219], a[192:195], v[72:75]
ds_read_b64_tr_b16 a[180:181], v28 offset:0
s_mul_i32 s29, s28, 224
v_mfma_f32_16x16x32_bf16 v[88:91], a[216:219], a[196:199], v[88:91]
ds_read_b64_tr_b16 a[182:183], v28 offset:512
v_mfma_f32_16x16x32_bf16 v[104:107], a[216:219], a[200:203], v[104:107]
buffer_load_dwordx4 v9, s[8:11], s28 offen offset:2048 sc1 lds
v_mfma_f32_16x16x32_bf16 v[120:123], a[216:219], a[204:207], v[120:123]
ds_read_b64_tr_b16 a[184:185], v29 offset:0
v_mfma_f32_16x16x32_bf16 v[124:127], a[220:223], a[204:207], v[124:127]
ds_read_b64_tr_b16 a[186:187], v29 offset:512
v_mfma_f32_16x16x32_bf16 v[108:111], a[220:223], a[200:203], v[108:111]
ds_read_b64_tr_b16 a[188:189], v30 offset:0
v_mfma_f32_16x16x32_bf16 v[92:95], a[220:223], a[196:199], v[92:95]
buffer_load_dwordx4 v9, s[8:11], s28 offen offset:3072 sc1 lds
v_mfma_f32_16x16x32_bf16 v[76:79], a[220:223], a[192:195], v[76:79]
ds_read_b64_tr_b16 a[190:191], v30 offset:512
s_waitcnt lgkmcnt(4)
v_mfma_f32_16x16x32_bf16 v[64:67], a[176:179], a[160:163], v[64:67]
ds_read_b64_tr_b16 a[208:209], v27 offset:4096
v_mfma_f32_16x16x32_bf16 v[80:83], a[176:179], a[164:167], v[80:83]
ds_read_b64_tr_b16 a[210:211], v27 offset:4608
s_add_u32 m0, s25, 0
v_mfma_f32_16x16x32_bf16 v[96:99], a[176:179], a[168:171], v[96:99]
buffer_load_dwordx4 v10, s[44:47], s29 offen offset:0 lds
v_mfma_f32_16x16x32_bf16 v[112:115], a[176:179], a[172:175], v[112:115]
ds_read_b128 a[192:195], v31 offset:1024
v_mfma_f32_16x16x32_bf16 v[116:119], a[180:183], a[172:175], v[116:119]
ds_read_b128 a[196:199], v31 offset:3072
s_add_u32 s31, s31, 1
v_mfma_f32_16x16x32_bf16 v[100:103], a[180:183], a[168:171], v[100:103]
ds_read_b128 a[200:203], v31 offset:5120
v_mfma_f32_16x16x32_bf16 v[84:87], a[180:183], a[164:167], v[84:87]
buffer_load_dwordx4 v11, s[44:47], s29 offen offset:1024 lds
v_mfma_f32_16x16x32_bf16 v[68:71], a[180:183], a[160:163], v[68:71]
ds_read_b128 a[204:207], v31 offset:7168
s_waitcnt lgkmcnt(4)
v_mfma_f32_16x16x32_bf16 v[72:75], a[184:187], a[160:163], v[72:75]
ds_read_b64_tr_b16 a[212:213], v28 offset:4096
v_readlane_b32 s28, v14, s31
v_mfma_f32_16x16x32_bf16 v[88:91], a[184:187], a[164:167], v[88:91]
ds_read_b64_tr_b16 a[214:215], v28 offset:4608
v_mfma_f32_16x16x32_bf16 v[104:107], a[184:187], a[168:171], v[104:107]
buffer_load_dwordx4 v12, s[44:47], s29 offen offset:2048 lds
v_mfma_f32_16x16x32_bf16 v[120:123], a[184:187], a[172:175], v[120:123]
ds_read_b64_tr_b16 a[216:217], v29 offset:4096
v_mfma_f32_16x16x32_bf16 v[124:127], a[188:191], a[172:175], v[124:127]
ds_read_b64_tr_b16 a[218:219], v29 offset:4608
v_mfma_f32_16x16x32_bf16 v[108:111], a[188:191], a[168:171], v[108:111]
ds_read_b64_tr_b16 a[220:221], v30 offset:4096
v_mfma_f32_16x16x32_bf16 v[92:95], a[188:191], a[164:167], v[92:95]
buffer_load_dwordx4 v13, s[44:47], s29 offen offset:3072 lds
v_mfma_f32_16x16x32_bf16 v[76:79], a[188:191], a[160:163], v[76:79]
ds_read_b64_tr_b16 a[222:223], v30 offset:4608
s_waitcnt vmcnt(9) lgkmcnt(4)
v_mfma_f32_16x16x32_bf16 v[64:67], a[208:211], a[192:195], v[64:67]
s_barrier
ds_read_b64_tr_b16 a[176:177], v27 offset:32768
v_mfma_f32_16x16x32_bf16 v[80:83], a[208:211], a[196:199], v[80:83]
ds_read_b64_tr_b16 a[178:179], v27 offset:33280
s_add_u32 m0, s24, 32768
v_mfma_f32_16x16x32_bf16 v[96:99], a[208:211], a[200:203], v[96:99]
buffer_load_dwordx4 v8, s[8:11], s28 offen offset:0 sc1 lds
v_mfma_f32_16x16x32_bf16 v[112:115], a[208:211], a[204:207], v[112:115]
ds_read_b128 a[160:163], v31 offset:32768
v_mfma_f32_16x16x32_bf16 v[116:119], a[212:215], a[204:207], v[116:119]
ds_read_b128 a[164:167], v31 offset:34816
v_mfma_f32_16x16x32_bf16 v[100:103], a[212:215], a[200:203], v[100:103]
ds_read_b128 a[168:171], v31 offset:36864
v_mfma_f32_16x16x32_bf16 v[84:87], a[212:215], a[196:199], v[84:87]
buffer_load_dwordx4 v8, s[8:11], s28 offen offset:1024 sc1 lds
v_mfma_f32_16x16x32_bf16 v[68:71], a[212:215], a[192:195], v[68:71]
ds_read_b128 a[172:175], v31 offset:38912
s_waitcnt lgkmcnt(4)
v_mfma_f32_16x16x32_bf16 v[72:75], a[216:219], a[192:195], v[72:75]
ds_read_b64_tr_b16 a[180:181], v28 offset:32768
s_mul_i32 s29, s28, 224
v_mfma_f32_16x16x32_bf16 v[88:91], a[216:219], a[196:199], v[88:91]
ds_read_b64_tr_b16 a[182:183], v28 offset:33280
v_mfma_f32_16x16x32_bf16 v[104:107], a[216:219], a[200:203], v[104:107]
buffer_load_dwordx4 v9, s[8:11], s28 offen offset:2048 sc1 lds
v_mfma_f32_16x16x32_bf16 v[120:123], a[216:219], a[204:207], v[120:123]
ds_read_b64_tr_b16 a[184:185], v29 offset:32768
v_mfma_f32_16x16x32_bf16 v[124:127], a[220:223], a[204:207], v[124:127]
ds_read_b64_tr_b16 a[186:187], v29 offset:33280
v_mfma_f32_16x16x32_bf16 v[108:111], a[220:223], a[200:203], v[108:111]
ds_read_b64_tr_b16 a[188:189], v30 offset:32768
v_mfma_f32_16x16x32_bf16 v[92:95], a[220:223], a[196:199], v[92:95]
buffer_load_dwordx4 v9, s[8:11], s28 offen offset:3072 sc1 lds
v_mfma_f32_16x16x32_bf16 v[76:79], a[220:223], a[192:195], v[76:79]
ds_read_b64_tr_b16 a[190:191], v30 offset:33280
s_waitcnt lgkmcnt(4)
v_mfma_f32_16x16x32_bf16 v[64:67], a[176:179], a[160:163], v[64:67]
ds_read_b64_tr_b16 a[208:209], v27 offset:36864
v_mfma_f32_16x16x32_bf16 v[80:83], a[176:179], a[164:167], v[80:83]
ds_read_b64_tr_b16 a[210:211], v27 offset:37376
s_add_u32 m0, s25, 32768
v_mfma_f32_16x16x32_bf16 v[96:99], a[176:179], a[168:171], v[96:99]
buffer_load_dwordx4 v10, s[44:47], s29 offen offset:0 lds
v_mfma_f32_16x16x32_bf16 v[112:115], a[176:179], a[172:175], v[112:115]
ds_read_b128 a[192:195], v31 offset:33792
v_mfma_f32_16x16x32_bf16 v[116:119], a[180:183], a[172:175], v[116:119]
ds_read_b128 a[196:199], v31 offset:35840
s_add_u32 s31, s31, 1
v_mfma_f32_16x16x32_bf16 v[100:103], a[180:183], a[168:171], v[100:103]
ds_read_b128 a[200:203], v31 offset:37888
v_mfma_f32_16x16x32_bf16 v[84:87], a[180:183], a[164:167], v[84:87]
buffer_load_dwordx4 v11, s[44:47], s29 offen offset:1024 lds
v_mfma_f32_16x16x32_bf16 v[68:71], a[180:183], a[160:163], v[68:71]
ds_read_b128 a[204:207], v31 offset:39936
s_waitcnt lgkmcnt(4)
v_mfma_f32_16x16x32_bf16 v[72:75], a[184:187], a[160:163], v[72:75]
ds_read_b64_tr_b16 a[212:213], v28 offset:36864
v_readlane_b32 s28, v14, s31
v_mfma_f32_16x16x32_bf16 v[88:91], a[184:187], a[164:167], v[88:91]
ds_read_b64_tr_b16 a[214:215], v28 offset:37376
v_mfma_f32_16x16x32_bf16 v[104:107], a[184:187], a[168:171], v[104:107]
buffer_load_dwordx4 v12, s[44:47], s29 offen offset:2048 lds
v_mfma_f32_16x16x32_bf16 v[120:123], a[184:187], a[172:175], v[120:123]
ds_read_b64_tr_b16 a[216:217], v29 offset:36864
v_mfma_f32_16x16x32_bf16 v[124:127], a[188:191], a[172:175], v[124:127]
ds_read_b64_tr_b16 a[218:219], v29 offset:37376
v_mfma_f32_16x16x32_bf16 v[108:111], a[188:191], a[168:171], v[108:111]
ds_read_b64_tr_b16 a[220:221], v30 offset:36864
v_mfma_f32_16x16x32_bf16 v[92:95], a[188:191], a[164:167], v[92:95]
buffer_load_dwordx4 v13, s[44:47], s29 offen offset:3072 lds
v_mfma_f32_16x16x32_bf16 v[76:79], a[188:191], a[160:163], v[76:79]
ds_read_b64_tr_b16 a[222:223], v30 offset:37376
s_waitcnt vmcnt(8) lgkmcnt(4)
v_mfma_f32_16x16x32_bf16 v[64:67], a[208:211], a[192:195], v[64:67]
s_barrier
ds_read_b64_tr_b16 a[176:177], v22 offset:0
v_mfma_f32_16x16x32_bf16 v[80:83], a[208:211], a[196:199], v[80:83]
ds_read_b64_tr_b16 a[178:179], v22 offset:512
s_add_u32 m0, s24, 65536
v_mfma_f32_16x16x32_bf16 v[96:99], a[208:211], a[200:203], v[96:99]
buffer_load_dwordx4 v8, s[8:11], s28 offen offset:0 sc1 lds
v_mfma_f32_16x16x32_bf16 v[112:115], a[208:211], a[204:207], v[112:115]
ds_read_b128 a[160:163], v26 offset:0
v_mfma_f32_16x16x32_bf16 v[116:119], a[212:215], a[204:207], v[116:119]
ds_read_b128 a[164:167], v26 offset:2048
v_mfma_f32_16x16x32_bf16 v[100:103], a[212:215], a[200:203], v[100:103]
ds_read_b128 a[168:171], v26 offset:4096
v_mfma_f32_16x16x32_bf16 v[84:87], a[212:215], a[196:199], v[84:87]
buffer_load_dwordx4 v8, s[8:11], s28 offen offset:1024 sc1 lds
v_mfma_f32_16x16x32_bf16 v[68:71], a[212:215], a[192:195], v[68:71]
ds_read_b128 a[172:175], v26 offset:6144
s_waitcnt lgkmcnt(4)
v_mfma_f32_16x16x32_bf16 v[72:75], a[216:219], a[192:195], v[72:75]
ds_read_b64_tr_b16 a[180:181], v23 offset:0
s_mul_i32 s29, s28, 224
v_mfma_f32_16x16x32_bf16 v[88:91], a[216:219], a[196:199], v[88:91]
ds_read_b64_tr_b16 a[182:183], v23 offset:512
v_mfma_f32_16x16x32_bf16 v[104:107], a[216:219], a[200:203], v[104:107]
buffer_load_dwordx4 v9, s[8:11], s28 offen offset:2048 sc1 lds
v_mfma_f32_16x16x32_bf16 v[120:123], a[216:219], a[204:207], v[120:123]
ds_read_b64_tr_b16 a[184:185], v24 offset:0
v_mfma_f32_16x16x32_bf16 v[124:127], a[220:223], a[204:207], v[124:127]
ds_read_b64_tr_b16 a[186:187], v24 offset:512
v_mfma_f32_16x16x32_bf16 v[108:111], a[220:223], a[200:203], v[108:111]
ds_read_b64_tr_b16 a[188:189], v25 offset:0
v_mfma_f32_16x16x32_bf16 v[92:95], a[220:223], a[196:199], v[92:95]
buffer_load_dwordx4 v9, s[8:11], s28 offen offset:3072 sc1 lds
v_mfma_f32_16x16x32_bf16 v[76:79], a[220:223], a[192:195], v[76:79]
ds_read_b64_tr_b16 a[190:191], v25 offset:512
s_waitcnt lgkmcnt(4)
v_mfma_f32_16x16x32_bf16 v[64:67], a[176:179], a[160:163], v[64:67]
ds_read_b64_tr_b16 a[208:209], v22 offset:4096
v_mfma_f32_16x16x32_bf16 v[80:83], a[176:179], a[164:167], v[80:83]
ds_read_b64_tr_b16 a[210:211], v22 offset:4608
s_add_u32 m0, s25, 65536
buffer_load_dwordx4 v[32:35], v1, s[40:43], 0 offen offset:0 sc1
v_mfma_f32_16x16x32_bf16 v[96:99], a[176:179], a[168:171], v[96:99]
buffer_load_dwordx4 v10, s[44:47], s29 offen offset:0 lds
v_mfma_f32_16x16x32_bf16 v[112:115], a[176:179], a[172:175], v[112:115]
ds_read_b128 a[192:195], v26 offset:1024
buffer_load_dwordx4 v[36:39], v1, s[40:43], 0 offen offset:1024 sc1
v_mfma_f32_16x16x32_bf16 v[116:119], a[180:183], a[172:175], v[116:119]
ds_read_b128 a[196:199], v26 offset:3072
s_add_u32 s31, s31, 1
v_mfma_f32_16x16x32_bf16 v[100:103], a[180:183], a[168:171], v[100:103]
ds_read_b128 a[200:203], v26 offset:5120
buffer_load_dwordx4 v[40:43], v1, s[40:43], 0 offen offset:2048 sc1
v_mfma_f32_16x16x32_bf16 v[84:87], a[180:183], a[164:167], v[84:87]
buffer_load_dwordx4 v11, s[44:47], s29 offen offset:1024 lds
v_mfma_f32_16x16x32_bf16 v[68:71], a[180:183], a[160:163], v[68:71]
ds_read_b128 a[204:207], v26 offset:7168
buffer_load_dwordx4 v[44:47], v1, s[40:43], 0 offen offset:3072 sc1
s_waitcnt lgkmcnt(4)
v_mfma_f32_16x16x32_bf16 v[72:75], a[184:187], a[160:163], v[72:75]
ds_read_b64_tr_b16 a[212:213], v23 offset:4096
v_readlane_b32 s28, v14, s31
v_mfma_f32_16x16x32_bf16 v[88:91], a[184:187], a[164:167], v[88:91]
ds_read_b64_tr_b16 a[214:215], v23 offset:4608
buffer_load_dwordx4 v[48:51], v2, s[40:43], 0 offen offset:0 sc1
v_mfma_f32_16x16x32_bf16 v[104:107], a[184:187], a[168:171], v[104:107]
buffer_load_dwordx4 v12, s[44:47], s29 offen offset:2048 lds
v_mfma_f32_16x16x32_bf16 v[120:123], a[184:187], a[172:175], v[120:123]
ds_read_b64_tr_b16 a[216:217], v24 offset:4096
buffer_load_dwordx4 v[52:55], v2, s[40:43], 0 offen offset:1024 sc1
v_mfma_f32_16x16x32_bf16 v[124:127], a[188:191], a[172:175], v[124:127]
ds_read_b64_tr_b16 a[218:219], v24 offset:4608
v_mfma_f32_16x16x32_bf16 v[108:111], a[188:191], a[168:171], v[108:111]
ds_read_b64_tr_b16 a[220:221], v25 offset:4096
buffer_load_dwordx4 v[56:59], v2, s[40:43], 0 offen offset:2048 sc1
v_mfma_f32_16x16x32_bf16 v[92:95], a[188:191], a[164:167], v[92:95]
buffer_load_dwordx4 v13, s[44:47], s29 offen offset:3072 lds
v_mfma_f32_16x16x32_bf16 v[76:79], a[188:191], a[160:163], v[76:79]
ds_read_b64_tr_b16 a[222:223], v25 offset:4608
buffer_load_dwordx4 v[60:63], v2, s[40:43], 0 offen offset:3072 sc1
s_waitcnt vmcnt(16) lgkmcnt(4)
v_mfma_f32_16x16x32_bf16 v[64:67], a[208:211], a[192:195], v[64:67]
s_barrier
ds_read_b64_tr_b16 a[176:177], v22 offset:32768
v_mfma_f32_16x16x32_bf16 v[80:83], a[208:211], a[196:199], v[80:83]
ds_read_b64_tr_b16 a[178:179], v22 offset:33280
s_add_u32 m0, s24, 98304
buffer_load_dwordx4 a[64:67], v3, s[40:43], 0 offen offset:0 sc1
v_mfma_f32_16x16x32_bf16 v[96:99], a[208:211], a[200:203], v[96:99]
buffer_load_dwordx4 v8, s[8:11], s28 offen offset:0 sc1 lds
v_mfma_f32_16x16x32_bf16 v[112:115], a[208:211], a[204:207], v[112:115]
ds_read_b128 a[160:163], v26 offset:32768
buffer_load_dwordx4 a[68:71], v3, s[40:43], 0 offen offset:1024 sc1
v_mfma_f32_16x16x32_bf16 v[116:119], a[212:215], a[204:207], v[116:119]
ds_read_b128 a[164:167], v26 offset:34816
v_mfma_f32_16x16x32_bf16 v[100:103], a[212:215], a[200:203], v[100:103]
ds_read_b128 a[168:171], v26 offset:36864
buffer_load_dwordx4 a[72:75], v3, s[40:43], 0 offen offset:2048 sc1
v_mfma_f32_16x16x32_bf16 v[84:87], a[212:215], a[196:199], v[84:87]
buffer_load_dwordx4 v8, s[8:11], s28 offen offset:1024 sc1 lds
v_mfma_f32_16x16x32_bf16 v[68:71], a[212:215], a[192:195], v[68:71]
ds_read_b128 a[172:175], v26 offset:38912
buffer_load_dwordx4 a[76:79], v3, s[40:43], 0 offen offset:3072 sc1
s_waitcnt lgkmcnt(4)
v_mfma_f32_16x16x32_bf16 v[72:75], a[216:219], a[192:195], v[72:75]
ds_read_b64_tr_b16 a[180:181], v23 offset:32768
s_mul_i32 s29, s28, 224
v_mfma_f32_16x16x32_bf16 v[88:91], a[216:219], a[196:199], v[88:91]
ds_read_b64_tr_b16 a[182:183], v23 offset:33280
buffer_load_dwordx4 a[80:83], v4, s[40:43], 0 offen offset:0 sc1
v_mfma_f32_16x16x32_bf16 v[104:107], a[216:219], a[200:203], v[104:107]
buffer_load_dwordx4 v9, s[8:11], s28 offen offset:2048 sc1 lds
v_mfma_f32_16x16x32_bf16 v[120:123], a[216:219], a[204:207], v[120:123]
ds_read_b64_tr_b16 a[184:185], v24 offset:32768
buffer_load_dwordx4 a[84:87], v4, s[40:43], 0 offen offset:1024 sc1
v_mfma_f32_16x16x32_bf16 v[124:127], a[220:223], a[204:207], v[124:127]
ds_read_b64_tr_b16 a[186:187], v24 offset:33280
v_mfma_f32_16x16x32_bf16 v[108:111], a[220:223], a[200:203], v[108:111]
ds_read_b64_tr_b16 a[188:189], v25 offset:32768
v_mfma_f32_16x16x32_bf16 v[92:95], a[220:223], a[196:199], v[92:95]
buffer_load_dwordx4 v9, s[8:11], s28 offen offset:3072 sc1 lds
v_mfma_f32_16x16x32_bf16 v[76:79], a[220:223], a[192:195], v[76:79]
ds_read_b64_tr_b16 a[190:191], v25 offset:33280
Lz_chk:
s_waitcnt vmcnt(21)
v_max3_u32 v20, v17, v33, v35
v_min3_u32 v21, v17, v33, v35
s_waitcnt vmcnt(19)
v_max3_u32 v20, v20, v37, v39
v_min3_u32 v21, v21, v37, v39
v_add_f32 v32, v32, v36
v_add_f32 v34, v34, v38
s_waitcnt vmcnt(18)
v_max3_u32 v20, v20, v41, v43
v_min3_u32 v21, v21, v41, v43
v_add_f32 v32, v32, v40
v_add_f32 v34, v34, v42
s_waitcnt vmcnt(16)
v_max3_u32 v20, v20, v45, v47
v_min3_u32 v21, v21, v45, v47
v_add_f32 v32, v32, v44
v_add_f32 v34, v34, v46
s_waitcnt vmcnt(15)
v_max3_u32 v20, v20, v49, v51
v_min3_u32 v21, v21, v49, v51
v_add_f32 v32, v32, v48
v_add_f32 v34, v34, v50
s_waitcnt vmcnt(13)
v_max3_u32 v20, v20, v53, v55
v_min3_u32 v21, v21, v53, v55
v_add_f32 v32, v32, v52
v_add_f32 v34, v34, v54
s_waitcnt vmcnt(12)
v_max3_u32 v20, v20, v57, v59
v_min3_u32 v21, v21, v57, v59
v_add_f32 v32, v32, v56
v_add_f32 v34, v34, v58
s_waitcnt vmcnt(10)
v_max3_u32 v20, v20, v61, v63
v_min3_u32 v21, v21, v61, v63
v_add_f32 v32, v32, v60
v_add_f32 v34, v34, v62
s_waitcnt vmcnt(9)
v_accvgpr_read_b32 v36, a64
v_accvgpr_read_b32 v37, a65
v_accvgpr_read_b32 v38, a66
v_accvgpr_read_b32 v39, a67
v_max3_u32 v20, v20, v37, v39
v_min3_u32 v21, v21, v37, v39
v_add_f32 v32, v32, v36
v_add_f32 v34, v34, v38
s_waitcnt vmcnt(7)
v_accvgpr_read_b32 v40, a68
v_accvgpr_read_b32 v41, a69
v_accvgpr_read_b32 v42, a70
v_accvgpr_read_b32 v43, a71
v_max3_u32 v20, v20, v41, v43
v_min3_u32 v21, v21, v41, v43
v_add_f32 v32, v32, v40
v_add_f32 v34, v34, v42
s_waitcnt vmcnt(6)
v_accvgpr_read_b32 v44, a72
v_accvgpr_read_b32 v45, a73
v_accvgpr_read_b32 v46, a74
v_accvgpr_read_b32 v47, a75
v_max3_u32 v20, v20, v45, v47
v_min3_u32 v21, v21, v45, v47
v_add_f32 v32, v32, v44
v_add_f32 v34, v34, v46
s_waitcnt vmcnt(4)
v_accvgpr_read_b32 v48, a76
v_accvgpr_read_b32 v49, a77
v_accvgpr_read_b32 v50, a78
v_accvgpr_read_b32 v51, a79
v_max3_u32 v20, v20, v49, v51
v_min3_u32 v21, v21, v49, v51
v_add_f32 v32, v32, v48
v_add_f32 v34, v34, v50
s_waitcnt vmcnt(3)
v_accvgpr_read_b32 v52, a80
v_accvgpr_read_b32 v53, a81
v_accvgpr_read_b32 v54, a82
v_accvgpr_read_b32 v55, a83
v_max3_u32 v20, v20, v53, v55
v_min3_u32 v21, v21, v53, v55
v_add_f32 v32, v32, v52
v_add_f32 v34, v34, v54
s_waitcnt vmcnt(1)
v_accvgpr_read_b32 v56, a84
v_accvgpr_read_b32 v57, a85
v_accvgpr_read_b32 v58, a86
v_accvgpr_read_b32 v59, a87
v_max3_u32 v20, v20, v57, v59
v_min3_u32 v21, v21, v57, v59
v_add_f32 v32, v32, v56
v_add_f32 v34, v34, v58
v_cmp_ne_u32 vcc, v20, v21
s_nop 0
s_cbranch_vccz Lz_go
Lz_slow:
buffer_load_dword v6, v5, s[40:43], 0 offen sc1
s_waitcnt vmcnt(0)
v_cmp_ne_u32 vcc, s78, v6
s_sub_u32 s79, s79, 1
s_cbranch_scc1 Lz_go
s_cbranch_vccnz Lz_slow
buffer_load_dwordx4 v[32:35], v1, s[40:43], 0 offen offset:0 sc1
buffer_load_dwordx4 v[36:39], v1, s[40:43], 0 offen offset:1024 sc1
buffer_load_dwordx4 v[40:43], v1, s[40:43], 0 offen offset:2048 sc1
buffer_load_dwordx4 v[44:47], v1, s[40:43], 0 offen offset:3072 sc1
buffer_load_dwordx4 v[48:51], v2, s[40:43], 0 offen offset:0 sc1
buffer_load_dwordx4 v[52:55], v2, s[40:43], 0 offen offset:1024 sc1
buffer_load_dwordx4 v[56:59], v2, s[40:43], 0 offen offset:2048 sc1
buffer_load_dwordx4 v[60:63], v2, s[40:43], 0 offen offset:3072 sc1
buffer_load_dwordx4 a[64:67], v3, s[40:43], 0 offen offset:0 sc1
buffer_load_dwordx4 a[68:71], v3, s[40:43], 0 offen offset:1024 sc1
buffer_load_dwordx4 a[72:75], v3, s[40:43], 0 offen offset:2048 sc1
buffer_load_dwordx4 a[76:79], v3, s[40:43], 0 offen offset:3072 sc1
buffer_load_dwordx4 a[80:83], v4, s[40:43], 0 offen offset:0 sc1
buffer_load_dwordx4 a[84:87], v4, s[40:43], 0 offen offset:1024 sc1
s_waitcnt vmcnt(0)
s_branch Lz_chk
Lz_go:
s_barrier
s_add_u32 s31, s31, 1
v_readlane_b32 s28, v14, s31
s_add_u32 m0, s25, 98304
s_nop 0
buffer_load_dwordx4 v10, s[44:47], s29 offen offset:0 lds
v_mul_f32 v16, 0x3a124925, v32
v_mul_f32 v17, 0x3a124925, v34
v_fma_f32 v17, -v16, v16, v17
v_max_f32 v17, 0, v17
buffer_load_dwordx4 v11, s[44:47], s29 offen offset:1024 lds
v_cvt_pk_bf16_f32 v16, v16, v16
v_and_b32 v16, 0xffff0000, v16
v_cvt_pk_bf16_f32 v17, v17, v17
v_and_b32 v17, 0xffff0000, v17
buffer_load_dwordx4 v12, s[44:47], s29 offen offset:2048 lds
v_add_f32 v17, 0x3727c5ac, v17
v_cvt_pk_bf16_f32 v17, v17, v17
v_and_b32 v17, 0xffff0000, v17
v_sqrt_f32 v17, v17
buffer_load_dwordx4 v13, s[44:47], s29 offen offset:3072 lds
v_cvt_pk_bf16_f32 v17, v17, v17
v_and_b32 v17, 0xffff0000, v17
v_rcp_f32 v17, v17
s_nop 0
v_mul_f32 v16, v16, v17
s_mul_i32 s29, s28, 224
s_add_u32 m0, s24, 0
s_nop 0
buffer_load_dwordx4 v8, s[8:11], s28 offen offset:0 sc1 lds
v_mov_b32_dpp v32, v17 row_newbcast:0 row_mask:0xf bank_mask:0xf
v_mov_b32_dpp v48, v16 row_newbcast:0 row_mask:0xf bank_mask:0xf
v_mov_b32_dpp v33, v17 row_newbcast:1 row_mask:0xf bank_mask:0xf
v_mov_b32_dpp v49, v16 row_newbcast:1 row_mask:0xf bank_mask:0xf
buffer_load_dwordx4 v8, s[8:11], s28 offen offset:1024 sc1 lds
v_mov_b32_dpp v34, v17 row_newbcast:2 row_mask:0xf bank_mask:0xf
v_mov_b32_dpp v50, v16 row_newbcast:2 row_mask:0xf bank_mask:0xf
v_mov_b32_dpp v35, v17 row_newbcast:3 row_mask:0xf bank_mask:0xf
v_mov_b32_dpp v51, v16 row_newbcast:3 row_mask:0xf bank_mask:0xf
buffer_load_dwordx4 v9, s[8:11], s28 offen offset:2048 sc1 lds
v_mov_b32_dpp v36, v17 row_newbcast:4 row_mask:0xf bank_mask:0xf
v_mov_b32_dpp v52, v16 row_newbcast:4 row_mask:0xf bank_mask:0xf
v_mov_b32_dpp v37, v17 row_newbcast:5 row_mask:0xf bank_mask:0xf
v_mov_b32_dpp v53, v16 row_newbcast:5 row_mask:0xf bank_mask:0xf
buffer_load_dwordx4 v9, s[8:11], s28 offen offset:3072 sc1 lds
v_mov_b32_dpp v38, v17 row_newbcast:6 row_mask:0xf bank_mask:0xf
v_mov_b32_dpp v54, v16 row_newbcast:6 row_mask:0xf bank_mask:0xf
v_mov_b32_dpp v39, v17 row_newbcast:7 row_mask:0xf bank_mask:0xf
v_mov_b32_dpp v55, v16 row_newbcast:7 row_mask:0xf bank_mask:0xf
s_add_u32 m0, s25, 0
s_nop 0
buffer_load_dwordx4 v10, s[44:47], s29 offen offset:0 lds
v_mov_b32_dpp v40, v17 row_newbcast:8 row_mask:0xf bank_mask:0xf
v_mov_b32_dpp v56, v16 row_newbcast:8 row_mask:0xf bank_mask:0xf
v_mov_b32_dpp v41, v17 row_newbcast:9 row_mask:0xf bank_mask:0xf
v_mov_b32_dpp v57, v16 row_newbcast:9 row_mask:0xf bank_mask:0xf
buffer_load_dwordx4 v11, s[44:47], s29 offen offset:1024 lds
v_mov_b32_dpp v42, v17 row_newbcast:10 row_mask:0xf bank_mask:0xf
v_mov_b32_dpp v58, v16 row_newbcast:10 row_mask:0xf bank_mask:0xf
v_mov_b32_dpp v43, v17 row_newbcast:11 row_mask:0xf bank_mask:0xf
v_mov_b32_dpp v59, v16 row_newbcast:11 row_mask:0xf bank_mask:0xf
buffer_load_dwordx4 v12, s[44:47], s29 offen offset:2048 lds
v_mov_b32_dpp v44, v17 row_newbcast:12 row_mask:0xf bank_mask:0xf
v_mov_b32_dpp v60, v16 row_newbcast:12 row_mask:0xf bank_mask:0xf
v_mov_b32_dpp v45, v17 row_newbcast:13 row_mask:0xf bank_mask:0xf
v_mov_b32_dpp v61, v16 row_newbcast:13 row_mask:0xf bank_mask:0xf
buffer_load_dwordx4 v13, s[44:47], s29 offen offset:3072 lds
v_mov_b32_dpp v46, v17 row_newbcast:14 row_mask:0xf bank_mask:0xf
v_mov_b32_dpp v62, v16 row_newbcast:14 row_mask:0xf bank_mask:0xf
v_mov_b32_dpp v47, v17 row_newbcast:15 row_mask:0xf bank_mask:0xf
v_mov_b32_dpp v63, v16 row_newbcast:15 row_mask:0xf bank_mask:0xf
v_lshrrev_b32 v1, 4, v0
v_and_b32 v2, 1, v1
v_lshrrev_b32 v1, 1, v1
v_lshl_add_u32 v1, v2, 1, v1
v_lshlrev_b32 v1, 8, v1
v_and_b32 v2, 15, v0
v_lshl_add_u32 v1, v2, 4, v1
s_lshl_b32 s27, s6, 13
s_lshl_b32 s38, s3, 11
s_add_u32 s27, s27, s38
s_mul_i32 s38, s7, 524288
s_add_u32 s27, s27, s38
v_pk_fma_f32 v[128:129], v[128:129], v[32:33], v[48:49] neg_lo:[0,0,1] neg_hi:[0,0,1]
v_pk_fma_f32 v[130:131], v[130:131], v[34:35], v[50:51] neg_lo:[0,0,1] neg_hi:[0,0,1]
v_pk_fma_f32 v[160:161], v[160:161], v[36:37], v[52:53] neg_lo:[0,0,1] neg_hi:[0,0,1]
v_pk_fma_f32 v[162:163], v[162:163], v[38:39], v[54:55] neg_lo:[0,0,1] neg_hi:[0,0,1]
v_cvt_pk_bf16_f32 v128, v128, v129
v_cvt_pk_bf16_f32 v129, v130, v131
v_cvt_pk_bf16_f32 v130, v160, v161
v_cvt_pk_bf16_f32 v131, v162, v163
s_nop 0
v_permlane16_swap_b32 v128, v130
v_permlane16_swap_b32 v129, v131
buffer_store_dwordx4 v[128:131], v1, s[52:55], s27 offen offset:0 sc1
v_pk_fma_f32 v[192:193], v[192:193], v[40:41], v[56:57] neg_lo:[0,0,1] neg_hi:[0,0,1]
v_pk_fma_f32 v[194:195], v[194:195], v[42:43], v[58:59] neg_lo:[0,0,1] neg_hi:[0,0,1]
v_pk_fma_f32 v[224:225], v[224:225], v[44:45], v[60:61] neg_lo:[0,0,1] neg_hi:[0,0,1]
v_pk_fma_f32 v[226:227], v[226:227], v[46:47], v[62:63] neg_lo:[0,0,1] neg_hi:[0,0,1]
v_cvt_pk_bf16_f32 v192, v192, v193
v_cvt_pk_bf16_f32 v193, v194, v195
v_cvt_pk_bf16_f32 v194, v224, v225
v_cvt_pk_bf16_f32 v195, v226, v227
s_nop 0
v_permlane16_swap_b32 v192, v194
v_permlane16_swap_b32 v193, v195
buffer_store_dwordx4 v[192:195], v1, s[52:55], s27 offen offset:1024 sc1
s_add_u32 s27, s27, 65536
v_pk_fma_f32 v[132:133], v[132:133], v[32:33], v[48:49] neg_lo:[0,0,1] neg_hi:[0,0,1]
v_pk_fma_f32 v[134:135], v[134:135], v[34:35], v[50:51] neg_lo:[0,0,1] neg_hi:[0,0,1]
v_pk_fma_f32 v[164:165], v[164:165], v[36:37], v[52:53] neg_lo:[0,0,1] neg_hi:[0,0,1]
v_pk_fma_f32 v[166:167], v[166:167], v[38:39], v[54:55] neg_lo:[0,0,1] neg_hi:[0,0,1]
v_cvt_pk_bf16_f32 v132, v132, v133
v_cvt_pk_bf16_f32 v133, v134, v135
v_cvt_pk_bf16_f32 v134, v164, v165
v_cvt_pk_bf16_f32 v135, v166, v167
s_nop 0
v_permlane16_swap_b32 v132, v134
v_permlane16_swap_b32 v133, v135
buffer_store_dwordx4 v[132:135], v1, s[52:55], s27 offen offset:0 sc1
v_pk_fma_f32 v[196:197], v[196:197], v[40:41], v[56:57] neg_lo:[0,0,1] neg_hi:[0,0,1]
v_pk_fma_f32 v[198:199], v[198:199], v[42:43], v[58:59] neg_lo:[0,0,1] neg_hi:[0,0,1]
v_pk_fma_f32 v[228:229], v[228:229], v[44:45], v[60:61] neg_lo:[0,0,1] neg_hi:[0,0,1]
v_pk_fma_f32 v[230:231], v[230:231], v[46:47], v[62:63] neg_lo:[0,0,1] neg_hi:[0,0,1]
v_cvt_pk_bf16_f32 v196, v196, v197
v_cvt_pk_bf16_f32 v197, v198, v199
v_cvt_pk_bf16_f32 v198, v228, v229
v_cvt_pk_bf16_f32 v199, v230, v231
s_nop 0
v_permlane16_swap_b32 v196, v198
v_permlane16_swap_b32 v197, v199
buffer_store_dwordx4 v[196:199], v1, s[52:55], s27 offen offset:1024 sc1
s_add_u32 s27, s27, 65536
v_pk_fma_f32 v[136:137], v[136:137], v[32:33], v[48:49] neg_lo:[0,0,1] neg_hi:[0,0,1]
v_pk_fma_f32 v[138:139], v[138:139], v[34:35], v[50:51] neg_lo:[0,0,1] neg_hi:[0,0,1]
v_pk_fma_f32 v[168:169], v[168:169], v[36:37], v[52:53] neg_lo:[0,0,1] neg_hi:[0,0,1]
v_pk_fma_f32 v[170:171], v[170:171], v[38:39], v[54:55] neg_lo:[0,0,1] neg_hi:[0,0,1]
v_cvt_pk_bf16_f32 v136, v136, v137
v_cvt_pk_bf16_f32 v137, v138, v139
v_cvt_pk_bf16_f32 v138, v168, v169
v_cvt_pk_bf16_f32 v139, v170, v171
s_nop 0
v_permlane16_swap_b32 v136, v138
v_permlane16_swap_b32 v137, v139
buffer_store_dwordx4 v[136:139], v1, s[52:55], s27 offen offset:0 sc1
v_pk_fma_f32 v[200:201], v[200:201], v[40:41], v[56:57] neg_lo:[0,0,1] neg_hi:[0,0,1]
v_pk_fma_f32 v[202:203], v[202:203], v[42:43], v[58:59] neg_lo:[0,0,1] neg_hi:[0,0,1]
v_pk_fma_f32 v[232:233], v[232:233], v[44:45], v[60:61] neg_lo:[0,0,1] neg_hi:[0,0,1]
v_pk_fma_f32 v[234:235], v[234:235], v[46:47], v[62:63] neg_lo:[0,0,1] neg_hi:[0,0,1]
v_cvt_pk_bf16_f32 v200, v200, v201
v_cvt_pk_bf16_f32 v201, v202, v203
v_cvt_pk_bf16_f32 v202, v232, v233
v_cvt_pk_bf16_f32 v203, v234, v235
s_nop 0
v_permlane16_swap_b32 v200, v202
v_permlane16_swap_b32 v201, v203
buffer_store_dwordx4 v[200:203], v1, s[52:55], s27 offen offset:1024 sc1
s_add_u32 s27, s27, 65536
v_pk_fma_f32 v[140:141], v[140:141], v[32:33], v[48:49] neg_lo:[0,0,1] neg_hi:[0,0,1]
v_pk_fma_f32 v[142:143], v[142:143], v[34:35], v[50:51] neg_lo:[0,0,1] neg_hi:[0,0,1]
v_pk_fma_f32 v[172:173], v[172:173], v[36:37], v[52:53] neg_lo:[0,0,1] neg_hi:[0,0,1]
v_pk_fma_f32 v[174:175], v[174:175], v[38:39], v[54:55] neg_lo:[0,0,1] neg_hi:[0,0,1]
v_cvt_pk_bf16_f32 v140, v140, v141
v_cvt_pk_bf16_f32 v141, v142, v143
v_cvt_pk_bf16_f32 v142, v172, v173
v_cvt_pk_bf16_f32 v143, v174, v175
s_nop 0
v_permlane16_swap_b32 v140, v142
v_permlane16_swap_b32 v141, v143
buffer_store_dwordx4 v[140:143], v1, s[52:55], s27 offen offset:0 sc1
v_pk_fma_f32 v[204:205], v[204:205], v[40:41], v[56:57] neg_lo:[0,0,1] neg_hi:[0,0,1]
v_pk_fma_f32 v[206:207], v[206:207], v[42:43], v[58:59] neg_lo:[0,0,1] neg_hi:[0,0,1]
v_pk_fma_f32 v[236:237], v[236:237], v[44:45], v[60:61] neg_lo:[0,0,1] neg_hi:[0,0,1]
v_pk_fma_f32 v[238:239], v[238:239], v[46:47], v[62:63] neg_lo:[0,0,1] neg_hi:[0,0,1]
v_cvt_pk_bf16_f32 v204, v204, v205
v_cvt_pk_bf16_f32 v205, v206, v207
v_cvt_pk_bf16_f32 v206, v236, v237
v_cvt_pk_bf16_f32 v207, v238, v239
s_nop 0
v_permlane16_swap_b32 v204, v206
v_permlane16_swap_b32 v205, v207
buffer_store_dwordx4 v[204:207], v1, s[52:55], s27 offen offset:1024 sc1
s_add_u32 s27, s27, 65536
v_pk_fma_f32 v[144:145], v[144:145], v[32:33], v[48:49] neg_lo:[0,0,1] neg_hi:[0,0,1]
v_pk_fma_f32 v[146:147], v[146:147], v[34:35], v[50:51] neg_lo:[0,0,1] neg_hi:[0,0,1]
v_pk_fma_f32 v[176:177], v[176:177], v[36:37], v[52:53] neg_lo:[0,0,1] neg_hi:[0,0,1]
v_pk_fma_f32 v[178:179], v[178:179], v[38:39], v[54:55] neg_lo:[0,0,1] neg_hi:[0,0,1]
v_cvt_pk_bf16_f32 v144, v144, v145
v_cvt_pk_bf16_f32 v145, v146, v147
v_cvt_pk_bf16_f32 v146, v176, v177
v_cvt_pk_bf16_f32 v147, v178, v179
s_nop 0
v_permlane16_swap_b32 v144, v146
v_permlane16_swap_b32 v145, v147
buffer_store_dwordx4 v[144:147], v1, s[52:55], s27 offen offset:0 sc1
v_pk_fma_f32 v[208:209], v[208:209], v[40:41], v[56:57] neg_lo:[0,0,1] neg_hi:[0,0,1]
v_pk_fma_f32 v[210:211], v[210:211], v[42:43], v[58:59] neg_lo:[0,0,1] neg_hi:[0,0,1]
v_pk_fma_f32 v[240:241], v[240:241], v[44:45], v[60:61] neg_lo:[0,0,1] neg_hi:[0,0,1]
v_pk_fma_f32 v[242:243], v[242:243], v[46:47], v[62:63] neg_lo:[0,0,1] neg_hi:[0,0,1]
v_cvt_pk_bf16_f32 v208, v208, v209
v_cvt_pk_bf16_f32 v209, v210, v211
v_cvt_pk_bf16_f32 v210, v240, v241
v_cvt_pk_bf16_f32 v211, v242, v243
s_nop 0
v_permlane16_swap_b32 v208, v210
v_permlane16_swap_b32 v209, v211
buffer_store_dwordx4 v[208:211], v1, s[52:55], s27 offen offset:1024 sc1
s_add_u32 s27, s27, 65536
v_pk_fma_f32 v[148:149], v[148:149], v[32:33], v[48:49] neg_lo:[0,0,1] neg_hi:[0,0,1]
v_pk_fma_f32 v[150:151], v[150:151], v[34:35], v[50:51] neg_lo:[0,0,1] neg_hi:[0,0,1]
v_pk_fma_f32 v[180:181], v[180:181], v[36:37], v[52:53] neg_lo:[0,0,1] neg_hi:[0,0,1]
v_pk_fma_f32 v[182:183], v[182:183], v[38:39], v[54:55] neg_lo:[0,0,1] neg_hi:[0,0,1]
v_cvt_pk_bf16_f32 v148, v148, v149
v_cvt_pk_bf16_f32 v149, v150, v151
v_cvt_pk_bf16_f32 v150, v180, v181
v_cvt_pk_bf16_f32 v151, v182, v183
s_nop 0
v_permlane16_swap_b32 v148, v150
v_permlane16_swap_b32 v149, v151
buffer_store_dwordx4 v[148:151], v1, s[52:55], s27 offen offset:0 sc1
v_pk_fma_f32 v[212:213], v[212:213], v[40:41], v[56:57] neg_lo:[0,0,1] neg_hi:[0,0,1]
v_pk_fma_f32 v[214:215], v[214:215], v[42:43], v[58:59] neg_lo:[0,0,1] neg_hi:[0,0,1]
v_pk_fma_f32 v[244:245], v[244:245], v[44:45], v[60:61] neg_lo:[0,0,1] neg_hi:[0,0,1]
v_pk_fma_f32 v[246:247], v[246:247], v[46:47], v[62:63] neg_lo:[0,0,1] neg_hi:[0,0,1]
v_cvt_pk_bf16_f32 v212, v212, v213
v_cvt_pk_bf16_f32 v213, v214, v215
v_cvt_pk_bf16_f32 v214, v244, v245
v_cvt_pk_bf16_f32 v215, v246, v247
s_nop 0
v_permlane16_swap_b32 v212, v214
v_permlane16_swap_b32 v213, v215
buffer_store_dwordx4 v[212:215], v1, s[52:55], s27 offen offset:1024 sc1
s_add_u32 s27, s27, 65536
v_pk_fma_f32 v[152:153], v[152:153], v[32:33], v[48:49] neg_lo:[0,0,1] neg_hi:[0,0,1]
v_pk_fma_f32 v[154:155], v[154:155], v[34:35], v[50:51] neg_lo:[0,0,1] neg_hi:[0,0,1]
v_pk_fma_f32 v[184:185], v[184:185], v[36:37], v[52:53] neg_lo:[0,0,1] neg_hi:[0,0,1]
v_pk_fma_f32 v[186:187], v[186:187], v[38:39], v[54:55] neg_lo:[0,0,1] neg_hi:[0,0,1]
v_cvt_pk_bf16_f32 v152, v152, v153
v_cvt_pk_bf16_f32 v153, v154, v155
v_cvt_pk_bf16_f32 v154, v184, v185
v_cvt_pk_bf16_f32 v155, v186, v187
s_nop 0
v_permlane16_swap_b32 v152, v154
v_permlane16_swap_b32 v153, v155
buffer_store_dwordx4 v[152:155], v1, s[52:55], s27 offen offset:0 sc1
v_pk_fma_f32 v[216:217], v[216:217], v[40:41], v[56:57] neg_lo:[0,0,1] neg_hi:[0,0,1]
v_pk_fma_f32 v[218:219], v[218:219], v[42:43], v[58:59] neg_lo:[0,0,1] neg_hi:[0,0,1]
v_pk_fma_f32 v[248:249], v[248:249], v[44:45], v[60:61] neg_lo:[0,0,1] neg_hi:[0,0,1]
v_pk_fma_f32 v[250:251], v[250:251], v[46:47], v[62:63] neg_lo:[0,0,1] neg_hi:[0,0,1]
v_cvt_pk_bf16_f32 v216, v216, v217
v_cvt_pk_bf16_f32 v217, v218, v219
v_cvt_pk_bf16_f32 v218, v248, v249
v_cvt_pk_bf16_f32 v219, v250, v251
s_nop 0
v_permlane16_swap_b32 v216, v218
v_permlane16_swap_b32 v217, v219
buffer_store_dwordx4 v[216:219], v1, s[52:55], s27 offen offset:1024 sc1
s_add_u32 s27, s27, 65536
v_pk_fma_f32 v[156:157], v[156:157], v[32:33], v[48:49] neg_lo:[0,0,1] neg_hi:[0,0,1]
v_pk_fma_f32 v[158:159], v[158:159], v[34:35], v[50:51] neg_lo:[0,0,1] neg_hi:[0,0,1]
v_pk_fma_f32 v[188:189], v[188:189], v[36:37], v[52:53] neg_lo:[0,0,1] neg_hi:[0,0,1]
v_pk_fma_f32 v[190:191], v[190:191], v[38:39], v[54:55] neg_lo:[0,0,1] neg_hi:[0,0,1]
v_cvt_pk_bf16_f32 v156, v156, v157
v_cvt_pk_bf16_f32 v157, v158, v159
v_cvt_pk_bf16_f32 v158, v188, v189
v_cvt_pk_bf16_f32 v159, v190, v191
s_nop 0
v_permlane16_swap_b32 v156, v158
v_permlane16_swap_b32 v157, v159
buffer_store_dwordx4 v[156:159], v1, s[52:55], s27 offen offset:0 sc1
v_pk_fma_f32 v[220:221], v[220:221], v[40:41], v[56:57] neg_lo:[0,0,1] neg_hi:[0,0,1]
v_pk_fma_f32 v[222:223], v[222:223], v[42:43], v[58:59] neg_lo:[0,0,1] neg_hi:[0,0,1]
v_pk_fma_f32 v[252:253], v[252:253], v[44:45], v[60:61] neg_lo:[0,0,1] neg_hi:[0,0,1]
v_pk_fma_f32 v[254:255], v[254:255], v[46:47], v[62:63] neg_lo:[0,0,1] neg_hi:[0,0,1]
v_cvt_pk_bf16_f32 v220, v220, v221
v_cvt_pk_bf16_f32 v221, v222, v223
v_cvt_pk_bf16_f32 v222, v252, v253
v_cvt_pk_bf16_f32 v223, v254, v255
s_nop 0
v_permlane16_swap_b32 v220, v222
v_permlane16_swap_b32 v221, v223
buffer_store_dwordx4 v[220:223], v1, s[52:55], s27 offen offset:1024 sc1
s_cmp_ge_u32 s5, 28
s_cbranch_scc1 L_idle
s_waitcnt lgkmcnt(4)
v_mfma_f32_16x16x32_bf16 v[64:67], a[176:179], a[160:163], v[64:67]
ds_read_b64_tr_b16 a[208:209], v22 offset:36864
v_mfma_f32_16x16x32_bf16 v[80:83], a[176:179], a[164:167], v[80:83]
ds_read_b64_tr_b16 a[210:211], v22 offset:37376
v_mfma_f32_16x16x32_bf16 v[96:99], a[176:179], a[168:171], v[96:99]
v_mfma_f32_16x16x32_bf16 v[112:115], a[176:179], a[172:175], v[112:115]
ds_read_b128 a[192:195], v26 offset:33792
v_mfma_f32_16x16x32_bf16 v[116:119], a[180:183], a[172:175], v[116:119]
ds_read_b128 a[196:199], v26 offset:35840
v_mfma_f32_16x16x32_bf16 v[100:103], a[180:183], a[168:171], v[100:103]
ds_read_b128 a[200:203], v26 offset:37888
v_mfma_f32_16x16x32_bf16 v[84:87], a[180:183], a[164:167], v[84:87]
v_mfma_f32_16x16x32_bf16 v[68:71], a[180:183], a[160:163], v[68:71]
ds_read_b128 a[204:207], v26 offset:39936
s_waitcnt lgkmcnt(4)
v_mfma_f32_16x16x32_bf16 v[72:75], a[184:187], a[160:163], v[72:75]
ds_read_b64_tr_b16 a[212:213], v23 offset:36864
v_mfma_f32_16x16x32_bf16 v[88:91], a[184:187], a[164:167], v[88:91]
ds_read_b64_tr_b16 a[214:215], v23 offset:37376
v_mfma_f32_16x16x32_bf16 v[104:107], a[184:187], a[168:171], v[104:107]
v_mfma_f32_16x16x32_bf16 v[120:123], a[184:187], a[172:175], v[120:123]
ds_read_b64_tr_b16 a[216:217], v24 offset:36864
v_mfma_f32_16x16x32_bf16 v[124:127], a[188:191], a[172:175], v[124:127]
ds_read_b64_tr_b16 a[218:219], v24 offset:37376
v_mfma_f32_16x16x32_bf16 v[108:111], a[188:191], a[168:171], v[108:111]
ds_read_b64_tr_b16 a[220:221], v25 offset:36864
v_mfma_f32_16x16x32_bf16 v[92:95], a[188:191], a[164:167], v[92:95]
v_mfma_f32_16x16x32_bf16 v[76:79], a[188:191], a[160:163], v[76:79]
ds_read_b64_tr_b16 a[222:223], v25 offset:37376
s_waitcnt lgkmcnt(4)
v_mfma_f32_16x16x32_bf16 v[64:67], a[208:211], a[192:195], v[64:67]
s_barrier
ds_read_b64_tr_b16 a[176:177], v27 offset:0
v_mfma_f32_16x16x32_bf16 v[80:83], a[208:211], a[196:199], v[80:83]
ds_read_b64_tr_b16 a[178:179], v27 offset:512
v_mfma_f32_16x16x32_bf16 v[96:99], a[208:211], a[200:203], v[96:99]
v_mfma_f32_16x16x32_bf16 v[112:115], a[208:211], a[204:207], v[112:115]
ds_read_b128 a[160:163], v31 offset:0
v_mfma_f32_16x16x32_bf16 v[116:119], a[212:215], a[204:207], v[116:119]
ds_read_b128 a[164:167], v31 offset:2048
v_mfma_f32_16x16x32_bf16 v[100:103], a[212:215], a[200:203], v[100:103]
ds_read_b128 a[168:171], v31 offset:4096
v_mfma_f32_16x16x32_bf16 v[84:87], a[212:215], a[196:199], v[84:87]
v_mfma_f32_16x16x32_bf16 v[68:71], a[212:215], a[192:195], v[68:71]
ds_read_b128 a[172:175], v31 offset:6144
s_waitcnt lgkmcnt(4)
v_mfma_f32_16x16x32_bf16 v[72:75], a[216:219], a[192:195], v[72:75]
ds_read_b64_tr_b16 a[180:181], v28 offset:0
v_mfma_f32_16x16x32_bf16 v[88:91], a[216:219], a[196:199], v[88:91]
ds_read_b64_tr_b16 a[182:183], v28 offset:512
v_mfma_f32_16x16x32_bf16 v[104:107], a[216:219], a[200:203], v[104:107]
v_mfma_f32_16x16x32_bf16 v[120:123], a[216:219], a[204:207], v[120:123]
ds_read_b64_tr_b16 a[184:185], v29 offset:0
v_mfma_f32_16x16x32_bf16 v[124:127], a[220:223], a[204:207], v[124:127]
ds_read_b64_tr_b16 a[186:187], v29 offset:512
v_mfma_f32_16x16x32_bf16 v[108:111], a[220:223], a[200:203], v[108:111]
ds_read_b64_tr_b16 a[188:189], v30 offset:0
v_mfma_f32_16x16x32_bf16 v[92:95], a[220:223], a[196:199], v[92:95]
v_mfma_f32_16x16x32_bf16 v[76:79], a[220:223], a[192:195], v[76:79]
ds_read_b64_tr_b16 a[190:191], v30 offset:512
s_waitcnt lgkmcnt(4)
v_mfma_f32_16x16x32_bf16 v[64:67], a[176:179], a[160:163], v[64:67]
ds_read_b64_tr_b16 a[208:209], v27 offset:4096
v_mfma_f32_16x16x32_bf16 v[80:83], a[176:179], a[164:167], v[80:83]
ds_read_b64_tr_b16 a[210:211], v27 offset:4608
v_mfma_f32_16x16x32_bf16 v[96:99], a[176:179], a[168:171], v[96:99]
v_mfma_f32_16x16x32_bf16 v[112:115], a[176:179], a[172:175], v[112:115]
ds_read_b128 a[192:195], v31 offset:1024
v_mfma_f32_16x16x32_bf16 v[116:119], a[180:183], a[172:175], v[116:119]
ds_read_b128 a[196:199], v31 offset:3072
s_add_u32 s31, s31, 1
v_mfma_f32_16x16x32_bf16 v[100:103], a[180:183], a[168:171], v[100:103]
ds_read_b128 a[200:203], v31 offset:5120
v_mfma_f32_16x16x32_bf16 v[84:87], a[180:183], a[164:167], v[84:87]
v_mfma_f32_16x16x32_bf16 v[68:71], a[180:183], a[160:163], v[68:71]
ds_read_b128 a[204:207], v31 offset:7168
s_waitcnt lgkmcnt(4)
v_mfma_f32_16x16x32_bf16 v[72:75], a[184:187], a[160:163], v[72:75]
ds_read_b64_tr_b16 a[212:213], v28 offset:4096
v_readlane_b32 s28, v14, s31
v_mfma_f32_16x16x32_bf16 v[88:91], a[184:187], a[164:167], v[88:91]
ds_read_b64_tr_b16 a[214:215], v28 offset:4608
v_mfma_f32_16x16x32_bf16 v[104:107], a[184:187], a[168:171], v[104:107]
v_mfma_f32_16x16x32_bf16 v[120:123], a[184:187], a[172:175], v[120:123]
ds_read_b64_tr_b16 a[216:217], v29 offset:4096
v_mfma_f32_16x16x32_bf16 v[124:127], a[188:191], a[172:175], v[124:127]
ds_read_b64_tr_b16 a[218:219], v29 offset:4608
v_mfma_f32_16x16x32_bf16 v[108:111], a[188:191], a[168:171], v[108:111]
ds_read_b64_tr_b16 a[220:221], v30 offset:4096
v_mfma_f32_16x16x32_bf16 v[92:95], a[188:191], a[164:167], v[92:95]
v_mfma_f32_16x16x32_bf16 v[76:79], a[188:191], a[160:163], v[76:79]
ds_read_b64_tr_b16 a[222:223], v30 offset:4608
s_waitcnt vmcnt(0) lgkmcnt(4)
v_mfma_f32_16x16x32_bf16 v[64:67], a[208:211], a[192:195], v[64:67]
s_barrier
ds_read_b64_tr_b16 a[176:177], v27 offset:32768
v_mfma_f32_16x16x32_bf16 v[80:83], a[208:211], a[196:199], v[80:83]
ds_read_b64_tr_b16 a[178:179], v27 offset:33280
s_add_u32 m0, s24, 32768
v_mfma_f32_16x16x32_bf16 v[96:99], a[208:211], a[200:203], v[96:99]
buffer_load_dwordx4 v8, s[8:11], s28 offen offset:0 sc1 lds
v_mfma_f32_16x16x32_bf16 v[112:115], a[208:211], a[204:207], v[112:115]
ds_read_b128 a[160:163], v31 offset:32768
v_mov_b32 v1, s78
v_mfma_f32_16x16x32_bf16 v[116:119], a[212:215], a[204:207], v[116:119]
ds_read_b128 a[164:167], v31 offset:34816
buffer_store_dword v1, off, s[40:43], s1 offset:128 sc1
v_mfma_f32_16x16x32_bf16 v[100:103], a[212:215], a[200:203], v[100:103]
ds_read_b128 a[168:171], v31 offset:36864
v_mfma_f32_16x16x32_bf16 v[84:87], a[212:215], a[196:199], v[84:87]
buffer_load_dwordx4 v8, s[8:11], s28 offen offset:1024 sc1 lds
v_mfma_f32_16x16x32_bf16 v[68:71], a[212:215], a[192:195], v[68:71]
ds_read_b128 a[172:175], v31 offset:38912
s_waitcnt lgkmcnt(4)
v_mfma_f32_16x16x32_bf16 v[72:75], a[216:219], a[192:195], v[72:75]
ds_read_b64_tr_b16 a[180:181], v28 offset:32768
s_mul_i32 s29, s28, 224
v_mfma_f32_16x16x32_bf16 v[88:91], a[216:219], a[196:199], v[88:91]
ds_read_b64_tr_b16 a[182:183], v28 offset:33280
v_mfma_f32_16x16x32_bf16 v[104:107], a[216:219], a[200:203], v[104:107]
buffer_load_dwordx4 v9, s[8:11], s28 offen offset:2048 sc1 lds
v_mfma_f32_16x16x32_bf16 v[120:123], a[216:219], a[204:207], v[120:123]
ds_read_b64_tr_b16 a[184:185], v29 offset:32768
v_mfma_f32_16x16x32_bf16 v[124:127], a[220:223], a[204:207], v[124:127]
ds_read_b64_tr_b16 a[186:187], v29 offset:33280
v_mfma_f32_16x16x32_bf16 v[108:111], a[220:223], a[200:203], v[108:111]
ds_read_b64_tr_b16 a[188:189], v30 offset:32768
v_mfma_f32_16x16x32_bf16 v[92:95], a[220:223], a[196:199], v[92:95]
buffer_load_dwordx4 v9, s[8:11], s28 offen offset:3072 sc1 lds
v_mfma_f32_16x16x32_bf16 v[76:79], a[220:223], a[192:195], v[76:79]
ds_read_b64_tr_b16 a[190:191], v30 offset:33280
s_waitcnt lgkmcnt(4)
v_mfma_f32_16x16x32_bf16 v[64:67], a[176:179], a[160:163], v[64:67]
ds_read_b64_tr_b16 a[208:209], v27 offset:36864
v_mfma_f32_16x16x32_bf16 v[80:83], a[176:179], a[164:167], v[80:83]
ds_read_b64_tr_b16 a[210:211], v27 offset:37376
s_add_u32 m0, s25, 32768
v_mfma_f32_16x16x32_bf16 v[96:99], a[176:179], a[168:171], v[96:99]
buffer_load_dwordx4 v10, s[44:47], s29 offen offset:0 lds
v_mfma_f32_16x16x32_bf16 v[112:115], a[176:179], a[172:175], v[112:115]
ds_read_b128 a[192:195], v31 offset:33792
v_mfma_f32_16x16x32_bf16 v[116:119], a[180:183], a[172:175], v[116:119]
ds_read_b128 a[196:199], v31 offset:35840
s_add_u32 s31, s31, 1
v_mfma_f32_16x16x32_bf16 v[100:103], a[180:183], a[168:171], v[100:103]
ds_read_b128 a[200:203], v31 offset:37888
v_mfma_f32_16x16x32_bf16 v[84:87], a[180:183], a[164:167], v[84:87]
buffer_load_dwordx4 v11, s[44:47], s29 offen offset:1024 lds
v_mfma_f32_16x16x32_bf16 v[68:71], a[180:183], a[160:163], v[68:71]
ds_read_b128 a[204:207], v31 offset:39936
s_waitcnt lgkmcnt(4)
v_mfma_f32_16x16x32_bf16 v[72:75], a[184:187], a[160:163], v[72:75]
ds_read_b64_tr_b16 a[212:213], v28 offset:36864
v_readlane_b32 s28, v14, s31
v_mfma_f32_16x16x32_bf16 v[88:91], a[184:187], a[164:167], v[88:91]
ds_read_b64_tr_b16 a[214:215], v28 offset:37376
v_mfma_f32_16x16x32_bf16 v[104:107], a[184:187], a[168:171], v[104:107]
buffer_load_dwordx4 v12, s[44:47], s29 offen offset:2048 lds
v_mfma_f32_16x16x32_bf16 v[120:123], a[184:187], a[172:175], v[120:123]
ds_read_b64_tr_b16 a[216:217], v29 offset:36864
v_mfma_f32_16x16x32_bf16 v[124:127], a[188:191], a[172:175], v[124:127]
ds_read_b64_tr_b16 a[218:219], v29 offset:37376
v_mfma_f32_16x16x32_bf16 v[108:111], a[188:191], a[168:171], v[108:111]
ds_read_b64_tr_b16 a[220:221], v30 offset:36864
v_mfma_f32_16x16x32_bf16 v[92:95], a[188:191], a[164:167], v[92:95]
buffer_load_dwordx4 v13, s[44:47], s29 offen offset:3072 lds
v_mfma_f32_16x16x32_bf16 v[76:79], a[188:191], a[160:163], v[76:79]
ds_read_b64_tr_b16 a[222:223], v30 offset:37376
s_waitcnt lgkmcnt(4)
v_mfma_f32_16x16x32_bf16 v[64:67], a[208:211], a[192:195], v[64:67]
s_barrier
ds_read_b64_tr_b16 a[176:177], v22 offset:0
v_mfma_f32_16x16x32_bf16 v[80:83], a[208:211], a[196:199], v[80:83]
ds_read_b64_tr_b16 a[178:179], v22 offset:512
s_add_u32 m0, s24, 65536
v_mfma_f32_16x16x32_bf16 v[96:99], a[208:211], a[200:203], v[96:99]
buffer_load_dwordx4 v8, s[8:11], s28 offen offset:0 sc1 lds
v_mfma_f32_16x16x32_bf16 v[112:115], a[208:211], a[204:207], v[112:115]
ds_read_b128 a[160:163], v26 offset:0
v_mfma_f32_16x16x32_bf16 v[116:119], a[212:215], a[204:207], v[116:119]
ds_read_b128 a[164:167], v26 offset:2048
v_mfma_f32_16x16x32_bf16 v[100:103], a[212:215], a[200:203], v[100:103]
ds_read_b128 a[168:171], v26 offset:4096
v_mfma_f32_16x16x32_bf16 v[84:87], a[212:215], a[196:199], v[84:87]
buffer_load_dwordx4 v8, s[8:11], s28 offen offset:1024 sc1 lds
v_mfma_f32_16x16x32_bf16 v[68:71], a[212:215], a[192:195], v[68:71]
ds_read_b128 a[172:175], v26 offset:6144
s_waitcnt lgkmcnt(4)
v_mfma_f32_16x16x32_bf16 v[72:75], a[216:219], a[192:195], v[72:75]
ds_read_b64_tr_b16 a[180:181], v23 offset:0
s_mul_i32 s29, s28, 224
v_mfma_f32_16x16x32_bf16 v[88:91], a[216:219], a[196:199], v[88:91]
ds_read_b64_tr_b16 a[182:183], v23 offset:512
v_mfma_f32_16x16x32_bf16 v[104:107], a[216:219], a[200:203], v[104:107]
buffer_load_dwordx4 v9, s[8:11], s28 offen offset:2048 sc1 lds
v_mfma_f32_16x16x32_bf16 v[120:123], a[216:219], a[204:207], v[120:123]
ds_read_b64_tr_b16 a[184:185], v24 offset:0
v_mfma_f32_16x16x32_bf16 v[124:127], a[220:223], a[204:207], v[124:127]
ds_read_b64_tr_b16 a[186:187], v24 offset:512
v_mfma_f32_16x16x32_bf16 v[108:111], a[220:223], a[200:203], v[108:111]
ds_read_b64_tr_b16 a[188:189], v25 offset:0
v_mfma_f32_16x16x32_bf16 v[92:95], a[220:223], a[196:199], v[92:95]
buffer_load_dwordx4 v9, s[8:11], s28 offen offset:3072 sc1 lds
v_mfma_f32_16x16x32_bf16 v[76:79], a[220:223], a[192:195], v[76:79]
ds_read_b64_tr_b16 a[190:191], v25 offset:512
s_waitcnt lgkmcnt(4)
v_mfma_f32_16x16x32_bf16 v[64:67], a[176:179], a[160:163], v[64:67]
ds_read_b64_tr_b16 a[208:209], v22 offset:4096
v_mfma_f32_16x16x32_bf16 v[80:83], a[176:179], a[164:167], v[80:83]
ds_read_b64_tr_b16 a[210:211], v22 offset:4608
s_add_u32 m0, s25, 65536
v_mfma_f32_16x16x32_bf16 v[96:99], a[176:179], a[168:171], v[96:99]
buffer_load_dwordx4 v10, s[44:47], s29 offen offset:0 lds
v_mfma_f32_16x16x32_bf16 v[112:115], a[176:179], a[172:175], v[112:115]
ds_read_b128 a[192:195], v26 offset:1024
v_mfma_f32_16x16x32_bf16 v[116:119], a[180:183], a[172:175], v[116:119]
ds_read_b128 a[196:199], v26 offset:3072
s_add_u32 s31, s31, 1
v_mfma_f32_16x16x32_bf16 v[100:103], a[180:183], a[168:171], v[100:103]
ds_read_b128 a[200:203], v26 offset:5120
v_mfma_f32_16x16x32_bf16 v[84:87], a[180:183], a[164:167], v[84:87]
buffer_load_dwordx4 v11, s[44:47], s29 offen offset:1024 lds
v_mfma_f32_16x16x32_bf16 v[68:71], a[180:183], a[160:163], v[68:71]
ds_read_b128 a[204:207], v26 offset:7168
s_waitcnt lgkmcnt(4)
v_mfma_f32_16x16x32_bf16 v[72:75], a[184:187], a[160:163], v[72:75]
ds_read_b64_tr_b16 a[212:213], v23 offset:4096
v_readlane_b32 s28, v14, s31
v_mfma_f32_16x16x32_bf16 v[88:91], a[184:187], a[164:167], v[88:91]
ds_read_b64_tr_b16 a[214:215], v23 offset:4608
v_mfma_f32_16x16x32_bf16 v[104:107], a[184:187], a[168:171], v[104:107]
buffer_load_dwordx4 v12, s[44:47], s29 offen offset:2048 lds
v_mfma_f32_16x16x32_bf16 v[120:123], a[184:187], a[172:175], v[120:123]
ds_read_b64_tr_b16 a[216:217], v24 offset:4096
v_mfma_f32_16x16x32_bf16 v[124:127], a[188:191], a[172:175], v[124:127]
ds_read_b64_tr_b16 a[218:219], v24 offset:4608
v_mfma_f32_16x16x32_bf16 v[108:111], a[188:191], a[168:171], v[108:111]
ds_read_b64_tr_b16 a[220:221], v25 offset:4096
v_mfma_f32_16x16x32_bf16 v[92:95], a[188:191], a[164:167], v[92:95]
buffer_load_dwordx4 v13, s[44:47], s29 offen offset:3072 lds
v_mfma_f32_16x16x32_bf16 v[76:79], a[188:191], a[160:163], v[76:79]
ds_read_b64_tr_b16 a[222:223], v25 offset:4608
s_waitcnt vmcnt(8) lgkmcnt(4)
v_mfma_f32_16x16x32_bf16 v[64:67], a[208:211], a[192:195], v[64:67]
s_barrier
ds_read_b64_tr_b16 a[176:177], v22 offset:32768
v_mfma_f32_16x16x32_bf16 v[80:83], a[208:211], a[196:199], v[80:83]
ds_read_b64_tr_b16 a[178:179], v22 offset:33280
s_add_u32 m0, s24, 98304
v_mfma_f32_16x16x32_bf16 v[96:99], a[208:211], a[200:203], v[96:99]
buffer_load_dwordx4 v8, s[8:11], s28 offen offset:0 sc1 lds
v_mfma_f32_16x16x32_bf16 v[112:115], a[208:211], a[204:207], v[112:115]
ds_read_b128 a[160:163], v26 offset:32768
v_mfma_f32_16x16x32_bf16 v[116:119], a[212:215], a[204:207], v[116:119]
ds_read_b128 a[164:167], v26 offset:34816
v_mfma_f32_16x16x32_bf16 v[100:103], a[212:215], a[200:203], v[100:103]
ds_read_b128 a[168:171], v26 offset:36864
v_mfma_f32_16x16x32_bf16 v[84:87], a[212:215], a[196:199], v[84:87]
buffer_load_dwordx4 v8, s[8:11], s28 offen offset:1024 sc1 lds
v_mfma_f32_16x16x32_bf16 v[68:71], a[212:215], a[192:195], v[68:71]
ds_read_b128 a[172:175], v26 offset:38912
s_waitcnt lgkmcnt(4)
v_mfma_f32_16x16x32_bf16 v[72:75], a[216:219], a[192:195], v[72:75]
ds_read_b64_tr_b16 a[180:181], v23 offset:32768
s_mul_i32 s29, s28, 224
v_mfma_f32_16x16x32_bf16 v[88:91], a[216:219], a[196:199], v[88:91]
ds_read_b64_tr_b16 a[182:183], v23 offset:33280
v_mfma_f32_16x16x32_bf16 v[104:107], a[216:219], a[200:203], v[104:107]
buffer_load_dwordx4 v9, s[8:11], s28 offen offset:2048 sc1 lds
v_mfma_f32_16x16x32_bf16 v[120:123], a[216:219], a[204:207], v[120:123]
ds_read_b64_tr_b16 a[184:185], v24 offset:32768
v_mfma_f32_16x16x32_bf16 v[124:127], a[220:223], a[204:207], v[124:127]
ds_read_b64_tr_b16 a[186:187], v24 offset:33280
v_mfma_f32_16x16x32_bf16 v[108:111], a[220:223], a[200:203], v[108:111]
ds_read_b64_tr_b16 a[188:189], v25 offset:32768
v_mfma_f32_16x16x32_bf16 v[92:95], a[220:223], a[196:199], v[92:95]
buffer_load_dwordx4 v9, s[8:11], s28 offen offset:3072 sc1 lds
v_mfma_f32_16x16x32_bf16 v[76:79], a[220:223], a[192:195], v[76:79]
ds_read_b64_tr_b16 a[190:191], v25 offset:33280
s_waitcnt lgkmcnt(4)
v_mfma_f32_16x16x32_bf16 v[64:67], a[176:179], a[160:163], v[64:67]
ds_read_b64_tr_b16 a[208:209], v22 offset:36864
v_mfma_f32_16x16x32_bf16 v[80:83], a[176:179], a[164:167], v[80:83]
ds_read_b64_tr_b16 a[210:211], v22 offset:37376
s_add_u32 m0, s25, 98304
v_mfma_f32_16x16x32_bf16 v[96:99], a[176:179], a[168:171], v[96:99]
buffer_load_dwordx4 v10, s[44:47], s29 offen offset:0 lds
v_mfma_f32_16x16x32_bf16 v[112:115], a[176:179], a[172:175], v[112:115]
ds_read_b128 a[192:195], v26 offset:33792
v_mfma_f32_16x16x32_bf16 v[116:119], a[180:183], a[172:175], v[116:119]
ds_read_b128 a[196:199], v26 offset:35840
s_add_u32 s31, s31, 1
v_mfma_f32_16x16x32_bf16 v[100:103], a[180:183], a[168:171], v[100:103]
ds_read_b128 a[200:203], v26 offset:37888
v_mfma_f32_16x16x32_bf16 v[84:87], a[180:183], a[164:167], v[84:87]
buffer_load_dwordx4 v11, s[44:47], s29 offen offset:1024 lds
v_mfma_f32_16x16x32_bf16 v[68:71], a[180:183], a[160:163], v[68:71]
ds_read_b128 a[204:207], v26 offset:39936
s_waitcnt lgkmcnt(4)
v_mfma_f32_16x16x32_bf16 v[72:75], a[184:187], a[160:163], v[72:75]
ds_read_b64_tr_b16 a[212:213], v23 offset:36864
v_readlane_b32 s28, v14, s31
v_mfma_f32_16x16x32_bf16 v[88:91], a[184:187], a[164:167], v[88:91]
ds_read_b64_tr_b16 a[214:215], v23 offset:37376
v_mfma_f32_16x16x32_bf16 v[104:107], a[184:187], a[168:171], v[104:107]
buffer_load_dwordx4 v12, s[44:47], s29 offen offset:2048 lds
v_mfma_f32_16x16x32_bf16 v[120:123], a[184:187], a[172:175], v[120:123]
ds_read_b64_tr_b16 a[216:217], v24 offset:36864
v_mfma_f32_16x16x32_bf16 v[124:127], a[188:191], a[172:175], v[124:127]
ds_read_b64_tr_b16 a[218:219], v24 offset:37376
v_mfma_f32_16x16x32_bf16 v[108:111], a[188:191], a[168:171], v[108:111]
ds_read_b64_tr_b16 a[220:221], v25 offset:36864
v_mfma_f32_16x16x32_bf16 v[92:95], a[188:191], a[164:167], v[92:95]
buffer_load_dwordx4 v13, s[44:47], s29 offen offset:3072 lds
v_mfma_f32_16x16x32_bf16 v[76:79], a[188:191], a[160:163], v[76:79]
ds_read_b64_tr_b16 a[222:223], v25 offset:37376
s_waitcnt vmcnt(8) lgkmcnt(4)
v_mfma_f32_16x16x32_bf16 v[64:67], a[208:211], a[192:195], v[64:67]
s_barrier
ds_read_b64_tr_b16 a[176:177], v27 offset:0
v_mfma_f32_16x16x32_bf16 v[80:83], a[208:211], a[196:199], v[80:83]
ds_read_b64_tr_b16 a[178:179], v27 offset:512
s_add_u32 m0, s24, 0
v_mfma_f32_16x16x32_bf16 v[96:99], a[208:211], a[200:203], v[96:99]
buffer_load_dwordx4 v8, s[8:11], s28 offen offset:0 sc1 lds
v_mfma_f32_16x16x32_bf16 v[112:115], a[208:211], a[204:207], v[112:115]
ds_read_b128 a[160:163], v31 offset:0
v_mfma_f32_16x16x32_bf16 v[116:119], a[212:215], a[204:207], v[116:119]
ds_read_b128 a[164:167], v31 offset:2048
v_mfma_f32_16x16x32_bf16 v[100:103], a[212:215], a[200:203], v[100:103]
ds_read_b128 a[168:171], v31 offset:4096
v_mfma_f32_16x16x32_bf16 v[84:87], a[212:215], a[196:199], v[84:87]
buffer_load_dwordx4 v8, s[8:11], s28 offen offset:1024 sc1 lds
v_mfma_f32_16x16x32_bf16 v[68:71], a[212:215], a[192:195], v[68:71]
ds_read_b128 a[172:175], v31 offset:6144
s_waitcnt lgkmcnt(4)
v_mfma_f32_16x16x32_bf16 v[72:75], a[216:219], a[192:195], v[72:75]
ds_read_b64_tr_b16 a[180:181], v28 offset:0
s_mul_i32 s29, s28, 224
v_mfma_f32_16x16x32_bf16 v[88:91], a[216:219], a[196:199], v[88:91]
ds_read_b64_tr_b16 a[182:183], v28 offset:512
v_mfma_f32_16x16x32_bf16 v[104:107], a[216:219], a[200:203], v[104:107]
buffer_load_dwordx4 v9, s[8:11], s28 offen offset:2048 sc1 lds
v_mfma_f32_16x16x32_bf16 v[120:123], a[216:219], a[204:207], v[120:123]
ds_read_b64_tr_b16 a[184:185], v29 offset:0
v_mfma_f32_16x16x32_bf16 v[124:127], a[220:223], a[204:207], v[124:127]
ds_read_b64_tr_b16 a[186:187], v29 offset:512
v_mfma_f32_16x16x32_bf16 v[108:111], a[220:223], a[200:203], v[108:111]
ds_read_b64_tr_b16 a[188:189], v30 offset:0
v_mfma_f32_16x16x32_bf16 v[92:95], a[220:223], a[196:199], v[92:95]
buffer_load_dwordx4 v9, s[8:11], s28 offen offset:3072 sc1 lds
v_mfma_f32_16x16x32_bf16 v[76:79], a[220:223], a[192:195], v[76:79]
ds_read_b64_tr_b16 a[190:191], v30 offset:512
s_waitcnt lgkmcnt(4)
v_mfma_f32_16x16x32_bf16 v[64:67], a[176:179], a[160:163], v[64:67]
ds_read_b64_tr_b16 a[208:209], v27 offset:4096
v_mfma_f32_16x16x32_bf16 v[80:83], a[176:179], a[164:167], v[80:83]
ds_read_b64_tr_b16 a[210:211], v27 offset:4608
s_add_u32 m0, s25, 0
v_mfma_f32_16x16x32_bf16 v[96:99], a[176:179], a[168:171], v[96:99]
buffer_load_dwordx4 v10, s[44:47], s29 offen offset:0 lds
v_mfma_f32_16x16x32_bf16 v[112:115], a[176:179], a[172:175], v[112:115]
ds_read_b128 a[192:195], v31 offset:1024
v_mfma_f32_16x16x32_bf16 v[116:119], a[180:183], a[172:175], v[116:119]
ds_read_b128 a[196:199], v31 offset:3072
s_add_u32 s31, s31, 1
v_mfma_f32_16x16x32_bf16 v[100:103], a[180:183], a[168:171], v[100:103]
ds_read_b128 a[200:203], v31 offset:5120
v_mfma_f32_16x16x32_bf16 v[84:87], a[180:183], a[164:167], v[84:87]
buffer_load_dwordx4 v11, s[44:47], s29 offen offset:1024 lds
v_mfma_f32_16x16x32_bf16 v[68:71], a[180:183], a[160:163], v[68:71]
ds_read_b128 a[204:207], v31 offset:7168
s_waitcnt lgkmcnt(4)
v_mfma_f32_16x16x32_bf16 v[72:75], a[184:187], a[160:163], v[72:75]
ds_read_b64_tr_b16 a[212:213], v28 offset:4096
v_readlane_b32 s28, v14, s31
v_mfma_f32_16x16x32_bf16 v[88:91], a[184:187], a[164:167], v[88:91]
ds_read_b64_tr_b16 a[214:215], v28 offset:4608
v_mfma_f32_16x16x32_bf16 v[104:107], a[184:187], a[168:171], v[104:107]
buffer_load_dwordx4 v12, s[44:47], s29 offen offset:2048 lds
v_mfma_f32_16x16x32_bf16 v[120:123], a[184:187], a[172:175], v[120:123]
ds_read_b64_tr_b16 a[216:217], v29 offset:4096
v_mfma_f32_16x16x32_bf16 v[124:127], a[188:191], a[172:175], v[124:127]
ds_read_b64_tr_b16 a[218:219], v29 offset:4608
v_mfma_f32_16x16x32_bf16 v[108:111], a[188:191], a[168:171], v[108:111]
ds_read_b64_tr_b16 a[220:221], v30 offset:4096
v_mfma_f32_16x16x32_bf16 v[92:95], a[188:191], a[164:167], v[92:95]
buffer_load_dwordx4 v13, s[44:47], s29 offen offset:3072 lds
v_mfma_f32_16x16x32_bf16 v[76:79], a[188:191], a[160:163], v[76:79]
ds_read_b64_tr_b16 a[222:223], v30 offset:4608
s_waitcnt vmcnt(8) lgkmcnt(4)
v_mfma_f32_16x16x32_bf16 v[64:67], a[208:211], a[192:195], v[64:67]
s_barrier
ds_read_b64_tr_b16 a[176:177], v27 offset:32768
v_mfma_f32_16x16x32_bf16 v[80:83], a[208:211], a[196:199], v[80:83]
ds_read_b64_tr_b16 a[178:179], v27 offset:33280
s_add_u32 m0, s24, 32768
v_mfma_f32_16x16x32_bf16 v[96:99], a[208:211], a[200:203], v[96:99]
buffer_load_dwordx4 v8, s[8:11], s28 offen offset:0 sc1 lds
v_mfma_f32_16x16x32_bf16 v[112:115], a[208:211], a[204:207], v[112:115]
ds_read_b128 a[160:163], v31 offset:32768
v_mfma_f32_16x16x32_bf16 v[116:119], a[212:215], a[204:207], v[116:119]
ds_read_b128 a[164:167], v31 offset:34816
v_mfma_f32_16x16x32_bf16 v[100:103], a[212:215], a[200:203], v[100:103]
ds_read_b128 a[168:171], v31 offset:36864
v_mfma_f32_16x16x32_bf16 v[84:87], a[212:215], a[196:199], v[84:87]
buffer_load_dwordx4 v8, s[8:11], s28 offen offset:1024 sc1 lds
v_mfma_f32_16x16x32_bf16 v[68:71], a[212:215], a[192:195], v[68:71]
ds_read_b128 a[172:175], v31 offset:38912
s_waitcnt lgkmcnt(4)
v_mfma_f32_16x16x32_bf16 v[72:75], a[216:219], a[192:195], v[72:75]
ds_read_b64_tr_b16 a[180:181], v28 offset:32768
s_mul_i32 s29, s28, 224
v_mfma_f32_16x16x32_bf16 v[88:91], a[216:219], a[196:199], v[88:91]
ds_read_b64_tr_b16 a[182:183], v28 offset:33280
v_mfma_f32_16x16x32_bf16 v[104:107], a[216:219], a[200:203], v[104:107]
buffer_load_dwordx4 v9, s[8:11], s28 offen offset:2048 sc1 lds
v_mfma_f32_16x16x32_bf16 v[120:123], a[216:219], a[204:207], v[120:123]
ds_read_b64_tr_b16 a[184:185], v29 offset:32768
v_mfma_f32_16x16x32_bf16 v[124:127], a[220:223], a[204:207], v[124:127]
ds_read_b64_tr_b16 a[186:187], v29 offset:33280
v_mfma_f32_16x16x32_bf16 v[108:111], a[220:223], a[200:203], v[108:111]
ds_read_b64_tr_b16 a[188:189], v30 offset:32768
v_mfma_f32_16x16x32_bf16 v[92:95], a[220:223], a[196:199], v[92:95]
buffer_load_dwordx4 v9, s[8:11], s28 offen offset:3072 sc1 lds
v_mfma_f32_16x16x32_bf16 v[76:79], a[220:223], a[192:195], v[76:79]
ds_read_b64_tr_b16 a[190:191], v30 offset:33280
s_waitcnt lgkmcnt(4)
v_mfma_f32_16x16x32_bf16 v[64:67], a[176:179], a[160:163], v[64:67]
ds_read_b64_tr_b16 a[208:209], v27 offset:36864
v_mfma_f32_16x16x32_bf16 v[80:83], a[176:179], a[164:167], v[80:83]
ds_read_b64_tr_b16 a[210:211], v27 offset:37376
s_add_u32 m0, s25, 32768
v_mfma_f32_16x16x32_bf16 v[96:99], a[176:179], a[168:171], v[96:99]
buffer_load_dwordx4 v10, s[44:47], s29 offen offset:0 lds
v_mfma_f32_16x16x32_bf16 v[112:115], a[176:179], a[172:175], v[112:115]
ds_read_b128 a[192:195], v31 offset:33792
v_mfma_f32_16x16x32_bf16 v[116:119], a[180:183], a[172:175], v[116:119]
ds_read_b128 a[196:199], v31 offset:35840
s_add_u32 s31, s31, 1
v_mfma_f32_16x16x32_bf16 v[100:103], a[180:183], a[168:171], v[100:103]
ds_read_b128 a[200:203], v31 offset:37888
v_mfma_f32_16x16x32_bf16 v[84:87], a[180:183], a[164:167], v[84:87]
buffer_load_dwordx4 v11, s[44:47], s29 offen offset:1024 lds
v_mfma_f32_16x16x32_bf16 v[68:71], a[180:183], a[160:163], v[68:71]
ds_read_b128 a[204:207], v31 offset:39936
s_waitcnt lgkmcnt(4)
v_mfma_f32_16x16x32_bf16 v[72:75], a[184:187], a[160:163], v[72:75]
ds_read_b64_tr_b16 a[212:213], v28 offset:36864
v_readlane_b32 s28, v14, s31
v_mfma_f32_16x16x32_bf16 v[88:91], a[184:187], a[164:167], v[88:91]
ds_read_b64_tr_b16 a[214:215], v28 offset:37376
v_mfma_f32_16x16x32_bf16 v[104:107], a[184:187], a[168:171], v[104:107]
buffer_load_dwordx4 v12, s[44:47], s29 offen offset:2048 lds
v_mfma_f32_16x16x32_bf16 v[120:123], a[184:187], a[172:175], v[120:123]
ds_read_b64_tr_b16 a[216:217], v29 offset:36864
v_mfma_f32_16x16x32_bf16 v[124:127], a[188:191], a[172:175], v[124:127]
ds_read_b64_tr_b16 a[218:219], v29 offset:37376
v_mfma_f32_16x16x32_bf16 v[108:111], a[188:191], a[168:171], v[108:111]
ds_read_b64_tr_b16 a[220:221], v30 offset:36864
v_mfma_f32_16x16x32_bf16 v[92:95], a[188:191], a[164:167], v[92:95]
buffer_load_dwordx4 v13, s[44:47], s29 offen offset:3072 lds
v_mfma_f32_16x16x32_bf16 v[76:79], a[188:191], a[160:163], v[76:79]
ds_read_b64_tr_b16 a[222:223], v30 offset:37376
s_waitcnt vmcnt(8) lgkmcnt(4)
v_mfma_f32_16x16x32_bf16 v[64:67], a[208:211], a[192:195], v[64:67]
s_barrier
ds_read_b64_tr_b16 a[176:177], v22 offset:0
v_mfma_f32_16x16x32_bf16 v[80:83], a[208:211], a[196:199], v[80:83]
ds_read_b64_tr_b16 a[178:179], v22 offset:512
s_add_u32 m0, s24, 65536
v_mfma_f32_16x16x32_bf16 v[96:99], a[208:211], a[200:203], v[96:99]
buffer_load_dwordx4 v8, s[8:11], s28 offen offset:0 sc1 lds
v_mfma_f32_16x16x32_bf16 v[112:115], a[208:211], a[204:207], v[112:115]
ds_read_b128 a[160:163], v26 offset:0
v_mfma_f32_16x16x32_bf16 v[116:119], a[212:215], a[204:207], v[116:119]
ds_read_b128 a[164:167], v26 offset:2048
v_mfma_f32_16x16x32_bf16 v[100:103], a[212:215], a[200:203], v[100:103]
ds_read_b128 a[168:171], v26 offset:4096
v_mfma_f32_16x16x32_bf16 v[84:87], a[212:215], a[196:199], v[84:87]
buffer_load_dwordx4 v8, s[8:11], s28 offen offset:1024 sc1 lds
v_mfma_f32_16x16x32_bf16 v[68:71], a[212:215], a[192:195], v[68:71]
ds_read_b128 a[172:175], v26 offset:6144
s_waitcnt lgkmcnt(4)
v_mfma_f32_16x16x32_bf16 v[72:75], a[216:219], a[192:195], v[72:75]
ds_read_b64_tr_b16 a[180:181], v23 offset:0
s_mul_i32 s29, s28, 224
v_mfma_f32_16x16x32_bf16 v[88:91], a[216:219], a[196:199], v[88:91]
ds_read_b64_tr_b16 a[182:183], v23 offset:512
v_mfma_f32_16x16x32_bf16 v[104:107], a[216:219], a[200:203], v[104:107]
buffer_load_dwordx4 v9, s[8:11], s28 offen offset:2048 sc1 lds
v_mfma_f32_16x16x32_bf16 v[120:123], a[216:219], a[204:207], v[120:123]
ds_read_b64_tr_b16 a[184:185], v24 offset:0
v_mfma_f32_16x16x32_bf16 v[124:127], a[220:223], a[204:207], v[124:127]
ds_read_b64_tr_b16 a[186:187], v24 offset:512
v_mfma_f32_16x16x32_bf16 v[108:111], a[220:223], a[200:203], v[108:111]
ds_read_b64_tr_b16 a[188:189], v25 offset:0
v_mfma_f32_16x16x32_bf16 v[92:95], a[220:223], a[196:199], v[92:95]
buffer_load_dwordx4 v9, s[8:11], s28 offen offset:3072 sc1 lds
v_mfma_f32_16x16x32_bf16 v[76:79], a[220:223], a[192:195], v[76:79]
ds_read_b64_tr_b16 a[190:191], v25 offset:512
L_p2:
s_waitcnt lgkmcnt(9)
v_mfma_f32_16x16x32_bf16 v[64:67], a[176:179], a[160:163], v[64:67]
ds_read_b64_tr_b16 a[208:209], v22 offset:4096
v_accvgpr_read_b32 v47, a247
s_waitcnt lgkmcnt(9)
v_mfma_f32_16x16x32_bf16 v[80:83], a[176:179], a[164:167], v[80:83]
ds_read_b64_tr_b16 a[210:211], v22 offset:4608
s_add_u32 m0, s25, 65536
s_waitcnt lgkmcnt(9)
v_mfma_f32_16x16x32_bf16 v[96:99], a[176:179], a[168:171], v[96:99]
buffer_load_dwordx4 v10, s[44:47], s29 offen offset:0 lds
v_add_u32 v27, 65536, v22
s_waitcnt lgkmcnt(8)
v_mfma_f32_16x16x32_bf16 v[112:115], a[176:179], a[172:175], v[112:115]
ds_read_b128 a[192:195], v26 offset:1024
s_mov_b32 s32, s68
s_mov_b32 s33, s69
s_mov_b32 s34, 4096
s_mov_b32 s35, 0x20000
s_waitcnt lgkmcnt(7)
v_mfma_f32_16x16x32_bf16 v[116:119], a[180:183], a[172:175], v[116:119]
ds_read_b128 a[196:199], v26 offset:3072
s_add_u32 s31, s31, 1
v_mfma_f32_16x16x32_bf16 v[100:103], a[180:183], a[168:171], v[100:103]
ds_read_b128 a[200:203], v26 offset:5120
v_add_u32 v28, 65536, v23
v_mfma_f32_16x16x32_bf16 v[84:87], a[180:183], a[164:167], v[84:87]
buffer_load_dwordx4 v11, s[44:47], s29 offen offset:1024 lds
v_add_u32 v29, 65536, v24
v_mfma_f32_16x16x32_bf16 v[68:71], a[180:183], a[160:163], v[68:71]
ds_read_b128 a[204:207], v26 offset:7168
v_add_u32 v30, 65536, v25
s_waitcnt lgkmcnt(4)
v_mfma_f32_16x16x32_bf16 v[72:75], a[184:187], a[160:163], v[72:75]
ds_read_b64_tr_b16 a[212:213], v23 offset:4096
v_readlane_b32 s28, v14, s31
v_mfma_f32_16x16x32_bf16 v[88:91], a[184:187], a[164:167], v[88:91]
ds_read_b64_tr_b16 a[214:215], v23 offset:4608
s_lshl_b32 s27, s80, 8
s_lshl_b32 s36, s83, 7
s_add_u32 s27, s27, s36
v_mfma_f32_16x16x32_bf16 v[104:107], a[184:187], a[168:171], v[104:107]
buffer_load_dwordx4 v12, s[44:47], s29 offen offset:2048 lds
v_add_u32 v31, 65536, v26
v_mfma_f32_16x16x32_bf16 v[120:123], a[184:187], a[172:175], v[120:123]
ds_read_b64_tr_b16 a[216:217], v24 offset:4096
v_and_b32 v1, 15, v0
v_lshl_add_u32 v1, v1, 1, s27
v_mfma_f32_16x16x32_bf16 v[124:127], a[188:191], a[172:175], v[124:127]
ds_read_b64_tr_b16 a[218:219], v24 offset:4608
v_accvgpr_read_b32 v16, a224
v_mfma_f32_16x16x32_bf16 v[108:111], a[188:191], a[168:171], v[108:111]
ds_read_b64_tr_b16 a[220:221], v25 offset:4096
v_accvgpr_read_b32 v17, a225
v_mfma_f32_16x16x32_bf16 v[92:95], a[188:191], a[164:167], v[92:95]
buffer_load_dwordx4 v13, s[44:47], s29 offen offset:3072 lds
v_accvgpr_read_b32 v18, a226
v_mfma_f32_16x16x32_bf16 v[76:79], a[188:191], a[160:163], v[76:79]
ds_read_b64_tr_b16 a[222:223], v25 offset:4608
buffer_load_dword v58, v47, s[40:43], 0 offen sc1
v_accvgpr_read_b32 v19, a227
s_waitcnt vmcnt(9) lgkmcnt(4)
v_mfma_f32_16x16x32_bf16 v[64:67], a[208:211], a[192:195], v[64:67]
s_barrier
ds_read_b64_tr_b16 a[176:177], v22 offset:32768
v_mfma_f32_16x16x32_bf16 v[80:83], a[208:211], a[196:199], v[80:83]
ds_read_b64_tr_b16 a[178:179], v22 offset:33280
s_add_u32 m0, s24, 98304
v_mfma_f32_16x16x32_bf16 v[96:99], a[208:211], a[200:203], v[96:99]
buffer_load_dwordx4 v8, s[8:11], s28 offen offset:0 sc1 lds
v_accvgpr_read_b32 v20, a228
v_mfma_f32_16x16x32_bf16 v[112:115], a[208:211], a[204:207], v[112:115]
ds_read_b128 a[160:163], v26 offset:32768
buffer_load_ushort v195, v1, s[32:35], 0 offen offset:0
v_accvgpr_read_b32 v21, a229
v_mfma_f32_16x16x32_bf16 v[116:119], a[212:215], a[204:207], v[116:119]
ds_read_b128 a[164:167], v26 offset:34816
v_accvgpr_read_b32 v32, a235
v_mfma_f32_16x16x32_bf16 v[100:103], a[212:215], a[200:203], v[100:103]
ds_read_b128 a[168:171], v26 offset:36864
v_accvgpr_read_b32 v33, a236
v_mfma_f32_16x16x32_bf16 v[84:87], a[212:215], a[196:199], v[84:87]
buffer_load_dwordx4 v8, s[8:11], s28 offen offset:1024 sc1 lds
v_accvgpr_read_b32 v34, a237
v_mfma_f32_16x16x32_bf16 v[68:71], a[212:215], a[192:195], v[68:71]
ds_read_b128 a[172:175], v26 offset:38912
buffer_load_ushort v199, v1, s[32:35], 0 offen offset:32
v_accvgpr_read_b32 v38, a238
s_waitcnt lgkmcnt(4)
v_mfma_f32_16x16x32_bf16 v[72:75], a[216:219], a[192:195], v[72:75]
ds_read_b64_tr_b16 a[180:181], v23 offset:32768
s_mul_i32 s29, s28, 224
v_mfma_f32_16x16x32_bf16 v[88:91], a[216:219], a[196:199], v[88:91]
ds_read_b64_tr_b16 a[182:183], v23 offset:33280
v_accvgpr_read_b32 v39, a239
v_mfma_f32_16x16x32_bf16 v[104:107], a[216:219], a[200:203], v[104:107]
buffer_load_dwordx4 v9, s[8:11], s28 offen offset:2048 sc1 lds
v_accvgpr_read_b32 v40, a240
v_mfma_f32_16x16x32_bf16 v[120:123], a[216:219], a[204:207], v[120:123]
ds_read_b64_tr_b16 a[184:185], v24 offset:32768
buffer_load_ushort v203, v1, s[32:35], 0 offen offset:64
v_accvgpr_read_b32 v41, a241
v_mfma_f32_16x16x32_bf16 v[124:127], a[220:223], a[204:207], v[124:127]
ds_read_b64_tr_b16 a[186:187], v24 offset:33280
v_accvgpr_read_b32 v42, a242
v_mfma_f32_16x16x32_bf16 v[108:111], a[220:223], a[200:203], v[108:111]
ds_read_b64_tr_b16 a[188:189], v25 offset:32768
v_accvgpr_read_b32 v43, a243
v_mfma_f32_16x16x32_bf16 v[92:95], a[220:223], a[196:199], v[92:95]
buffer_load_dwordx4 v9, s[8:11], s28 offen offset:3072 sc1 lds
v_accvgpr_read_b32 v44, a244
v_mfma_f32_16x16x32_bf16 v[76:79], a[220:223], a[192:195], v[76:79]
ds_read_b64_tr_b16 a[190:191], v25 offset:33280
buffer_load_ushort v207, v1, s[32:35], 0 offen offset:96
v_accvgpr_read_b32 v45, a245
s_waitcnt lgkmcnt(4)
v_mfma_f32_16x16x32_bf16 v[64:67], a[176:179], a[160:163], v[64:67]
ds_read_b64_tr_b16 a[208:209], v22 offset:36864
v_accvgpr_read_b32 v46, a246
v_mfma_f32_16x16x32_bf16 v[80:83], a[176:179], a[164:167], v[80:83]
ds_read_b64_tr_b16 a[210:211], v22 offset:37376
s_add_u32 m0, s25, 98304
v_mfma_f32_16x16x32_bf16 v[96:99], a[176:179], a[168:171], v[96:99]
buffer_load_dwordx4 v10, s[44:47], s29 offen offset:0 lds
v_accvgpr_read_b32 v48, a248
v_mfma_f32_16x16x32_bf16 v[112:115], a[176:179], a[172:175], v[112:115]
ds_read_b128 a[192:195], v26 offset:33792
v_accvgpr_read_b32 v49, a249
v_mfma_f32_16x16x32_bf16 v[116:119], a[180:183], a[172:175], v[116:119]
ds_read_b128 a[196:199], v26 offset:35840
s_add_u32 s31, s31, 1
v_mfma_f32_16x16x32_bf16 v[100:103], a[180:183], a[168:171], v[100:103]
ds_read_b128 a[200:203], v26 offset:37888
v_accvgpr_read_b32 v50, a250
v_mfma_f32_16x16x32_bf16 v[84:87], a[180:183], a[164:167], v[84:87]
buffer_load_dwordx4 v11, s[44:47], s29 offen offset:1024 lds
v_accvgpr_read_b32 v51, a251
v_mfma_f32_16x16x32_bf16 v[68:71], a[180:183], a[160:163], v[68:71]
ds_read_b128 a[204:207], v26 offset:39936
v_accvgpr_read_b32 v52, a252
s_waitcnt lgkmcnt(4)
v_mfma_f32_16x16x32_bf16 v[72:75], a[184:187], a[160:163], v[72:75]
ds_read_b64_tr_b16 a[212:213], v23 offset:36864
v_readlane_b32 s28, v14, s31
v_mfma_f32_16x16x32_bf16 v[88:91], a[184:187], a[164:167], v[88:91]
ds_read_b64_tr_b16 a[214:215], v23 offset:37376
v_accvgpr_read_b32 v53, a253
v_mfma_f32_16x16x32_bf16 v[104:107], a[184:187], a[168:171], v[104:107]
buffer_load_dwordx4 v12, s[44:47], s29 offen offset:2048 lds
v_add_u32 v35, 65536, v32
v_mfma_f32_16x16x32_bf16 v[120:123], a[184:187], a[172:175], v[120:123]
ds_read_b64_tr_b16 a[216:217], v24 offset:36864
v_add_u32 v36, 65536, v33
v_mfma_f32_16x16x32_bf16 v[124:127], a[188:191], a[172:175], v[124:127]
ds_read_b64_tr_b16 a[218:219], v24 offset:37376
v_add_u32 v37, 65536, v34
v_mfma_f32_16x16x32_bf16 v[108:111], a[188:191], a[168:171], v[108:111]
ds_read_b64_tr_b16 a[220:221], v25 offset:36864
v_add_u32 v54, 65536, v52
v_mfma_f32_16x16x32_bf16 v[92:95], a[188:191], a[164:167], v[92:95]
buffer_load_dwordx4 v13, s[44:47], s29 offen offset:3072 lds
v_add_u32 v55, 65536, v53
v_mfma_f32_16x16x32_bf16 v[76:79], a[188:191], a[160:163], v[76:79]
ds_read_b64_tr_b16 a[222:223], v25 offset:37376
v_add_u32 v56, 32768, v38
s_waitcnt vmcnt(13) lgkmcnt(4)
v_mfma_f32_16x16x32_bf16 v[64:67], a[208:211], a[192:195], v[64:67]
s_barrier
ds_read_b64_tr_b16 a[176:177], v27 offset:0
v_mfma_f32_16x16x32_bf16 v[80:83], a[208:211], a[196:199], v[80:83]
ds_read_b64_tr_b16 a[178:179], v27 offset:512
s_add_u32 m0, s24, 0
v_mfma_f32_16x16x32_bf16 v[96:99], a[208:211], a[200:203], v[96:99]
buffer_load_dwordx4 v16, s[48:51], s28 offen offset:0 lds
v_add_u32 v57, 32768, v39
v_mfma_f32_16x16x32_bf16 v[112:115], a[208:211], a[204:207], v[112:115]
ds_read_b128 a[160:163], v31 offset:0
v_mov_b32 v1, s78
v_mfma_f32_16x16x32_bf16 v[116:119], a[212:215], a[204:207], v[116:119]
ds_read_b128 a[164:167], v31 offset:2048
buffer_store_dword v1, off, s[40:43], s1 offset:128 sc1
s_mov_b32 s12, s60
v_mfma_f32_16x16x32_bf16 v[100:103], a[212:215], a[200:203], v[100:103]
ds_read_b128 a[168:171], v31 offset:4096
s_mov_b32 s13, s61
v_mfma_f32_16x16x32_bf16 v[84:87], a[212:215], a[196:199], v[84:87]
buffer_load_dwordx4 v17, s[48:51], s28 offen offset:1024 lds
s_mov_b32 s14, 2097152
v_mfma_f32_16x16x32_bf16 v[68:71], a[212:215], a[192:195], v[68:71]
ds_read_b128 a[172:175], v31 offset:6144
s_mov_b32 s15, 0x20000
s_waitcnt lgkmcnt(4)
v_mfma_f32_16x16x32_bf16 v[72:75], a[216:219], a[192:195], v[72:75]
ds_read_b64_tr_b16 a[180:181], v28 offset:0
s_mul_i32 s29, s28, 16
v_mfma_f32_16x16x32_bf16 v[88:91], a[216:219], a[196:199], v[88:91]
ds_read_b64_tr_b16 a[182:183], v28 offset:512
v_mfma_f32_16x16x32_bf16 v[104:107], a[216:219], a[200:203], v[104:107]
buffer_load_dwordx4 v18, s[48:51], s28 offen offset:2048 lds
v_mfma_f32_16x16x32_bf16 v[120:123], a[216:219], a[204:207], v[120:123]
ds_read_b64_tr_b16 a[184:185], v29 offset:0
v_mfma_f32_16x16x32_bf16 v[124:127], a[220:223], a[204:207], v[124:127]
ds_read_b64_tr_b16 a[186:187], v29 offset:512
v_mfma_f32_16x16x32_bf16 v[108:111], a[220:223], a[200:203], v[108:111]
ds_read_b64_tr_b16 a[188:189], v30 offset:0
s_waitcnt vmcnt(16)
v_cmp_ne_u32 vcc, s78, v58
v_mfma_f32_16x16x32_bf16 v[92:95], a[220:223], a[196:199], v[92:95]
buffer_load_dwordx4 v19, s[48:51], s28 offen offset:3072 lds
s_cbranch_vccz Lok_14
s_mov_b32 s79, 32768
Lspin_13:
buffer_load_dword v58, v47, s[40:43], 0 offen sc1
s_waitcnt vmcnt(0)
v_cmp_ne_u32 vcc, s78, v58
s_sub_u32 s79, s79, 1
s_cbranch_scc1 Lok_14
s_cbranch_vccnz Lspin_13
Lok_14:
v_mfma_f32_16x16x32_bf16 v[76:79], a[220:223], a[192:195], v[76:79]
ds_read_b64_tr_b16 a[190:191], v30 offset:512
s_waitcnt lgkmcnt(4)
v_mfma_f32_16x16x32_bf16 v[64:67], a[176:179], a[160:163], v[64:67]
ds_read_b64_tr_b16 a[208:209], v27 offset:4096
s_waitcnt vmcnt(15)
v_lshlrev_b32 v192, 16, v195
v_mfma_f32_16x16x32_bf16 v[80:83], a[176:179], a[164:167], v[80:83]
ds_read_b64_tr_b16 a[210:211], v27 offset:4608
s_add_u32 m0, s25, 0
v_mfma_f32_16x16x32_bf16 v[96:99], a[176:179], a[168:171], v[96:99]
buffer_load_dwordx4 v20, s[52:55], s29 offen offset:0 sc1 lds
v_mfma_f32_16x16x32_bf16 v[112:115], a[176:179], a[172:175], v[112:115]
ds_read_b128 a[192:195], v31 offset:1024
v_lshlrev_b32 v193, 16, v195
v_mfma_f32_16x16x32_bf16 v[116:119], a[180:183], a[172:175], v[116:119]
ds_read_b128 a[196:199], v31 offset:3072
s_add_u32 s31, s31, 1
v_mfma_f32_16x16x32_bf16 v[100:103], a[180:183], a[168:171], v[100:103]
ds_read_b128 a[200:203], v31 offset:5120
v_lshlrev_b32 v194, 16, v195
v_mfma_f32_16x16x32_bf16 v[84:87], a[180:183], a[164:167], v[84:87]
buffer_load_dwordx4 v20, s[52:55], s29 offen offset:1024 sc1 lds
v_mfma_f32_16x16x32_bf16 v[68:71], a[180:183], a[160:163], v[68:71]
ds_read_b128 a[204:207], v31 offset:7168
v_lshlrev_b32 v195, 16, v195
s_waitcnt lgkmcnt(4)
v_mfma_f32_16x16x32_bf16 v[72:75], a[184:187], a[160:163], v[72:75]
ds_read_b64_tr_b16 a[212:213], v28 offset:4096
v_readlane_b32 s28, v14, s31
v_mfma_f32_16x16x32_bf16 v[88:91], a[184:187], a[164:167], v[88:91]
ds_read_b64_tr_b16 a[214:215], v28 offset:4608
s_waitcnt vmcnt(15)
v_lshlrev_b32 v196, 16, v199
v_mfma_f32_16x16x32_bf16 v[104:107], a[184:187], a[168:171], v[104:107]
buffer_load_dwordx4 v21, s[52:55], s29 offen offset:2048 sc1 lds
v_mfma_f32_16x16x32_bf16 v[120:123], a[184:187], a[172:175], v[120:123]
ds_read_b64_tr_b16 a[216:217], v29 offset:4096
v_lshlrev_b32 v197, 16, v199
v_mfma_f32_16x16x32_bf16 v[124:127], a[188:191], a[172:175], v[124:127]
ds_read_b64_tr_b16 a[218:219], v29 offset:4608
v_lshlrev_b32 v198, 16, v199
v_mfma_f32_16x16x32_bf16 v[108:111], a[188:191], a[168:171], v[108:111]
ds_read_b64_tr_b16 a[220:221], v30 offset:4096
v_lshlrev_b32 v199, 16, v199
v_mfma_f32_16x16x32_bf16 v[92:95], a[188:191], a[164:167], v[92:95]
buffer_load_dwordx4 v21, s[52:55], s29 offen offset:3072 sc1 lds
v_mfma_f32_16x16x32_bf16 v[76:79], a[188:191], a[160:163], v[76:79]
ds_read_b64_tr_b16 a[222:223], v30 offset:4608
s_waitcnt vmcnt(9) lgkmcnt(4)
v_mfma_f32_16x16x32_bf16 v[64:67], a[208:211], a[192:195], v[64:67]
s_barrier
ds_read_b64_tr_b16 a[176:177], v27 offset:32768
v_mfma_f32_16x16x32_bf16 v[80:83], a[208:211], a[196:199], v[80:83]
ds_read_b64_tr_b16 a[178:179], v27 offset:33280
s_add_u32 m0, s25, 32768
v_mfma_f32_16x16x32_bf16 v[96:99], a[208:211], a[200:203], v[96:99]
buffer_load_dwordx4 v20, s[52:55], s28 offen offset:0 sc1 lds
v_mfma_f32_16x16x32_bf16 v[112:115], a[208:211], a[204:207], v[112:115]
ds_read_b128 a[160:163], v31 offset:32768
v_lshlrev_b32 v200, 16, v203
v_mfma_f32_16x16x32_bf16 v[116:119], a[212:215], a[204:207], v[116:119]
ds_read_b128 a[164:167], v31 offset:34816
v_lshlrev_b32 v201, 16, v203
v_mfma_f32_16x16x32_bf16 v[100:103], a[212:215], a[200:203], v[100:103]
ds_read_b128 a[168:171], v31 offset:36864
v_lshlrev_b32 v202, 16, v203
v_mfma_f32_16x16x32_bf16 v[84:87], a[212:215], a[196:199], v[84:87]
buffer_load_dwordx4 v20, s[52:55], s28 offen offset:1024 sc1 lds
v_mfma_f32_16x16x32_bf16 v[68:71], a[212:215], a[192:195], v[68:71]
ds_read_b128 a[172:175], v31 offset:38912
v_lshlrev_b32 v203, 16, v203
s_waitcnt lgkmcnt(4)
v_mfma_f32_16x16x32_bf16 v[72:75], a[216:219], a[192:195], v[72:75]
ds_read_b64_tr_b16 a[180:181], v28 offset:32768
s_mul_hi_u32 s29, s28, 268435456
v_mfma_f32_16x16x32_bf16 v[88:91], a[216:219], a[196:199], v[88:91]
ds_read_b64_tr_b16 a[182:183], v28 offset:33280
v_lshlrev_b32 v204, 16, v207
v_mfma_f32_16x16x32_bf16 v[104:107], a[216:219], a[200:203], v[104:107]
buffer_load_dwordx4 v21, s[52:55], s28 offen offset:2048 sc1 lds
v_mfma_f32_16x16x32_bf16 v[120:123], a[216:219], a[204:207], v[120:123]
ds_read_b64_tr_b16 a[184:185], v29 offset:32768
v_lshlrev_b32 v205, 16, v207
v_mfma_f32_16x16x32_bf16 v[124:127], a[220:223], a[204:207], v[124:127]
ds_read_b64_tr_b16 a[186:187], v29 offset:33280
v_lshlrev_b32 v206, 16, v207
v_mfma_f32_16x16x32_bf16 v[108:111], a[220:223], a[200:203], v[108:111]
ds_read_b64_tr_b16 a[188:189], v30 offset:32768
v_lshlrev_b32 v207, 16, v207
v_mfma_f32_16x16x32_bf16 v[92:95], a[220:223], a[196:199], v[92:95]
buffer_load_dwordx4 v21, s[52:55], s28 offen offset:3072 sc1 lds
v_mfma_f32_16x16x32_bf16 v[76:79], a[220:223], a[192:195], v[76:79]
ds_read_b64_tr_b16 a[190:191], v30 offset:33280
s_waitcnt lgkmcnt(4)
v_mfma_f32_16x16x32_bf16 v[64:67], a[176:179], a[160:163], v[64:67]
ds_read_b64_tr_b16 a[208:209], v27 offset:36864
v_mfma_f32_16x16x32_bf16 v[80:83], a[176:179], a[164:167], v[80:83]
ds_read_b64_tr_b16 a[210:211], v27 offset:37376
s_add_u32 m0, s24, 32768
v_mfma_f32_16x16x32_bf16 v[96:99], a[176:179], a[168:171], v[96:99]
buffer_load_dwordx4 v16, s[48:51], s29 offen offset:0 lds
v_mfma_f32_16x16x32_bf16 v[112:115], a[176:179], a[172:175], v[112:115]
ds_read_b128 a[192:195], v31 offset:33792
v_mfma_f32_16x16x32_bf16 v[116:119], a[180:183], a[172:175], v[116:119]
ds_read_b128 a[196:199], v31 offset:35840
s_add_u32 s31, s31, 1
v_mfma_f32_16x16x32_bf16 v[100:103], a[180:183], a[168:171], v[100:103]
ds_read_b128 a[200:203], v31 offset:37888
v_mfma_f32_16x16x32_bf16 v[84:87], a[180:183], a[164:167], v[84:87]
buffer_load_dwordx4 v17, s[48:51], s29 offen offset:1024 lds
v_mfma_f32_16x16x32_bf16 v[68:71], a[180:183], a[160:163], v[68:71]
ds_read_b128 a[204:207], v31 offset:39936
s_waitcnt lgkmcnt(4)
v_mfma_f32_16x16x32_bf16 v[72:75], a[184:187], a[160:163], v[72:75]
ds_read_b64_tr_b16 a[212:213], v28 offset:36864
v_readlane_b32 s28, v14, s31
v_mfma_f32_16x16x32_bf16 v[88:91], a[184:187], a[164:167], v[88:91]
ds_read_b64_tr_b16 a[214:215], v28 offset:37376
v_mfma_f32_16x16x32_bf16 v[104:107], a[184:187], a[168:171], v[104:107]
buffer_load_dwordx4 v18, s[48:51], s29 offen offset:2048 lds
v_mfma_f32_16x16x32_bf16 v[120:123], a[184:187], a[172:175], v[120:123]
ds_read_b64_tr_b16 a[216:217], v29 offset:36864
v_mfma_f32_16x16x32_bf16 v[124:127], a[188:191], a[172:175], v[124:127]
ds_read_b64_tr_b16 a[218:219], v29 offset:37376
v_mfma_f32_16x16x32_bf16 v[108:111], a[188:191], a[168:171], v[108:111]
ds_read_b64_tr_b16 a[220:221], v30 offset:36864
v_mfma_f32_16x16x32_bf16 v[92:95], a[188:191], a[164:167], v[92:95]
buffer_load_dwordx4 v19, s[48:51], s29 offen offset:3072 lds
v_mfma_f32_16x16x32_bf16 v[76:79], a[188:191], a[160:163], v[76:79]
ds_read_b64_tr_b16 a[222:223], v30 offset:37376
s_waitcnt vmcnt(8) lgkmcnt(4)
v_mfma_f32_16x16x32_bf16 v[64:67], a[208:211], a[192:195], v[64:67]
s_barrier
v_mfma_f32_16x16x32_bf16 v[80:83], a[208:211], a[196:199], v[80:83]
ds_read_b128 a[176:179], v34 offset:0
s_add_u32 m0, s24, 65536
v_mfma_f32_16x16x32_bf16 v[96:99], a[208:211], a[200:203], v[96:99]
buffer_load_dwordx4 v16, s[48:51], s28 offen offset:0 lds
v_mfma_f32_16x16x32_bf16 v[112:115], a[208:211], a[204:207], v[112:115]
ds_read_b128 a[160:163], v32 offset:0
s_mov_b32 s39, 0xbdd2d3e8
v_mfma_f32_16x16x32_bf16 v[116:119], a[212:215], a[204:207], v[116:119]
ds_read_b128 a[164:167], v32 offset:2048
v_mov_b32 v2, 0xc0135761
v_mfma_f32_16x16x32_bf16 v[100:103], a[212:215], a[200:203], v[100:103]
ds_read_b128 a[168:171], v32 offset:4096
v_mfma_f32_16x16x32_bf16 v[84:87], a[212:215], a[196:199], v[84:87]
buffer_load_dwordx4 v17, s[48:51], s28 offen offset:1024 lds
v_mfma_f32_16x16x32_bf16 v[68:71], a[212:215], a[192:195], v[68:71]
ds_read_b128 a[172:175], v32 offset:6144
s_waitcnt lgkmcnt(4)
v_mfma_f32_16x16x32_bf16 v[72:75], a[216:219], a[192:195], v[72:75]
ds_read_b128 a[180:183], v34 offset:2048
s_mul_i32 s29, s28, 16
v_mfma_f32_16x16x32_bf16 v[88:91], a[216:219], a[196:199], v[88:91]
s_mov_b32 s44, s70
s_mov_b32 s45, s71
v_mfma_f32_16x16x32_bf16 v[104:107], a[216:219], a[200:203], v[104:107]
buffer_load_dwordx4 v18, s[48:51], s28 offen offset:2048 lds
v_mfma_f32_16x16x32_bf16 v[120:123], a[216:219], a[204:207], v[120:123]
ds_read_b128 a[184:187], v34 offset:4096
v_mfma_f32_16x16x32_bf16 v[124:127], a[220:223], a[204:207], v[124:127]
ds_read_b128 a[188:191], v34 offset:6144
v_mfma_f32_16x16x32_bf16 v[108:111], a[220:223], a[200:203], v[108:111]
s_mov_b32 s46, 3670016
s_mov_b32 s47, 0x20000
v_mfma_f32_16x16x32_bf16 v[92:95], a[220:223], a[196:199], v[92:95]
buffer_load_dwordx4 v19, s[48:51], s28 offen offset:3072 lds
v_mfma_f32_16x16x32_bf16 v[76:79], a[220:223], a[192:195], v[76:79]
s_add_u32 m0, s25, 65536
s_waitcnt lgkmcnt(2)
v_mfma_f32_16x16x32_bf16 v[128:131], a[176:179], a[160:163], v[192:195]
ds_read_b128 a[208:211], v34 offset:1024
v_mul_f32 v60, v64, v64
v_mfma_f32_16x16x32_bf16 v[144:147], a[176:179], a[164:167], v[196:199]
ds_read_b128 a[192:195], v33 offset:0
v_fma_f32 v60, v60, s39, v2
v_mfma_f32_16x16x32_bf16 v[160:163], a[176:179], a[168:171], v[200:203]
buffer_load_dwordx4 v20, s[52:55], s29 offen offset:0 sc1 lds
v_mfma_f32_16x16x32_bf16 v[176:179], a[176:179], a[172:175], v[204:207]
ds_read_b128 a[196:199], v33 offset:2048
v_mfma_f32_16x16x32_bf16 v[180:183], a[180:183], a[172:175], v[204:207]
ds_read_b128 a[200:203], v33 offset:4096
v_mul_f32 v60, v60, v64
v_mfma_f32_16x16x32_bf16 v[164:167], a[180:183], a[168:171], v[200:203]
s_add_u32 s31, s31, 1
v_exp_f32 v60, v60
v_mfma_f32_16x16x32_bf16 v[148:151], a[180:183], a[164:167], v[196:199]
buffer_load_dwordx4 v20, s[52:55], s29 offen offset:1024 sc1 lds
v_mfma_f32_16x16x32_bf16 v[132:135], a[180:183], a[160:163], v[192:195]
ds_read_b128 a[204:207], v33 offset:6144
v_mul_f32 v61, v65, v65
s_waitcnt lgkmcnt(3)
v_mfma_f32_16x16x32_bf16 v[136:139], a[184:187], a[160:163], v[192:195]
ds_read_b128 a[212:215], v34 offset:3072
v_fma_f32 v61, v61, s39, v2
v_mfma_f32_16x16x32_bf16 v[152:155], a[184:187], a[164:167], v[196:199]
v_readlane_b32 s28, v14, s31
v_mfma_f32_16x16x32_bf16 v[168:171], a[184:187], a[168:171], v[200:203]
buffer_load_dwordx4 v21, s[52:55], s29 offen offset:2048 sc1 lds
v_mfma_f32_16x16x32_bf16 v[184:187], a[184:187], a[172:175], v[204:207]
ds_read_b128 a[216:219], v34 offset:5120
v_mfma_f32_16x16x32_bf16 v[188:191], a[188:191], a[172:175], v[204:207]
ds_read_b128 a[220:223], v34 offset:7168
v_mul_f32 v61, v61, v65
v_mfma_f32_16x16x32_bf16 v[172:175], a[188:191], a[168:171], v[200:203]
v_exp_f32 v61, v61
v_mfma_f32_16x16x32_bf16 v[156:159], a[188:191], a[164:167], v[196:199]
buffer_load_dwordx4 v21, s[52:55], s29 offen offset:3072 sc1 lds
v_mfma_f32_16x16x32_bf16 v[140:143], a[188:191], a[160:163], v[192:195]
s_add_u32 m0, s25, 98304
s_waitcnt vmcnt(8)
v_mfma_f32_16x16x32_bf16 v[128:131], a[208:211], a[192:195], v[128:131]
s_barrier
s_waitcnt lgkmcnt(1)
v_mfma_f32_16x16x32_bf16 v[144:147], a[208:211], a[196:199], v[144:147]
ds_read_b128 a[176:179], v34 offset:32768
v_mfma_f32_16x16x32_bf16 v[160:163], a[208:211], a[200:203], v[160:163]
buffer_load_dwordx4 v20, s[52:55], s28 offen offset:0 sc1 lds
v_mfma_f32_16x16x32_bf16 v[176:179], a[208:211], a[204:207], v[176:179]
ds_read_b128 a[160:163], v32 offset:32768
v_add_f32 v60, 1.0, v60
v_mfma_f32_16x16x32_bf16 v[180:183], a[212:215], a[204:207], v[180:183]
ds_read_b128 a[164:167], v32 offset:34816
v_add_f32 v61, 1.0, v61
v_mfma_f32_16x16x32_bf16 v[164:167], a[212:215], a[200:203], v[164:167]
ds_read_b128 a[168:171], v32 offset:36864
v_mfma_f32_16x16x32_bf16 v[148:151], a[212:215], a[196:199], v[148:151]
buffer_load_dwordx4 v20, s[52:55], s28 offen offset:1024 sc1 lds
v_mfma_f32_16x16x32_bf16 v[132:135], a[212:215], a[192:195], v[132:135]
ds_read_b128 a[172:175], v32 offset:38912
v_mfma_f32_16x16x32_bf16 v[136:139], a[216:219], a[192:195], v[136:139]
ds_read_b128 a[180:183], v34 offset:34816
s_mul_hi_u32 s29, s28, 268435456
v_mfma_f32_16x16x32_bf16 v[152:155], a[216:219], a[196:199], v[152:155]
v_rcp_f32 v60, v60
v_mfma_f32_16x16x32_bf16 v[168:171], a[216:219], a[200:203], v[168:171]
buffer_load_dwordx4 v21, s[52:55], s28 offen offset:2048 sc1 lds
v_mfma_f32_16x16x32_bf16 v[184:187], a[216:219], a[204:207], v[184:187]
ds_read_b128 a[184:187], v34 offset:36864
s_waitcnt lgkmcnt(3)
v_mfma_f32_16x16x32_bf16 v[188:191], a[220:223], a[204:207], v[188:191]
ds_read_b128 a[188:191], v34 offset:38912
v_mul_f32 v64, v64, v60
v_mfma_f32_16x16x32_bf16 v[172:175], a[220:223], a[200:203], v[172:175]
v_rcp_f32 v61, v61
v_mfma_f32_16x16x32_bf16 v[156:159], a[220:223], a[196:199], v[156:159]
buffer_load_dwordx4 v21, s[52:55], s28 offen offset:3072 sc1 lds
v_mfma_f32_16x16x32_bf16 v[140:143], a[220:223], a[192:195], v[140:143]
s_add_u32 m0, s24, 98304
v_mfma_f32_16x16x32_bf16 v[128:131], a[176:179], a[160:163], v[128:131]
ds_read_b128 a[208:211], v34 offset:33792
v_mul_f32 v60, v66, v66
v_mfma_f32_16x16x32_bf16 v[144:147], a[176:179], a[164:167], v[144:147]
ds_read_b128 a[192:195], v33 offset:32768
v_fma_f32 v60, v60, s39, v2
v_mfma_f32_16x16x32_bf16 v[160:163], a[176:179], a[168:171], v[160:163]
buffer_load_dwordx4 v16, s[48:51], s29 offen offset:0 lds
s_waitcnt lgkmcnt(2)
v_mfma_f32_16x16x32_bf16 v[176:179], a[176:179], a[172:175], v[176:179]
ds_read_b128 a[196:199], v33 offset:34816
s_mov_b32 s32, s74
v_mfma_f32_16x16x32_bf16 v[180:183], a[180:183], a[172:175], v[180:183]
ds_read_b128 a[200:203], v33 offset:36864
v_mul_f32 v60, v60, v66
v_mfma_f32_16x16x32_bf16 v[164:167], a[180:183], a[168:171], v[164:167]
s_add_u32 s31, s31, 1
v_exp_f32 v60, v60
v_mfma_f32_16x16x32_bf16 v[148:151], a[180:183], a[164:167], v[148:151]
buffer_load_dwordx4 v17, s[48:51], s29 offen offset:1024 lds
v_mfma_f32_16x16x32_bf16 v[132:135], a[180:183], a[160:163], v[132:135]
ds_read_b128 a[204:207], v33 offset:38912
v_mul_f32 v62, v67, v67
v_mfma_f32_16x16x32_bf16 v[136:139], a[184:187], a[160:163], v[136:139]
ds_read_b128 a[212:215], v34 offset:35840
v_fma_f32 v62, v62, s39, v2
v_mfma_f32_16x16x32_bf16 v[152:155], a[184:187], a[164:167], v[152:155]
v_readlane_b32 s28, v14, s31
s_mov_b32 s33, s75
v_mfma_f32_16x16x32_bf16 v[168:171], a[184:187], a[168:171], v[168:171]
buffer_load_dwordx4 v18, s[48:51], s29 offen offset:2048 lds
v_mfma_f32_16x16x32_bf16 v[184:187], a[184:187], a[172:175], v[184:187]
ds_read_b128 a[216:219], v34 offset:37888
s_mov_b32 s34, 256
v_mfma_f32_16x16x32_bf16 v[188:191], a[188:191], a[172:175], v[188:191]
ds_read_b128 a[220:223], v34 offset:39936
v_mul_f32 v62, v62, v67
v_mfma_f32_16x16x32_bf16 v[172:175], a[188:191], a[168:171], v[172:175]
v_exp_f32 v62, v62
v_mfma_f32_16x16x32_bf16 v[156:159], a[188:191], a[164:167], v[156:159]
buffer_load_dwordx4 v19, s[48:51], s29 offen offset:3072 lds
v_mfma_f32_16x16x32_bf16 v[140:143], a[188:191], a[160:163], v[140:143]
s_add_u32 m0, s24, 0
s_waitcnt vmcnt(8) lgkmcnt(2)
v_mfma_f32_16x16x32_bf16 v[128:131], a[208:211], a[192:195], v[128:131]
s_barrier
v_mfma_f32_16x16x32_bf16 v[144:147], a[208:211], a[196:199], v[144:147]
ds_read_b128 a[176:179], v37 offset:0
v_mov_b32 v3, 0
v_mfma_f32_16x16x32_bf16 v[160:163], a[208:211], a[200:203], v[160:163]
buffer_load_dwordx4 v16, s[48:51], s28 offen offset:0 lds
v_mfma_f32_16x16x32_bf16 v[176:179], a[208:211], a[204:207], v[176:179]
ds_read_b128 a[160:163], v35 offset:0
v_add_f32 v60, 1.0, v60
v_mfma_f32_16x16x32_bf16 v[180:183], a[212:215], a[204:207], v[180:183]
ds_read_b128 a[164:167], v35 offset:2048
v_add_f32 v62, 1.0, v62
v_mfma_f32_16x16x32_bf16 v[164:167], a[212:215], a[200:203], v[164:167]
ds_read_b128 a[168:171], v35 offset:4096
s_or_b32 s27, s2, s3
s_cselect_b32 s27, 2147483648, 0
v_mfma_f32_16x16x32_bf16 v[148:151], a[212:215], a[196:199], v[148:151]
buffer_load_dwordx4 v17, s[48:51], s28 offen offset:1024 lds
v_mfma_f32_16x16x32_bf16 v[132:135], a[212:215], a[192:195], v[132:135]
ds_read_b128 a[172:175], v35 offset:6144
v_mul_f32 v65, v65, v61
s_waitcnt lgkmcnt(4)
v_mfma_f32_16x16x32_bf16 v[136:139], a[216:219], a[192:195], v[136:139]
ds_read_b128 a[180:183], v37 offset:2048
s_mul_i32 s29, s28, 16
v_mfma_f32_16x16x32_bf16 v[152:155], a[216:219], a[196:199], v[152:155]
v_rcp_f32 v60, v60
buffer_store_dword v3, off, s[32:35], s27 sc1
v_mfma_f32_16x16x32_bf16 v[168:171], a[216:219], a[200:203], v[168:171]
buffer_load_dwordx4 v18, s[48:51], s28 offen offset:2048 lds
v_mfma_f32_16x16x32_bf16 v[184:187], a[216:219], a[204:207], v[184:187]
ds_read_b128 a[184:187], v37 offset:4096
v_mfma_f32_16x16x32_bf16 v[188:191], a[220:223], a[204:207], v[188:191]
ds_read_b128 a[188:191], v37 offset:6144
v_mul_f32 v66, v66, v60
v_mfma_f32_16x16x32_bf16 v[172:175], a[220:223], a[200:203], v[172:175]
v_rcp_f32 v62, v62
v_mfma_f32_16x16x32_bf16 v[156:159], a[220:223], a[196:199], v[156:159]
buffer_load_dwordx4 v19, s[48:51], s28 offen offset:3072 lds
v_mfma_f32_16x16x32_bf16 v[140:143], a[220:223], a[192:195], v[140:143]
s_add_u32 m0, s25, 0
s_waitcnt lgkmcnt(2)
v_mfma_f32_16x16x32_bf16 v[128:131], a[176:179], a[160:163], v[128:131]
ds_read_b128 a[208:211], v37 offset:1024
v_mul_f32 v60, v68, v68
v_mfma_f32_16x16x32_bf16 v[144:147], a[176:179], a[164:167], v[144:147]
ds_read_b128 a[192:195], v36 offset:0
v_fma_f32 v60, v60, s39, v2
v_mfma_f32_16x16x32_bf16 v[160:163], a[176:179], a[168:171], v[160:163]
buffer_load_dwordx4 v20, s[52:55], s29 offen offset:0 sc1 lds
v_mfma_f32_16x16x32_bf16 v[176:179], a[176:179], a[172:175], v[176:179]
ds_read_b128 a[196:199], v36 offset:2048
v_mfma_f32_16x16x32_bf16 v[180:183], a[180:183], a[172:175], v[180:183]
ds_read_b128 a[200:203], v36 offset:4096
v_mul_f32 v60, v60, v68
v_mfma_f32_16x16x32_bf16 v[164:167], a[180:183], a[168:171], v[164:167]
s_add_u32 s31, s31, 1
v_exp_f32 v60, v60
v_mfma_f32_16x16x32_bf16 v[148:151], a[180:183], a[164:167], v[148:151]
buffer_load_dwordx4 v20, s[52:55], s29 offen offset:1024 sc1 lds
v_mfma_f32_16x16x32_bf16 v[132:135], a[180:183], a[160:163], v[132:135]
ds_read_b128 a[204:207], v36 offset:6144
v_mul_f32 v61, v69, v69
s_waitcnt lgkmcnt(3)
v_mfma_f32_16x16x32_bf16 v[136:139], a[184:187], a[160:163], v[136:139]
ds_read_b128 a[212:215], v37 offset:3072
v_fma_f32 v61, v61, s39, v2
v_mfma_f32_16x16x32_bf16 v[152:155], a[184:187], a[164:167], v[152:155]
v_readlane_b32 s28, v14, s31
v_mfma_f32_16x16x32_bf16 v[168:171], a[184:187], a[168:171], v[168:171]
buffer_load_dwordx4 v21, s[52:55], s29 offen offset:2048 sc1 lds
v_mfma_f32_16x16x32_bf16 v[184:187], a[184:187], a[172:175], v[184:187]
ds_read_b128 a[216:219], v37 offset:5120
v_mfma_f32_16x16x32_bf16 v[188:191], a[188:191], a[172:175], v[188:191]
ds_read_b128 a[220:223], v37 offset:7168
v_mul_f32 v61, v61, v69
v_mfma_f32_16x16x32_bf16 v[172:175], a[188:191], a[168:171], v[172:175]
v_exp_f32 v61, v61
v_mfma_f32_16x16x32_bf16 v[156:159], a[188:191], a[164:167], v[156:159]
buffer_load_dwordx4 v21, s[52:55], s29 offen offset:3072 sc1 lds
v_mfma_f32_16x16x32_bf16 v[140:143], a[188:191], a[160:163], v[140:143]
s_add_u32 m0, s25, 32768
s_waitcnt vmcnt(9)
v_mfma_f32_16x16x32_bf16 v[128:131], a[208:211], a[192:195], v[128:131]
s_barrier
s_waitcnt lgkmcnt(1)
v_mfma_f32_16x16x32_bf16 v[144:147], a[208:211], a[196:199], v[144:147]
ds_read_b128 a[176:179], v37 offset:32768
v_mfma_f32_16x16x32_bf16 v[160:163], a[208:211], a[200:203], v[160:163]
buffer_load_dwordx4 v20, s[52:55], s28 offen offset:0 sc1 lds
v_mfma_f32_16x16x32_bf16 v[176:179], a[208:211], a[204:207], v[176:179]
ds_read_b128 a[160:163], v35 offset:32768
v_add_f32 v60, 1.0, v60
v_mfma_f32_16x16x32_bf16 v[180:183], a[212:215], a[204:207], v[180:183]
ds_read_b128 a[164:167], v35 offset:34816
v_add_f32 v61, 1.0, v61
v_mfma_f32_16x16x32_bf16 v[164:167], a[212:215], a[200:203], v[164:167]
ds_read_b128 a[168:171], v35 offset:36864
v_mfma_f32_16x16x32_bf16 v[148:151], a[212:215], a[196:199], v[148:151]
buffer_load_dwordx4 v20, s[52:55], s28 offen offset:1024 sc1 lds
v_mfma_f32_16x16x32_bf16 v[132:135], a[212:215], a[192:195], v[132:135]
ds_read_b128 a[172:175], v35 offset:38912
v_mul_f32 v67, v67, v62
v_mfma_f32_16x16x32_bf16 v[136:139], a[216:219], a[192:195], v[136:139]
ds_read_b128 a[180:183], v37 offset:34816
s_mul_hi_u32 s29, s28, 268435456
v_mfma_f32_16x16x32_bf16 v[152:155], a[216:219], a[196:199], v[152:155]
v_rcp_f32 v60, v60
v_mfma_f32_16x16x32_bf16 v[168:171], a[216:219], a[200:203], v[168:171]
buffer_load_dwordx4 v21, s[52:55], s28 offen offset:2048 sc1 lds
v_mfma_f32_16x16x32_bf16 v[184:187], a[216:219], a[204:207], v[184:187]
ds_read_b128 a[184:187], v37 offset:36864
s_waitcnt lgkmcnt(3)
v_mfma_f32_16x16x32_bf16 v[188:191], a[220:223], a[204:207], v[188:191]
ds_read_b128 a[188:191], v37 offset:38912
v_mul_f32 v68, v68, v60
v_mfma_f32_16x16x32_bf16 v[172:175], a[220:223], a[200:203], v[172:175]
v_rcp_f32 v61, v61
v_mfma_f32_16x16x32_bf16 v[156:159], a[220:223], a[196:199], v[156:159]
buffer_load_dwordx4 v21, s[52:55], s28 offen offset:3072 sc1 lds
v_mfma_f32_16x16x32_bf16 v[140:143], a[220:223], a[192:195], v[140:143]
s_add_u32 m0, s24, 32768
v_mfma_f32_16x16x32_bf16 v[128:131], a[176:179], a[160:163], v[128:131]
ds_read_b128 a[208:211], v37 offset:33792
v_mul_f32 v60, v70, v70
v_mfma_f32_16x16x32_bf16 v[144:147], a[176:179], a[164:167], v[144:147]
ds_read_b128 a[192:195], v36 offset:32768
v_fma_f32 v60, v60, s39, v2
v_mfma_f32_16x16x32_bf16 v[160:163], a[176:179], a[168:171], v[160:163]
buffer_load_dwordx4 v16, s[48:51], s29 offen offset:0 lds
s_waitcnt lgkmcnt(2)
v_mfma_f32_16x16x32_bf16 v[176:179], a[176:179], a[172:175], v[176:179]
ds_read_b128 a[196:199], v36 offset:34816
v_mfma_f32_16x16x32_bf16 v[180:183], a[180:183], a[172:175], v[180:183]
ds_read_b128 a[200:203], v36 offset:36864
v_mul_f32 v60, v60, v70
v_mfma_f32_16x16x32_bf16 v[164:167], a[180:183], a[168:171], v[164:167]
s_add_u32 s31, s31, 1
v_exp_f32 v60, v60
v_mfma_f32_16x16x32_bf16 v[148:151], a[180:183], a[164:167], v[148:151]
buffer_load_dwordx4 v17, s[48:51], s29 offen offset:1024 lds
v_mfma_f32_16x16x32_bf16 v[132:135], a[180:183], a[160:163], v[132:135]
ds_read_b128 a[204:207], v36 offset:38912
v_mul_f32 v62, v71, v71
v_mfma_f32_16x16x32_bf16 v[136:139], a[184:187], a[160:163], v[136:139]
ds_read_b128 a[212:215], v37 offset:35840
v_fma_f32 v62, v62, s39, v2
v_mfma_f32_16x16x32_bf16 v[152:155], a[184:187], a[164:167], v[152:155]
v_readlane_b32 s28, v14, s31
v_mfma_f32_16x16x32_bf16 v[168:171], a[184:187], a[168:171], v[168:171]
buffer_load_dwordx4 v18, s[48:51], s29 offen offset:2048 lds
v_mfma_f32_16x16x32_bf16 v[184:187], a[184:187], a[172:175], v[184:187]
ds_read_b128 a[216:219], v37 offset:37888
v_mfma_f32_16x16x32_bf16 v[188:191], a[188:191], a[172:175], v[188:191]
ds_read_b128 a[220:223], v37 offset:39936
v_mul_f32 v62, v62, v71
v_mfma_f32_16x16x32_bf16 v[172:175], a[188:191], a[168:171], v[172:175]
v_exp_f32 v62, v62
v_mfma_f32_16x16x32_bf16 v[156:159], a[188:191], a[164:167], v[156:159]
buffer_load_dwordx4 v19, s[48:51], s29 offen offset:3072 lds
v_mfma_f32_16x16x32_bf16 v[140:143], a[188:191], a[160:163], v[140:143]
s_add_u32 m0, s24, 65536
s_waitcnt vmcnt(8) lgkmcnt(2)
v_mfma_f32_16x16x32_bf16 v[128:131], a[208:211], a[192:195], v[128:131]
s_barrier
v_mfma_f32_16x16x32_bf16 v[144:147], a[208:211], a[196:199], v[144:147]
ds_read_b128 a[176:179], v34 offset:0
v_mfma_f32_16x16x32_bf16 v[160:163], a[208:211], a[200:203], v[160:163]
buffer_load_dwordx4 v16, s[48:51], s28 offen offset:0 lds
v_mfma_f32_16x16x32_bf16 v[176:179], a[208:211], a[204:207], v[176:179]
ds_read_b128 a[160:163], v32 offset:0
v_add_f32 v60, 1.0, v60
v_mfma_f32_16x16x32_bf16 v[180:183], a[212:215], a[204:207], v[180:183]
ds_read_b128 a[164:167], v32 offset:2048
v_add_f32 v62, 1.0, v62
v_mfma_f32_16x16x32_bf16 v[164:167], a[212:215], a[200:203], v[164:167]
ds_read_b128 a[168:171], v32 offset:4096
v_mfma_f32_16x16x32_bf16 v[148:151], a[212:215], a[196:199], v[148:151]
buffer_load_dwordx4 v17, s[48:51], s28 offen offset:1024 lds
v_mfma_f32_16x16x32_bf16 v[132:135], a[212:215], a[192:195], v[132:135]
ds_read_b128 a[172:175], v32 offset:6144
v_mul_f32 v69, v69, v61
s_waitcnt lgkmcnt(4)
v_mfma_f32_16x16x32_bf16 v[136:139], a[216:219], a[192:195], v[136:139]
ds_read_b128 a[180:183], v34 offset:2048
s_mul_i32 s29, s28, 16
v_mfma_f32_16x16x32_bf16 v[152:155], a[216:219], a[196:199], v[152:155]
v_rcp_f32 v60, v60
v_mfma_f32_16x16x32_bf16 v[168:171], a[216:219], a[200:203], v[168:171]
buffer_load_dwordx4 v18, s[48:51], s28 offen offset:2048 lds
v_mfma_f32_16x16x32_bf16 v[184:187], a[216:219], a[204:207], v[184:187]
ds_read_b128 a[184:187], v34 offset:4096
v_mfma_f32_16x16x32_bf16 v[188:191], a[220:223], a[204:207], v[188:191]
ds_read_b128 a[188:191], v34 offset:6144
v_mul_f32 v70, v70, v60
v_mfma_f32_16x16x32_bf16 v[172:175], a[220:223], a[200:203], v[172:175]
v_rcp_f32 v62, v62
v_mfma_f32_16x16x32_bf16 v[156:159], a[220:223], a[196:199], v[156:159]
buffer_load_dwordx4 v19, s[48:51], s28 offen offset:3072 lds
v_mfma_f32_16x16x32_bf16 v[140:143], a[220:223], a[192:195], v[140:143]
s_add_u32 m0, s25, 65536
s_waitcnt lgkmcnt(2)
v_mfma_f32_16x16x32_bf16 v[128:131], a[176:179], a[160:163], v[128:131]
ds_read_b128 a[208:211], v34 offset:1024
v_mul_f32 v60, v72, v72
v_mfma_f32_16x16x32_bf16 v[144:147], a[176:179], a[164:167], v[144:147]
ds_read_b128 a[192:195], v33 offset:0
v_fma_f32 v60, v60, s39, v2
v_mfma_f32_16x16x32_bf16 v[160:163], a[176:179], a[168:171], v[160:163]
buffer_load_dwordx4 v20, s[52:55], s29 offen offset:0 sc1 lds
v_mfma_f32_16x16x32_bf16 v[176:179], a[176:179], a[172:175], v[176:179]
ds_read_b128 a[196:199], v33 offset:2048
v_mfma_f32_16x16x32_bf16 v[180:183], a[180:183], a[172:175], v[180:183]
ds_read_b128 a[200:203], v33 offset:4096
v_mul_f32 v60, v60, v72
v_mfma_f32_16x16x32_bf16 v[164:167], a[180:183], a[168:171], v[164:167]
s_add_u32 s31, s31, 1
v_exp_f32 v60, v60
v_mfma_f32_16x16x32_bf16 v[148:151], a[180:183], a[164:167], v[148:151]
buffer_load_dwordx4 v20, s[52:55], s29 offen offset:1024 sc1 lds
v_mfma_f32_16x16x32_bf16 v[132:135], a[180:183], a[160:163], v[132:135]
ds_read_b128 a[204:207], v33 offset:6144
v_mul_f32 v61, v73, v73
s_waitcnt lgkmcnt(3)
v_mfma_f32_16x16x32_bf16 v[136:139], a[184:187], a[160:163], v[136:139]
ds_read_b128 a[212:215], v34 offset:3072
v_fma_f32 v61, v61, s39, v2
v_mfma_f32_16x16x32_bf16 v[152:155], a[184:187], a[164:167], v[152:155]
v_readlane_b32 s28, v14, s31
v_mfma_f32_16x16x32_bf16 v[168:171], a[184:187], a[168:171], v[168:171]
buffer_load_dwordx4 v21, s[52:55], s29 offen offset:2048 sc1 lds
v_mfma_f32_16x16x32_bf16 v[184:187], a[184:187], a[172:175], v[184:187]
ds_read_b128 a[216:219], v34 offset:5120
v_mfma_f32_16x16x32_bf16 v[188:191], a[188:191], a[172:175], v[188:191]
ds_read_b128 a[220:223], v34 offset:7168
v_mul_f32 v61, v61, v73
v_mfma_f32_16x16x32_bf16 v[172:175], a[188:191], a[168:171], v[172:175]
v_exp_f32 v61, v61
v_mfma_f32_16x16x32_bf16 v[156:159], a[188:191], a[164:167], v[156:159]
buffer_load_dwordx4 v21, s[52:55], s29 offen offset:3072 sc1 lds
v_mfma_f32_16x16x32_bf16 v[140:143], a[188:191], a[160:163], v[140:143]
s_add_u32 m0, s25, 98304
s_waitcnt vmcnt(8)
v_mfma_f32_16x16x32_bf16 v[128:131], a[208:211], a[192:195], v[128:131]
s_barrier
s_waitcnt lgkmcnt(1)
v_mfma_f32_16x16x32_bf16 v[144:147], a[208:211], a[196:199], v[144:147]
ds_read_b128 a[176:179], v34 offset:32768
v_mfma_f32_16x16x32_bf16 v[160:163], a[208:211], a[200:203], v[160:163]
buffer_load_dwordx4 v20, s[52:55], s28 offen offset:0 sc1 lds
v_mfma_f32_16x16x32_bf16 v[176:179], a[208:211], a[204:207], v[176:179]
ds_read_b128 a[160:163], v32 offset:32768
v_add_f32 v60, 1.0, v60
v_mfma_f32_16x16x32_bf16 v[180:183], a[212:215], a[204:207], v[180:183]
ds_read_b128 a[164:167], v32 offset:34816
v_add_f32 v61, 1.0, v61
v_mfma_f32_16x16x32_bf16 v[164:167], a[212:215], a[200:203], v[164:167]
ds_read_b128 a[168:171], v32 offset:36864
v_mfma_f32_16x16x32_bf16 v[148:151], a[212:215], a[196:199], v[148:151]
buffer_load_dwordx4 v20, s[52:55], s28 offen offset:1024 sc1 lds
v_mfma_f32_16x16x32_bf16 v[132:135], a[212:215], a[192:195], v[132:135]
ds_read_b128 a[172:175], v32 offset:38912
v_mul_f32 v71, v71, v62
v_mfma_f32_16x16x32_bf16 v[136:139], a[216:219], a[192:195], v[136:139]
ds_read_b128 a[180:183], v34 offset:34816
s_mul_hi_u32 s29, s28, 268435456
v_mfma_f32_16x16x32_bf16 v[152:155], a[216:219], a[196:199], v[152:155]
v_rcp_f32 v60, v60
v_mfma_f32_16x16x32_bf16 v[168:171], a[216:219], a[200:203], v[168:171]
buffer_load_dwordx4 v21, s[52:55], s28 offen offset:2048 sc1 lds
v_mfma_f32_16x16x32_bf16 v[184:187], a[216:219], a[204:207], v[184:187]
ds_read_b128 a[184:187], v34 offset:36864
s_waitcnt lgkmcnt(3)
v_mfma_f32_16x16x32_bf16 v[188:191], a[220:223], a[204:207], v[188:191]
ds_read_b128 a[188:191], v34 offset:38912
v_mul_f32 v72, v72, v60
v_mfma_f32_16x16x32_bf16 v[172:175], a[220:223], a[200:203], v[172:175]
v_rcp_f32 v61, v61
v_mfma_f32_16x16x32_bf16 v[156:159], a[220:223], a[196:199], v[156:159]
buffer_load_dwordx4 v21, s[52:55], s28 offen offset:3072 sc1 lds
v_mfma_f32_16x16x32_bf16 v[140:143], a[220:223], a[192:195], v[140:143]
s_add_u32 m0, s24, 98304
v_mfma_f32_16x16x32_bf16 v[128:131], a[176:179], a[160:163], v[128:131]
ds_read_b128 a[208:211], v34 offset:33792
v_mul_f32 v60, v74, v74
v_mfma_f32_16x16x32_bf16 v[144:147], a[176:179], a[164:167], v[144:147]
ds_read_b128 a[192:195], v33 offset:32768
v_fma_f32 v60, v60, s39, v2
v_mfma_f32_16x16x32_bf16 v[160:163], a[176:179], a[168:171], v[160:163]
buffer_load_dwordx4 v16, s[48:51], s29 offen offset:0 lds
s_waitcnt lgkmcnt(2)
v_mfma_f32_16x16x32_bf16 v[176:179], a[176:179], a[172:175], v[176:179]
ds_read_b128 a[196:199], v33 offset:34816
v_mfma_f32_16x16x32_bf16 v[180:183], a[180:183], a[172:175], v[180:183]
ds_read_b128 a[200:203], v33 offset:36864
v_mul_f32 v60, v60, v74
v_mfma_f32_16x16x32_bf16 v[164:167], a[180:183], a[168:171], v[164:167]
s_add_u32 s31, s31, 1
v_exp_f32 v60, v60
v_mfma_f32_16x16x32_bf16 v[148:151], a[180:183], a[164:167], v[148:151]
buffer_load_dwordx4 v17, s[48:51], s29 offen offset:1024 lds
v_mfma_f32_16x16x32_bf16 v[132:135], a[180:183], a[160:163], v[132:135]
ds_read_b128 a[204:207], v33 offset:38912
v_mul_f32 v62, v75, v75
v_mfma_f32_16x16x32_bf16 v[136:139], a[184:187], a[160:163], v[136:139]
ds_read_b128 a[212:215], v34 offset:35840
v_fma_f32 v62, v62, s39, v2
v_mfma_f32_16x16x32_bf16 v[152:155], a[184:187], a[164:167], v[152:155]
v_readlane_b32 s28, v14, s31
v_mfma_f32_16x16x32_bf16 v[168:171], a[184:187], a[168:171], v[168:171]
buffer_load_dwordx4 v18, s[48:51], s29 offen offset:2048 lds
v_mfma_f32_16x16x32_bf16 v[184:187], a[184:187], a[172:175], v[184:187]
ds_read_b128 a[216:219], v34 offset:37888
v_mfma_f32_16x16x32_bf16 v[188:191], a[188:191], a[172:175], v[188:191]
ds_read_b128 a[220:223], v34 offset:39936
v_mul_f32 v62, v62, v75
v_mfma_f32_16x16x32_bf16 v[172:175], a[188:191], a[168:171], v[172:175]
v_exp_f32 v62, v62
v_mfma_f32_16x16x32_bf16 v[156:159], a[188:191], a[164:167], v[156:159]
buffer_load_dwordx4 v19, s[48:51], s29 offen offset:3072 lds
v_mfma_f32_16x16x32_bf16 v[140:143], a[188:191], a[160:163], v[140:143]
s_add_u32 m0, s24, 0
s_waitcnt vmcnt(8) lgkmcnt(2)
v_mfma_f32_16x16x32_bf16 v[128:131], a[208:211], a[192:195], v[128:131]
s_barrier
v_mfma_f32_16x16x32_bf16 v[144:147], a[208:211], a[196:199], v[144:147]
ds_read_b128 a[176:179], v37 offset:0
v_mfma_f32_16x16x32_bf16 v[160:163], a[208:211], a[200:203], v[160:163]
buffer_load_dwordx4 v16, s[48:51], s28 offen offset:0 lds
v_mfma_f32_16x16x32_bf16 v[176:179], a[208:211], a[204:207], v[176:179]
ds_read_b128 a[160:163], v35 offset:0
v_add_f32 v60, 1.0, v60
v_mfma_f32_16x16x32_bf16 v[180:183], a[212:215], a[204:207], v[180:183]
ds_read_b128 a[164:167], v35 offset:2048
v_add_f32 v62, 1.0, v62
v_mfma_f32_16x16x32_bf16 v[164:167], a[212:215], a[200:203], v[164:167]
ds_read_b128 a[168:171], v35 offset:4096
v_mfma_f32_16x16x32_bf16 v[148:151], a[212:215], a[196:199], v[148:151]
buffer_load_dwordx4 v17, s[48:51], s28 offen offset:1024 lds
v_mfma_f32_16x16x32_bf16 v[132:135], a[212:215], a[192:195], v[132:135]
ds_read_b128 a[172:175], v35 offset:6144
v_mul_f32 v73, v73, v61
s_waitcnt lgkmcnt(4)
v_mfma_f32_16x16x32_bf16 v[136:139], a[216:219], a[192:195], v[136:139]
ds_read_b128 a[180:183], v37 offset:2048
s_mul_i32 s29, s28, 16
v_mfma_f32_16x16x32_bf16 v[152:155], a[216:219], a[196:199], v[152:155]
v_rcp_f32 v60, v60
v_mfma_f32_16x16x32_bf16 v[168:171], a[216:219], a[200:203], v[168:171]
buffer_load_dwordx4 v18, s[48:51], s28 offen offset:2048 lds
v_mfma_f32_16x16x32_bf16 v[184:187], a[216:219], a[204:207], v[184:187]
ds_read_b128 a[184:187], v37 offset:4096
v_mfma_f32_16x16x32_bf16 v[188:191], a[220:223], a[204:207], v[188:191]
ds_read_b128 a[188:191], v37 offset:6144
v_mul_f32 v74, v74, v60
v_mfma_f32_16x16x32_bf16 v[172:175], a[220:223], a[200:203], v[172:175]
v_rcp_f32 v62, v62
v_mfma_f32_16x16x32_bf16 v[156:159], a[220:223], a[196:199], v[156:159]
buffer_load_dwordx4 v19, s[48:51], s28 offen offset:3072 lds
v_mfma_f32_16x16x32_bf16 v[140:143], a[220:223], a[192:195], v[140:143]
s_add_u32 m0, s25, 0
s_waitcnt lgkmcnt(2)
v_mfma_f32_16x16x32_bf16 v[128:131], a[176:179], a[160:163], v[128:131]
ds_read_b128 a[208:211], v37 offset:1024
v_mul_f32 v60, v76, v76
v_mfma_f32_16x16x32_bf16 v[144:147], a[176:179], a[164:167], v[144:147]
ds_read_b128 a[192:195], v36 offset:0
v_fma_f32 v60, v60, s39, v2
v_mfma_f32_16x16x32_bf16 v[160:163], a[176:179], a[168:171], v[160:163]
buffer_load_dwordx4 v20, s[52:55], s29 offen offset:0 sc1 lds
v_mfma_f32_16x16x32_bf16 v[176:179], a[176:179], a[172:175], v[176:179]
ds_read_b128 a[196:199], v36 offset:2048
v_mfma_f32_16x16x32_bf16 v[180:183], a[180:183], a[172:175], v[180:183]
ds_read_b128 a[200:203], v36 offset:4096
v_mul_f32 v60, v60, v76
v_mfma_f32_16x16x32_bf16 v[164:167], a[180:183], a[168:171], v[164:167]
s_add_u32 s31, s31, 1
v_exp_f32 v60, v60
v_mfma_f32_16x16x32_bf16 v[148:151], a[180:183], a[164:167], v[148:151]
buffer_load_dwordx4 v20, s[52:55], s29 offen offset:1024 sc1 lds
v_mfma_f32_16x16x32_bf16 v[132:135], a[180:183], a[160:163], v[132:135]
ds_read_b128 a[204:207], v36 offset:6144
v_mul_f32 v61, v77, v77
s_waitcnt lgkmcnt(3)
v_mfma_f32_16x16x32_bf16 v[136:139], a[184:187], a[160:163], v[136:139]
ds_read_b128 a[212:215], v37 offset:3072
v_fma_f32 v61, v61, s39, v2
v_mfma_f32_16x16x32_bf16 v[152:155], a[184:187], a[164:167], v[152:155]
v_readlane_b32 s28, v14, s31
v_mfma_f32_16x16x32_bf16 v[168:171], a[184:187], a[168:171], v[168:171]
buffer_load_dwordx4 v21, s[52:55], s29 offen offset:2048 sc1 lds
v_mfma_f32_16x16x32_bf16 v[184:187], a[184:187], a[172:175], v[184:187]
ds_read_b128 a[216:219], v37 offset:5120
v_mfma_f32_16x16x32_bf16 v[188:191], a[188:191], a[172:175], v[188:191]
ds_read_b128 a[220:223], v37 offset:7168
v_mul_f32 v61, v61, v77
v_mfma_f32_16x16x32_bf16 v[172:175], a[188:191], a[168:171], v[172:175]
v_exp_f32 v61, v61
v_mfma_f32_16x16x32_bf16 v[156:159], a[188:191], a[164:167], v[156:159]
buffer_load_dwordx4 v21, s[52:55], s29 offen offset:3072 sc1 lds
v_mfma_f32_16x16x32_bf16 v[140:143], a[188:191], a[160:163], v[140:143]
s_add_u32 m0, s25, 32768
s_waitcnt vmcnt(8)
v_mfma_f32_16x16x32_bf16 v[128:131], a[208:211], a[192:195], v[128:131]
s_barrier
s_waitcnt lgkmcnt(1)
v_mfma_f32_16x16x32_bf16 v[144:147], a[208:211], a[196:199], v[144:147]
ds_read_b128 a[176:179], v37 offset:32768
v_mfma_f32_16x16x32_bf16 v[160:163], a[208:211], a[200:203], v[160:163]
buffer_load_dwordx4 v20, s[52:55], s28 offen offset:0 sc1 lds
v_mfma_f32_16x16x32_bf16 v[176:179], a[208:211], a[204:207], v[176:179]
ds_read_b128 a[160:163], v35 offset:32768
v_add_f32 v60, 1.0, v60
v_mfma_f32_16x16x32_bf16 v[180:183], a[212:215], a[204:207], v[180:183]
ds_read_b128 a[164:167], v35 offset:34816
v_add_f32 v61, 1.0, v61
v_mfma_f32_16x16x32_bf16 v[164:167], a[212:215], a[200:203], v[164:167]
ds_read_b128 a[168:171], v35 offset:36864
v_mfma_f32_16x16x32_bf16 v[148:151], a[212:215], a[196:199], v[148:151]
buffer_load_dwordx4 v20, s[52:55], s28 offen offset:1024 sc1 lds
v_mfma_f32_16x16x32_bf16 v[132:135], a[212:215], a[192:195], v[132:135]
ds_read_b128 a[172:175], v35 offset:38912
v_mul_f32 v75, v75, v62
v_mfma_f32_16x16x32_bf16 v[136:139], a[216:219], a[192:195], v[136:139]
ds_read_b128 a[180:183], v37 offset:34816
s_mul_hi_u32 s29, s28, 268435456
v_mfma_f32_16x16x32_bf16 v[152:155], a[216:219], a[196:199], v[152:155]
v_rcp_f32 v60, v60
v_mfma_f32_16x16x32_bf16 v[168:171], a[216:219], a[200:203], v[168:171]
buffer_load_dwordx4 v21, s[52:55], s28 offen offset:2048 sc1 lds
v_mfma_f32_16x16x32_bf16 v[184:187], a[216:219], a[204:207], v[184:187]
ds_read_b128 a[184:187], v37 offset:36864
s_waitcnt lgkmcnt(3)
v_mfma_f32_16x16x32_bf16 v[188:191], a[220:223], a[204:207], v[188:191]
ds_read_b128 a[188:191], v37 offset:38912
v_mul_f32 v76, v76, v60
v_mfma_f32_16x16x32_bf16 v[172:175], a[220:223], a[200:203], v[172:175]
v_rcp_f32 v61, v61
v_mfma_f32_16x16x32_bf16 v[156:159], a[220:223], a[196:199], v[156:159]
buffer_load_dwordx4 v21, s[52:55], s28 offen offset:3072 sc1 lds
v_mfma_f32_16x16x32_bf16 v[140:143], a[220:223], a[192:195], v[140:143]
s_add_u32 m0, s24, 32768
v_mfma_f32_16x16x32_bf16 v[128:131], a[176:179], a[160:163], v[128:131]
ds_read_b128 a[208:211], v37 offset:33792
v_mul_f32 v60, v78, v78
v_mfma_f32_16x16x32_bf16 v[144:147], a[176:179], a[164:167], v[144:147]
ds_read_b128 a[192:195], v36 offset:32768
v_fma_f32 v60, v60, s39, v2
v_mfma_f32_16x16x32_bf16 v[160:163], a[176:179], a[168:171], v[160:163]
buffer_load_dwordx4 v16, s[48:51], s29 offen offset:0 lds
s_waitcnt lgkmcnt(2)
v_mfma_f32_16x16x32_bf16 v[176:179], a[176:179], a[172:175], v[176:179]
ds_read_b128 a[196:199], v36 offset:34816
v_mfma_f32_16x16x32_bf16 v[180:183], a[180:183], a[172:175], v[180:183]
ds_read_b128 a[200:203], v36 offset:36864
v_mul_f32 v60, v60, v78
v_mfma_f32_16x16x32_bf16 v[164:167], a[180:183], a[168:171], v[164:167]
s_add_u32 s31, s31, 1
v_exp_f32 v60, v60
v_mfma_f32_16x16x32_bf16 v[148:151], a[180:183], a[164:167], v[148:151]
buffer_load_dwordx4 v17, s[48:51], s29 offen offset:1024 lds
v_mfma_f32_16x16x32_bf16 v[132:135], a[180:183], a[160:163], v[132:135]
ds_read_b128 a[204:207], v36 offset:38912
v_mul_f32 v62, v79, v79
v_mfma_f32_16x16x32_bf16 v[136:139], a[184:187], a[160:163], v[136:139]
ds_read_b128 a[212:215], v37 offset:35840
v_fma_f32 v62, v62, s39, v2
v_mfma_f32_16x16x32_bf16 v[152:155], a[184:187], a[164:167], v[152:155]
v_readlane_b32 s28, v14, s31
v_mfma_f32_16x16x32_bf16 v[168:171], a[184:187], a[168:171], v[168:171]
buffer_load_dwordx4 v18, s[48:51], s29 offen offset:2048 lds
v_mfma_f32_16x16x32_bf16 v[184:187], a[184:187], a[172:175], v[184:187]
ds_read_b128 a[216:219], v37 offset:37888
v_mfma_f32_16x16x32_bf16 v[188:191], a[188:191], a[172:175], v[188:191]
ds_read_b128 a[220:223], v37 offset:39936
v_mul_f32 v62, v62, v79
v_mfma_f32_16x16x32_bf16 v[172:175], a[188:191], a[168:171], v[172:175]
v_exp_f32 v62, v62
v_mfma_f32_16x16x32_bf16 v[156:159], a[188:191], a[164:167], v[156:159]
buffer_load_dwordx4 v19, s[48:51], s29 offen offset:3072 lds
v_mfma_f32_16x16x32_bf16 v[140:143], a[188:191], a[160:163], v[140:143]
s_add_u32 m0, s24, 65536
s_waitcnt vmcnt(8) lgkmcnt(2)
v_mfma_f32_16x16x32_bf16 v[128:131], a[208:211], a[192:195], v[128:131]
s_barrier
v_mfma_f32_16x16x32_bf16 v[144:147], a[208:211], a[196:199], v[144:147]
ds_read_b128 a[176:179], v34 offset:0
v_mfma_f32_16x16x32_bf16 v[160:163], a[208:211], a[200:203], v[160:163]
buffer_load_dwordx4 v16, s[48:51], s28 offen offset:0 lds
v_mfma_f32_16x16x32_bf16 v[176:179], a[208:211], a[204:207], v[176:179]
ds_read_b128 a[160:163], v32 offset:0
v_add_f32 v60, 1.0, v60
v_mfma_f32_16x16x32_bf16 v[180:183], a[212:215], a[204:207], v[180:183]
ds_read_b128 a[164:167], v32 offset:2048
v_add_f32 v62, 1.0, v62
v_mfma_f32_16x16x32_bf16 v[164:167], a[212:215], a[200:203], v[164:167]
ds_read_b128 a[168:171], v32 offset:4096
v_mfma_f32_16x16x32_bf16 v[148:151], a[212:215], a[196:199], v[148:151]
buffer_load_dwordx4 v17, s[48:51], s28 offen offset:1024 lds
v_mfma_f32_16x16x32_bf16 v[132:135], a[212:215], a[192:195], v[132:135]
ds_read_b128 a[172:175], v32 offset:6144
v_mul_f32 v77, v77, v61
s_waitcnt lgkmcnt(4)
v_mfma_f32_16x16x32_bf16 v[136:139], a[216:219], a[192:195], v[136:139]
ds_read_b128 a[180:183], v34 offset:2048
s_mul_i32 s29, s28, 16
v_mfma_f32_16x16x32_bf16 v[152:155], a[216:219], a[196:199], v[152:155]
v_rcp_f32 v60, v60
v_mfma_f32_16x16x32_bf16 v[168:171], a[216:219], a[200:203], v[168:171]
buffer_load_dwordx4 v18, s[48:51], s28 offen offset:2048 lds
v_mfma_f32_16x16x32_bf16 v[184:187], a[216:219], a[204:207], v[184:187]
ds_read_b128 a[184:187], v34 offset:4096
v_mfma_f32_16x16x32_bf16 v[188:191], a[220:223], a[204:207], v[188:191]
ds_read_b128 a[188:191], v34 offset:6144
v_mul_f32 v78, v78, v60
v_mfma_f32_16x16x32_bf16 v[172:175], a[220:223], a[200:203], v[172:175]
v_rcp_f32 v62, v62
v_mfma_f32_16x16x32_bf16 v[156:159], a[220:223], a[196:199], v[156:159]
buffer_load_dwordx4 v19, s[48:51], s28 offen offset:3072 lds
v_mfma_f32_16x16x32_bf16 v[140:143], a[220:223], a[192:195], v[140:143]
s_add_u32 m0, s25, 65536
s_waitcnt lgkmcnt(2)
v_mfma_f32_16x16x32_bf16 v[128:131], a[176:179], a[160:163], v[128:131]
ds_read_b128 a[208:211], v34 offset:1024
v_mul_f32 v60, v80, v80
v_mfma_f32_16x16x32_bf16 v[144:147], a[176:179], a[164:167], v[144:147]
ds_read_b128 a[192:195], v33 offset:0
v_fma_f32 v60, v60, s39, v2
v_mfma_f32_16x16x32_bf16 v[160:163], a[176:179], a[168:171], v[160:163]
buffer_load_dwordx4 v20, s[52:55], s29 offen offset:0 sc1 lds
v_mfma_f32_16x16x32_bf16 v[176:179], a[176:179], a[172:175], v[176:179]
ds_read_b128 a[196:199], v33 offset:2048
v_mfma_f32_16x16x32_bf16 v[180:183], a[180:183], a[172:175], v[180:183]
ds_read_b128 a[200:203], v33 offset:4096
v_mul_f32 v60, v60, v80
v_mfma_f32_16x16x32_bf16 v[164:167], a[180:183], a[168:171], v[164:167]
s_add_u32 s31, s31, 1
v_exp_f32 v60, v60
v_mfma_f32_16x16x32_bf16 v[148:151], a[180:183], a[164:167], v[148:151]
buffer_load_dwordx4 v20, s[52:55], s29 offen offset:1024 sc1 lds
v_mfma_f32_16x16x32_bf16 v[132:135], a[180:183], a[160:163], v[132:135]
ds_read_b128 a[204:207], v33 offset:6144
v_mul_f32 v61, v81, v81
s_waitcnt lgkmcnt(3)
v_mfma_f32_16x16x32_bf16 v[136:139], a[184:187], a[160:163], v[136:139]
ds_read_b128 a[212:215], v34 offset:3072
v_fma_f32 v61, v61, s39, v2
v_mfma_f32_16x16x32_bf16 v[152:155], a[184:187], a[164:167], v[152:155]
v_readlane_b32 s28, v14, s31
v_mfma_f32_16x16x32_bf16 v[168:171], a[184:187], a[168:171], v[168:171]
buffer_load_dwordx4 v21, s[52:55], s29 offen offset:2048 sc1 lds
v_mfma_f32_16x16x32_bf16 v[184:187], a[184:187], a[172:175], v[184:187]
ds_read_b128 a[216:219], v34 offset:5120
v_mfma_f32_16x16x32_bf16 v[188:191], a[188:191], a[172:175], v[188:191]
ds_read_b128 a[220:223], v34 offset:7168
v_mul_f32 v61, v61, v81
v_mfma_f32_16x16x32_bf16 v[172:175], a[188:191], a[168:171], v[172:175]
v_exp_f32 v61, v61
v_mfma_f32_16x16x32_bf16 v[156:159], a[188:191], a[164:167], v[156:159]
buffer_load_dwordx4 v21, s[52:55], s29 offen offset:3072 sc1 lds
v_mfma_f32_16x16x32_bf16 v[140:143], a[188:191], a[160:163], v[140:143]
s_add_u32 m0, s25, 98304
s_waitcnt vmcnt(8)
v_mfma_f32_16x16x32_bf16 v[128:131], a[208:211], a[192:195], v[128:131]
s_barrier
s_waitcnt lgkmcnt(1)
v_mfma_f32_16x16x32_bf16 v[144:147], a[208:211], a[196:199], v[144:147]
ds_read_b128 a[176:179], v34 offset:32768
v_mfma_f32_16x16x32_bf16 v[160:163], a[208:211], a[200:203], v[160:163]
buffer_load_dwordx4 v20, s[52:55], s28 offen offset:0 sc1 lds
v_mfma_f32_16x16x32_bf16 v[176:179], a[208:211], a[204:207], v[176:179]
ds_read_b128 a[160:163], v32 offset:32768
v_add_f32 v60, 1.0, v60
v_mfma_f32_16x16x32_bf16 v[180:183], a[212:215], a[204:207], v[180:183]
ds_read_b128 a[164:167], v32 offset:34816
v_add_f32 v61, 1.0, v61
v_mfma_f32_16x16x32_bf16 v[164:167], a[212:215], a[200:203], v[164:167]
ds_read_b128 a[168:171], v32 offset:36864
v_mfma_f32_16x16x32_bf16 v[148:151], a[212:215], a[196:199], v[148:151]
buffer_load_dwordx4 v20, s[52:55], s28 offen offset:1024 sc1 lds
v_mfma_f32_16x16x32_bf16 v[132:135], a[212:215], a[192:195], v[132:135]
ds_read_b128 a[172:175], v32 offset:38912
v_mul_f32 v79, v79, v62
v_mfma_f32_16x16x32_bf16 v[136:139], a[216:219], a[192:195], v[136:139]
ds_read_b128 a[180:183], v34 offset:34816
s_mul_hi_u32 s29, s28, 268435456
v_mfma_f32_16x16x32_bf16 v[152:155], a[216:219], a[196:199], v[152:155]
v_rcp_f32 v60, v60
v_mfma_f32_16x16x32_bf16 v[168:171], a[216:219], a[200:203], v[168:171]
buffer_load_dwordx4 v21, s[52:55], s28 offen offset:2048 sc1 lds
v_mfma_f32_16x16x32_bf16 v[184:187], a[216:219], a[204:207], v[184:187]
ds_read_b128 a[184:187], v34 offset:36864
s_waitcnt lgkmcnt(3)
v_mfma_f32_16x16x32_bf16 v[188:191], a[220:223], a[204:207], v[188:191]
ds_read_b128 a[188:191], v34 offset:38912
v_mul_f32 v80, v80, v60
v_mfma_f32_16x16x32_bf16 v[172:175], a[220:223], a[200:203], v[172:175]
v_rcp_f32 v61, v61
v_mfma_f32_16x16x32_bf16 v[156:159], a[220:223], a[196:199], v[156:159]
buffer_load_dwordx4 v21, s[52:55], s28 offen offset:3072 sc1 lds
v_mfma_f32_16x16x32_bf16 v[140:143], a[220:223], a[192:195], v[140:143]
s_add_u32 m0, s24, 98304
v_mfma_f32_16x16x32_bf16 v[128:131], a[176:179], a[160:163], v[128:131]
ds_read_b128 a[208:211], v34 offset:33792
v_mul_f32 v60, v82, v82
v_mfma_f32_16x16x32_bf16 v[144:147], a[176:179], a[164:167], v[144:147]
ds_read_b128 a[192:195], v33 offset:32768
v_fma_f32 v60, v60, s39, v2
v_mfma_f32_16x16x32_bf16 v[160:163], a[176:179], a[168:171], v[160:163]
buffer_load_dwordx4 v16, s[48:51], s29 offen offset:0 lds
s_waitcnt lgkmcnt(2)
v_mfma_f32_16x16x32_bf16 v[176:179], a[176:179], a[172:175], v[176:179]
ds_read_b128 a[196:199], v33 offset:34816
v_mfma_f32_16x16x32_bf16 v[180:183], a[180:183], a[172:175], v[180:183]
ds_read_b128 a[200:203], v33 offset:36864
v_mul_f32 v60, v60, v82
v_mfma_f32_16x16x32_bf16 v[164:167], a[180:183], a[168:171], v[164:167]
s_add_u32 s31, s31, 1
v_exp_f32 v60, v60
v_mfma_f32_16x16x32_bf16 v[148:151], a[180:183], a[164:167], v[148:151]
buffer_load_dwordx4 v17, s[48:51], s29 offen offset:1024 lds
v_mfma_f32_16x16x32_bf16 v[132:135], a[180:183], a[160:163], v[132:135]
ds_read_b128 a[204:207], v33 offset:38912
v_mul_f32 v62, v83, v83
v_mfma_f32_16x16x32_bf16 v[136:139], a[184:187], a[160:163], v[136:139]
ds_read_b128 a[212:215], v34 offset:35840
v_fma_f32 v62, v62, s39, v2
v_mfma_f32_16x16x32_bf16 v[152:155], a[184:187], a[164:167], v[152:155]
v_readlane_b32 s28, v14, s31
v_mfma_f32_16x16x32_bf16 v[168:171], a[184:187], a[168:171], v[168:171]
buffer_load_dwordx4 v18, s[48:51], s29 offen offset:2048 lds
v_mfma_f32_16x16x32_bf16 v[184:187], a[184:187], a[172:175], v[184:187]
ds_read_b128 a[216:219], v34 offset:37888
v_mfma_f32_16x16x32_bf16 v[188:191], a[188:191], a[172:175], v[188:191]
ds_read_b128 a[220:223], v34 offset:39936
v_mul_f32 v62, v62, v83
v_mfma_f32_16x16x32_bf16 v[172:175], a[188:191], a[168:171], v[172:175]
v_exp_f32 v62, v62
v_mfma_f32_16x16x32_bf16 v[156:159], a[188:191], a[164:167], v[156:159]
buffer_load_dwordx4 v19, s[48:51], s29 offen offset:3072 lds
v_mfma_f32_16x16x32_bf16 v[140:143], a[188:191], a[160:163], v[140:143]
s_add_u32 m0, s24, 0
s_waitcnt vmcnt(8) lgkmcnt(2)
v_mfma_f32_16x16x32_bf16 v[128:131], a[208:211], a[192:195], v[128:131]
s_barrier
v_mfma_f32_16x16x32_bf16 v[144:147], a[208:211], a[196:199], v[144:147]
ds_read_b128 a[176:179], v37 offset:0
v_mfma_f32_16x16x32_bf16 v[160:163], a[208:211], a[200:203], v[160:163]
buffer_load_dwordx4 v16, s[48:51], s28 offen offset:0 lds
v_mfma_f32_16x16x32_bf16 v[176:179], a[208:211], a[204:207], v[176:179]
ds_read_b128 a[160:163], v35 offset:0
v_add_f32 v60, 1.0, v60
v_mfma_f32_16x16x32_bf16 v[180:183], a[212:215], a[204:207], v[180:183]
ds_read_b128 a[164:167], v35 offset:2048
v_add_f32 v62, 1.0, v62
v_mfma_f32_16x16x32_bf16 v[164:167], a[212:215], a[200:203], v[164:167]
ds_read_b128 a[168:171], v35 offset:4096
v_mfma_f32_16x16x32_bf16 v[148:151], a[212:215], a[196:199], v[148:151]
buffer_load_dwordx4 v17, s[48:51], s28 offen offset:1024 lds
v_mfma_f32_16x16x32_bf16 v[132:135], a[212:215], a[192:195], v[132:135]
ds_read_b128 a[172:175], v35 offset:6144
v_mul_f32 v81, v81, v61
s_waitcnt lgkmcnt(4)
v_mfma_f32_16x16x32_bf16 v[136:139], a[216:219], a[192:195], v[136:139]
ds_read_b128 a[180:183], v37 offset:2048
s_mul_i32 s29, s28, 16
v_mfma_f32_16x16x32_bf16 v[152:155], a[216:219], a[196:199], v[152:155]
v_rcp_f32 v60, v60
v_mfma_f32_16x16x32_bf16 v[168:171], a[216:219], a[200:203], v[168:171]
buffer_load_dwordx4 v18, s[48:51], s28 offen offset:2048 lds
v_mfma_f32_16x16x32_bf16 v[184:187], a[216:219], a[204:207], v[184:187]
ds_read_b128 a[184:187], v37 offset:4096
v_mfma_f32_16x16x32_bf16 v[188:191], a[220:223], a[204:207], v[188:191]
ds_read_b128 a[188:191], v37 offset:6144
v_mul_f32 v82, v82, v60
v_mfma_f32_16x16x32_bf16 v[172:175], a[220:223], a[200:203], v[172:175]
v_rcp_f32 v62, v62
v_mfma_f32_16x16x32_bf16 v[156:159], a[220:223], a[196:199], v[156:159]
buffer_load_dwordx4 v19, s[48:51], s28 offen offset:3072 lds
v_mfma_f32_16x16x32_bf16 v[140:143], a[220:223], a[192:195], v[140:143]
s_add_u32 m0, s25, 0
s_waitcnt lgkmcnt(2)
v_mfma_f32_16x16x32_bf16 v[128:131], a[176:179], a[160:163], v[128:131]
ds_read_b128 a[208:211], v37 offset:1024
v_mul_f32 v60, v84, v84
v_mfma_f32_16x16x32_bf16 v[144:147], a[176:179], a[164:167], v[144:147]
ds_read_b128 a[192:195], v36 offset:0
v_fma_f32 v60, v60, s39, v2
v_mfma_f32_16x16x32_bf16 v[160:163], a[176:179], a[168:171], v[160:163]
buffer_load_dwordx4 v20, s[52:55], s29 offen offset:0 sc1 lds
v_mfma_f32_16x16x32_bf16 v[176:179], a[176:179], a[172:175], v[176:179]
ds_read_b128 a[196:199], v36 offset:2048
v_mfma_f32_16x16x32_bf16 v[180:183], a[180:183], a[172:175], v[180:183]
ds_read_b128 a[200:203], v36 offset:4096
v_mul_f32 v60, v60, v84
v_mfma_f32_16x16x32_bf16 v[164:167], a[180:183], a[168:171], v[164:167]
s_add_u32 s31, s31, 1
v_exp_f32 v60, v60
v_mfma_f32_16x16x32_bf16 v[148:151], a[180:183], a[164:167], v[148:151]
buffer_load_dwordx4 v20, s[52:55], s29 offen offset:1024 sc1 lds
v_mfma_f32_16x16x32_bf16 v[132:135], a[180:183], a[160:163], v[132:135]
ds_read_b128 a[204:207], v36 offset:6144
v_mul_f32 v61, v85, v85
s_waitcnt lgkmcnt(3)
v_mfma_f32_16x16x32_bf16 v[136:139], a[184:187], a[160:163], v[136:139]
ds_read_b128 a[212:215], v37 offset:3072
v_fma_f32 v61, v61, s39, v2
v_mfma_f32_16x16x32_bf16 v[152:155], a[184:187], a[164:167], v[152:155]
v_readlane_b32 s28, v14, s31
v_mfma_f32_16x16x32_bf16 v[168:171], a[184:187], a[168:171], v[168:171]
buffer_load_dwordx4 v21, s[52:55], s29 offen offset:2048 sc1 lds
v_mfma_f32_16x16x32_bf16 v[184:187], a[184:187], a[172:175], v[184:187]
ds_read_b128 a[216:219], v37 offset:5120
v_mfma_f32_16x16x32_bf16 v[188:191], a[188:191], a[172:175], v[188:191]
ds_read_b128 a[220:223], v37 offset:7168
v_mul_f32 v61, v61, v85
v_mfma_f32_16x16x32_bf16 v[172:175], a[188:191], a[168:171], v[172:175]
v_exp_f32 v61, v61
v_mfma_f32_16x16x32_bf16 v[156:159], a[188:191], a[164:167], v[156:159]
buffer_load_dwordx4 v21, s[52:55], s29 offen offset:3072 sc1 lds
v_mfma_f32_16x16x32_bf16 v[140:143], a[188:191], a[160:163], v[140:143]
s_add_u32 m0, s25, 32768
s_waitcnt vmcnt(8)
v_mfma_f32_16x16x32_bf16 v[128:131], a[208:211], a[192:195], v[128:131]
s_barrier
s_waitcnt lgkmcnt(1)
v_mfma_f32_16x16x32_bf16 v[144:147], a[208:211], a[196:199], v[144:147]
ds_read_b128 a[176:179], v37 offset:32768
v_mfma_f32_16x16x32_bf16 v[160:163], a[208:211], a[200:203], v[160:163]
buffer_load_dwordx4 v20, s[52:55], s28 offen offset:0 sc1 lds
v_mfma_f32_16x16x32_bf16 v[176:179], a[208:211], a[204:207], v[176:179]
ds_read_b128 a[160:163], v35 offset:32768
v_add_f32 v60, 1.0, v60
v_mfma_f32_16x16x32_bf16 v[180:183], a[212:215], a[204:207], v[180:183]
ds_read_b128 a[164:167], v35 offset:34816
v_add_f32 v61, 1.0, v61
v_mfma_f32_16x16x32_bf16 v[164:167], a[212:215], a[200:203], v[164:167]
ds_read_b128 a[168:171], v35 offset:36864
v_mfma_f32_16x16x32_bf16 v[148:151], a[212:215], a[196:199], v[148:151]
buffer_load_dwordx4 v20, s[52:55], s28 offen offset:1024 sc1 lds
v_mfma_f32_16x16x32_bf16 v[132:135], a[212:215], a[192:195], v[132:135]
ds_read_b128 a[172:175], v35 offset:38912
v_mul_f32 v83, v83, v62
v_mfma_f32_16x16x32_bf16 v[136:139], a[216:219], a[192:195], v[136:139]
ds_read_b128 a[180:183], v37 offset:34816
s_mul_hi_u32 s29, s28, 268435456
v_mfma_f32_16x16x32_bf16 v[152:155], a[216:219], a[196:199], v[152:155]
v_rcp_f32 v60, v60
v_mfma_f32_16x16x32_bf16 v[168:171], a[216:219], a[200:203], v[168:171]
buffer_load_dwordx4 v21, s[52:55], s28 offen offset:2048 sc1 lds
v_mfma_f32_16x16x32_bf16 v[184:187], a[216:219], a[204:207], v[184:187]
ds_read_b128 a[184:187], v37 offset:36864
s_waitcnt lgkmcnt(3)
v_mfma_f32_16x16x32_bf16 v[188:191], a[220:223], a[204:207], v[188:191]
ds_read_b128 a[188:191], v37 offset:38912
v_mul_f32 v84, v84, v60
v_mfma_f32_16x16x32_bf16 v[172:175], a[220:223], a[200:203], v[172:175]
v_rcp_f32 v61, v61
v_mfma_f32_16x16x32_bf16 v[156:159], a[220:223], a[196:199], v[156:159]
buffer_load_dwordx4 v21, s[52:55], s28 offen offset:3072 sc1 lds
v_mfma_f32_16x16x32_bf16 v[140:143], a[220:223], a[192:195], v[140:143]
s_add_u32 m0, s24, 32768
v_mfma_f32_16x16x32_bf16 v[128:131], a[176:179], a[160:163], v[128:131]
ds_read_b128 a[208:211], v37 offset:33792
v_mul_f32 v60, v86, v86
v_mfma_f32_16x16x32_bf16 v[144:147], a[176:179], a[164:167], v[144:147]
ds_read_b128 a[192:195], v36 offset:32768
v_fma_f32 v60, v60, s39, v2
v_mfma_f32_16x16x32_bf16 v[160:163], a[176:179], a[168:171], v[160:163]
buffer_load_dwordx4 v16, s[48:51], s29 offen offset:0 lds
s_waitcnt lgkmcnt(2)
v_mfma_f32_16x16x32_bf16 v[176:179], a[176:179], a[172:175], v[176:179]
ds_read_b128 a[196:199], v36 offset:34816
v_and_b32 v3, 15, v0
v_mfma_f32_16x16x32_bf16 v[180:183], a[180:183], a[172:175], v[180:183]
ds_read_b128 a[200:203], v36 offset:36864
v_mul_f32 v60, v60, v86
v_mfma_f32_16x16x32_bf16 v[164:167], a[180:183], a[168:171], v[164:167]
s_add_u32 s31, s31, 1
v_exp_f32 v60, v60
v_mfma_f32_16x16x32_bf16 v[148:151], a[180:183], a[164:167], v[148:151]
buffer_load_dwordx4 v17, s[48:51], s29 offen offset:1024 lds
v_mfma_f32_16x16x32_bf16 v[132:135], a[180:183], a[160:163], v[132:135]
ds_read_b128 a[204:207], v36 offset:38912
v_mul_f32 v62, v87, v87
v_mfma_f32_16x16x32_bf16 v[136:139], a[184:187], a[160:163], v[136:139]
ds_read_b128 a[212:215], v37 offset:35840
v_fma_f32 v62, v62, s39, v2
v_mfma_f32_16x16x32_bf16 v[152:155], a[184:187], a[164:167], v[152:155]
v_readlane_b32 s28, v14, s31
v_mfma_f32_16x16x32_bf16 v[168:171], a[184:187], a[168:171], v[168:171]
buffer_load_dwordx4 v18, s[48:51], s29 offen offset:2048 lds
v_mfma_f32_16x16x32_bf16 v[184:187], a[184:187], a[172:175], v[184:187]
ds_read_b128 a[216:219], v37 offset:37888
s_lshl_b32 s27, s83, 13
v_mfma_f32_16x16x32_bf16 v[188:191], a[188:191], a[172:175], v[188:191]
ds_read_b128 a[220:223], v37 offset:39936
v_mul_f32 v62, v62, v87
v_mfma_f32_16x16x32_bf16 v[172:175], a[188:191], a[168:171], v[172:175]
v_exp_f32 v62, v62
v_mfma_f32_16x16x32_bf16 v[156:159], a[188:191], a[164:167], v[156:159]
buffer_load_dwordx4 v19, s[48:51], s29 offen offset:3072 lds
v_mfma_f32_16x16x32_bf16 v[140:143], a[188:191], a[160:163], v[140:143]
s_add_u32 m0, s24, 65536
s_waitcnt vmcnt(8) lgkmcnt(2)
v_mfma_f32_16x16x32_bf16 v[128:131], a[208:211], a[192:195], v[128:131]
s_barrier
v_mfma_f32_16x16x32_bf16 v[144:147], a[208:211], a[196:199], v[144:147]
ds_read_b128 a[176:179], v34 offset:0
v_mfma_f32_16x16x32_bf16 v[160:163], a[208:211], a[200:203], v[160:163]
buffer_load_dwordx4 v16, s[48:51], s28 offen offset:0 lds
v_mfma_f32_16x16x32_bf16 v[176:179], a[208:211], a[204:207], v[176:179]
ds_read_b128 a[160:163], v32 offset:0
v_add_f32 v60, 1.0, v60
v_mfma_f32_16x16x32_bf16 v[180:183], a[212:215], a[204:207], v[180:183]
ds_read_b128 a[164:167], v32 offset:2048
v_add_f32 v62, 1.0, v62
v_mfma_f32_16x16x32_bf16 v[164:167], a[212:215], a[200:203], v[164:167]
ds_read_b128 a[168:171], v32 offset:4096
s_add_u32 s27, s27, 147456
v_mfma_f32_16x16x32_bf16 v[148:151], a[212:215], a[196:199], v[148:151]
buffer_load_dwordx4 v17, s[48:51], s28 offen offset:1024 lds
v_mfma_f32_16x16x32_bf16 v[132:135], a[212:215], a[192:195], v[132:135]
ds_read_b128 a[172:175], v32 offset:6144
v_mul_f32 v85, v85, v61
s_waitcnt lgkmcnt(4)
v_mfma_f32_16x16x32_bf16 v[136:139], a[216:219], a[192:195], v[136:139]
ds_read_b128 a[180:183], v34 offset:2048
s_mul_i32 s29, s28, 16
v_mfma_f32_16x16x32_bf16 v[152:155], a[216:219], a[196:199], v[152:155]
v_rcp_f32 v60, v60
v_mfma_f32_16x16x32_bf16 v[168:171], a[216:219], a[200:203], v[168:171]
buffer_load_dwordx4 v18, s[48:51], s28 offen offset:2048 lds
v_mfma_f32_16x16x32_bf16 v[184:187], a[216:219], a[204:207], v[184:187]
ds_read_b128 a[184:187], v34 offset:4096
v_lshl_add_u32 v4, v3, 7, s27
v_mfma_f32_16x16x32_bf16 v[188:191], a[220:223], a[204:207], v[188:191]
ds_read_b128 a[188:191], v34 offset:6144
v_mul_f32 v86, v86, v60
v_mfma_f32_16x16x32_bf16 v[172:175], a[220:223], a[200:203], v[172:175]
v_rcp_f32 v62, v62
v_mfma_f32_16x16x32_bf16 v[156:159], a[220:223], a[196:199], v[156:159]
buffer_load_dwordx4 v19, s[48:51], s28 offen offset:3072 lds
v_mfma_f32_16x16x32_bf16 v[140:143], a[220:223], a[192:195], v[140:143]
s_add_u32 m0, s25, 65536
s_waitcnt lgkmcnt(2)
v_mfma_f32_16x16x32_bf16 v[128:131], a[176:179], a[160:163], v[128:131]
ds_read_b128 a[208:211], v34 offset:1024
v_mul_f32 v60, v88, v88
v_mfma_f32_16x16x32_bf16 v[144:147], a[176:179], a[164:167], v[144:147]
ds_read_b128 a[192:195], v33 offset:0
v_fma_f32 v60, v60, s39, v2
v_mfma_f32_16x16x32_bf16 v[160:163], a[176:179], a[168:171], v[160:163]
buffer_load_dwordx4 v20, s[52:55], s29 offen offset:0 sc1 lds
v_mfma_f32_16x16x32_bf16 v[176:179], a[176:179], a[172:175], v[176:179]
ds_read_b128 a[196:199], v33 offset:2048
v_lshrrev_b32 v5, 5, v0
v_mfma_f32_16x16x32_bf16 v[180:183], a[180:183], a[172:175], v[180:183]
ds_read_b128 a[200:203], v33 offset:4096
v_mul_f32 v60, v60, v88
v_mfma_f32_16x16x32_bf16 v[164:167], a[180:183], a[168:171], v[164:167]
s_add_u32 s31, s31, 1
v_exp_f32 v60, v60
v_mfma_f32_16x16x32_bf16 v[148:151], a[180:183], a[164:167], v[148:151]
buffer_load_dwordx4 v20, s[52:55], s29 offen offset:1024 sc1 lds
v_mfma_f32_16x16x32_bf16 v[132:135], a[180:183], a[160:163], v[132:135]
ds_read_b128 a[204:207], v33 offset:6144
v_mul_f32 v61, v89, v89
s_waitcnt lgkmcnt(3)
v_mfma_f32_16x16x32_bf16 v[136:139], a[184:187], a[160:163], v[136:139]
ds_read_b128 a[212:215], v34 offset:3072
v_fma_f32 v61, v61, s39, v2
v_mfma_f32_16x16x32_bf16 v[152:155], a[184:187], a[164:167], v[152:155]
v_readlane_b32 s28, v14, s31
v_mfma_f32_16x16x32_bf16 v[168:171], a[184:187], a[168:171], v[168:171]
buffer_load_dwordx4 v21, s[52:55], s29 offen offset:2048 sc1 lds
v_mfma_f32_16x16x32_bf16 v[184:187], a[184:187], a[172:175], v[184:187]
ds_read_b128 a[216:219], v34 offset:5120
v_lshl_add_u32 v5, s84, 2, v5
v_mfma_f32_16x16x32_bf16 v[188:191], a[188:191], a[172:175], v[188:191]
ds_read_b128 a[220:223], v34 offset:7168
v_mul_f32 v61, v61, v89
v_mfma_f32_16x16x32_bf16 v[172:175], a[188:191], a[168:171], v[172:175]
v_exp_f32 v61, v61
v_mfma_f32_16x16x32_bf16 v[156:159], a[188:191], a[164:167], v[156:159]
buffer_load_dwordx4 v21, s[52:55], s29 offen offset:3072 sc1 lds
v_mfma_f32_16x16x32_bf16 v[140:143], a[188:191], a[160:163], v[140:143]
s_add_u32 m0, s25, 98304
s_waitcnt vmcnt(8)
v_mfma_f32_16x16x32_bf16 v[128:131], a[208:211], a[192:195], v[128:131]
s_barrier
s_waitcnt lgkmcnt(1)
v_mfma_f32_16x16x32_bf16 v[144:147], a[208:211], a[196:199], v[144:147]
ds_read_b128 a[176:179], v34 offset:32768
v_mfma_f32_16x16x32_bf16 v[160:163], a[208:211], a[200:203], v[160:163]
buffer_load_dwordx4 v20, s[52:55], s28 offen offset:0 sc1 lds
v_mfma_f32_16x16x32_bf16 v[176:179], a[208:211], a[204:207], v[176:179]
ds_read_b128 a[160:163], v32 offset:32768
v_add_f32 v60, 1.0, v60
v_mfma_f32_16x16x32_bf16 v[180:183], a[212:215], a[204:207], v[180:183]
ds_read_b128 a[164:167], v32 offset:34816
v_add_f32 v61, 1.0, v61
v_mfma_f32_16x16x32_bf16 v[164:167], a[212:215], a[200:203], v[164:167]
ds_read_b128 a[168:171], v32 offset:36864
v_xor_b32 v5, v5, v3
v_mfma_f32_16x16x32_bf16 v[148:151], a[212:215], a[196:199], v[148:151]
buffer_load_dwordx4 v20, s[52:55], s28 offen offset:1024 sc1 lds
v_mfma_f32_16x16x32_bf16 v[132:135], a[212:215], a[192:195], v[132:135]
ds_read_b128 a[172:175], v32 offset:38912
v_mul_f32 v87, v87, v62
v_mfma_f32_16x16x32_bf16 v[136:139], a[216:219], a[192:195], v[136:139]
ds_read_b128 a[180:183], v34 offset:34816
s_mul_hi_u32 s29, s28, 268435456
v_mfma_f32_16x16x32_bf16 v[152:155], a[216:219], a[196:199], v[152:155]
v_rcp_f32 v60, v60
v_mfma_f32_16x16x32_bf16 v[168:171], a[216:219], a[200:203], v[168:171]
buffer_load_dwordx4 v21, s[52:55], s28 offen offset:2048 sc1 lds
v_mfma_f32_16x16x32_bf16 v[184:187], a[216:219], a[204:207], v[184:187]
ds_read_b128 a[184:187], v34 offset:36864
v_and_b32 v5, 7, v5
s_waitcnt lgkmcnt(3)
v_mfma_f32_16x16x32_bf16 v[188:191], a[220:223], a[204:207], v[188:191]
ds_read_b128 a[188:191], v34 offset:38912
v_mul_f32 v88, v88, v60
v_mfma_f32_16x16x32_bf16 v[172:175], a[220:223], a[200:203], v[172:175]
v_rcp_f32 v61, v61
v_mfma_f32_16x16x32_bf16 v[156:159], a[220:223], a[196:199], v[156:159]
buffer_load_dwordx4 v21, s[52:55], s28 offen offset:3072 sc1 lds
v_mfma_f32_16x16x32_bf16 v[140:143], a[220:223], a[192:195], v[140:143]
s_add_u32 m0, s24, 98304
v_mfma_f32_16x16x32_bf16 v[128:131], a[176:179], a[160:163], v[128:131]
ds_read_b128 a[208:211], v34 offset:33792
v_mul_f32 v60, v90, v90
v_mfma_f32_16x16x32_bf16 v[144:147], a[176:179], a[164:167], v[144:147]
ds_read_b128 a[192:195], v33 offset:32768
v_fma_f32 v60, v60, s39, v2
v_mfma_f32_16x16x32_bf16 v[160:163], a[176:179], a[168:171], v[160:163]
buffer_load_dwordx4 v16, s[48:51], s29 offen offset:0 lds
s_waitcnt lgkmcnt(2)
v_mfma_f32_16x16x32_bf16 v[176:179], a[176:179], a[172:175], v[176:179]
ds_read_b128 a[196:199], v33 offset:34816
v_lshl_add_u32 v4, v5, 4, v4
v_mfma_f32_16x16x32_bf16 v[180:183], a[180:183], a[172:175], v[180:183]
ds_read_b128 a[200:203], v33 offset:36864
v_mul_f32 v60, v60, v90
v_mfma_f32_16x16x32_bf16 v[164:167], a[180:183], a[168:171], v[164:167]
s_add_u32 s31, s31, 1
v_exp_f32 v60, v60
v_mfma_f32_16x16x32_bf16 v[148:151], a[180:183], a[164:167], v[148:151]
buffer_load_dwordx4 v17, s[48:51], s29 offen offset:1024 lds
v_mfma_f32_16x16x32_bf16 v[132:135], a[180:183], a[160:163], v[132:135]
ds_read_b128 a[204:207], v33 offset:38912
v_mul_f32 v62, v91, v91
v_mfma_f32_16x16x32_bf16 v[136:139], a[184:187], a[160:163], v[136:139]
ds_read_b128 a[212:215], v34 offset:35840
v_fma_f32 v62, v62, s39, v2
v_mfma_f32_16x16x32_bf16 v[152:155], a[184:187], a[164:167], v[152:155]
v_readlane_b32 s28, v14, s31
v_mfma_f32_16x16x32_bf16 v[168:171], a[184:187], a[168:171], v[168:171]
buffer_load_dwordx4 v18, s[48:51], s29 offen offset:2048 lds
v_mfma_f32_16x16x32_bf16 v[184:187], a[184:187], a[172:175], v[184:187]
ds_read_b128 a[216:219], v34 offset:37888
v_bfe_u32 v5, v0, 4, 1
v_mfma_f32_16x16x32_bf16 v[188:191], a[188:191], a[172:175], v[188:191]
ds_read_b128 a[220:223], v34 offset:39936
v_mul_f32 v62, v62, v91
v_mfma_f32_16x16x32_bf16 v[172:175], a[188:191], a[168:171], v[172:175]
v_exp_f32 v62, v62
v_mfma_f32_16x16x32_bf16 v[156:159], a[188:191], a[164:167], v[156:159]
buffer_load_dwordx4 v19, s[48:51], s29 offen offset:3072 lds
v_mfma_f32_16x16x32_bf16 v[140:143], a[188:191], a[160:163], v[140:143]
s_add_u32 m0, s24, 0
s_waitcnt vmcnt(8) lgkmcnt(2)
v_mfma_f32_16x16x32_bf16 v[128:131], a[208:211], a[192:195], v[128:131]
s_barrier
v_mfma_f32_16x16x32_bf16 v[144:147], a[208:211], a[196:199], v[144:147]
ds_read_b128 a[176:179], v37 offset:0
v_mfma_f32_16x16x32_bf16 v[160:163], a[208:211], a[200:203], v[160:163]
buffer_load_dwordx4 v16, s[48:51], s28 offen offset:0 lds
v_mfma_f32_16x16x32_bf16 v[176:179], a[208:211], a[204:207], v[176:179]
ds_read_b128 a[160:163], v35 offset:0
v_add_f32 v60, 1.0, v60
v_mfma_f32_16x16x32_bf16 v[180:183], a[212:215], a[204:207], v[180:183]
ds_read_b128 a[164:167], v35 offset:2048
v_add_f32 v62, 1.0, v62
v_mfma_f32_16x16x32_bf16 v[164:167], a[212:215], a[200:203], v[164:167]
ds_read_b128 a[168:171], v35 offset:4096
v_lshl_add_u32 v4, v5, 3, v4
v_mfma_f32_16x16x32_bf16 v[148:151], a[212:215], a[196:199], v[148:151]
buffer_load_dwordx4 v17, s[48:51], s28 offen offset:1024 lds
v_mfma_f32_16x16x32_bf16 v[132:135], a[212:215], a[192:195], v[132:135]
ds_read_b128 a[172:175], v35 offset:6144
v_mul_f32 v89, v89, v61
s_waitcnt lgkmcnt(4)
v_mfma_f32_16x16x32_bf16 v[136:139], a[216:219], a[192:195], v[136:139]
ds_read_b128 a[180:183], v37 offset:2048
s_mul_i32 s29, s28, 16
v_mfma_f32_16x16x32_bf16 v[152:155], a[216:219], a[196:199], v[152:155]
v_rcp_f32 v60, v60
v_mfma_f32_16x16x32_bf16 v[168:171], a[216:219], a[200:203], v[168:171]
buffer_load_dwordx4 v18, s[48:51], s28 offen offset:2048 lds
v_mfma_f32_16x16x32_bf16 v[184:187], a[216:219], a[204:207], v[184:187]
ds_read_b128 a[184:187], v37 offset:4096
v_xor_b32 v5, 32, v4
v_mfma_f32_16x16x32_bf16 v[188:191], a[220:223], a[204:207], v[188:191]
ds_read_b128 a[188:191], v37 offset:6144
v_mul_f32 v90, v90, v60
v_mfma_f32_16x16x32_bf16 v[172:175], a[220:223], a[200:203], v[172:175]
v_rcp_f32 v62, v62
v_mfma_f32_16x16x32_bf16 v[156:159], a[220:223], a[196:199], v[156:159]
buffer_load_dwordx4 v19, s[48:51], s28 offen offset:3072 lds
v_mfma_f32_16x16x32_bf16 v[140:143], a[220:223], a[192:195], v[140:143]
s_add_u32 m0, s25, 0
s_waitcnt lgkmcnt(2)
v_mfma_f32_16x16x32_bf16 v[128:131], a[176:179], a[160:163], v[128:131]
ds_read_b128 a[208:211], v37 offset:1024
v_mul_f32 v60, v92, v92
v_mfma_f32_16x16x32_bf16 v[144:147], a[176:179], a[164:167], v[144:147]
ds_read_b128 a[192:195], v36 offset:0
v_fma_f32 v60, v60, s39, v2
v_mfma_f32_16x16x32_bf16 v[160:163], a[176:179], a[168:171], v[160:163]
buffer_load_dwordx4 v20, s[52:55], s29 offen offset:0 sc1 lds
v_mfma_f32_16x16x32_bf16 v[176:179], a[176:179], a[172:175], v[176:179]
ds_read_b128 a[196:199], v36 offset:2048
v_mfma_f32_16x16x32_bf16 v[180:183], a[180:183], a[172:175], v[180:183]
ds_read_b128 a[200:203], v36 offset:4096
v_mul_f32 v60, v60, v92
v_mfma_f32_16x16x32_bf16 v[164:167], a[180:183], a[168:171], v[164:167]
s_add_u32 s31, s31, 1
v_exp_f32 v60, v60
v_mfma_f32_16x16x32_bf16 v[148:151], a[180:183], a[164:167], v[148:151]
buffer_load_dwordx4 v20, s[52:55], s29 offen offset:1024 sc1 lds
v_mfma_f32_16x16x32_bf16 v[132:135], a[180:183], a[160:163], v[132:135]
ds_read_b128 a[204:207], v36 offset:6144
v_mul_f32 v61, v93, v93
s_waitcnt lgkmcnt(3)
v_mfma_f32_16x16x32_bf16 v[136:139], a[184:187], a[160:163], v[136:139]
ds_read_b128 a[212:215], v37 offset:3072
v_fma_f32 v61, v61, s39, v2
v_mfma_f32_16x16x32_bf16 v[152:155], a[184:187], a[164:167], v[152:155]
v_readlane_b32 s28, v14, s31
ds_read_b64 v[194:195], v4 offset:0
v_mfma_f32_16x16x32_bf16 v[168:171], a[184:187], a[168:171], v[168:171]
buffer_load_dwordx4 v21, s[52:55], s29 offen offset:2048 sc1 lds
v_mfma_f32_16x16x32_bf16 v[184:187], a[184:187], a[172:175], v[184:187]
ds_read_b128 a[216:219], v37 offset:5120
v_mfma_f32_16x16x32_bf16 v[188:191], a[188:191], a[172:175], v[188:191]
ds_read_b128 a[220:223], v37 offset:7168
v_mul_f32 v61, v61, v93
v_mfma_f32_16x16x32_bf16 v[172:175], a[188:191], a[168:171], v[172:175]
v_exp_f32 v61, v61
v_mfma_f32_16x16x32_bf16 v[156:159], a[188:191], a[164:167], v[156:159]
buffer_load_dwordx4 v21, s[52:55], s29 offen offset:3072 sc1 lds
v_mfma_f32_16x16x32_bf16 v[140:143], a[188:191], a[160:163], v[140:143]
s_add_u32 m0, s25, 32768
s_waitcnt vmcnt(8)
v_mfma_f32_16x16x32_bf16 v[128:131], a[208:211], a[192:195], v[128:131]
s_barrier
s_waitcnt lgkmcnt(1)
v_mfma_f32_16x16x32_bf16 v[144:147], a[208:211], a[196:199], v[144:147]
ds_read_b128 a[176:179], v37 offset:32768
v_mfma_f32_16x16x32_bf16 v[160:163], a[208:211], a[200:203], v[160:163]
buffer_load_dwordx4 v20, s[52:55], s28 offen offset:0 sc1 lds
v_mfma_f32_16x16x32_bf16 v[176:179], a[208:211], a[204:207], v[176:179]
ds_read_b128 a[160:163], v35 offset:32768
v_add_f32 v60, 1.0, v60
v_mfma_f32_16x16x32_bf16 v[180:183], a[212:215], a[204:207], v[180:183]
ds_read_b128 a[164:167], v35 offset:34816
v_add_f32 v61, 1.0, v61
v_mfma_f32_16x16x32_bf16 v[164:167], a[212:215], a[200:203], v[164:167]
ds_read_b128 a[168:171], v35 offset:36864
v_mfma_f32_16x16x32_bf16 v[148:151], a[212:215], a[196:199], v[148:151]
buffer_load_dwordx4 v20, s[52:55], s28 offen offset:1024 sc1 lds
v_mfma_f32_16x16x32_bf16 v[132:135], a[212:215], a[192:195], v[132:135]
ds_read_b128 a[172:175], v35 offset:38912
v_mul_f32 v91, v91, v62
v_mfma_f32_16x16x32_bf16 v[136:139], a[216:219], a[192:195], v[136:139]
ds_read_b128 a[180:183], v37 offset:34816
s_mul_hi_u32 s29, s28, 268435456
v_mfma_f32_16x16x32_bf16 v[152:155], a[216:219], a[196:199], v[152:155]
v_rcp_f32 v60, v60
v_mfma_f32_16x16x32_bf16 v[168:171], a[216:219], a[200:203], v[168:171]
buffer_load_dwordx4 v21, s[52:55], s28 offen offset:2048 sc1 lds
v_mfma_f32_16x16x32_bf16 v[184:187], a[216:219], a[204:207], v[184:187]
ds_read_b128 a[184:187], v37 offset:36864
s_waitcnt lgkmcnt(3)
v_mfma_f32_16x16x32_bf16 v[188:191], a[220:223], a[204:207], v[188:191]
ds_read_b128 a[188:191], v37 offset:38912
v_mul_f32 v92, v92, v60
v_mfma_f32_16x16x32_bf16 v[172:175], a[220:223], a[200:203], v[172:175]
v_rcp_f32 v61, v61
v_mfma_f32_16x16x32_bf16 v[156:159], a[220:223], a[196:199], v[156:159]
buffer_load_dwordx4 v21, s[52:55], s28 offen offset:3072 sc1 lds
v_mfma_f32_16x16x32_bf16 v[140:143], a[220:223], a[192:195], v[140:143]
s_add_u32 m0, s24, 32768
v_mfma_f32_16x16x32_bf16 v[128:131], a[176:179], a[160:163], v[128:131]
ds_read_b128 a[208:211], v37 offset:33792
v_mul_f32 v60, v94, v94
v_mfma_f32_16x16x32_bf16 v[144:147], a[176:179], a[164:167], v[144:147]
ds_read_b128 a[192:195], v36 offset:32768
v_fma_f32 v60, v60, s39, v2
v_mfma_f32_16x16x32_bf16 v[160:163], a[176:179], a[168:171], v[160:163]
buffer_load_dwordx4 v16, s[48:51], s29 offen offset:0 lds
s_waitcnt lgkmcnt(2)
v_mfma_f32_16x16x32_bf16 v[176:179], a[176:179], a[172:175], v[176:179]
ds_read_b128 a[196:199], v36 offset:34816
v_lshlrev_b32 v192, 16, v194
v_mfma_f32_16x16x32_bf16 v[180:183], a[180:183], a[172:175], v[180:183]
ds_read_b128 a[200:203], v36 offset:36864
v_mul_f32 v60, v60, v94
v_mfma_f32_16x16x32_bf16 v[164:167], a[180:183], a[168:171], v[164:167]
s_add_u32 s31, s31, 1
v_exp_f32 v60, v60
v_mfma_f32_16x16x32_bf16 v[148:151], a[180:183], a[164:167], v[148:151]
buffer_load_dwordx4 v17, s[48:51], s29 offen offset:1024 lds
v_mfma_f32_16x16x32_bf16 v[132:135], a[180:183], a[160:163], v[132:135]
ds_read_b128 a[204:207], v36 offset:38912
v_mul_f32 v62, v95, v95
v_mfma_f32_16x16x32_bf16 v[136:139], a[184:187], a[160:163], v[136:139]
ds_read_b128 a[212:215], v37 offset:35840
v_fma_f32 v62, v62, s39, v2
v_mfma_f32_16x16x32_bf16 v[152:155], a[184:187], a[164:167], v[152:155]
v_readlane_b32 s28, v14, s31
ds_read_b64 v[210:211], v4 offset:2048
v_mfma_f32_16x16x32_bf16 v[168:171], a[184:187], a[168:171], v[168:171]
buffer_load_dwordx4 v18, s[48:51], s29 offen offset:2048 lds
v_mfma_f32_16x16x32_bf16 v[184:187], a[184:187], a[172:175], v[184:187]
ds_read_b128 a[216:219], v37 offset:37888
v_and_b32 v193, 0xffff0000, v194
v_mfma_f32_16x16x32_bf16 v[188:191], a[188:191], a[172:175], v[188:191]
ds_read_b128 a[220:223], v37 offset:39936
v_mul_f32 v62, v62, v95
v_mfma_f32_16x16x32_bf16 v[172:175], a[188:191], a[168:171], v[172:175]
v_exp_f32 v62, v62
v_mfma_f32_16x16x32_bf16 v[156:159], a[188:191], a[164:167], v[156:159]
buffer_load_dwordx4 v19, s[48:51], s29 offen offset:3072 lds
v_mfma_f32_16x16x32_bf16 v[140:143], a[188:191], a[160:163], v[140:143]
s_add_u32 m0, s24, 65536
s_waitcnt vmcnt(8) lgkmcnt(2)
v_mfma_f32_16x16x32_bf16 v[128:131], a[208:211], a[192:195], v[128:131]
s_barrier
v_mfma_f32_16x16x32_bf16 v[144:147], a[208:211], a[196:199], v[144:147]
ds_read_b128 a[176:179], v34 offset:0
v_mfma_f32_16x16x32_bf16 v[160:163], a[208:211], a[200:203], v[160:163]
buffer_load_dwordx4 v16, s[48:51], s28 offen offset:0 lds
v_mfma_f32_16x16x32_bf16 v[176:179], a[208:211], a[204:207], v[176:179]
ds_read_b128 a[160:163], v32 offset:0
v_add_f32 v60, 1.0, v60
v_mfma_f32_16x16x32_bf16 v[180:183], a[212:215], a[204:207], v[180:183]
ds_read_b128 a[164:167], v32 offset:2048
v_add_f32 v62, 1.0, v62
v_mfma_f32_16x16x32_bf16 v[164:167], a[212:215], a[200:203], v[164:167]
ds_read_b128 a[168:171], v32 offset:4096
v_lshlrev_b32 v194, 16, v195
v_mfma_f32_16x16x32_bf16 v[148:151], a[212:215], a[196:199], v[148:151]
buffer_load_dwordx4 v17, s[48:51], s28 offen offset:1024 lds
v_mfma_f32_16x16x32_bf16 v[132:135], a[212:215], a[192:195], v[132:135]
ds_read_b128 a[172:175], v32 offset:6144
v_mul_f32 v93, v93, v61
s_waitcnt lgkmcnt(4)
v_mfma_f32_16x16x32_bf16 v[136:139], a[216:219], a[192:195], v[136:139]
ds_read_b128 a[180:183], v34 offset:2048
s_mul_i32 s29, s28, 16
v_mfma_f32_16x16x32_bf16 v[152:155], a[216:219], a[196:199], v[152:155]
v_rcp_f32 v60, v60
v_mfma_f32_16x16x32_bf16 v[168:171], a[216:219], a[200:203], v[168:171]
buffer_load_dwordx4 v18, s[48:51], s28 offen offset:2048 lds
v_mfma_f32_16x16x32_bf16 v[184:187], a[216:219], a[204:207], v[184:187]
ds_read_b128 a[184:187], v34 offset:4096
v_and_b32 v195, 0xffff0000, v195
v_mfma_f32_16x16x32_bf16 v[188:191], a[220:223], a[204:207], v[188:191]
ds_read_b128 a[188:191], v34 offset:6144
v_mul_f32 v94, v94, v60
v_mfma_f32_16x16x32_bf16 v[172:175], a[220:223], a[200:203], v[172:175]
v_rcp_f32 v62, v62
v_mfma_f32_16x16x32_bf16 v[156:159], a[220:223], a[196:199], v[156:159]
buffer_load_dwordx4 v19, s[48:51], s28 offen offset:3072 lds
v_mfma_f32_16x16x32_bf16 v[140:143], a[220:223], a[192:195], v[140:143]
s_add_u32 m0, s25, 65536
s_waitcnt lgkmcnt(2)
v_mfma_f32_16x16x32_bf16 v[128:131], a[176:179], a[160:163], v[128:131]
ds_read_b128 a[208:211], v34 offset:1024
v_mul_f32 v60, v96, v96
v_mfma_f32_16x16x32_bf16 v[144:147], a[176:179], a[164:167], v[144:147]
ds_read_b128 a[192:195], v33 offset:0
v_fma_f32 v60, v60, s39, v2
v_mfma_f32_16x16x32_bf16 v[160:163], a[176:179], a[168:171], v[160:163]
buffer_load_dwordx4 v20, s[52:55], s29 offen offset:0 sc1 lds
v_mfma_f32_16x16x32_bf16 v[176:179], a[176:179], a[172:175], v[176:179]
ds_read_b128 a[196:199], v33 offset:2048
v_lshlrev_b32 v208, 16, v210
v_mfma_f32_16x16x32_bf16 v[180:183], a[180:183], a[172:175], v[180:183]
ds_read_b128 a[200:203], v33 offset:4096
v_mul_f32 v60, v60, v96
v_mfma_f32_16x16x32_bf16 v[164:167], a[180:183], a[168:171], v[164:167]
s_add_u32 s31, s31, 1
v_exp_f32 v60, v60
v_mfma_f32_16x16x32_bf16 v[148:151], a[180:183], a[164:167], v[148:151]
buffer_load_dwordx4 v20, s[52:55], s29 offen offset:1024 sc1 lds
v_mfma_f32_16x16x32_bf16 v[132:135], a[180:183], a[160:163], v[132:135]
ds_read_b128 a[204:207], v33 offset:6144
v_mul_f32 v61, v97, v97
s_waitcnt lgkmcnt(3)
v_mfma_f32_16x16x32_bf16 v[136:139], a[184:187], a[160:163], v[136:139]
ds_read_b128 a[212:215], v34 offset:3072
v_fma_f32 v61, v61, s39, v2
v_mfma_f32_16x16x32_bf16 v[152:155], a[184:187], a[164:167], v[152:155]
v_readlane_b32 s28, v14, s31
ds_read_b64 v[226:227], v4 offset:4096
v_mfma_f32_16x16x32_bf16 v[168:171], a[184:187], a[168:171], v[168:171]
buffer_load_dwordx4 v21, s[52:55], s29 offen offset:2048 sc1 lds
v_mfma_f32_16x16x32_bf16 v[184:187], a[184:187], a[172:175], v[184:187]
ds_read_b128 a[216:219], v34 offset:5120
v_and_b32 v209, 0xffff0000, v210
v_mfma_f32_16x16x32_bf16 v[188:191], a[188:191], a[172:175], v[188:191]
ds_read_b128 a[220:223], v34 offset:7168
v_mul_f32 v61, v61, v97
v_mfma_f32_16x16x32_bf16 v[172:175], a[188:191], a[168:171], v[172:175]
v_exp_f32 v61, v61
v_mfma_f32_16x16x32_bf16 v[156:159], a[188:191], a[164:167], v[156:159]
buffer_load_dwordx4 v21, s[52:55], s29 offen offset:3072 sc1 lds
v_mfma_f32_16x16x32_bf16 v[140:143], a[188:191], a[160:163], v[140:143]
s_add_u32 m0, s25, 98304
s_waitcnt vmcnt(8)
v_mfma_f32_16x16x32_bf16 v[128:131], a[208:211], a[192:195], v[128:131]
s_barrier
s_waitcnt lgkmcnt(1)
v_mfma_f32_16x16x32_bf16 v[144:147], a[208:211], a[196:199], v[144:147]
ds_read_b128 a[176:179], v34 offset:32768
v_mfma_f32_16x16x32_bf16 v[160:163], a[208:211], a[200:203], v[160:163]
buffer_load_dwordx4 v20, s[52:55], s28 offen offset:0 sc1 lds
v_mfma_f32_16x16x32_bf16 v[176:179], a[208:211], a[204:207], v[176:179]
ds_read_b128 a[160:163], v32 offset:32768
v_add_f32 v60, 1.0, v60
v_mfma_f32_16x16x32_bf16 v[180:183], a[212:215], a[204:207], v[180:183]
ds_read_b128 a[164:167], v32 offset:34816
v_add_f32 v61, 1.0, v61
v_mfma_f32_16x16x32_bf16 v[164:167], a[212:215], a[200:203], v[164:167]
ds_read_b128 a[168:171], v32 offset:36864
v_lshlrev_b32 v210, 16, v211
v_mfma_f32_16x16x32_bf16 v[148:151], a[212:215], a[196:199], v[148:151]
buffer_load_dwordx4 v20, s[52:55], s28 offen offset:1024 sc1 lds
v_mfma_f32_16x16x32_bf16 v[132:135], a[212:215], a[192:195], v[132:135]
ds_read_b128 a[172:175], v32 offset:38912
v_mul_f32 v95, v95, v62
v_mfma_f32_16x16x32_bf16 v[136:139], a[216:219], a[192:195], v[136:139]
ds_read_b128 a[180:183], v34 offset:34816
s_mul_hi_u32 s29, s28, 268435456
v_mfma_f32_16x16x32_bf16 v[152:155], a[216:219], a[196:199], v[152:155]
v_rcp_f32 v60, v60
v_mfma_f32_16x16x32_bf16 v[168:171], a[216:219], a[200:203], v[168:171]
buffer_load_dwordx4 v21, s[52:55], s28 offen offset:2048 sc1 lds
v_mfma_f32_16x16x32_bf16 v[184:187], a[216:219], a[204:207], v[184:187]
ds_read_b128 a[184:187], v34 offset:36864
v_and_b32 v211, 0xffff0000, v211
s_waitcnt lgkmcnt(3)
v_mfma_f32_16x16x32_bf16 v[188:191], a[220:223], a[204:207], v[188:191]
ds_read_b128 a[188:191], v34 offset:38912
v_mul_f32 v96, v96, v60
v_mfma_f32_16x16x32_bf16 v[172:175], a[220:223], a[200:203], v[172:175]
v_rcp_f32 v61, v61
v_mfma_f32_16x16x32_bf16 v[156:159], a[220:223], a[196:199], v[156:159]
buffer_load_dwordx4 v21, s[52:55], s28 offen offset:3072 sc1 lds
v_mfma_f32_16x16x32_bf16 v[140:143], a[220:223], a[192:195], v[140:143]
s_add_u32 m0, s24, 98304
v_mfma_f32_16x16x32_bf16 v[128:131], a[176:179], a[160:163], v[128:131]
ds_read_b128 a[208:211], v34 offset:33792
v_mul_f32 v60, v98, v98
v_mfma_f32_16x16x32_bf16 v[144:147], a[176:179], a[164:167], v[144:147]
ds_read_b128 a[192:195], v33 offset:32768
v_fma_f32 v60, v60, s39, v2
v_mfma_f32_16x16x32_bf16 v[160:163], a[176:179], a[168:171], v[160:163]
buffer_load_dwordx4 v16, s[48:51], s29 offen offset:0 lds
s_waitcnt lgkmcnt(2)
v_mfma_f32_16x16x32_bf16 v[176:179], a[176:179], a[172:175], v[176:179]
ds_read_b128 a[196:199], v33 offset:34816
v_lshlrev_b32 v224, 16, v226
v_mfma_f32_16x16x32_bf16 v[180:183], a[180:183], a[172:175], v[180:183]
ds_read_b128 a[200:203], v33 offset:36864
v_mul_f32 v60, v60, v98
v_mfma_f32_16x16x32_bf16 v[164:167], a[180:183], a[168:171], v[164:167]
s_add_u32 s31, s31, 1
v_exp_f32 v60, v60
v_mfma_f32_16x16x32_bf16 v[148:151], a[180:183], a[164:167], v[148:151]
buffer_load_dwordx4 v17, s[48:51], s29 offen offset:1024 lds
v_mfma_f32_16x16x32_bf16 v[132:135], a[180:183], a[160:163], v[132:135]
ds_read_b128 a[204:207], v33 offset:38912
v_mul_f32 v62, v99, v99
v_mfma_f32_16x16x32_bf16 v[136:139], a[184:187], a[160:163], v[136:139]
ds_read_b128 a[212:215], v34 offset:35840
v_fma_f32 v62, v62, s39, v2
v_mfma_f32_16x16x32_bf16 v[152:155], a[184:187], a[164:167], v[152:155]
v_readlane_b32 s28, v14, s31
ds_read_b64 v[242:243], v4 offset:6144
v_mfma_f32_16x16x32_bf16 v[168:171], a[184:187], a[168:171], v[168:171]
buffer_load_dwordx4 v18, s[48:51], s29 offen offset:2048 lds
v_mfma_f32_16x16x32_bf16 v[184:187], a[184:187], a[172:175], v[184:187]
ds_read_b128 a[216:219], v34 offset:37888
v_and_b32 v225, 0xffff0000, v226
v_mfma_f32_16x16x32_bf16 v[188:191], a[188:191], a[172:175], v[188:191]
ds_read_b128 a[220:223], v34 offset:39936
v_mul_f32 v62, v62, v99
v_mfma_f32_16x16x32_bf16 v[172:175], a[188:191], a[168:171], v[172:175]
v_exp_f32 v62, v62
v_mfma_f32_16x16x32_bf16 v[156:159], a[188:191], a[164:167], v[156:159]
buffer_load_dwordx4 v19, s[48:51], s29 offen offset:3072 lds
v_mfma_f32_16x16x32_bf16 v[140:143], a[188:191], a[160:163], v[140:143]
s_add_u32 m0, s24, 0
s_waitcnt vmcnt(8) lgkmcnt(2)
v_mfma_f32_16x16x32_bf16 v[128:131], a[208:211], a[192:195], v[128:131]
s_barrier
v_mfma_f32_16x16x32_bf16 v[144:147], a[208:211], a[196:199], v[144:147]
ds_read_b128 a[176:179], v37 offset:0
v_mfma_f32_16x16x32_bf16 v[160:163], a[208:211], a[200:203], v[160:163]
buffer_load_dwordx4 v16, s[48:51], s28 offen offset:0 lds
v_mfma_f32_16x16x32_bf16 v[176:179], a[208:211], a[204:207], v[176:179]
ds_read_b128 a[160:163], v35 offset:0
v_add_f32 v60, 1.0, v60
v_mfma_f32_16x16x32_bf16 v[180:183], a[212:215], a[204:207], v[180:183]
ds_read_b128 a[164:167], v35 offset:2048
v_add_f32 v62, 1.0, v62
v_mfma_f32_16x16x32_bf16 v[164:167], a[212:215], a[200:203], v[164:167]
ds_read_b128 a[168:171], v35 offset:4096
v_lshlrev_b32 v226, 16, v227
v_mfma_f32_16x16x32_bf16 v[148:151], a[212:215], a[196:199], v[148:151]
buffer_load_dwordx4 v17, s[48:51], s28 offen offset:1024 lds
v_mfma_f32_16x16x32_bf16 v[132:135], a[212:215], a[192:195], v[132:135]
ds_read_b128 a[172:175], v35 offset:6144
v_mul_f32 v97, v97, v61
s_waitcnt lgkmcnt(4)
v_mfma_f32_16x16x32_bf16 v[136:139], a[216:219], a[192:195], v[136:139]
ds_read_b128 a[180:183], v37 offset:2048
s_mul_i32 s29, s28, 16
v_mfma_f32_16x16x32_bf16 v[152:155], a[216:219], a[196:199], v[152:155]
v_rcp_f32 v60, v60
v_mfma_f32_16x16x32_bf16 v[168:171], a[216:219], a[200:203], v[168:171]
buffer_load_dwordx4 v18, s[48:51], s28 offen offset:2048 lds
v_mfma_f32_16x16x32_bf16 v[184:187], a[216:219], a[204:207], v[184:187]
ds_read_b128 a[184:187], v37 offset:4096
v_and_b32 v227, 0xffff0000, v227
v_mfma_f32_16x16x32_bf16 v[188:191], a[220:223], a[204:207], v[188:191]
ds_read_b128 a[188:191], v37 offset:6144
v_mul_f32 v98, v98, v60
v_mfma_f32_16x16x32_bf16 v[172:175], a[220:223], a[200:203], v[172:175]
v_rcp_f32 v62, v62
v_mfma_f32_16x16x32_bf16 v[156:159], a[220:223], a[196:199], v[156:159]
buffer_load_dwordx4 v19, s[48:51], s28 offen offset:3072 lds
v_mfma_f32_16x16x32_bf16 v[140:143], a[220:223], a[192:195], v[140:143]
s_add_u32 m0, s25, 0
s_waitcnt lgkmcnt(2)
v_mfma_f32_16x16x32_bf16 v[128:131], a[176:179], a[160:163], v[128:131]
ds_read_b128 a[208:211], v37 offset:1024
v_mul_f32 v60, v100, v100
v_mfma_f32_16x16x32_bf16 v[144:147], a[176:179], a[164:167], v[144:147]
ds_read_b128 a[192:195], v36 offset:0
v_fma_f32 v60, v60, s39, v2
v_mfma_f32_16x16x32_bf16 v[160:163], a[176:179], a[168:171], v[160:163]
buffer_load_dwordx4 v20, s[52:55], s29 offen offset:0 sc1 lds
v_mfma_f32_16x16x32_bf16 v[176:179], a[176:179], a[172:175], v[176:179]
ds_read_b128 a[196:199], v36 offset:2048
v_lshlrev_b32 v240, 16, v242
v_mfma_f32_16x16x32_bf16 v[180:183], a[180:183], a[172:175], v[180:183]
ds_read_b128 a[200:203], v36 offset:4096
v_mul_f32 v60, v60, v100
v_mfma_f32_16x16x32_bf16 v[164:167], a[180:183], a[168:171], v[164:167]
s_add_u32 s31, s31, 1
v_exp_f32 v60, v60
v_mfma_f32_16x16x32_bf16 v[148:151], a[180:183], a[164:167], v[148:151]
buffer_load_dwordx4 v20, s[52:55], s29 offen offset:1024 sc1 lds
v_mfma_f32_16x16x32_bf16 v[132:135], a[180:183], a[160:163], v[132:135]
ds_read_b128 a[204:207], v36 offset:6144
v_mul_f32 v61, v101, v101
s_waitcnt lgkmcnt(3)
v_mfma_f32_16x16x32_bf16 v[136:139], a[184:187], a[160:163], v[136:139]
ds_read_b128 a[212:215], v37 offset:3072
v_fma_f32 v61, v61, s39, v2
v_mfma_f32_16x16x32_bf16 v[152:155], a[184:187], a[164:167], v[152:155]
v_readlane_b32 s28, v14, s31
ds_read_b64 v[198:199], v5 offset:0
v_mfma_f32_16x16x32_bf16 v[168:171], a[184:187], a[168:171], v[168:171]
buffer_load_dwordx4 v21, s[52:55], s29 offen offset:2048 sc1 lds
v_mfma_f32_16x16x32_bf16 v[184:187], a[184:187], a[172:175], v[184:187]
ds_read_b128 a[216:219], v37 offset:5120
v_and_b32 v241, 0xffff0000, v242
v_mfma_f32_16x16x32_bf16 v[188:191], a[188:191], a[172:175], v[188:191]
ds_read_b128 a[220:223], v37 offset:7168
v_mul_f32 v61, v61, v101
v_mfma_f32_16x16x32_bf16 v[172:175], a[188:191], a[168:171], v[172:175]
v_exp_f32 v61, v61
v_mfma_f32_16x16x32_bf16 v[156:159], a[188:191], a[164:167], v[156:159]
buffer_load_dwordx4 v21, s[52:55], s29 offen offset:3072 sc1 lds
v_mfma_f32_16x16x32_bf16 v[140:143], a[188:191], a[160:163], v[140:143]
s_add_u32 m0, s25, 32768
s_waitcnt vmcnt(8)
v_mfma_f32_16x16x32_bf16 v[128:131], a[208:211], a[192:195], v[128:131]
s_barrier
s_waitcnt lgkmcnt(1)
v_mfma_f32_16x16x32_bf16 v[144:147], a[208:211], a[196:199], v[144:147]
ds_read_b128 a[176:179], v37 offset:32768
v_mfma_f32_16x16x32_bf16 v[160:163], a[208:211], a[200:203], v[160:163]
buffer_load_dwordx4 v20, s[52:55], s28 offen offset:0 sc1 lds
v_mfma_f32_16x16x32_bf16 v[176:179], a[208:211], a[204:207], v[176:179]
ds_read_b128 a[160:163], v35 offset:32768
v_add_f32 v60, 1.0, v60
v_mfma_f32_16x16x32_bf16 v[180:183], a[212:215], a[204:207], v[180:183]
ds_read_b128 a[164:167], v35 offset:34816
v_add_f32 v61, 1.0, v61
v_mfma_f32_16x16x32_bf16 v[164:167], a[212:215], a[200:203], v[164:167]
ds_read_b128 a[168:171], v35 offset:36864
v_lshlrev_b32 v242, 16, v243
v_mfma_f32_16x16x32_bf16 v[148:151], a[212:215], a[196:199], v[148:151]
buffer_load_dwordx4 v20, s[52:55], s28 offen offset:1024 sc1 lds
v_mfma_f32_16x16x32_bf16 v[132:135], a[212:215], a[192:195], v[132:135]
ds_read_b128 a[172:175], v35 offset:38912
v_mul_f32 v99, v99, v62
v_mfma_f32_16x16x32_bf16 v[136:139], a[216:219], a[192:195], v[136:139]
ds_read_b128 a[180:183], v37 offset:34816
s_mul_hi_u32 s29, s28, 268435456
v_mfma_f32_16x16x32_bf16 v[152:155], a[216:219], a[196:199], v[152:155]
v_rcp_f32 v60, v60
v_mfma_f32_16x16x32_bf16 v[168:171], a[216:219], a[200:203], v[168:171]
buffer_load_dwordx4 v21, s[52:55], s28 offen offset:2048 sc1 lds
v_mfma_f32_16x16x32_bf16 v[184:187], a[216:219], a[204:207], v[184:187]
ds_read_b128 a[184:187], v37 offset:36864
v_and_b32 v243, 0xffff0000, v243
s_waitcnt lgkmcnt(3)
v_mfma_f32_16x16x32_bf16 v[188:191], a[220:223], a[204:207], v[188:191]
ds_read_b128 a[188:191], v37 offset:38912
v_mul_f32 v100, v100, v60
v_mfma_f32_16x16x32_bf16 v[172:175], a[220:223], a[200:203], v[172:175]
v_rcp_f32 v61, v61
v_mfma_f32_16x16x32_bf16 v[156:159], a[220:223], a[196:199], v[156:159]
buffer_load_dwordx4 v21, s[52:55], s28 offen offset:3072 sc1 lds
v_mfma_f32_16x16x32_bf16 v[140:143], a[220:223], a[192:195], v[140:143]
s_add_u32 m0, s24, 32768
v_mfma_f32_16x16x32_bf16 v[128:131], a[176:179], a[160:163], v[128:131]
ds_read_b128 a[208:211], v37 offset:33792
v_mul_f32 v60, v102, v102
v_mfma_f32_16x16x32_bf16 v[144:147], a[176:179], a[164:167], v[144:147]
ds_read_b128 a[192:195], v36 offset:32768
v_fma_f32 v60, v60, s39, v2
v_mfma_f32_16x16x32_bf16 v[160:163], a[176:179], a[168:171], v[160:163]
buffer_load_dwordx4 v16, s[48:51], s29 offen offset:0 lds
s_waitcnt lgkmcnt(2)
v_mfma_f32_16x16x32_bf16 v[176:179], a[176:179], a[172:175], v[176:179]
ds_read_b128 a[196:199], v36 offset:34816
v_lshlrev_b32 v196, 16, v198
v_mfma_f32_16x16x32_bf16 v[180:183], a[180:183], a[172:175], v[180:183]
ds_read_b128 a[200:203], v36 offset:36864
v_mul_f32 v60, v60, v102
v_mfma_f32_16x16x32_bf16 v[164:167], a[180:183], a[168:171], v[164:167]
s_add_u32 s31, s31, 1
v_exp_f32 v60, v60
v_mfma_f32_16x16x32_bf16 v[148:151], a[180:183], a[164:167], v[148:151]
buffer_load_dwordx4 v17, s[48:51], s29 offen offset:1024 lds
v_mfma_f32_16x16x32_bf16 v[132:135], a[180:183], a[160:163], v[132:135]
ds_read_b128 a[204:207], v36 offset:38912
v_mul_f32 v62, v103, v103
v_mfma_f32_16x16x32_bf16 v[136:139], a[184:187], a[160:163], v[136:139]
ds_read_b128 a[212:215], v37 offset:35840
v_fma_f32 v62, v62, s39, v2
v_mfma_f32_16x16x32_bf16 v[152:155], a[184:187], a[164:167], v[152:155]
v_readlane_b32 s28, v14, s31
ds_read_b64 v[214:215], v5 offset:2048
v_mfma_f32_16x16x32_bf16 v[168:171], a[184:187], a[168:171], v[168:171]
buffer_load_dwordx4 v18, s[48:51], s29 offen offset:2048 lds
v_mfma_f32_16x16x32_bf16 v[184:187], a[184:187], a[172:175], v[184:187]
ds_read_b128 a[216:219], v37 offset:37888
v_and_b32 v197, 0xffff0000, v198
v_mfma_f32_16x16x32_bf16 v[188:191], a[188:191], a[172:175], v[188:191]
ds_read_b128 a[220:223], v37 offset:39936
v_mul_f32 v62, v62, v103
v_mfma_f32_16x16x32_bf16 v[172:175], a[188:191], a[168:171], v[172:175]
v_exp_f32 v62, v62
v_mfma_f32_16x16x32_bf16 v[156:159], a[188:191], a[164:167], v[156:159]
buffer_load_dwordx4 v19, s[48:51], s29 offen offset:3072 lds
v_mfma_f32_16x16x32_bf16 v[140:143], a[188:191], a[160:163], v[140:143]
s_add_u32 m0, s24, 65536
s_waitcnt vmcnt(8) lgkmcnt(2)
v_mfma_f32_16x16x32_bf16 v[128:131], a[208:211], a[192:195], v[128:131]
s_barrier
v_mfma_f32_16x16x32_bf16 v[144:147], a[208:211], a[196:199], v[144:147]
ds_read_b128 a[176:179], v34 offset:0
v_mfma_f32_16x16x32_bf16 v[160:163], a[208:211], a[200:203], v[160:163]
buffer_load_dwordx4 v16, s[48:51], s28 offen offset:0 lds
v_mfma_f32_16x16x32_bf16 v[176:179], a[208:211], a[204:207], v[176:179]
ds_read_b128 a[160:163], v32 offset:0
v_add_f32 v60, 1.0, v60
v_mfma_f32_16x16x32_bf16 v[180:183], a[212:215], a[204:207], v[180:183]
ds_read_b128 a[164:167], v32 offset:2048
v_add_f32 v62, 1.0, v62
v_mfma_f32_16x16x32_bf16 v[164:167], a[212:215], a[200:203], v[164:167]
ds_read_b128 a[168:171], v32 offset:4096
v_lshlrev_b32 v198, 16, v199
v_mfma_f32_16x16x32_bf16 v[148:151], a[212:215], a[196:199], v[148:151]
buffer_load_dwordx4 v17, s[48:51], s28 offen offset:1024 lds
v_mfma_f32_16x16x32_bf16 v[132:135], a[212:215], a[192:195], v[132:135]
ds_read_b128 a[172:175], v32 offset:6144
v_mul_f32 v101, v101, v61
s_waitcnt lgkmcnt(4)
v_mfma_f32_16x16x32_bf16 v[136:139], a[216:219], a[192:195], v[136:139]
ds_read_b128 a[180:183], v34 offset:2048
s_mul_i32 s29, s28, 16
v_mfma_f32_16x16x32_bf16 v[152:155], a[216:219], a[196:199], v[152:155]
v_rcp_f32 v60, v60
v_mfma_f32_16x16x32_bf16 v[168:171], a[216:219], a[200:203], v[168:171]
buffer_load_dwordx4 v18, s[48:51], s28 offen offset:2048 lds
v_mfma_f32_16x16x32_bf16 v[184:187], a[216:219], a[204:207], v[184:187]
ds_read_b128 a[184:187], v34 offset:4096
v_and_b32 v199, 0xffff0000, v199
v_mfma_f32_16x16x32_bf16 v[188:191], a[220:223], a[204:207], v[188:191]
ds_read_b128 a[188:191], v34 offset:6144
v_mul_f32 v102, v102, v60
v_mfma_f32_16x16x32_bf16 v[172:175], a[220:223], a[200:203], v[172:175]
v_rcp_f32 v62, v62
v_mfma_f32_16x16x32_bf16 v[156:159], a[220:223], a[196:199], v[156:159]
buffer_load_dwordx4 v19, s[48:51], s28 offen offset:3072 lds
v_mfma_f32_16x16x32_bf16 v[140:143], a[220:223], a[192:195], v[140:143]
s_add_u32 m0, s25, 65536
s_waitcnt lgkmcnt(2)
v_mfma_f32_16x16x32_bf16 v[128:131], a[176:179], a[160:163], v[128:131]
ds_read_b128 a[208:211], v34 offset:1024
v_mul_f32 v60, v104, v104
v_mfma_f32_16x16x32_bf16 v[144:147], a[176:179], a[164:167], v[144:147]
ds_read_b128 a[192:195], v33 offset:0
v_fma_f32 v60, v60, s39, v2
v_mfma_f32_16x16x32_bf16 v[160:163], a[176:179], a[168:171], v[160:163]
buffer_load_dwordx4 v20, s[52:55], s29 offen offset:0 sc1 lds
v_mfma_f32_16x16x32_bf16 v[176:179], a[176:179], a[172:175], v[176:179]
ds_read_b128 a[196:199], v33 offset:2048
v_lshlrev_b32 v212, 16, v214
v_mfma_f32_16x16x32_bf16 v[180:183], a[180:183], a[172:175], v[180:183]
ds_read_b128 a[200:203], v33 offset:4096
v_mul_f32 v60, v60, v104
v_mfma_f32_16x16x32_bf16 v[164:167], a[180:183], a[168:171], v[164:167]
s_add_u32 s31, s31, 1
v_exp_f32 v60, v60
v_mfma_f32_16x16x32_bf16 v[148:151], a[180:183], a[164:167], v[148:151]
buffer_load_dwordx4 v20, s[52:55], s29 offen offset:1024 sc1 lds
v_mfma_f32_16x16x32_bf16 v[132:135], a[180:183], a[160:163], v[132:135]
ds_read_b128 a[204:207], v33 offset:6144
v_mul_f32 v61, v105, v105
s_waitcnt lgkmcnt(3)
v_mfma_f32_16x16x32_bf16 v[136:139], a[184:187], a[160:163], v[136:139]
ds_read_b128 a[212:215], v34 offset:3072
v_fma_f32 v61, v61, s39, v2
v_mfma_f32_16x16x32_bf16 v[152:155], a[184:187], a[164:167], v[152:155]
v_readlane_b32 s28, v14, s31
ds_read_b64 v[230:231], v5 offset:4096
v_mfma_f32_16x16x32_bf16 v[168:171], a[184:187], a[168:171], v[168:171]
buffer_load_dwordx4 v21, s[52:55], s29 offen offset:2048 sc1 lds
v_mfma_f32_16x16x32_bf16 v[184:187], a[184:187], a[172:175], v[184:187]
ds_read_b128 a[216:219], v34 offset:5120
v_and_b32 v213, 0xffff0000, v214
v_mfma_f32_16x16x32_bf16 v[188:191], a[188:191], a[172:175], v[188:191]
ds_read_b128 a[220:223], v34 offset:7168
v_mul_f32 v61, v61, v105
v_mfma_f32_16x16x32_bf16 v[172:175], a[188:191], a[168:171], v[172:175]
v_exp_f32 v61, v61
v_mfma_f32_16x16x32_bf16 v[156:159], a[188:191], a[164:167], v[156:159]
buffer_load_dwordx4 v21, s[52:55], s29 offen offset:3072 sc1 lds
v_mfma_f32_16x16x32_bf16 v[140:143], a[188:191], a[160:163], v[140:143]
s_add_u32 m0, s25, 98304
s_waitcnt vmcnt(8)
v_mfma_f32_16x16x32_bf16 v[128:131], a[208:211], a[192:195], v[128:131]
s_barrier
s_waitcnt lgkmcnt(1)
v_mfma_f32_16x16x32_bf16 v[144:147], a[208:211], a[196:199], v[144:147]
ds_read_b128 a[176:179], v34 offset:32768
v_mfma_f32_16x16x32_bf16 v[160:163], a[208:211], a[200:203], v[160:163]
buffer_load_dwordx4 v20, s[52:55], s28 offen offset:0 sc1 lds
v_mfma_f32_16x16x32_bf16 v[176:179], a[208:211], a[204:207], v[176:179]
ds_read_b128 a[160:163], v32 offset:32768
v_add_f32 v60, 1.0, v60
v_mfma_f32_16x16x32_bf16 v[180:183], a[212:215], a[204:207], v[180:183]
ds_read_b128 a[164:167], v32 offset:34816
v_add_f32 v61, 1.0, v61
v_mfma_f32_16x16x32_bf16 v[164:167], a[212:215], a[200:203], v[164:167]
ds_read_b128 a[168:171], v32 offset:36864
v_lshlrev_b32 v214, 16, v215
v_mfma_f32_16x16x32_bf16 v[148:151], a[212:215], a[196:199], v[148:151]
buffer_load_dwordx4 v20, s[52:55], s28 offen offset:1024 sc1 lds
v_mfma_f32_16x16x32_bf16 v[132:135], a[212:215], a[192:195], v[132:135]
ds_read_b128 a[172:175], v32 offset:38912
v_mul_f32 v103, v103, v62
v_mfma_f32_16x16x32_bf16 v[136:139], a[216:219], a[192:195], v[136:139]
ds_read_b128 a[180:183], v34 offset:34816
s_mul_hi_u32 s29, s28, 268435456
v_mfma_f32_16x16x32_bf16 v[152:155], a[216:219], a[196:199], v[152:155]
v_rcp_f32 v60, v60
v_mfma_f32_16x16x32_bf16 v[168:171], a[216:219], a[200:203], v[168:171]
buffer_load_dwordx4 v21, s[52:55], s28 offen offset:2048 sc1 lds
v_mfma_f32_16x16x32_bf16 v[184:187], a[216:219], a[204:207], v[184:187]
ds_read_b128 a[184:187], v34 offset:36864
v_and_b32 v215, 0xffff0000, v215
s_waitcnt lgkmcnt(3)
v_mfma_f32_16x16x32_bf16 v[188:191], a[220:223], a[204:207], v[188:191]
ds_read_b128 a[188:191], v34 offset:38912
v_mul_f32 v104, v104, v60
v_mfma_f32_16x16x32_bf16 v[172:175], a[220:223], a[200:203], v[172:175]
v_rcp_f32 v61, v61
v_mfma_f32_16x16x32_bf16 v[156:159], a[220:223], a[196:199], v[156:159]
buffer_load_dwordx4 v21, s[52:55], s28 offen offset:3072 sc1 lds
v_mfma_f32_16x16x32_bf16 v[140:143], a[220:223], a[192:195], v[140:143]
s_add_u32 m0, s24, 98304
v_mfma_f32_16x16x32_bf16 v[128:131], a[176:179], a[160:163], v[128:131]
ds_read_b128 a[208:211], v34 offset:33792
v_mul_f32 v60, v106, v106
v_mfma_f32_16x16x32_bf16 v[144:147], a[176:179], a[164:167], v[144:147]
ds_read_b128 a[192:195], v33 offset:32768
v_fma_f32 v60, v60, s39, v2
v_mfma_f32_16x16x32_bf16 v[160:163], a[176:179], a[168:171], v[160:163]
buffer_load_dwordx4 v16, s[48:51], s29 offen offset:0 lds
s_waitcnt lgkmcnt(2)
v_mfma_f32_16x16x32_bf16 v[176:179], a[176:179], a[172:175], v[176:179]
ds_read_b128 a[196:199], v33 offset:34816
v_lshlrev_b32 v228, 16, v230
v_mfma_f32_16x16x32_bf16 v[180:183], a[180:183], a[172:175], v[180:183]
ds_read_b128 a[200:203], v33 offset:36864
v_mul_f32 v60, v60, v106
v_mfma_f32_16x16x32_bf16 v[164:167], a[180:183], a[168:171], v[164:167]
s_add_u32 s31, s31, 1
v_exp_f32 v60, v60
v_mfma_f32_16x16x32_bf16 v[148:151], a[180:183], a[164:167], v[148:151]
buffer_load_dwordx4 v17, s[48:51], s29 offen offset:1024 lds
v_mfma_f32_16x16x32_bf16 v[132:135], a[180:183], a[160:163], v[132:135]
ds_read_b128 a[204:207], v33 offset:38912
v_mul_f32 v62, v107, v107
v_mfma_f32_16x16x32_bf16 v[136:139], a[184:187], a[160:163], v[136:139]
ds_read_b128 a[212:215], v34 offset:35840
v_fma_f32 v62, v62, s39, v2
v_mfma_f32_16x16x32_bf16 v[152:155], a[184:187], a[164:167], v[152:155]
v_readlane_b32 s28, v14, s31
ds_read_b64 v[246:247], v5 offset:6144
v_mfma_f32_16x16x32_bf16 v[168:171], a[184:187], a[168:171], v[168:171]
buffer_load_dwordx4 v18, s[48:51], s29 offen offset:2048 lds
v_mfma_f32_16x16x32_bf16 v[184:187], a[184:187], a[172:175], v[184:187]
ds_read_b128 a[216:219], v34 offset:37888
v_and_b32 v229, 0xffff0000, v230
v_mfma_f32_16x16x32_bf16 v[188:191], a[188:191], a[172:175], v[188:191]
ds_read_b128 a[220:223], v34 offset:39936
v_mul_f32 v62, v62, v107
v_mfma_f32_16x16x32_bf16 v[172:175], a[188:191], a[168:171], v[172:175]
v_exp_f32 v62, v62
v_mfma_f32_16x16x32_bf16 v[156:159], a[188:191], a[164:167], v[156:159]
buffer_load_dwordx4 v19, s[48:51], s29 offen offset:3072 lds
v_mfma_f32_16x16x32_bf16 v[140:143], a[188:191], a[160:163], v[140:143]
s_add_u32 m0, s24, 0
s_waitcnt vmcnt(8) lgkmcnt(2)
v_mfma_f32_16x16x32_bf16 v[128:131], a[208:211], a[192:195], v[128:131]
s_barrier
v_mfma_f32_16x16x32_bf16 v[144:147], a[208:211], a[196:199], v[144:147]
ds_read_b128 a[176:179], v37 offset:0
v_mfma_f32_16x16x32_bf16 v[160:163], a[208:211], a[200:203], v[160:163]
buffer_load_dwordx4 v16, s[48:51], s28 offen offset:0 lds
v_mfma_f32_16x16x32_bf16 v[176:179], a[208:211], a[204:207], v[176:179]
ds_read_b128 a[160:163], v35 offset:0
v_add_f32 v60, 1.0, v60
v_mfma_f32_16x16x32_bf16 v[180:183], a[212:215], a[204:207], v[180:183]
ds_read_b128 a[164:167], v35 offset:2048
v_add_f32 v62, 1.0, v62
v_mfma_f32_16x16x32_bf16 v[164:167], a[212:215], a[200:203], v[164:167]
ds_read_b128 a[168:171], v35 offset:4096
v_lshlrev_b32 v230, 16, v231
v_mfma_f32_16x16x32_bf16 v[148:151], a[212:215], a[196:199], v[148:151]
buffer_load_dwordx4 v17, s[48:51], s28 offen offset:1024 lds
v_mfma_f32_16x16x32_bf16 v[132:135], a[212:215], a[192:195], v[132:135]
ds_read_b128 a[172:175], v35 offset:6144
v_mul_f32 v105, v105, v61
s_waitcnt lgkmcnt(4)
v_mfma_f32_16x16x32_bf16 v[136:139], a[216:219], a[192:195], v[136:139]
ds_read_b128 a[180:183], v37 offset:2048
s_mul_i32 s29, s28, 16
v_mfma_f32_16x16x32_bf16 v[152:155], a[216:219], a[196:199], v[152:155]
v_rcp_f32 v60, v60
v_mfma_f32_16x16x32_bf16 v[168:171], a[216:219], a[200:203], v[168:171]
buffer_load_dwordx4 v18, s[48:51], s28 offen offset:2048 lds
v_mfma_f32_16x16x32_bf16 v[184:187], a[216:219], a[204:207], v[184:187]
ds_read_b128 a[184:187], v37 offset:4096
v_and_b32 v231, 0xffff0000, v231
v_mfma_f32_16x16x32_bf16 v[188:191], a[220:223], a[204:207], v[188:191]
ds_read_b128 a[188:191], v37 offset:6144
v_mul_f32 v106, v106, v60
v_mfma_f32_16x16x32_bf16 v[172:175], a[220:223], a[200:203], v[172:175]
v_rcp_f32 v62, v62
v_mfma_f32_16x16x32_bf16 v[156:159], a[220:223], a[196:199], v[156:159]
buffer_load_dwordx4 v19, s[48:51], s28 offen offset:3072 lds
v_mfma_f32_16x16x32_bf16 v[140:143], a[220:223], a[192:195], v[140:143]
s_add_u32 m0, s25, 0
s_waitcnt lgkmcnt(2)
v_mfma_f32_16x16x32_bf16 v[128:131], a[176:179], a[160:163], v[128:131]
ds_read_b128 a[208:211], v37 offset:1024
v_mul_f32 v60, v108, v108
v_mfma_f32_16x16x32_bf16 v[144:147], a[176:179], a[164:167], v[144:147]
ds_read_b128 a[192:195], v36 offset:0
v_fma_f32 v60, v60, s39, v2
v_mfma_f32_16x16x32_bf16 v[160:163], a[176:179], a[168:171], v[160:163]
buffer_load_dwordx4 v20, s[52:55], s29 offen offset:0 sc1 lds
v_mfma_f32_16x16x32_bf16 v[176:179], a[176:179], a[172:175], v[176:179]
ds_read_b128 a[196:199], v36 offset:2048
v_lshlrev_b32 v244, 16, v246
v_mfma_f32_16x16x32_bf16 v[180:183], a[180:183], a[172:175], v[180:183]
ds_read_b128 a[200:203], v36 offset:4096
v_mul_f32 v60, v60, v108
v_mfma_f32_16x16x32_bf16 v[164:167], a[180:183], a[168:171], v[164:167]
s_add_u32 s31, s31, 1
v_exp_f32 v60, v60
v_mfma_f32_16x16x32_bf16 v[148:151], a[180:183], a[164:167], v[148:151]
buffer_load_dwordx4 v20, s[52:55], s29 offen offset:1024 sc1 lds
v_mfma_f32_16x16x32_bf16 v[132:135], a[180:183], a[160:163], v[132:135]
ds_read_b128 a[204:207], v36 offset:6144
v_mul_f32 v61, v109, v109
s_waitcnt lgkmcnt(3)
v_mfma_f32_16x16x32_bf16 v[136:139], a[184:187], a[160:163], v[136:139]
ds_read_b128 a[212:215], v37 offset:3072
v_fma_f32 v61, v61, s39, v2
v_mfma_f32_16x16x32_bf16 v[152:155], a[184:187], a[164:167], v[152:155]
v_readlane_b32 s28, v14, s31
v_mfma_f32_16x16x32_bf16 v[168:171], a[184:187], a[168:171], v[168:171]
buffer_load_dwordx4 v21, s[52:55], s29 offen offset:2048 sc1 lds
v_mfma_f32_16x16x32_bf16 v[184:187], a[184:187], a[172:175], v[184:187]
ds_read_b128 a[216:219], v37 offset:5120
v_and_b32 v245, 0xffff0000, v246
v_mfma_f32_16x16x32_bf16 v[188:191], a[188:191], a[172:175], v[188:191]
ds_read_b128 a[220:223], v37 offset:7168
v_mul_f32 v61, v61, v109
v_mfma_f32_16x16x32_bf16 v[172:175], a[188:191], a[168:171], v[172:175]
v_exp_f32 v61, v61
v_mfma_f32_16x16x32_bf16 v[156:159], a[188:191], a[164:167], v[156:159]
buffer_load_dwordx4 v21, s[52:55], s29 offen offset:3072 sc1 lds
v_mfma_f32_16x16x32_bf16 v[140:143], a[188:191], a[160:163], v[140:143]
s_add_u32 m0, s25, 32768
s_waitcnt vmcnt(8)
v_mfma_f32_16x16x32_bf16 v[128:131], a[208:211], a[192:195], v[128:131]
s_barrier
s_waitcnt lgkmcnt(1)
v_mfma_f32_16x16x32_bf16 v[144:147], a[208:211], a[196:199], v[144:147]
ds_read_b128 a[176:179], v37 offset:32768
v_mfma_f32_16x16x32_bf16 v[160:163], a[208:211], a[200:203], v[160:163]
buffer_load_dwordx4 v20, s[52:55], s28 offen offset:0 sc1 lds
v_mfma_f32_16x16x32_bf16 v[176:179], a[208:211], a[204:207], v[176:179]
ds_read_b128 a[160:163], v35 offset:32768
v_add_f32 v60, 1.0, v60
v_mfma_f32_16x16x32_bf16 v[180:183], a[212:215], a[204:207], v[180:183]
ds_read_b128 a[164:167], v35 offset:34816
v_add_f32 v61, 1.0, v61
v_mfma_f32_16x16x32_bf16 v[164:167], a[212:215], a[200:203], v[164:167]
ds_read_b128 a[168:171], v35 offset:36864
v_lshlrev_b32 v246, 16, v247
v_mfma_f32_16x16x32_bf16 v[148:151], a[212:215], a[196:199], v[148:151]
buffer_load_dwordx4 v20, s[52:55], s28 offen offset:1024 sc1 lds
v_mfma_f32_16x16x32_bf16 v[132:135], a[212:215], a[192:195], v[132:135]
ds_read_b128 a[172:175], v35 offset:38912
v_mul_f32 v107, v107, v62
v_mfma_f32_16x16x32_bf16 v[136:139], a[216:219], a[192:195], v[136:139]
ds_read_b128 a[180:183], v37 offset:34816
s_mul_hi_u32 s29, s28, 268435456
v_mfma_f32_16x16x32_bf16 v[152:155], a[216:219], a[196:199], v[152:155]
v_rcp_f32 v60, v60
v_mfma_f32_16x16x32_bf16 v[168:171], a[216:219], a[200:203], v[168:171]
buffer_load_dwordx4 v21, s[52:55], s28 offen offset:2048 sc1 lds
v_mfma_f32_16x16x32_bf16 v[184:187], a[216:219], a[204:207], v[184:187]
ds_read_b128 a[184:187], v37 offset:36864
v_and_b32 v247, 0xffff0000, v247
s_waitcnt lgkmcnt(3)
v_mfma_f32_16x16x32_bf16 v[188:191], a[220:223], a[204:207], v[188:191]
ds_read_b128 a[188:191], v37 offset:38912
v_mul_f32 v108, v108, v60
v_mfma_f32_16x16x32_bf16 v[172:175], a[220:223], a[200:203], v[172:175]
v_rcp_f32 v61, v61
v_mfma_f32_16x16x32_bf16 v[156:159], a[220:223], a[196:199], v[156:159]
buffer_load_dwordx4 v21, s[52:55], s28 offen offset:3072 sc1 lds
v_mfma_f32_16x16x32_bf16 v[140:143], a[220:223], a[192:195], v[140:143]
s_add_u32 m0, s24, 32768
v_mfma_f32_16x16x32_bf16 v[128:131], a[176:179], a[160:163], v[128:131]
ds_read_b128 a[208:211], v37 offset:33792
v_mul_f32 v60, v110, v110
v_mfma_f32_16x16x32_bf16 v[144:147], a[176:179], a[164:167], v[144:147]
ds_read_b128 a[192:195], v36 offset:32768
v_fma_f32 v60, v60, s39, v2
v_mfma_f32_16x16x32_bf16 v[160:163], a[176:179], a[168:171], v[160:163]
buffer_load_dwordx4 v16, s[48:51], s29 offen offset:0 lds
s_waitcnt lgkmcnt(2)
v_mfma_f32_16x16x32_bf16 v[176:179], a[176:179], a[172:175], v[176:179]
ds_read_b128 a[196:199], v36 offset:34816
v_mfma_f32_16x16x32_bf16 v[180:183], a[180:183], a[172:175], v[180:183]
ds_read_b128 a[200:203], v36 offset:36864
v_mul_f32 v60, v60, v110
v_mfma_f32_16x16x32_bf16 v[164:167], a[180:183], a[168:171], v[164:167]
s_add_u32 s31, s31, 1
v_exp_f32 v60, v60
v_mfma_f32_16x16x32_bf16 v[148:151], a[180:183], a[164:167], v[148:151]
buffer_load_dwordx4 v17, s[48:51], s29 offen offset:1024 lds
v_mfma_f32_16x16x32_bf16 v[132:135], a[180:183], a[160:163], v[132:135]
ds_read_b128 a[204:207], v36 offset:38912
v_mul_f32 v62, v111, v111
v_mfma_f32_16x16x32_bf16 v[136:139], a[184:187], a[160:163], v[136:139]
ds_read_b128 a[212:215], v37 offset:35840
v_fma_f32 v62, v62, s39, v2
v_mfma_f32_16x16x32_bf16 v[152:155], a[184:187], a[164:167], v[152:155]
v_readlane_b32 s28, v14, s31
v_mfma_f32_16x16x32_bf16 v[168:171], a[184:187], a[168:171], v[168:171]
buffer_load_dwordx4 v18, s[48:51], s29 offen offset:2048 lds
v_mfma_f32_16x16x32_bf16 v[184:187], a[184:187], a[172:175], v[184:187]
ds_read_b128 a[216:219], v37 offset:37888
v_mfma_f32_16x16x32_bf16 v[188:191], a[188:191], a[172:175], v[188:191]
ds_read_b128 a[220:223], v37 offset:39936
v_mul_f32 v62, v62, v111
v_mfma_f32_16x16x32_bf16 v[172:175], a[188:191], a[168:171], v[172:175]
v_exp_f32 v62, v62
v_mfma_f32_16x16x32_bf16 v[156:159], a[188:191], a[164:167], v[156:159]
buffer_load_dwordx4 v19, s[48:51], s29 offen offset:3072 lds
v_mfma_f32_16x16x32_bf16 v[140:143], a[188:191], a[160:163], v[140:143]
s_add_u32 m0, s24, 65536
s_waitcnt vmcnt(8) lgkmcnt(2)
v_mfma_f32_16x16x32_bf16 v[128:131], a[208:211], a[192:195], v[128:131]
s_barrier
v_mfma_f32_16x16x32_bf16 v[144:147], a[208:211], a[196:199], v[144:147]
ds_read_b128 a[176:179], v34 offset:0
v_mfma_f32_16x16x32_bf16 v[160:163], a[208:211], a[200:203], v[160:163]
buffer_load_dwordx4 v16, s[48:51], s28 offen offset:0 lds
v_mfma_f32_16x16x32_bf16 v[176:179], a[208:211], a[204:207], v[176:179]
ds_read_b128 a[160:163], v32 offset:0
v_add_f32 v60, 1.0, v60
v_mfma_f32_16x16x32_bf16 v[180:183], a[212:215], a[204:207], v[180:183]
ds_read_b128 a[164:167], v32 offset:2048
v_add_f32 v62, 1.0, v62
v_mfma_f32_16x16x32_bf16 v[164:167], a[212:215], a[200:203], v[164:167]
ds_read_b128 a[168:171], v32 offset:4096
v_mfma_f32_16x16x32_bf16 v[148:151], a[212:215], a[196:199], v[148:151]
buffer_load_dwordx4 v17, s[48:51], s28 offen offset:1024 lds
v_mfma_f32_16x16x32_bf16 v[132:135], a[212:215], a[192:195], v[132:135]
ds_read_b128 a[172:175], v32 offset:6144
v_mul_f32 v109, v109, v61
s_waitcnt lgkmcnt(4)
v_mfma_f32_16x16x32_bf16 v[136:139], a[216:219], a[192:195], v[136:139]
ds_read_b128 a[180:183], v34 offset:2048
s_mul_i32 s29, s28, 16
v_mfma_f32_16x16x32_bf16 v[152:155], a[216:219], a[196:199], v[152:155]
v_rcp_f32 v60, v60
v_mfma_f32_16x16x32_bf16 v[168:171], a[216:219], a[200:203], v[168:171]
buffer_load_dwordx4 v18, s[48:51], s28 offen offset:2048 lds
v_mfma_f32_16x16x32_bf16 v[184:187], a[216:219], a[204:207], v[184:187]
ds_read_b128 a[184:187], v34 offset:4096
v_mfma_f32_16x16x32_bf16 v[188:191], a[220:223], a[204:207], v[188:191]
ds_read_b128 a[188:191], v34 offset:6144
v_mul_f32 v110, v110, v60
v_mfma_f32_16x16x32_bf16 v[172:175], a[220:223], a[200:203], v[172:175]
v_rcp_f32 v62, v62
v_mfma_f32_16x16x32_bf16 v[156:159], a[220:223], a[196:199], v[156:159]
buffer_load_dwordx4 v19, s[48:51], s28 offen offset:3072 lds
v_mfma_f32_16x16x32_bf16 v[140:143], a[220:223], a[192:195], v[140:143]
s_add_u32 m0, s25, 65536
s_waitcnt lgkmcnt(2)
v_mfma_f32_16x16x32_bf16 v[128:131], a[176:179], a[160:163], v[128:131]
ds_read_b128 a[208:211], v34 offset:1024
v_mul_f32 v60, v112, v112
v_mfma_f32_16x16x32_bf16 v[144:147], a[176:179], a[164:167], v[144:147]
ds_read_b128 a[192:195], v33 offset:0
v_fma_f32 v60, v60, s39, v2
v_mfma_f32_16x16x32_bf16 v[160:163], a[176:179], a[168:171], v[160:163]
buffer_load_dwordx4 v20, s[52:55], s29 offen offset:0 sc1 lds
v_mfma_f32_16x16x32_bf16 v[176:179], a[176:179], a[172:175], v[176:179]
ds_read_b128 a[196:199], v33 offset:2048
v_mfma_f32_16x16x32_bf16 v[180:183], a[180:183], a[172:175], v[180:183]
ds_read_b128 a[200:203], v33 offset:4096
v_mul_f32 v60, v60, v112
v_mfma_f32_16x16x32_bf16 v[164:167], a[180:183], a[168:171], v[164:167]
s_add_u32 s31, s31, 1
v_exp_f32 v60, v60
v_mfma_f32_16x16x32_bf16 v[148:151], a[180:183], a[164:167], v[148:151]
buffer_load_dwordx4 v20, s[52:55], s29 offen offset:1024 sc1 lds
v_mfma_f32_16x16x32_bf16 v[132:135], a[180:183], a[160:163], v[132:135]
ds_read_b128 a[204:207], v33 offset:6144
v_mul_f32 v61, v113, v113
s_waitcnt lgkmcnt(3)
v_mfma_f32_16x16x32_bf16 v[136:139], a[184:187], a[160:163], v[136:139]
ds_read_b128 a[212:215], v34 offset:3072
v_fma_f32 v61, v61, s39, v2
v_mfma_f32_16x16x32_bf16 v[152:155], a[184:187], a[164:167], v[152:155]
v_readlane_b32 s28, v14, s31
v_mfma_f32_16x16x32_bf16 v[168:171], a[184:187], a[168:171], v[168:171]
buffer_load_dwordx4 v21, s[52:55], s29 offen offset:2048 sc1 lds
v_mfma_f32_16x16x32_bf16 v[184:187], a[184:187], a[172:175], v[184:187]
ds_read_b128 a[216:219], v34 offset:5120
v_mfma_f32_16x16x32_bf16 v[188:191], a[188:191], a[172:175], v[188:191]
ds_read_b128 a[220:223], v34 offset:7168
v_mul_f32 v61, v61, v113
v_mfma_f32_16x16x32_bf16 v[172:175], a[188:191], a[168:171], v[172:175]
v_exp_f32 v61, v61
v_mfma_f32_16x16x32_bf16 v[156:159], a[188:191], a[164:167], v[156:159]
buffer_load_dwordx4 v21, s[52:55], s29 offen offset:3072 sc1 lds
v_mfma_f32_16x16x32_bf16 v[140:143], a[188:191], a[160:163], v[140:143]
s_add_u32 m0, s25, 98304
s_waitcnt vmcnt(8)
v_mfma_f32_16x16x32_bf16 v[128:131], a[208:211], a[192:195], v[128:131]
s_barrier
s_waitcnt lgkmcnt(1)
v_mfma_f32_16x16x32_bf16 v[144:147], a[208:211], a[196:199], v[144:147]
ds_read_b128 a[176:179], v34 offset:32768
v_mfma_f32_16x16x32_bf16 v[160:163], a[208:211], a[200:203], v[160:163]
buffer_load_dwordx4 v20, s[52:55], s28 offen offset:0 sc1 lds
v_mfma_f32_16x16x32_bf16 v[176:179], a[208:211], a[204:207], v[176:179]
ds_read_b128 a[160:163], v32 offset:32768
v_add_f32 v60, 1.0, v60
v_mfma_f32_16x16x32_bf16 v[180:183], a[212:215], a[204:207], v[180:183]
ds_read_b128 a[164:167], v32 offset:34816
v_add_f32 v61, 1.0, v61
v_mfma_f32_16x16x32_bf16 v[164:167], a[212:215], a[200:203], v[164:167]
ds_read_b128 a[168:171], v32 offset:36864
v_mfma_f32_16x16x32_bf16 v[148:151], a[212:215], a[196:199], v[148:151]
buffer_load_dwordx4 v20, s[52:55], s28 offen offset:1024 sc1 lds
v_mfma_f32_16x16x32_bf16 v[132:135], a[212:215], a[192:195], v[132:135]
ds_read_b128 a[172:175], v32 offset:38912
v_mul_f32 v111, v111, v62
v_mfma_f32_16x16x32_bf16 v[136:139], a[216:219], a[192:195], v[136:139]
ds_read_b128 a[180:183], v34 offset:34816
s_mul_hi_u32 s29, s28, 268435456
v_mfma_f32_16x16x32_bf16 v[152:155], a[216:219], a[196:199], v[152:155]
v_rcp_f32 v60, v60
v_mfma_f32_16x16x32_bf16 v[168:171], a[216:219], a[200:203], v[168:171]
buffer_load_dwordx4 v21, s[52:55], s28 offen offset:2048 sc1 lds
v_mfma_f32_16x16x32_bf16 v[184:187], a[216:219], a[204:207], v[184:187]
ds_read_b128 a[184:187], v34 offset:36864
s_waitcnt lgkmcnt(3)
v_mfma_f32_16x16x32_bf16 v[188:191], a[220:223], a[204:207], v[188:191]
ds_read_b128 a[188:191], v34 offset:38912
v_mul_f32 v112, v112, v60
v_mfma_f32_16x16x32_bf16 v[172:175], a[220:223], a[200:203], v[172:175]
v_rcp_f32 v61, v61
v_mfma_f32_16x16x32_bf16 v[156:159], a[220:223], a[196:199], v[156:159]
buffer_load_dwordx4 v21, s[52:55], s28 offen offset:3072 sc1 lds
v_mfma_f32_16x16x32_bf16 v[140:143], a[220:223], a[192:195], v[140:143]
s_add_u32 m0, s24, 98304
v_mfma_f32_16x16x32_bf16 v[128:131], a[176:179], a[160:163], v[128:131]
ds_read_b128 a[208:211], v34 offset:33792
v_mul_f32 v60, v114, v114
v_mfma_f32_16x16x32_bf16 v[144:147], a[176:179], a[164:167], v[144:147]
ds_read_b128 a[192:195], v33 offset:32768
v_fma_f32 v60, v60, s39, v2
v_mfma_f32_16x16x32_bf16 v[160:163], a[176:179], a[168:171], v[160:163]
buffer_load_dwordx4 v16, s[48:51], s29 offen offset:0 lds
s_waitcnt lgkmcnt(2)
v_mfma_f32_16x16x32_bf16 v[176:179], a[176:179], a[172:175], v[176:179]
ds_read_b128 a[196:199], v33 offset:34816
v_mfma_f32_16x16x32_bf16 v[180:183], a[180:183], a[172:175], v[180:183]
ds_read_b128 a[200:203], v33 offset:36864
v_mul_f32 v60, v60, v114
v_mfma_f32_16x16x32_bf16 v[164:167], a[180:183], a[168:171], v[164:167]
s_add_u32 s31, s31, 1
v_exp_f32 v60, v60
v_mfma_f32_16x16x32_bf16 v[148:151], a[180:183], a[164:167], v[148:151]
buffer_load_dwordx4 v17, s[48:51], s29 offen offset:1024 lds
v_mfma_f32_16x16x32_bf16 v[132:135], a[180:183], a[160:163], v[132:135]
ds_read_b128 a[204:207], v33 offset:38912
v_mul_f32 v62, v115, v115
v_mfma_f32_16x16x32_bf16 v[136:139], a[184:187], a[160:163], v[136:139]
ds_read_b128 a[212:215], v34 offset:35840
v_fma_f32 v62, v62, s39, v2
v_mfma_f32_16x16x32_bf16 v[152:155], a[184:187], a[164:167], v[152:155]
v_readlane_b32 s28, v14, s31
v_mfma_f32_16x16x32_bf16 v[168:171], a[184:187], a[168:171], v[168:171]
buffer_load_dwordx4 v18, s[48:51], s29 offen offset:2048 lds
v_mfma_f32_16x16x32_bf16 v[184:187], a[184:187], a[172:175], v[184:187]
ds_read_b128 a[216:219], v34 offset:37888
v_mfma_f32_16x16x32_bf16 v[188:191], a[188:191], a[172:175], v[188:191]
ds_read_b128 a[220:223], v34 offset:39936
v_mul_f32 v62, v62, v115
v_mfma_f32_16x16x32_bf16 v[172:175], a[188:191], a[168:171], v[172:175]
v_exp_f32 v62, v62
v_mfma_f32_16x16x32_bf16 v[156:159], a[188:191], a[164:167], v[156:159]
buffer_load_dwordx4 v19, s[48:51], s29 offen offset:3072 lds
v_mfma_f32_16x16x32_bf16 v[140:143], a[188:191], a[160:163], v[140:143]
s_add_u32 m0, s24, 0
s_waitcnt vmcnt(8) lgkmcnt(2)
v_mfma_f32_16x16x32_bf16 v[128:131], a[208:211], a[192:195], v[128:131]
s_barrier
v_mfma_f32_16x16x32_bf16 v[144:147], a[208:211], a[196:199], v[144:147]
ds_read_b128 a[176:179], v37 offset:0
v_mfma_f32_16x16x32_bf16 v[160:163], a[208:211], a[200:203], v[160:163]
buffer_load_dwordx4 v16, s[48:51], s28 offen offset:0 lds
v_mfma_f32_16x16x32_bf16 v[176:179], a[208:211], a[204:207], v[176:179]
ds_read_b128 a[160:163], v35 offset:0
v_add_f32 v60, 1.0, v60
v_mfma_f32_16x16x32_bf16 v[180:183], a[212:215], a[204:207], v[180:183]
ds_read_b128 a[164:167], v35 offset:2048
v_add_f32 v62, 1.0, v62
v_mfma_f32_16x16x32_bf16 v[164:167], a[212:215], a[200:203], v[164:167]
ds_read_b128 a[168:171], v35 offset:4096
v_mfma_f32_16x16x32_bf16 v[148:151], a[212:215], a[196:199], v[148:151]
buffer_load_dwordx4 v17, s[48:51], s28 offen offset:1024 lds
v_mfma_f32_16x16x32_bf16 v[132:135], a[212:215], a[192:195], v[132:135]
ds_read_b128 a[172:175], v35 offset:6144
v_mul_f32 v113, v113, v61
s_waitcnt lgkmcnt(4)
v_mfma_f32_16x16x32_bf16 v[136:139], a[216:219], a[192:195], v[136:139]
ds_read_b128 a[180:183], v37 offset:2048
s_mul_i32 s29, s28, 16
v_mfma_f32_16x16x32_bf16 v[152:155], a[216:219], a[196:199], v[152:155]
v_rcp_f32 v60, v60
v_mfma_f32_16x16x32_bf16 v[168:171], a[216:219], a[200:203], v[168:171]
buffer_load_dwordx4 v18, s[48:51], s28 offen offset:2048 lds
v_mfma_f32_16x16x32_bf16 v[184:187], a[216:219], a[204:207], v[184:187]
ds_read_b128 a[184:187], v37 offset:4096
v_mfma_f32_16x16x32_bf16 v[188:191], a[220:223], a[204:207], v[188:191]
ds_read_b128 a[188:191], v37 offset:6144
v_mul_f32 v114, v114, v60
v_mfma_f32_16x16x32_bf16 v[172:175], a[220:223], a[200:203], v[172:175]
v_rcp_f32 v62, v62
v_mfma_f32_16x16x32_bf16 v[156:159], a[220:223], a[196:199], v[156:159]
buffer_load_dwordx4 v19, s[48:51], s28 offen offset:3072 lds
v_mfma_f32_16x16x32_bf16 v[140:143], a[220:223], a[192:195], v[140:143]
s_add_u32 m0, s25, 0
s_waitcnt lgkmcnt(2)
v_mfma_f32_16x16x32_bf16 v[128:131], a[176:179], a[160:163], v[128:131]
ds_read_b128 a[208:211], v37 offset:1024
v_mul_f32 v60, v116, v116
v_mfma_f32_16x16x32_bf16 v[144:147], a[176:179], a[164:167], v[144:147]
ds_read_b128 a[192:195], v36 offset:0
v_fma_f32 v60, v60, s39, v2
v_mfma_f32_16x16x32_bf16 v[160:163], a[176:179], a[168:171], v[160:163]
buffer_load_dwordx4 v20, s[52:55], s29 offen offset:0 sc1 lds
v_mfma_f32_16x16x32_bf16 v[176:179], a[176:179], a[172:175], v[176:179]
ds_read_b128 a[196:199], v36 offset:2048
v_mfma_f32_16x16x32_bf16 v[180:183], a[180:183], a[172:175], v[180:183]
ds_read_b128 a[200:203], v36 offset:4096
v_mul_f32 v60, v60, v116
v_mfma_f32_16x16x32_bf16 v[164:167], a[180:183], a[168:171], v[164:167]
s_add_u32 s31, s31, 1
v_exp_f32 v60, v60
v_mfma_f32_16x16x32_bf16 v[148:151], a[180:183], a[164:167], v[148:151]
buffer_load_dwordx4 v20, s[52:55], s29 offen offset:1024 sc1 lds
v_mfma_f32_16x16x32_bf16 v[132:135], a[180:183], a[160:163], v[132:135]
ds_read_b128 a[204:207], v36 offset:6144
v_mul_f32 v61, v117, v117
s_waitcnt lgkmcnt(3)
v_mfma_f32_16x16x32_bf16 v[136:139], a[184:187], a[160:163], v[136:139]
ds_read_b128 a[212:215], v37 offset:3072
v_fma_f32 v61, v61, s39, v2
v_mfma_f32_16x16x32_bf16 v[152:155], a[184:187], a[164:167], v[152:155]
v_readlane_b32 s28, v14, s31
v_mfma_f32_16x16x32_bf16 v[168:171], a[184:187], a[168:171], v[168:171]
buffer_load_dwordx4 v21, s[52:55], s29 offen offset:2048 sc1 lds
v_mfma_f32_16x16x32_bf16 v[184:187], a[184:187], a[172:175], v[184:187]
ds_read_b128 a[216:219], v37 offset:5120
v_mfma_f32_16x16x32_bf16 v[188:191], a[188:191], a[172:175], v[188:191]
ds_read_b128 a[220:223], v37 offset:7168
v_mul_f32 v61, v61, v117
v_mfma_f32_16x16x32_bf16 v[172:175], a[188:191], a[168:171], v[172:175]
v_exp_f32 v61, v61
v_mfma_f32_16x16x32_bf16 v[156:159], a[188:191], a[164:167], v[156:159]
buffer_load_dwordx4 v21, s[52:55], s29 offen offset:3072 sc1 lds
v_mfma_f32_16x16x32_bf16 v[140:143], a[188:191], a[160:163], v[140:143]
s_add_u32 m0, s25, 32768
s_waitcnt vmcnt(8)
v_mfma_f32_16x16x32_bf16 v[128:131], a[208:211], a[192:195], v[128:131]
s_barrier
s_waitcnt lgkmcnt(1)
v_mfma_f32_16x16x32_bf16 v[144:147], a[208:211], a[196:199], v[144:147]
ds_read_b128 a[176:179], v37 offset:32768
v_mfma_f32_16x16x32_bf16 v[160:163], a[208:211], a[200:203], v[160:163]
buffer_load_dwordx4 v20, s[52:55], s28 offen offset:0 sc1 lds
v_mfma_f32_16x16x32_bf16 v[176:179], a[208:211], a[204:207], v[176:179]
ds_read_b128 a[160:163], v35 offset:32768
v_add_f32 v60, 1.0, v60
v_mfma_f32_16x16x32_bf16 v[180:183], a[212:215], a[204:207], v[180:183]
ds_read_b128 a[164:167], v35 offset:34816
v_add_f32 v61, 1.0, v61
v_mfma_f32_16x16x32_bf16 v[164:167], a[212:215], a[200:203], v[164:167]
ds_read_b128 a[168:171], v35 offset:36864
v_mfma_f32_16x16x32_bf16 v[148:151], a[212:215], a[196:199], v[148:151]
buffer_load_dwordx4 v20, s[52:55], s28 offen offset:1024 sc1 lds
v_mfma_f32_16x16x32_bf16 v[132:135], a[212:215], a[192:195], v[132:135]
ds_read_b128 a[172:175], v35 offset:38912
v_mul_f32 v115, v115, v62
v_mfma_f32_16x16x32_bf16 v[136:139], a[216:219], a[192:195], v[136:139]
ds_read_b128 a[180:183], v37 offset:34816
s_mul_hi_u32 s29, s28, 268435456
v_mfma_f32_16x16x32_bf16 v[152:155], a[216:219], a[196:199], v[152:155]
v_rcp_f32 v60, v60
v_mfma_f32_16x16x32_bf16 v[168:171], a[216:219], a[200:203], v[168:171]
buffer_load_dwordx4 v21, s[52:55], s28 offen offset:2048 sc1 lds
v_mfma_f32_16x16x32_bf16 v[184:187], a[216:219], a[204:207], v[184:187]
ds_read_b128 a[184:187], v37 offset:36864
s_waitcnt lgkmcnt(3)
v_mfma_f32_16x16x32_bf16 v[188:191], a[220:223], a[204:207], v[188:191]
ds_read_b128 a[188:191], v37 offset:38912
v_mul_f32 v116, v116, v60
v_mfma_f32_16x16x32_bf16 v[172:175], a[220:223], a[200:203], v[172:175]
v_rcp_f32 v61, v61
v_mfma_f32_16x16x32_bf16 v[156:159], a[220:223], a[196:199], v[156:159]
buffer_load_dwordx4 v21, s[52:55], s28 offen offset:3072 sc1 lds
v_mfma_f32_16x16x32_bf16 v[140:143], a[220:223], a[192:195], v[140:143]
s_add_u32 m0, s24, 32768
v_mfma_f32_16x16x32_bf16 v[128:131], a[176:179], a[160:163], v[128:131]
ds_read_b128 a[208:211], v37 offset:33792
v_mul_f32 v60, v118, v118
v_mfma_f32_16x16x32_bf16 v[144:147], a[176:179], a[164:167], v[144:147]
ds_read_b128 a[192:195], v36 offset:32768
v_fma_f32 v60, v60, s39, v2
v_mfma_f32_16x16x32_bf16 v[160:163], a[176:179], a[168:171], v[160:163]
buffer_load_dwordx4 v16, s[48:51], s29 offen offset:0 lds
s_waitcnt lgkmcnt(2)
v_mfma_f32_16x16x32_bf16 v[176:179], a[176:179], a[172:175], v[176:179]
ds_read_b128 a[196:199], v36 offset:34816
v_mfma_f32_16x16x32_bf16 v[180:183], a[180:183], a[172:175], v[180:183]
ds_read_b128 a[200:203], v36 offset:36864
v_mul_f32 v60, v60, v118
v_mfma_f32_16x16x32_bf16 v[164:167], a[180:183], a[168:171], v[164:167]
s_add_u32 s31, s31, 1
v_exp_f32 v60, v60
v_mfma_f32_16x16x32_bf16 v[148:151], a[180:183], a[164:167], v[148:151]
buffer_load_dwordx4 v17, s[48:51], s29 offen offset:1024 lds
v_mfma_f32_16x16x32_bf16 v[132:135], a[180:183], a[160:163], v[132:135]
ds_read_b128 a[204:207], v36 offset:38912
v_mul_f32 v62, v119, v119
v_mfma_f32_16x16x32_bf16 v[136:139], a[184:187], a[160:163], v[136:139]
ds_read_b128 a[212:215], v37 offset:35840
v_fma_f32 v62, v62, s39, v2
v_mfma_f32_16x16x32_bf16 v[152:155], a[184:187], a[164:167], v[152:155]
v_readlane_b32 s28, v14, s31
v_mfma_f32_16x16x32_bf16 v[168:171], a[184:187], a[168:171], v[168:171]
buffer_load_dwordx4 v18, s[48:51], s29 offen offset:2048 lds
v_mfma_f32_16x16x32_bf16 v[184:187], a[184:187], a[172:175], v[184:187]
ds_read_b128 a[216:219], v37 offset:37888
v_mfma_f32_16x16x32_bf16 v[188:191], a[188:191], a[172:175], v[188:191]
ds_read_b128 a[220:223], v37 offset:39936
v_mul_f32 v62, v62, v119
v_mfma_f32_16x16x32_bf16 v[172:175], a[188:191], a[168:171], v[172:175]
v_exp_f32 v62, v62
v_mfma_f32_16x16x32_bf16 v[156:159], a[188:191], a[164:167], v[156:159]
buffer_load_dwordx4 v19, s[48:51], s29 offen offset:3072 lds
v_mfma_f32_16x16x32_bf16 v[140:143], a[188:191], a[160:163], v[140:143]
s_add_u32 m0, s24, 65536
s_waitcnt vmcnt(8) lgkmcnt(2)
v_mfma_f32_16x16x32_bf16 v[128:131], a[208:211], a[192:195], v[128:131]
s_barrier
v_mfma_f32_16x16x32_bf16 v[144:147], a[208:211], a[196:199], v[144:147]
ds_read_b128 a[176:179], v34 offset:0
v_mfma_f32_16x16x32_bf16 v[160:163], a[208:211], a[200:203], v[160:163]
buffer_load_dwordx4 v16, s[48:51], s28 offen offset:0 lds
v_mfma_f32_16x16x32_bf16 v[176:179], a[208:211], a[204:207], v[176:179]
ds_read_b128 a[160:163], v32 offset:0
v_add_f32 v60, 1.0, v60
v_mfma_f32_16x16x32_bf16 v[180:183], a[212:215], a[204:207], v[180:183]
ds_read_b128 a[164:167], v32 offset:2048
v_add_f32 v62, 1.0, v62
v_mfma_f32_16x16x32_bf16 v[164:167], a[212:215], a[200:203], v[164:167]
ds_read_b128 a[168:171], v32 offset:4096
v_mfma_f32_16x16x32_bf16 v[148:151], a[212:215], a[196:199], v[148:151]
buffer_load_dwordx4 v17, s[48:51], s28 offen offset:1024 lds
v_mfma_f32_16x16x32_bf16 v[132:135], a[212:215], a[192:195], v[132:135]
ds_read_b128 a[172:175], v32 offset:6144
v_mul_f32 v117, v117, v61
s_waitcnt lgkmcnt(4)
v_mfma_f32_16x16x32_bf16 v[136:139], a[216:219], a[192:195], v[136:139]
ds_read_b128 a[180:183], v34 offset:2048
s_mul_i32 s29, s28, 16
v_mfma_f32_16x16x32_bf16 v[152:155], a[216:219], a[196:199], v[152:155]
v_rcp_f32 v60, v60
v_mfma_f32_16x16x32_bf16 v[168:171], a[216:219], a[200:203], v[168:171]
buffer_load_dwordx4 v18, s[48:51], s28 offen offset:2048 lds
v_mfma_f32_16x16x32_bf16 v[184:187], a[216:219], a[204:207], v[184:187]
ds_read_b128 a[184:187], v34 offset:4096
v_mfma_f32_16x16x32_bf16 v[188:191], a[220:223], a[204:207], v[188:191]
ds_read_b128 a[188:191], v34 offset:6144
v_mul_f32 v118, v118, v60
v_mfma_f32_16x16x32_bf16 v[172:175], a[220:223], a[200:203], v[172:175]
v_rcp_f32 v62, v62
v_mfma_f32_16x16x32_bf16 v[156:159], a[220:223], a[196:199], v[156:159]
buffer_load_dwordx4 v19, s[48:51], s28 offen offset:3072 lds
v_mfma_f32_16x16x32_bf16 v[140:143], a[220:223], a[192:195], v[140:143]
s_add_u32 m0, s25, 65536
buffer_load_dword v58, v48, s[40:43], 0 offen sc1
s_waitcnt lgkmcnt(2)
v_mfma_f32_16x16x32_bf16 v[128:131], a[176:179], a[160:163], v[128:131]
ds_read_b128 a[208:211], v34 offset:1024
v_mul_f32 v60, v120, v120
v_mfma_f32_16x16x32_bf16 v[144:147], a[176:179], a[164:167], v[144:147]
ds_read_b128 a[192:195], v33 offset:0
v_fma_f32 v60, v60, s39, v2
v_mfma_f32_16x16x32_bf16 v[160:163], a[176:179], a[168:171], v[160:163]
buffer_load_dwordx4 v20, s[52:55], s29 offen offset:0 sc1 lds
v_mfma_f32_16x16x32_bf16 v[176:179], a[176:179], a[172:175], v[176:179]
ds_read_b128 a[196:199], v33 offset:2048
v_mfma_f32_16x16x32_bf16 v[180:183], a[180:183], a[172:175], v[180:183]
ds_read_b128 a[200:203], v33 offset:4096
v_mul_f32 v60, v60, v120
v_mfma_f32_16x16x32_bf16 v[164:167], a[180:183], a[168:171], v[164:167]
s_add_u32 s31, s31, 1
v_exp_f32 v60, v60
v_mfma_f32_16x16x32_bf16 v[148:151], a[180:183], a[164:167], v[148:151]
buffer_load_dwordx4 v20, s[52:55], s29 offen offset:1024 sc1 lds
v_mfma_f32_16x16x32_bf16 v[132:135], a[180:183], a[160:163], v[132:135]
ds_read_b128 a[204:207], v33 offset:6144
v_mul_f32 v61, v121, v121
s_waitcnt lgkmcnt(3)
v_mfma_f32_16x16x32_bf16 v[136:139], a[184:187], a[160:163], v[136:139]
ds_read_b128 a[212:215], v34 offset:3072
v_fma_f32 v61, v61, s39, v2
v_mfma_f32_16x16x32_bf16 v[152:155], a[184:187], a[164:167], v[152:155]
v_readlane_b32 s28, v14, s31
v_mfma_f32_16x16x32_bf16 v[168:171], a[184:187], a[168:171], v[168:171]
buffer_load_dwordx4 v21, s[52:55], s29 offen offset:2048 sc1 lds
v_mfma_f32_16x16x32_bf16 v[184:187], a[184:187], a[172:175], v[184:187]
ds_read_b128 a[216:219], v34 offset:5120
v_mfma_f32_16x16x32_bf16 v[188:191], a[188:191], a[172:175], v[188:191]
ds_read_b128 a[220:223], v34 offset:7168
v_mul_f32 v61, v61, v121
v_mfma_f32_16x16x32_bf16 v[172:175], a[188:191], a[168:171], v[172:175]
v_exp_f32 v61, v61
v_mfma_f32_16x16x32_bf16 v[156:159], a[188:191], a[164:167], v[156:159]
buffer_load_dwordx4 v21, s[52:55], s29 offen offset:3072 sc1 lds
v_mfma_f32_16x16x32_bf16 v[140:143], a[188:191], a[160:163], v[140:143]
s_add_u32 m0, s25, 98304
s_waitcnt vmcnt(9)
v_mfma_f32_16x16x32_bf16 v[128:131], a[208:211], a[192:195], v[128:131]
s_barrier
s_waitcnt lgkmcnt(1)
v_mfma_f32_16x16x32_bf16 v[144:147], a[208:211], a[196:199], v[144:147]
ds_read_b128 a[176:179], v34 offset:32768
v_mfma_f32_16x16x32_bf16 v[160:163], a[208:211], a[200:203], v[160:163]
buffer_load_dwordx4 v20, s[52:55], s28 offen offset:0 sc1 lds
v_mfma_f32_16x16x32_bf16 v[176:179], a[208:211], a[204:207], v[176:179]
ds_read_b128 a[160:163], v32 offset:32768
v_add_f32 v60, 1.0, v60
v_mfma_f32_16x16x32_bf16 v[180:183], a[212:215], a[204:207], v[180:183]
ds_read_b128 a[164:167], v32 offset:34816
v_add_f32 v61, 1.0, v61
v_mfma_f32_16x16x32_bf16 v[164:167], a[212:215], a[200:203], v[164:167]
ds_read_b128 a[168:171], v32 offset:36864
v_mfma_f32_16x16x32_bf16 v[148:151], a[212:215], a[196:199], v[148:151]
buffer_load_dwordx4 v20, s[52:55], s28 offen offset:1024 sc1 lds
v_mfma_f32_16x16x32_bf16 v[132:135], a[212:215], a[192:195], v[132:135]
ds_read_b128 a[172:175], v32 offset:38912
v_mul_f32 v119, v119, v62
v_mfma_f32_16x16x32_bf16 v[136:139], a[216:219], a[192:195], v[136:139]
ds_read_b128 a[180:183], v34 offset:34816
s_mul_hi_u32 s29, s28, 268435456
v_mfma_f32_16x16x32_bf16 v[152:155], a[216:219], a[196:199], v[152:155]
v_rcp_f32 v60, v60
v_mfma_f32_16x16x32_bf16 v[168:171], a[216:219], a[200:203], v[168:171]
buffer_load_dwordx4 v21, s[52:55], s28 offen offset:2048 sc1 lds
v_mfma_f32_16x16x32_bf16 v[184:187], a[216:219], a[204:207], v[184:187]
ds_read_b128 a[184:187], v34 offset:36864
s_waitcnt lgkmcnt(3)
v_mfma_f32_16x16x32_bf16 v[188:191], a[220:223], a[204:207], v[188:191]
ds_read_b128 a[188:191], v34 offset:38912
v_mul_f32 v120, v120, v60
v_mfma_f32_16x16x32_bf16 v[172:175], a[220:223], a[200:203], v[172:175]
v_rcp_f32 v61, v61
v_mfma_f32_16x16x32_bf16 v[156:159], a[220:223], a[196:199], v[156:159]
buffer_load_dwordx4 v21, s[52:55], s28 offen offset:3072 sc1 lds
v_mfma_f32_16x16x32_bf16 v[140:143], a[220:223], a[192:195], v[140:143]
s_add_u32 m0, s24, 98304
v_mfma_f32_16x16x32_bf16 v[128:131], a[176:179], a[160:163], v[128:131]
ds_read_b128 a[208:211], v34 offset:33792
v_mul_f32 v60, v122, v122
v_mfma_f32_16x16x32_bf16 v[144:147], a[176:179], a[164:167], v[144:147]
ds_read_b128 a[192:195], v33 offset:32768
v_fma_f32 v60, v60, s39, v2
v_mfma_f32_16x16x32_bf16 v[160:163], a[176:179], a[168:171], v[160:163]
buffer_load_dwordx4 v16, s[48:51], s29 offen offset:0 lds
s_waitcnt lgkmcnt(2)
v_mfma_f32_16x16x32_bf16 v[176:179], a[176:179], a[172:175], v[176:179]
ds_read_b128 a[196:199], v33 offset:34816
v_mfma_f32_16x16x32_bf16 v[180:183], a[180:183], a[172:175], v[180:183]
ds_read_b128 a[200:203], v33 offset:36864
v_mul_f32 v60, v60, v122
v_mfma_f32_16x16x32_bf16 v[164:167], a[180:183], a[168:171], v[164:167]
s_mov_b32 s31, 0
v_exp_f32 v60, v60
v_mfma_f32_16x16x32_bf16 v[148:151], a[180:183], a[164:167], v[148:151]
buffer_load_dwordx4 v17, s[48:51], s29 offen offset:1024 lds
v_mfma_f32_16x16x32_bf16 v[132:135], a[180:183], a[160:163], v[132:135]
ds_read_b128 a[204:207], v33 offset:38912
v_mul_f32 v62, v123, v123
v_mfma_f32_16x16x32_bf16 v[136:139], a[184:187], a[160:163], v[136:139]
ds_read_b128 a[212:215], v34 offset:35840
v_fma_f32 v62, v62, s39, v2
v_mfma_f32_16x16x32_bf16 v[152:155], a[184:187], a[164:167], v[152:155]
v_readlane_b32 s28, v46, s31
v_mfma_f32_16x16x32_bf16 v[168:171], a[184:187], a[168:171], v[168:171]
buffer_load_dwordx4 v18, s[48:51], s29 offen offset:2048 lds
v_mfma_f32_16x16x32_bf16 v[184:187], a[184:187], a[172:175], v[184:187]
ds_read_b128 a[216:219], v34 offset:37888
v_mfma_f32_16x16x32_bf16 v[188:191], a[188:191], a[172:175], v[188:191]
ds_read_b128 a[220:223], v34 offset:39936
v_mul_f32 v62, v62, v123
v_mfma_f32_16x16x32_bf16 v[172:175], a[188:191], a[168:171], v[172:175]
v_exp_f32 v62, v62
v_mfma_f32_16x16x32_bf16 v[156:159], a[188:191], a[164:167], v[156:159]
buffer_load_dwordx4 v19, s[48:51], s29 offen offset:3072 lds
v_mfma_f32_16x16x32_bf16 v[140:143], a[188:191], a[160:163], v[140:143]
s_add_u32 m0, s25, 0
s_waitcnt vmcnt(8) lgkmcnt(2)
v_mfma_f32_16x16x32_bf16 v[128:131], a[208:211], a[192:195], v[128:131]
s_barrier
v_mfma_f32_16x16x32_bf16 v[144:147], a[208:211], a[196:199], v[144:147]
ds_read_b128 a[176:179], v37 offset:0
v_mfma_f32_16x16x32_bf16 v[160:163], a[208:211], a[200:203], v[160:163]
buffer_load_dwordx4 v40, s[12:15], s28 offen offset:0 lds
v_mfma_f32_16x16x32_bf16 v[176:179], a[208:211], a[204:207], v[176:179]
ds_read_b128 a[160:163], v35 offset:0
v_add_f32 v60, 1.0, v60
v_mfma_f32_16x16x32_bf16 v[180:183], a[212:215], a[204:207], v[180:183]
ds_read_b128 a[164:167], v35 offset:2048
v_add_f32 v62, 1.0, v62
v_mfma_f32_16x16x32_bf16 v[164:167], a[212:215], a[200:203], v[164:167]
ds_read_b128 a[168:171], v35 offset:4096
v_mfma_f32_16x16x32_bf16 v[148:151], a[212:215], a[196:199], v[148:151]
buffer_load_dwordx4 v41, s[12:15], s28 offen offset:1024 lds
v_mfma_f32_16x16x32_bf16 v[132:135], a[212:215], a[192:195], v[132:135]
ds_read_b128 a[172:175], v35 offset:6144
v_mul_f32 v121, v121, v61
s_waitcnt lgkmcnt(4)
v_mfma_f32_16x16x32_bf16 v[136:139], a[216:219], a[192:195], v[136:139]
ds_read_b128 a[180:183], v37 offset:2048
s_mul_hi_u32 s29, s28, 67108864
v_mfma_f32_16x16x32_bf16 v[152:155], a[216:219], a[196:199], v[152:155]
v_rcp_f32 v60, v60
v_mfma_f32_16x16x32_bf16 v[168:171], a[216:219], a[200:203], v[168:171]
buffer_load_dwordx4 v42, s[12:15], s28 offen offset:2048 lds
v_mfma_f32_16x16x32_bf16 v[184:187], a[216:219], a[204:207], v[184:187]
ds_read_b128 a[184:187], v37 offset:4096
v_mfma_f32_16x16x32_bf16 v[188:191], a[220:223], a[204:207], v[188:191]
ds_read_b128 a[188:191], v37 offset:6144
v_mul_f32 v122, v122, v60
v_mfma_f32_16x16x32_bf16 v[172:175], a[220:223], a[200:203], v[172:175]
v_rcp_f32 v62, v62
v_cmp_ne_u32 vcc, s78, v58
v_mfma_f32_16x16x32_bf16 v[156:159], a[220:223], a[196:199], v[156:159]
buffer_load_dwordx4 v43, s[12:15], s28 offen offset:3072 lds
s_cbranch_vccz Lok_16
s_mov_b32 s79, 32768
Lspin_15:
buffer_load_dword v58, v48, s[40:43], 0 offen sc1
s_waitcnt vmcnt(0)
v_cmp_ne_u32 vcc, s78, v58
s_sub_u32 s79, s79, 1
s_cbranch_scc1 Lok_16
s_cbranch_vccnz Lspin_15
Lok_16:
v_mfma_f32_16x16x32_bf16 v[140:143], a[220:223], a[192:195], v[140:143]
s_add_u32 m0, s24, 0
s_waitcnt lgkmcnt(2)
v_mfma_f32_16x16x32_bf16 v[128:131], a[176:179], a[160:163], v[128:131]
ds_read_b128 a[208:211], v37 offset:1024
v_mul_f32 v60, v124, v124
v_mfma_f32_16x16x32_bf16 v[144:147], a[176:179], a[164:167], v[144:147]
ds_read_b128 a[192:195], v36 offset:0
v_fma_f32 v60, v60, s39, v2
v_mfma_f32_16x16x32_bf16 v[160:163], a[176:179], a[168:171], v[160:163]
buffer_load_dwordx4 v38, s[16:19], s29 offen offset:0 sc1 lds
v_mfma_f32_16x16x32_bf16 v[176:179], a[176:179], a[172:175], v[176:179]
ds_read_b128 a[196:199], v36 offset:2048
v_mfma_f32_16x16x32_bf16 v[180:183], a[180:183], a[172:175], v[180:183]
ds_read_b128 a[200:203], v36 offset:4096
v_mul_f32 v60, v60, v124
v_mfma_f32_16x16x32_bf16 v[164:167], a[180:183], a[168:171], v[164:167]
s_add_u32 s31, s31, 1
v_exp_f32 v60, v60
v_mfma_f32_16x16x32_bf16 v[148:151], a[180:183], a[164:167], v[148:151]
buffer_load_dwordx4 v38, s[16:19], s29 offen offset:1024 sc1 lds
v_mfma_f32_16x16x32_bf16 v[132:135], a[180:183], a[160:163], v[132:135]
ds_read_b128 a[204:207], v36 offset:6144
v_mul_f32 v61, v125, v125
s_waitcnt lgkmcnt(3)
v_mfma_f32_16x16x32_bf16 v[136:139], a[184:187], a[160:163], v[136:139]
ds_read_b128 a[212:215], v37 offset:3072
v_fma_f32 v61, v61, s39, v2
v_mfma_f32_16x16x32_bf16 v[152:155], a[184:187], a[164:167], v[152:155]
v_readlane_b32 s28, v46, s31
v_mfma_f32_16x16x32_bf16 v[168:171], a[184:187], a[168:171], v[168:171]
buffer_load_dwordx4 v39, s[16:19], s29 offen offset:2048 sc1 lds
v_mfma_f32_16x16x32_bf16 v[184:187], a[184:187], a[172:175], v[184:187]
ds_read_b128 a[216:219], v37 offset:5120
v_mfma_f32_16x16x32_bf16 v[188:191], a[188:191], a[172:175], v[188:191]
ds_read_b128 a[220:223], v37 offset:7168
v_mul_f32 v61, v61, v125
v_mfma_f32_16x16x32_bf16 v[172:175], a[188:191], a[168:171], v[172:175]
v_exp_f32 v61, v61
v_mfma_f32_16x16x32_bf16 v[156:159], a[188:191], a[164:167], v[156:159]
buffer_load_dwordx4 v39, s[16:19], s29 offen offset:3072 sc1 lds
v_mfma_f32_16x16x32_bf16 v[140:143], a[188:191], a[160:163], v[140:143]
s_add_u32 m0, s25, 32768
s_waitcnt vmcnt(8)
v_mfma_f32_16x16x32_bf16 v[128:131], a[208:211], a[192:195], v[128:131]
s_barrier
s_waitcnt lgkmcnt(1)
v_mfma_f32_16x16x32_bf16 v[144:147], a[208:211], a[196:199], v[144:147]
ds_read_b128 a[176:179], v37 offset:32768
v_mfma_f32_16x16x32_bf16 v[160:163], a[208:211], a[200:203], v[160:163]
buffer_load_dwordx4 v40, s[12:15], s28 offen offset:0 lds
v_mfma_f32_16x16x32_bf16 v[176:179], a[208:211], a[204:207], v[176:179]
ds_read_b128 a[160:163], v35 offset:32768
v_add_f32 v60, 1.0, v60
v_mfma_f32_16x16x32_bf16 v[180:183], a[212:215], a[204:207], v[180:183]
ds_read_b128 a[164:167], v35 offset:34816
v_add_f32 v61, 1.0, v61
v_mfma_f32_16x16x32_bf16 v[164:167], a[212:215], a[200:203], v[164:167]
ds_read_b128 a[168:171], v35 offset:36864
v_mfma_f32_16x16x32_bf16 v[148:151], a[212:215], a[196:199], v[148:151]
buffer_load_dwordx4 v41, s[12:15], s28 offen offset:1024 lds
v_mfma_f32_16x16x32_bf16 v[132:135], a[212:215], a[192:195], v[132:135]
ds_read_b128 a[172:175], v35 offset:38912
v_mul_f32 v123, v123, v62
v_mfma_f32_16x16x32_bf16 v[136:139], a[216:219], a[192:195], v[136:139]
ds_read_b128 a[180:183], v37 offset:34816
s_mul_hi_u32 s29, s28, 67108864
v_mfma_f32_16x16x32_bf16 v[152:155], a[216:219], a[196:199], v[152:155]
v_rcp_f32 v60, v60
v_mfma_f32_16x16x32_bf16 v[168:171], a[216:219], a[200:203], v[168:171]
buffer_load_dwordx4 v42, s[12:15], s28 offen offset:2048 lds
v_mfma_f32_16x16x32_bf16 v[184:187], a[216:219], a[204:207], v[184:187]
ds_read_b128 a[184:187], v37 offset:36864
s_waitcnt lgkmcnt(3)
v_mfma_f32_16x16x32_bf16 v[188:191], a[220:223], a[204:207], v[188:191]
ds_read_b128 a[188:191], v37 offset:38912
v_mul_f32 v124, v124, v60
v_mfma_f32_16x16x32_bf16 v[172:175], a[220:223], a[200:203], v[172:175]
v_rcp_f32 v61, v61
v_mfma_f32_16x16x32_bf16 v[156:159], a[220:223], a[196:199], v[156:159]
buffer_load_dwordx4 v43, s[12:15], s28 offen offset:3072 lds
v_mfma_f32_16x16x32_bf16 v[140:143], a[220:223], a[192:195], v[140:143]
s_add_u32 m0, s24, 32768
v_mfma_f32_16x16x32_bf16 v[128:131], a[176:179], a[160:163], v[128:131]
ds_read_b128 a[208:211], v37 offset:33792
v_mul_f32 v60, v126, v126
v_mfma_f32_16x16x32_bf16 v[144:147], a[176:179], a[164:167], v[144:147]
ds_read_b128 a[192:195], v36 offset:32768
v_fma_f32 v60, v60, s39, v2
v_mfma_f32_16x16x32_bf16 v[160:163], a[176:179], a[168:171], v[160:163]
buffer_load_dwordx4 v38, s[16:19], s29 offen offset:0 sc1 lds
s_waitcnt lgkmcnt(2)
v_mfma_f32_16x16x32_bf16 v[176:179], a[176:179], a[172:175], v[176:179]
ds_read_b128 a[196:199], v36 offset:34816
v_mfma_f32_16x16x32_bf16 v[180:183], a[180:183], a[172:175], v[180:183]
ds_read_b128 a[200:203], v36 offset:36864
v_mul_f32 v60, v60, v126
v_mfma_f32_16x16x32_bf16 v[164:167], a[180:183], a[168:171], v[164:167]
s_add_u32 s31, s31, 1
v_exp_f32 v60, v60
v_mfma_f32_16x16x32_bf16 v[148:151], a[180:183], a[164:167], v[148:151]
buffer_load_dwordx4 v38, s[16:19], s29 offen offset:1024 sc1 lds
v_mfma_f32_16x16x32_bf16 v[132:135], a[180:183], a[160:163], v[132:135]
ds_read_b128 a[204:207], v36 offset:38912
v_mul_f32 v62, v127, v127
v_mfma_f32_16x16x32_bf16 v[136:139], a[184:187], a[160:163], v[136:139]
ds_read_b128 a[212:215], v37 offset:35840
v_fma_f32 v62, v62, s39, v2
v_mfma_f32_16x16x32_bf16 v[152:155], a[184:187], a[164:167], v[152:155]
v_readlane_b32 s28, v46, s31
v_mfma_f32_16x16x32_bf16 v[168:171], a[184:187], a[168:171], v[168:171]
buffer_load_dwordx4 v39, s[16:19], s29 offen offset:2048 sc1 lds
v_mfma_f32_16x16x32_bf16 v[184:187], a[184:187], a[172:175], v[184:187]
ds_read_b128 a[216:219], v37 offset:37888
v_mfma_f32_16x16x32_bf16 v[188:191], a[188:191], a[172:175], v[188:191]
ds_read_b128 a[220:223], v37 offset:39936
v_mul_f32 v62, v62, v127
v_mfma_f32_16x16x32_bf16 v[172:175], a[188:191], a[168:171], v[172:175]
v_exp_f32 v62, v62
v_mfma_f32_16x16x32_bf16 v[156:159], a[188:191], a[164:167], v[156:159]
buffer_load_dwordx4 v39, s[16:19], s29 offen offset:3072 sc1 lds
v_mfma_f32_16x16x32_bf16 v[140:143], a[188:191], a[160:163], v[140:143]
s_add_u32 m0, s25, 65536
s_waitcnt vmcnt(8) lgkmcnt(2)
v_mfma_f32_16x16x32_bf16 v[128:131], a[208:211], a[192:195], v[128:131]
s_barrier
ds_read_b64_tr_b16 a[176:177], v52 offset:0
v_mfma_f32_16x16x32_bf16 v[144:147], a[208:211], a[196:199], v[144:147]
ds_read_b64_tr_b16 a[178:179], v52 offset:512
v_mfma_f32_16x16x32_bf16 v[160:163], a[208:211], a[200:203], v[160:163]
buffer_load_dwordx4 v40, s[12:15], s28 offen offset:0 lds
v_mfma_f32_16x16x32_bf16 v[176:179], a[208:211], a[204:207], v[176:179]
ds_read_b128 a[160:163], v26 offset:0
v_mfma_f32_16x16x32_bf16 v[180:183], a[212:215], a[204:207], v[180:183]
ds_read_b128 a[164:167], v26 offset:2048
v_mfma_f32_16x16x32_bf16 v[164:167], a[212:215], a[200:203], v[164:167]
ds_read_b128 a[168:171], v26 offset:4096
v_mfma_f32_16x16x32_bf16 v[148:151], a[212:215], a[196:199], v[148:151]
buffer_load_dwordx4 v41, s[12:15], s28 offen offset:1024 lds
v_mfma_f32_16x16x32_bf16 v[132:135], a[212:215], a[192:195], v[132:135]
ds_read_b128 a[172:175], v26 offset:6144
s_waitcnt lgkmcnt(4)
v_mfma_f32_16x16x32_bf16 v[136:139], a[216:219], a[192:195], v[136:139]
ds_read_b64_tr_b16 a[180:181], v53 offset:0
s_mul_hi_u32 s29, s28, 67108864
v_mfma_f32_16x16x32_bf16 v[152:155], a[216:219], a[196:199], v[152:155]
ds_read_b64_tr_b16 a[182:183], v53 offset:512
v_mfma_f32_16x16x32_bf16 v[168:171], a[216:219], a[200:203], v[168:171]
buffer_load_dwordx4 v42, s[12:15], s28 offen offset:2048 lds
v_mfma_f32_16x16x32_bf16 v[184:187], a[216:219], a[204:207], v[184:187]
ds_read_b64_tr_b16 a[184:185], v52 offset:8192
v_mfma_f32_16x16x32_bf16 v[188:191], a[220:223], a[204:207], v[188:191]
ds_read_b64_tr_b16 a[186:187], v52 offset:8704
v_mfma_f32_16x16x32_bf16 v[172:175], a[220:223], a[200:203], v[172:175]
ds_read_b64_tr_b16 a[188:189], v53 offset:8192
v_mfma_f32_16x16x32_bf16 v[156:159], a[220:223], a[196:199], v[156:159]
buffer_load_dwordx4 v43, s[12:15], s28 offen offset:3072 lds
v_mfma_f32_16x16x32_bf16 v[140:143], a[220:223], a[192:195], v[140:143]
ds_read_b64_tr_b16 a[190:191], v53 offset:8704
v_add_f32 v60, 1.0, v60
v_add_f32 v62, 1.0, v62
v_mul_f32 v125, v125, v61
v_rcp_f32 v60, v60
s_nop 0
v_mul_f32 v126, v126, v60
v_rcp_f32 v62, v62
s_nop 0
v_mul_f32 v127, v127, v62
s_lshl_b32 s27, s80, 3
s_lshl_b32 s36, s83, 2
s_add_u32 s27, s27, s36
s_mul_i32 s27, s27, 90112
s_lshl_b32 s36, s81, 12
s_add_u32 s27, s27, s36
s_lshl_b32 s36, s84, 11
s_add_u32 s27, s27, s36
s_add_u32 s27, s27, 32768
v_lshlrev_b32 v1, 4, v0
v_pk_mul_f32 v[128:129], v[128:129], v[64:65]
v_pk_mul_f32 v[130:131], v[130:131], v[66:67]
v_pk_mul_f32 v[132:133], v[132:133], v[68:69]
v_pk_mul_f32 v[134:135], v[134:135], v[70:71]
v_cvt_pk_bf16_f32 v64, v128, v129
v_cvt_pk_bf16_f32 v65, v130, v131
v_cvt_pk_bf16_f32 v66, v132, v133
v_cvt_pk_bf16_f32 v67, v134, v135
buffer_store_dwordx4 v[64:67], v1, s[16:19], s27 offen offset:0 sc1
v_pk_mul_f32 v[136:137], v[136:137], v[72:73]
v_pk_mul_f32 v[138:139], v[138:139], v[74:75]
v_pk_mul_f32 v[140:141], v[140:141], v[76:77]
v_pk_mul_f32 v[142:143], v[142:143], v[78:79]
v_cvt_pk_bf16_f32 v72, v136, v137
v_cvt_pk_bf16_f32 v73, v138, v139
v_cvt_pk_bf16_f32 v74, v140, v141
v_cvt_pk_bf16_f32 v75, v142, v143
buffer_store_dwordx4 v[72:75], v1, s[16:19], s27 offen offset:1024 sc1
s_add_u32 s27, s27, 90112
v_pk_mul_f32 v[144:145], v[144:145], v[80:81]
v_pk_mul_f32 v[146:147], v[146:147], v[82:83]
v_pk_mul_f32 v[148:149], v[148:149], v[84:85]
v_pk_mul_f32 v[150:151], v[150:151], v[86:87]
v_cvt_pk_bf16_f32 v80, v144, v145
v_cvt_pk_bf16_f32 v81, v146, v147
v_cvt_pk_bf16_f32 v82, v148, v149
v_cvt_pk_bf16_f32 v83, v150, v151
buffer_store_dwordx4 v[80:83], v1, s[16:19], s27 offen offset:0 sc1
v_pk_mul_f32 v[152:153], v[152:153], v[88:89]
v_pk_mul_f32 v[154:155], v[154:155], v[90:91]
v_pk_mul_f32 v[156:157], v[156:157], v[92:93]
v_pk_mul_f32 v[158:159], v[158:159], v[94:95]
v_cvt_pk_bf16_f32 v88, v152, v153
v_cvt_pk_bf16_f32 v89, v154, v155
v_cvt_pk_bf16_f32 v90, v156, v157
v_cvt_pk_bf16_f32 v91, v158, v159
buffer_store_dwordx4 v[88:91], v1, s[16:19], s27 offen offset:1024 sc1
s_add_u32 s27, s27, 90112
v_pk_mul_f32 v[160:161], v[160:161], v[96:97]
v_pk_mul_f32 v[162:163], v[162:163], v[98:99]
v_pk_mul_f32 v[164:165], v[164:165], v[100:101]
v_pk_mul_f32 v[166:167], v[166:167], v[102:103]
v_cvt_pk_bf16_f32 v96, v160, v161
v_cvt_pk_bf16_f32 v97, v162, v163
v_cvt_pk_bf16_f32 v98, v164, v165
v_cvt_pk_bf16_f32 v99, v166, v167
buffer_store_dwordx4 v[96:99], v1, s[16:19], s27 offen offset:0 sc1
v_pk_mul_f32 v[168:169], v[168:169], v[104:105]
v_pk_mul_f32 v[170:171], v[170:171], v[106:107]
v_pk_mul_f32 v[172:173], v[172:173], v[108:109]
v_pk_mul_f32 v[174:175], v[174:175], v[110:111]
v_cvt_pk_bf16_f32 v104, v168, v169
v_cvt_pk_bf16_f32 v105, v170, v171
v_cvt_pk_bf16_f32 v106, v172, v173
v_cvt_pk_bf16_f32 v107, v174, v175
buffer_store_dwordx4 v[104:107], v1, s[16:19], s27 offen offset:1024 sc1
s_add_u32 s27, s27, 90112
v_pk_mul_f32 v[176:177], v[176:177], v[112:113]
v_pk_mul_f32 v[178:179], v[178:179], v[114:115]
v_pk_mul_f32 v[180:181], v[180:181], v[116:117]
v_pk_mul_f32 v[182:183], v[182:183], v[118:119]
v_cvt_pk_bf16_f32 v112, v176, v177
v_cvt_pk_bf16_f32 v113, v178, v179
v_cvt_pk_bf16_f32 v114, v180, v181
v_cvt_pk_bf16_f32 v115, v182, v183
buffer_store_dwordx4 v[112:115], v1, s[16:19], s27 offen offset:0 sc1
v_pk_mul_f32 v[184:185], v[184:185], v[120:121]
v_pk_mul_f32 v[186:187], v[186:187], v[122:123]
v_pk_mul_f32 v[188:189], v[188:189], v[124:125]
v_pk_mul_f32 v[190:191], v[190:191], v[126:127]
v_cvt_pk_bf16_f32 v120, v184, v185
v_cvt_pk_bf16_f32 v121, v186, v187
v_cvt_pk_bf16_f32 v122, v188, v189
v_cvt_pk_bf16_f32 v123, v190, v191
buffer_store_dwordx4 v[120:123], v1, s[16:19], s27 offen offset:1024 sc1
L_p3:
s_waitcnt lgkmcnt(4)
v_mfma_f32_16x16x32_bf16 v[192:195], a[176:179], a[160:163], v[192:195]
ds_read_b64_tr_b16 a[208:209], v52 offset:4096
v_mfma_f32_16x16x32_bf16 v[208:211], a[176:179], a[164:167], v[208:211]
ds_read_b64_tr_b16 a[210:211], v52 offset:4608
s_add_u32 m0, s24, 65536
v_mfma_f32_16x16x32_bf16 v[224:227], a[176:179], a[168:171], v[224:227]
buffer_load_dwordx4 v38, s[16:19], s29 offen offset:0 sc1 lds
v_mfma_f32_16x16x32_bf16 v[240:243], a[176:179], a[172:175], v[240:243]
ds_read_b128 a[192:195], v26 offset:1024
v_mfma_f32_16x16x32_bf16 v[244:247], a[180:183], a[172:175], v[244:247]
ds_read_b128 a[196:199], v26 offset:3072
s_add_u32 s31, s31, 1
v_mfma_f32_16x16x32_bf16 v[228:231], a[180:183], a[168:171], v[228:231]
ds_read_b128 a[200:203], v26 offset:5120
v_mfma_f32_16x16x32_bf16 v[212:215], a[180:183], a[164:167], v[212:215]
buffer_load_dwordx4 v38, s[16:19], s29 offen offset:1024 sc1 lds
v_mfma_f32_16x16x32_bf16 v[196:199], a[180:183], a[160:163], v[196:199]
ds_read_b128 a[204:207], v26 offset:7168
s_waitcnt lgkmcnt(4)
v_mfma_f32_16x16x32_bf16 v[200:203], a[184:187], a[160:163], 0
ds_read_b64_tr_b16 a[212:213], v53 offset:4096
v_readlane_b32 s28, v46, s31
v_mfma_f32_16x16x32_bf16 v[216:219], a[184:187], a[164:167], 0
ds_read_b64_tr_b16 a[214:215], v53 offset:4608
v_mfma_f32_16x16x32_bf16 v[232:235], a[184:187], a[168:171], 0
buffer_load_dwordx4 v39, s[16:19], s29 offen offset:2048 sc1 lds
v_mfma_f32_16x16x32_bf16 v[248:251], a[184:187], a[172:175], 0
ds_read_b64_tr_b16 a[216:217], v52 offset:12288
v_mfma_f32_16x16x32_bf16 v[252:255], a[188:191], a[172:175], 0
ds_read_b64_tr_b16 a[218:219], v52 offset:12800
v_mfma_f32_16x16x32_bf16 v[236:239], a[188:191], a[168:171], 0
ds_read_b64_tr_b16 a[220:221], v53 offset:12288
v_mfma_f32_16x16x32_bf16 v[220:223], a[188:191], a[164:167], 0
buffer_load_dwordx4 v39, s[16:19], s29 offen offset:3072 sc1 lds
v_mfma_f32_16x16x32_bf16 v[204:207], a[188:191], a[160:163], 0
ds_read_b64_tr_b16 a[222:223], v53 offset:12800
s_waitcnt vmcnt(16) lgkmcnt(4)
v_mfma_f32_16x16x32_bf16 v[192:195], a[208:211], a[192:195], v[192:195]
s_barrier
ds_read_b64_tr_b16 a[176:177], v52 offset:32768
v_mfma_f32_16x16x32_bf16 v[208:211], a[208:211], a[196:199], v[208:211]
ds_read_b64_tr_b16 a[178:179], v52 offset:33280
s_add_u32 m0, s25, 98304
v_mfma_f32_16x16x32_bf16 v[224:227], a[208:211], a[200:203], v[224:227]
buffer_load_dwordx4 v40, s[12:15], s28 offen offset:0 lds
v_mfma_f32_16x16x32_bf16 v[240:243], a[208:211], a[204:207], v[240:243]
ds_read_b128 a[160:163], v26 offset:32768
v_mfma_f32_16x16x32_bf16 v[244:247], a[212:215], a[204:207], v[244:247]
ds_read_b128 a[164:167], v26 offset:34816
v_mfma_f32_16x16x32_bf16 v[228:231], a[212:215], a[200:203], v[228:231]
ds_read_b128 a[168:171], v26 offset:36864
v_mfma_f32_16x16x32_bf16 v[212:215], a[212:215], a[196:199], v[212:215]
buffer_load_dwordx4 v41, s[12:15], s28 offen offset:1024 lds
v_mfma_f32_16x16x32_bf16 v[196:199], a[212:215], a[192:195], v[196:199]
ds_read_b128 a[172:175], v26 offset:38912
s_waitcnt lgkmcnt(4)
v_mfma_f32_16x16x32_bf16 v[200:203], a[216:219], a[192:195], v[200:203]
ds_read_b64_tr_b16 a[180:181], v53 offset:32768
s_mul_hi_u32 s29, s28, 67108864
v_mfma_f32_16x16x32_bf16 v[216:219], a[216:219], a[196:199], v[216:219]
ds_read_b64_tr_b16 a[182:183], v53 offset:33280
v_mfma_f32_16x16x32_bf16 v[232:235], a[216:219], a[200:203], v[232:235]
buffer_load_dwordx4 v42, s[12:15], s28 offen offset:2048 lds
v_mfma_f32_16x16x32_bf16 v[248:251], a[216:219], a[204:207], v[248:251]
ds_read_b64_tr_b16 a[184:185], v52 offset:40960
v_mfma_f32_16x16x32_bf16 v[252:255], a[220:223], a[204:207], v[252:255]
ds_read_b64_tr_b16 a[186:187], v52 offset:41472
v_mfma_f32_16x16x32_bf16 v[236:239], a[220:223], a[200:203], v[236:239]
ds_read_b64_tr_b16 a[188:189], v53 offset:40960
v_mfma_f32_16x16x32_bf16 v[220:223], a[220:223], a[196:199], v[220:223]
buffer_load_dwordx4 v43, s[12:15], s28 offen offset:3072 lds
v_mfma_f32_16x16x32_bf16 v[204:207], a[220:223], a[192:195], v[204:207]
ds_read_b64_tr_b16 a[190:191], v53 offset:41472
s_waitcnt lgkmcnt(4)
v_mfma_f32_16x16x32_bf16 v[192:195], a[176:179], a[160:163], v[192:195]
ds_read_b64_tr_b16 a[208:209], v52 offset:36864
v_mfma_f32_16x16x32_bf16 v[208:211], a[176:179], a[164:167], v[208:211]
ds_read_b64_tr_b16 a[210:211], v52 offset:37376
s_add_u32 m0, s24, 98304
v_mfma_f32_16x16x32_bf16 v[224:227], a[176:179], a[168:171], v[224:227]
buffer_load_dwordx4 v38, s[16:19], s29 offen offset:0 sc1 lds
v_mfma_f32_16x16x32_bf16 v[240:243], a[176:179], a[172:175], v[240:243]
ds_read_b128 a[192:195], v26 offset:33792
v_mfma_f32_16x16x32_bf16 v[244:247], a[180:183], a[172:175], v[244:247]
ds_read_b128 a[196:199], v26 offset:35840
s_add_u32 s31, s31, 1
v_mfma_f32_16x16x32_bf16 v[228:231], a[180:183], a[168:171], v[228:231]
ds_read_b128 a[200:203], v26 offset:37888
v_mfma_f32_16x16x32_bf16 v[212:215], a[180:183], a[164:167], v[212:215]
buffer_load_dwordx4 v38, s[16:19], s29 offen offset:1024 sc1 lds
v_mfma_f32_16x16x32_bf16 v[196:199], a[180:183], a[160:163], v[196:199]
ds_read_b128 a[204:207], v26 offset:39936
s_waitcnt lgkmcnt(4)
v_mfma_f32_16x16x32_bf16 v[200:203], a[184:187], a[160:163], v[200:203]
ds_read_b64_tr_b16 a[212:213], v53 offset:36864
v_readlane_b32 s28, v46, s31
v_mfma_f32_16x16x32_bf16 v[216:219], a[184:187], a[164:167], v[216:219]
ds_read_b64_tr_b16 a[214:215], v53 offset:37376
v_mfma_f32_16x16x32_bf16 v[232:235], a[184:187], a[168:171], v[232:235]
buffer_load_dwordx4 v39, s[16:19], s29 offen offset:2048 sc1 lds
v_mfma_f32_16x16x32_bf16 v[248:251], a[184:187], a[172:175], v[248:251]
ds_read_b64_tr_b16 a[216:217], v52 offset:45056
v_mfma_f32_16x16x32_bf16 v[252:255], a[188:191], a[172:175], v[252:255]
ds_read_b64_tr_b16 a[218:219], v52 offset:45568
v_mfma_f32_16x16x32_bf16 v[236:239], a[188:191], a[168:171], v[236:239]
ds_read_b64_tr_b16 a[220:221], v53 offset:45056
v_mfma_f32_16x16x32_bf16 v[220:223], a[188:191], a[164:167], v[220:223]
buffer_load_dwordx4 v39, s[16:19], s29 offen offset:3072 sc1 lds
v_mfma_f32_16x16x32_bf16 v[204:207], a[188:191], a[160:163], v[204:207]
ds_read_b64_tr_b16 a[222:223], v53 offset:45568
s_waitcnt vmcnt(8) lgkmcnt(4)
v_mfma_f32_16x16x32_bf16 v[192:195], a[208:211], a[192:195], v[192:195]
s_barrier
ds_read_b64_tr_b16 a[176:177], v54 offset:0
v_mfma_f32_16x16x32_bf16 v[208:211], a[208:211], a[196:199], v[208:211]
ds_read_b64_tr_b16 a[178:179], v54 offset:512
s_add_u32 m0, s25, 0
v_mfma_f32_16x16x32_bf16 v[224:227], a[208:211], a[200:203], v[224:227]
buffer_load_dwordx4 v40, s[12:15], s28 offen offset:0 lds
v_mfma_f32_16x16x32_bf16 v[240:243], a[208:211], a[204:207], v[240:243]
ds_read_b128 a[160:163], v31 offset:0
v_mov_b32 v1, s78
v_mfma_f32_16x16x32_bf16 v[244:247], a[212:215], a[204:207], v[244:247]
ds_read_b128 a[164:167], v31 offset:2048
buffer_store_dword v1, off, s[40:43], s1 offset:256 sc1
v_mfma_f32_16x16x32_bf16 v[228:231], a[212:215], a[200:203], v[228:231]
ds_read_b128 a[168:171], v31 offset:4096
v_mfma_f32_16x16x32_bf16 v[212:215], a[212:215], a[196:199], v[212:215]
buffer_load_dwordx4 v41, s[12:15], s28 offen offset:1024 lds
v_mfma_f32_16x16x32_bf16 v[196:199], a[212:215], a[192:195], v[196:199]
ds_read_b128 a[172:175], v31 offset:6144
s_waitcnt lgkmcnt(4)
v_mfma_f32_16x16x32_bf16 v[200:203], a[216:219], a[192:195], v[200:203]
ds_read_b64_tr_b16 a[180:181], v55 offset:0
s_mul_hi_u32 s29, s28, 67108864
v_mfma_f32_16x16x32_bf16 v[216:219], a[216:219], a[196:199], v[216:219]
ds_read_b64_tr_b16 a[182:183], v55 offset:512
v_mfma_f32_16x16x32_bf16 v[232:235], a[216:219], a[200:203], v[232:235]
buffer_load_dwordx4 v42, s[12:15], s28 offen offset:2048 lds
v_mfma_f32_16x16x32_bf16 v[248:251], a[216:219], a[204:207], v[248:251]
ds_read_b64_tr_b16 a[184:185], v54 offset:8192
v_mfma_f32_16x16x32_bf16 v[252:255], a[220:223], a[204:207], v[252:255]
ds_read_b64_tr_b16 a[186:187], v54 offset:8704
v_mfma_f32_16x16x32_bf16 v[236:239], a[220:223], a[200:203], v[236:239]
ds_read_b64_tr_b16 a[188:189], v55 offset:8192
v_mfma_f32_16x16x32_bf16 v[220:223], a[220:223], a[196:199], v[220:223]
buffer_load_dwordx4 v43, s[12:15], s28 offen offset:3072 lds
v_mfma_f32_16x16x32_bf16 v[204:207], a[220:223], a[192:195], v[204:207]
ds_read_b64_tr_b16 a[190:191], v55 offset:8704
s_waitcnt lgkmcnt(4)
v_mfma_f32_16x16x32_bf16 v[192:195], a[176:179], a[160:163], v[192:195]
ds_read_b64_tr_b16 a[208:209], v54 offset:4096
v_mfma_f32_16x16x32_bf16 v[208:211], a[176:179], a[164:167], v[208:211]
ds_read_b64_tr_b16 a[210:211], v54 offset:4608
s_add_u32 m0, s24, 0
v_mfma_f32_16x16x32_bf16 v[224:227], a[176:179], a[168:171], v[224:227]
buffer_load_dwordx4 v38, s[16:19], s29 offen offset:0 sc1 lds
v_mfma_f32_16x16x32_bf16 v[240:243], a[176:179], a[172:175], v[240:243]
ds_read_b128 a[192:195], v31 offset:1024
v_mfma_f32_16x16x32_bf16 v[244:247], a[180:183], a[172:175], v[244:247]
ds_read_b128 a[196:199], v31 offset:3072
s_add_u32 s31, s31, 1
v_mfma_f32_16x16x32_bf16 v[228:231], a[180:183], a[168:171], v[228:231]
ds_read_b128 a[200:203], v31 offset:5120
v_mfma_f32_16x16x32_bf16 v[212:215], a[180:183], a[164:167], v[212:215]
buffer_load_dwordx4 v38, s[16:19], s29 offen offset:1024 sc1 lds
v_mfma_f32_16x16x32_bf16 v[196:199], a[180:183], a[160:163], v[196:199]
ds_read_b128 a[204:207], v31 offset:7168
s_waitcnt lgkmcnt(4)
v_mfma_f32_16x16x32_bf16 v[200:203], a[184:187], a[160:163], v[200:203]
ds_read_b64_tr_b16 a[212:213], v55 offset:4096
v_readlane_b32 s28, v46, s31
v_mfma_f32_16x16x32_bf16 v[216:219], a[184:187], a[164:167], v[216:219]
ds_read_b64_tr_b16 a[214:215], v55 offset:4608
v_mfma_f32_16x16x32_bf16 v[232:235], a[184:187], a[168:171], v[232:235]
buffer_load_dwordx4 v39, s[16:19], s29 offen offset:2048 sc1 lds
v_mfma_f32_16x16x32_bf16 v[248:251], a[184:187], a[172:175], v[248:251]
ds_read_b64_tr_b16 a[216:217], v54 offset:12288
v_mfma_f32_16x16x32_bf16 v[252:255], a[188:191], a[172:175], v[252:255]
ds_read_b64_tr_b16 a[218:219], v54 offset:12800
v_mfma_f32_16x16x32_bf16 v[236:239], a[188:191], a[168:171], v[236:239]
ds_read_b64_tr_b16 a[220:221], v55 offset:12288
v_mfma_f32_16x16x32_bf16 v[220:223], a[188:191], a[164:167], v[220:223]
buffer_load_dwordx4 v39, s[16:19], s29 offen offset:3072 sc1 lds
v_mfma_f32_16x16x32_bf16 v[204:207], a[188:191], a[160:163], v[204:207]
ds_read_b64_tr_b16 a[222:223], v55 offset:12800
s_waitcnt vmcnt(9) lgkmcnt(4)
v_mfma_f32_16x16x32_bf16 v[192:195], a[208:211], a[192:195], v[192:195]
s_barrier
ds_read_b64_tr_b16 a[176:177], v54 offset:32768
v_mfma_f32_16x16x32_bf16 v[208:211], a[208:211], a[196:199], v[208:211]
ds_read_b64_tr_b16 a[178:179], v54 offset:33280
s_add_u32 m0, s25, 32768
v_mfma_f32_16x16x32_bf16 v[224:227], a[208:211], a[200:203], v[224:227]
buffer_load_dwordx4 v40, s[12:15], s28 offen offset:0 lds
v_mfma_f32_16x16x32_bf16 v[240:243], a[208:211], a[204:207], v[240:243]
ds_read_b128 a[160:163], v31 offset:32768
v_mfma_f32_16x16x32_bf16 v[244:247], a[212:215], a[204:207], v[244:247]
ds_read_b128 a[164:167], v31 offset:34816
v_mfma_f32_16x16x32_bf16 v[228:231], a[212:215], a[200:203], v[228:231]
ds_read_b128 a[168:171], v31 offset:36864
v_mfma_f32_16x16x32_bf16 v[212:215], a[212:215], a[196:199], v[212:215]
buffer_load_dwordx4 v41, s[12:15], s28 offen offset:1024 lds
v_mfma_f32_16x16x32_bf16 v[196:199], a[212:215], a[192:195], v[196:199]
ds_read_b128 a[172:175], v31 offset:38912
s_waitcnt lgkmcnt(4)
v_mfma_f32_16x16x32_bf16 v[200:203], a[216:219], a[192:195], v[200:203]
ds_read_b64_tr_b16 a[180:181], v55 offset:32768
s_mul_hi_u32 s29, s28, 67108864
v_mfma_f32_16x16x32_bf16 v[216:219], a[216:219], a[196:199], v[216:219]
ds_read_b64_tr_b16 a[182:183], v55 offset:33280
v_mfma_f32_16x16x32_bf16 v[232:235], a[216:219], a[200:203], v[232:235]
buffer_load_dwordx4 v42, s[12:15], s28 offen offset:2048 lds
v_mfma_f32_16x16x32_bf16 v[248:251], a[216:219], a[204:207], v[248:251]
ds_read_b64_tr_b16 a[184:185], v54 offset:40960
v_mfma_f32_16x16x32_bf16 v[252:255], a[220:223], a[204:207], v[252:255]
ds_read_b64_tr_b16 a[186:187], v54 offset:41472
v_mfma_f32_16x16x32_bf16 v[236:239], a[220:223], a[200:203], v[236:239]
ds_read_b64_tr_b16 a[188:189], v55 offset:40960
v_mfma_f32_16x16x32_bf16 v[220:223], a[220:223], a[196:199], v[220:223]
buffer_load_dwordx4 v43, s[12:15], s28 offen offset:3072 lds
v_mfma_f32_16x16x32_bf16 v[204:207], a[220:223], a[192:195], v[204:207]
ds_read_b64_tr_b16 a[190:191], v55 offset:41472
s_waitcnt lgkmcnt(4)
v_mfma_f32_16x16x32_bf16 v[192:195], a[176:179], a[160:163], v[192:195]
ds_read_b64_tr_b16 a[208:209], v54 offset:36864
v_mfma_f32_16x16x32_bf16 v[208:211], a[176:179], a[164:167], v[208:211]
ds_read_b64_tr_b16 a[210:211], v54 offset:37376
s_add_u32 m0, s24, 32768
v_mfma_f32_16x16x32_bf16 v[224:227], a[176:179], a[168:171], v[224:227]
buffer_load_dwordx4 v38, s[16:19], s29 offen offset:0 sc1 lds
v_mfma_f32_16x16x32_bf16 v[240:243], a[176:179], a[172:175], v[240:243]
ds_read_b128 a[192:195], v31 offset:33792
v_mfma_f32_16x16x32_bf16 v[244:247], a[180:183], a[172:175], v[244:247]
ds_read_b128 a[196:199], v31 offset:35840
s_add_u32 s31, s31, 1
v_mfma_f32_16x16x32_bf16 v[228:231], a[180:183], a[168:171], v[228:231]
ds_read_b128 a[200:203], v31 offset:37888
v_mfma_f32_16x16x32_bf16 v[212:215], a[180:183], a[164:167], v[212:215]
buffer_load_dwordx4 v38, s[16:19], s29 offen offset:1024 sc1 lds
v_mfma_f32_16x16x32_bf16 v[196:199], a[180:183], a[160:163], v[196:199]
ds_read_b128 a[204:207], v31 offset:39936
s_waitcnt lgkmcnt(4)
v_mfma_f32_16x16x32_bf16 v[200:203], a[184:187], a[160:163], v[200:203]
ds_read_b64_tr_b16 a[212:213], v55 offset:36864
v_readlane_b32 s28, v46, s31
v_mfma_f32_16x16x32_bf16 v[216:219], a[184:187], a[164:167], v[216:219]
ds_read_b64_tr_b16 a[214:215], v55 offset:37376
v_mfma_f32_16x16x32_bf16 v[232:235], a[184:187], a[168:171], v[232:235]
buffer_load_dwordx4 v39, s[16:19], s29 offen offset:2048 sc1 lds
v_mfma_f32_16x16x32_bf16 v[248:251], a[184:187], a[172:175], v[248:251]
ds_read_b64_tr_b16 a[216:217], v54 offset:45056
v_mfma_f32_16x16x32_bf16 v[252:255], a[188:191], a[172:175], v[252:255]
ds_read_b64_tr_b16 a[218:219], v54 offset:45568
v_mfma_f32_16x16x32_bf16 v[236:239], a[188:191], a[168:171], v[236:239]
ds_read_b64_tr_b16 a[220:221], v55 offset:45056
v_mfma_f32_16x16x32_bf16 v[220:223], a[188:191], a[164:167], v[220:223]
buffer_load_dwordx4 v39, s[16:19], s29 offen offset:3072 sc1 lds
v_mfma_f32_16x16x32_bf16 v[204:207], a[188:191], a[160:163], v[204:207]
ds_read_b64_tr_b16 a[222:223], v55 offset:45568
s_waitcnt vmcnt(8) lgkmcnt(4)
v_mfma_f32_16x16x32_bf16 v[192:195], a[208:211], a[192:195], v[192:195]
s_barrier
ds_read_b64_tr_b16 a[176:177], v52 offset:0
v_mfma_f32_16x16x32_bf16 v[208:211], a[208:211], a[196:199], v[208:211]
ds_read_b64_tr_b16 a[178:179], v52 offset:512
s_add_u32 m0, s25, 65536
v_mfma_f32_16x16x32_bf16 v[224:227], a[208:211], a[200:203], v[224:227]
buffer_load_dwordx4 v40, s[12:15], s28 offen offset:0 lds
v_mfma_f32_16x16x32_bf16 v[240:243], a[208:211], a[204:207], v[240:243]
ds_read_b128 a[160:163], v26 offset:0
v_mfma_f32_16x16x32_bf16 v[244:247], a[212:215], a[204:207], v[244:247]
ds_read_b128 a[164:167], v26 offset:2048
v_mfma_f32_16x16x32_bf16 v[228:231], a[212:215], a[200:203], v[228:231]
ds_read_b128 a[168:171], v26 offset:4096
v_mfma_f32_16x16x32_bf16 v[212:215], a[212:215], a[196:199], v[212:215]
buffer_load_dwordx4 v41, s[12:15], s28 offen offset:1024 lds
v_mfma_f32_16x16x32_bf16 v[196:199], a[212:215], a[192:195], v[196:199]
ds_read_b128 a[172:175], v26 offset:6144
s_waitcnt lgkmcnt(4)
v_mfma_f32_16x16x32_bf16 v[200:203], a[216:219], a[192:195], v[200:203]
ds_read_b64_tr_b16 a[180:181], v53 offset:0
s_mul_hi_u32 s29, s28, 67108864
v_mfma_f32_16x16x32_bf16 v[216:219], a[216:219], a[196:199], v[216:219]
ds_read_b64_tr_b16 a[182:183], v53 offset:512
v_mfma_f32_16x16x32_bf16 v[232:235], a[216:219], a[200:203], v[232:235]
buffer_load_dwordx4 v42, s[12:15], s28 offen offset:2048 lds
v_mfma_f32_16x16x32_bf16 v[248:251], a[216:219], a[204:207], v[248:251]
ds_read_b64_tr_b16 a[184:185], v52 offset:8192
v_mfma_f32_16x16x32_bf16 v[252:255], a[220:223], a[204:207], v[252:255]
ds_read_b64_tr_b16 a[186:187], v52 offset:8704
v_mfma_f32_16x16x32_bf16 v[236:239], a[220:223], a[200:203], v[236:239]
ds_read_b64_tr_b16 a[188:189], v53 offset:8192
v_mfma_f32_16x16x32_bf16 v[220:223], a[220:223], a[196:199], v[220:223]
buffer_load_dwordx4 v43, s[12:15], s28 offen offset:3072 lds
v_mfma_f32_16x16x32_bf16 v[204:207], a[220:223], a[192:195], v[204:207]
ds_read_b64_tr_b16 a[190:191], v53 offset:8704
s_waitcnt lgkmcnt(4)
v_mfma_f32_16x16x32_bf16 v[192:195], a[176:179], a[160:163], v[192:195]
ds_read_b64_tr_b16 a[208:209], v52 offset:4096
v_mfma_f32_16x16x32_bf16 v[208:211], a[176:179], a[164:167], v[208:211]
ds_read_b64_tr_b16 a[210:211], v52 offset:4608
s_add_u32 m0, s24, 65536
v_mfma_f32_16x16x32_bf16 v[224:227], a[176:179], a[168:171], v[224:227]
buffer_load_dwordx4 v38, s[16:19], s29 offen offset:0 sc1 lds
v_mfma_f32_16x16x32_bf16 v[240:243], a[176:179], a[172:175], v[240:243]
ds_read_b128 a[192:195], v26 offset:1024
v_mfma_f32_16x16x32_bf16 v[244:247], a[180:183], a[172:175], v[244:247]
ds_read_b128 a[196:199], v26 offset:3072
s_add_u32 s31, s31, 1
v_mfma_f32_16x16x32_bf16 v[228:231], a[180:183], a[168:171], v[228:231]
ds_read_b128 a[200:203], v26 offset:5120
v_mfma_f32_16x16x32_bf16 v[212:215], a[180:183], a[164:167], v[212:215]
buffer_load_dwordx4 v38, s[16:19], s29 offen offset:1024 sc1 lds
v_mfma_f32_16x16x32_bf16 v[196:199], a[180:183], a[160:163], v[196:199]
ds_read_b128 a[204:207], v26 offset:7168
s_waitcnt lgkmcnt(4)
v_mfma_f32_16x16x32_bf16 v[200:203], a[184:187], a[160:163], v[200:203]
ds_read_b64_tr_b16 a[212:213], v53 offset:4096
v_readlane_b32 s28, v46, s31
v_mfma_f32_16x16x32_bf16 v[216:219], a[184:187], a[164:167], v[216:219]
ds_read_b64_tr_b16 a[214:215], v53 offset:4608
v_mfma_f32_16x16x32_bf16 v[232:235], a[184:187], a[168:171], v[232:235]
buffer_load_dwordx4 v39, s[16:19], s29 offen offset:2048 sc1 lds
v_mfma_f32_16x16x32_bf16 v[248:251], a[184:187], a[172:175], v[248:251]
ds_read_b64_tr_b16 a[216:217], v52 offset:12288
v_mfma_f32_16x16x32_bf16 v[252:255], a[188:191], a[172:175], v[252:255]
ds_read_b64_tr_b16 a[218:219], v52 offset:12800
v_mfma_f32_16x16x32_bf16 v[236:239], a[188:191], a[168:171], v[236:239]
ds_read_b64_tr_b16 a[220:221], v53 offset:12288
v_mfma_f32_16x16x32_bf16 v[220:223], a[188:191], a[164:167], v[220:223]
buffer_load_dwordx4 v39, s[16:19], s29 offen offset:3072 sc1 lds
v_mfma_f32_16x16x32_bf16 v[204:207], a[188:191], a[160:163], v[204:207]
ds_read_b64_tr_b16 a[222:223], v53 offset:12800
buffer_load_dword v58, v49, s[40:43], 0 offen sc1
s_waitcnt vmcnt(9) lgkmcnt(4)
v_mfma_f32_16x16x32_bf16 v[192:195], a[208:211], a[192:195], v[192:195]
s_barrier
ds_read_b64_tr_b16 a[176:177], v52 offset:32768
v_mfma_f32_16x16x32_bf16 v[208:211], a[208:211], a[196:199], v[208:211]
ds_read_b64_tr_b16 a[178:179], v52 offset:33280
s_add_u32 m0, s25, 98304
v_mfma_f32_16x16x32_bf16 v[224:227], a[208:211], a[200:203], v[224:227]
buffer_load_dwordx4 v40, s[12:15], s28 offen offset:0 lds
v_mfma_f32_16x16x32_bf16 v[240:243], a[208:211], a[204:207], v[240:243]
ds_read_b128 a[160:163], v26 offset:32768
v_mfma_f32_16x16x32_bf16 v[244:247], a[212:215], a[204:207], v[244:247]
ds_read_b128 a[164:167], v26 offset:34816
v_mfma_f32_16x16x32_bf16 v[228:231], a[212:215], a[200:203], v[228:231]
ds_read_b128 a[168:171], v26 offset:36864
v_mfma_f32_16x16x32_bf16 v[212:215], a[212:215], a[196:199], v[212:215]
buffer_load_dwordx4 v41, s[12:15], s28 offen offset:1024 lds
v_mfma_f32_16x16x32_bf16 v[196:199], a[212:215], a[192:195], v[196:199]
ds_read_b128 a[172:175], v26 offset:38912
s_waitcnt lgkmcnt(4)
v_mfma_f32_16x16x32_bf16 v[200:203], a[216:219], a[192:195], v[200:203]
ds_read_b64_tr_b16 a[180:181], v53 offset:32768
s_mul_hi_u32 s29, s28, 67108864
v_mfma_f32_16x16x32_bf16 v[216:219], a[216:219], a[196:199], v[216:219]
ds_read_b64_tr_b16 a[182:183], v53 offset:33280
v_mfma_f32_16x16x32_bf16 v[232:235], a[216:219], a[200:203], v[232:235]
buffer_load_dwordx4 v42, s[12:15], s28 offen offset:2048 lds
v_mfma_f32_16x16x32_bf16 v[248:251], a[216:219], a[204:207], v[248:251]
ds_read_b64_tr_b16 a[184:185], v52 offset:40960
v_mfma_f32_16x16x32_bf16 v[252:255], a[220:223], a[204:207], v[252:255]
ds_read_b64_tr_b16 a[186:187], v52 offset:41472
v_mfma_f32_16x16x32_bf16 v[236:239], a[220:223], a[200:203], v[236:239]
ds_read_b64_tr_b16 a[188:189], v53 offset:40960
v_mfma_f32_16x16x32_bf16 v[220:223], a[220:223], a[196:199], v[220:223]
buffer_load_dwordx4 v43, s[12:15], s28 offen offset:3072 lds
v_mfma_f32_16x16x32_bf16 v[204:207], a[220:223], a[192:195], v[204:207]
ds_read_b64_tr_b16 a[190:191], v53 offset:41472
s_waitcnt lgkmcnt(4)
v_mfma_f32_16x16x32_bf16 v[192:195], a[176:179], a[160:163], v[192:195]
ds_read_b64_tr_b16 a[208:209], v52 offset:36864
v_mfma_f32_16x16x32_bf16 v[208:211], a[176:179], a[164:167], v[208:211]
ds_read_b64_tr_b16 a[210:211], v52 offset:37376
s_add_u32 m0, s24, 98304
v_mfma_f32_16x16x32_bf16 v[224:227], a[176:179], a[168:171], v[224:227]
buffer_load_dwordx4 v38, s[16:19], s29 offen offset:0 sc1 lds
v_mfma_f32_16x16x32_bf16 v[240:243], a[176:179], a[172:175], v[240:243]
ds_read_b128 a[192:195], v26 offset:33792
v_mfma_f32_16x16x32_bf16 v[244:247], a[180:183], a[172:175], v[244:247]
ds_read_b128 a[196:199], v26 offset:35840
s_add_u32 s31, s31, 1
v_mfma_f32_16x16x32_bf16 v[228:231], a[180:183], a[168:171], v[228:231]
ds_read_b128 a[200:203], v26 offset:37888
v_mfma_f32_16x16x32_bf16 v[212:215], a[180:183], a[164:167], v[212:215]
buffer_load_dwordx4 v38, s[16:19], s29 offen offset:1024 sc1 lds
v_mfma_f32_16x16x32_bf16 v[196:199], a[180:183], a[160:163], v[196:199]
ds_read_b128 a[204:207], v26 offset:39936
s_waitcnt lgkmcnt(4)
v_mfma_f32_16x16x32_bf16 v[200:203], a[184:187], a[160:163], v[200:203]
ds_read_b64_tr_b16 a[212:213], v53 offset:36864
v_readlane_b32 s28, v46, s31
v_mfma_f32_16x16x32_bf16 v[216:219], a[184:187], a[164:167], v[216:219]
ds_read_b64_tr_b16 a[214:215], v53 offset:37376
v_mfma_f32_16x16x32_bf16 v[232:235], a[184:187], a[168:171], v[232:235]
buffer_load_dwordx4 v39, s[16:19], s29 offen offset:2048 sc1 lds
v_mfma_f32_16x16x32_bf16 v[248:251], a[184:187], a[172:175], v[248:251]
ds_read_b64_tr_b16 a[216:217], v52 offset:45056
v_mfma_f32_16x16x32_bf16 v[252:255], a[188:191], a[172:175], v[252:255]
ds_read_b64_tr_b16 a[218:219], v52 offset:45568
v_mfma_f32_16x16x32_bf16 v[236:239], a[188:191], a[168:171], v[236:239]
ds_read_b64_tr_b16 a[220:221], v53 offset:45056
v_mfma_f32_16x16x32_bf16 v[220:223], a[188:191], a[164:167], v[220:223]
buffer_load_dwordx4 v39, s[16:19], s29 offen offset:3072 sc1 lds
v_mfma_f32_16x16x32_bf16 v[204:207], a[188:191], a[160:163], v[204:207]
ds_read_b64_tr_b16 a[222:223], v53 offset:45568
s_waitcnt vmcnt(9) lgkmcnt(4)
v_mfma_f32_16x16x32_bf16 v[192:195], a[208:211], a[192:195], v[192:195]
s_barrier
ds_read_b64_tr_b16 a[176:177], v54 offset:0
v_mfma_f32_16x16x32_bf16 v[208:211], a[208:211], a[196:199], v[208:211]
ds_read_b64_tr_b16 a[178:179], v54 offset:512
s_add_u32 m0, s25, 0
v_mfma_f32_16x16x32_bf16 v[224:227], a[208:211], a[200:203], v[224:227]
buffer_load_dwordx4 v40, s[44:47], s28 offen offset:0 lds
v_mfma_f32_16x16x32_bf16 v[240:243], a[208:211], a[204:207], v[240:243]
ds_read_b128 a[160:163], v31 offset:0
v_mfma_f32_16x16x32_bf16 v[244:247], a[212:215], a[204:207], v[244:247]
ds_read_b128 a[164:167], v31 offset:2048
v_mfma_f32_16x16x32_bf16 v[228:231], a[212:215], a[200:203], v[228:231]
ds_read_b128 a[168:171], v31 offset:4096
v_mfma_f32_16x16x32_bf16 v[212:215], a[212:215], a[196:199], v[212:215]
buffer_load_dwordx4 v41, s[44:47], s28 offen offset:1024 lds
v_mfma_f32_16x16x32_bf16 v[196:199], a[212:215], a[192:195], v[196:199]
ds_read_b128 a[172:175], v31 offset:6144
s_waitcnt lgkmcnt(4)
v_mfma_f32_16x16x32_bf16 v[200:203], a[216:219], a[192:195], v[200:203]
ds_read_b64_tr_b16 a[180:181], v55 offset:0
s_mul_hi_u32 s29, s28, 67108864
v_mfma_f32_16x16x32_bf16 v[216:219], a[216:219], a[196:199], v[216:219]
ds_read_b64_tr_b16 a[182:183], v55 offset:512
v_mfma_f32_16x16x32_bf16 v[232:235], a[216:219], a[200:203], v[232:235]
buffer_load_dwordx4 v42, s[44:47], s28 offen offset:2048 lds
v_mfma_f32_16x16x32_bf16 v[248:251], a[216:219], a[204:207], v[248:251]
ds_read_b64_tr_b16 a[184:185], v54 offset:8192
v_mfma_f32_16x16x32_bf16 v[252:255], a[220:223], a[204:207], v[252:255]
ds_read_b64_tr_b16 a[186:187], v54 offset:8704
v_mfma_f32_16x16x32_bf16 v[236:239], a[220:223], a[200:203], v[236:239]
ds_read_b64_tr_b16 a[188:189], v55 offset:8192
s_waitcnt vmcnt(11)
v_cmp_ne_u32 vcc, s78, v58
v_mfma_f32_16x16x32_bf16 v[220:223], a[220:223], a[196:199], v[220:223]
buffer_load_dwordx4 v43, s[44:47], s28 offen offset:3072 lds
s_cbranch_vccz Lok_18
s_mov_b32 s79, 32768
Lspin_17:
buffer_load_dword v58, v49, s[40:43], 0 offen sc1
s_waitcnt vmcnt(0)
v_cmp_ne_u32 vcc, s78, v58
s_sub_u32 s79, s79, 1
s_cbranch_scc1 Lok_18
s_cbranch_vccnz Lspin_17
Lok_18:
v_mfma_f32_16x16x32_bf16 v[204:207], a[220:223], a[192:195], v[204:207]
ds_read_b64_tr_b16 a[190:191], v55 offset:8704
s_waitcnt lgkmcnt(4)
v_mfma_f32_16x16x32_bf16 v[192:195], a[176:179], a[160:163], v[192:195]
ds_read_b64_tr_b16 a[208:209], v54 offset:4096
s_xor_b32 s37, s2, 4
v_mfma_f32_16x16x32_bf16 v[208:211], a[176:179], a[164:167], v[208:211]
ds_read_b64_tr_b16 a[210:211], v54 offset:4608
s_add_u32 m0, s24, 0
v_mfma_f32_16x16x32_bf16 v[224:227], a[176:179], a[168:171], v[224:227]
buffer_load_dwordx4 v56, s[16:19], s29 offen offset:0 sc1 lds
v_mfma_f32_16x16x32_bf16 v[240:243], a[176:179], a[172:175], v[240:243]
ds_read_b128 a[192:195], v31 offset:1024
s_mov_b32 s52, s72
v_mfma_f32_16x16x32_bf16 v[244:247], a[180:183], a[172:175], v[244:247]
ds_read_b128 a[196:199], v31 offset:3072
s_add_u32 s31, s31, 1
v_mfma_f32_16x16x32_bf16 v[228:231], a[180:183], a[168:171], v[228:231]
ds_read_b128 a[200:203], v31 offset:5120
s_mov_b32 s53, s73
v_mfma_f32_16x16x32_bf16 v[212:215], a[180:183], a[164:167], v[212:215]
buffer_load_dwordx4 v56, s[16:19], s29 offen offset:1024 sc1 lds
v_mfma_f32_16x16x32_bf16 v[196:199], a[180:183], a[160:163], v[196:199]
ds_read_b128 a[204:207], v31 offset:7168
s_mov_b32 s54, 4194304
s_waitcnt lgkmcnt(4)
v_mfma_f32_16x16x32_bf16 v[200:203], a[184:187], a[160:163], v[200:203]
ds_read_b64_tr_b16 a[212:213], v55 offset:4096
v_readlane_b32 s28, v46, s31
v_mfma_f32_16x16x32_bf16 v[216:219], a[184:187], a[164:167], v[216:219]
ds_read_b64_tr_b16 a[214:215], v55 offset:4608
v_lshlrev_b32 v8, 4, v0
v_mfma_f32_16x16x32_bf16 v[232:235], a[184:187], a[168:171], v[232:235]
buffer_load_dwordx4 v57, s[16:19], s29 offen offset:2048 sc1 lds
v_mfma_f32_16x16x32_bf16 v[248:251], a[184:187], a[172:175], v[248:251]
ds_read_b64_tr_b16 a[216:217], v54 offset:12288
v_add_u32 v9, 4096, v8
v_mfma_f32_16x16x32_bf16 v[252:255], a[188:191], a[172:175], v[252:255]
ds_read_b64_tr_b16 a[218:219], v54 offset:12800
s_lshl2_add_u32 s36, s2, s3
v_mfma_f32_16x16x32_bf16 v[236:239], a[188:191], a[168:171], v[236:239]
ds_read_b64_tr_b16 a[220:221], v55 offset:12288
s_lshl2_add_u32 s37, s37, s3
v_mfma_f32_16x16x32_bf16 v[220:223], a[188:191], a[164:167], v[220:223]
buffer_load_dwordx4 v57, s[16:19], s29 offen offset:3072 sc1 lds
v_mfma_f32_16x16x32_bf16 v[204:207], a[188:191], a[160:163], v[204:207]
ds_read_b64_tr_b16 a[222:223], v55 offset:12800
s_waitcnt vmcnt(8) lgkmcnt(4)
v_mfma_f32_16x16x32_bf16 v[192:195], a[208:211], a[192:195], v[192:195]
s_barrier
ds_read_b64_tr_b16 a[176:177], v54 offset:32768
v_mfma_f32_16x16x32_bf16 v[208:211], a[208:211], a[196:199], v[208:211]
ds_read_b64_tr_b16 a[178:179], v54 offset:33280
s_add_u32 m0, s25, 32768
v_mfma_f32_16x16x32_bf16 v[224:227], a[208:211], a[200:203], v[224:227]
buffer_load_dwordx4 v40, s[44:47], s28 offen offset:0 lds
v_mfma_f32_16x16x32_bf16 v[240:243], a[208:211], a[204:207], v[240:243]
ds_read_b128 a[160:163], v31 offset:32768
s_add_u32 s32, s76, 27262976
s_addc_u32 s33, s77, 0
v_mfma_f32_16x16x32_bf16 v[244:247], a[212:215], a[204:207], v[244:247]
ds_read_b128 a[164:167], v31 offset:34816
v_mfma_f32_16x16x32_bf16 v[228:231], a[212:215], a[200:203], v[228:231]
ds_read_b128 a[168:171], v31 offset:36864
s_mov_b32 s34, 6291456
v_mfma_f32_16x16x32_bf16 v[212:215], a[212:215], a[196:199], v[212:215]
buffer_load_dwordx4 v41, s[44:47], s28 offen offset:1024 lds
v_mfma_f32_16x16x32_bf16 v[196:199], a[212:215], a[192:195], v[196:199]
ds_read_b128 a[172:175], v31 offset:38912
s_mov_b32 s35, 0x20000
s_waitcnt lgkmcnt(4)
v_mfma_f32_16x16x32_bf16 v[200:203], a[216:219], a[192:195], v[200:203]
ds_read_b64_tr_b16 a[180:181], v55 offset:32768
s_mul_hi_u32 s29, s28, 67108864
v_mfma_f32_16x16x32_bf16 v[216:219], a[216:219], a[196:199], v[216:219]
ds_read_b64_tr_b16 a[182:183], v55 offset:33280
s_mul_i32 s36, s36, 6144
v_mfma_f32_16x16x32_bf16 v[232:235], a[216:219], a[200:203], v[232:235]
buffer_load_dwordx4 v42, s[44:47], s28 offen offset:2048 lds
v_mfma_f32_16x16x32_bf16 v[248:251], a[216:219], a[204:207], v[248:251]
ds_read_b64_tr_b16 a[184:185], v54 offset:40960
s_mul_i32 s37, s37, 6144
v_mfma_f32_16x16x32_bf16 v[252:255], a[220:223], a[204:207], v[252:255]
ds_read_b64_tr_b16 a[186:187], v54 offset:41472
s_mov_b32 s38, 0x3f80
v_mfma_f32_16x16x32_bf16 v[236:239], a[220:223], a[200:203], v[236:239]
ds_read_b64_tr_b16 a[188:189], v55 offset:40960
s_mov_b32 s39, 0x3f800000
v_mfma_f32_16x16x32_bf16 v[220:223], a[220:223], a[196:199], v[220:223]
buffer_load_dwordx4 v43, s[44:47], s28 offen offset:3072 lds
v_mfma_f32_16x16x32_bf16 v[204:207], a[220:223], a[192:195], v[204:207]
ds_read_b64_tr_b16 a[190:191], v55 offset:41472
s_mov_b32 s30, 1
Lg_loop1:
s_waitcnt lgkmcnt(4)
v_mfma_f32_16x16x32_bf16 v[192:195], a[176:179], a[160:163], v[192:195]
ds_read_b64_tr_b16 a[208:209], v54 offset:36864
v_mfma_f32_16x16x32_bf16 v[208:211], a[176:179], a[164:167], v[208:211]
ds_read_b64_tr_b16 a[210:211], v54 offset:37376
s_add_u32 m0, s24, 32768
v_mfma_f32_16x16x32_bf16 v[224:227], a[176:179], a[168:171], v[224:227]
buffer_load_dwordx4 v56, s[16:19], s29 offen offset:0 sc1 lds
v_mfma_f32_16x16x32_bf16 v[240:243], a[176:179], a[172:175], v[240:243]
ds_read_b128 a[192:195], v31 offset:33792
v_mfma_f32_16x16x32_bf16 v[244:247], a[180:183], a[172:175], v[244:247]
ds_read_b128 a[196:199], v31 offset:35840
s_add_u32 s31, s31, 1
v_mfma_f32_16x16x32_bf16 v[228:231], a[180:183], a[168:171], v[228:231]
ds_read_b128 a[200:203], v31 offset:37888
v_mfma_f32_16x16x32_bf16 v[212:215], a[180:183], a[164:167], v[212:215]
buffer_load_dwordx4 v56, s[16:19], s29 offen offset:1024 sc1 lds
v_mfma_f32_16x16x32_bf16 v[196:199], a[180:183], a[160:163], v[196:199]
ds_read_b128 a[204:207], v31 offset:39936
s_waitcnt lgkmcnt(4)
v_mfma_f32_16x16x32_bf16 v[200:203], a[184:187], a[160:163], v[200:203]
ds_read_b64_tr_b16 a[212:213], v55 offset:36864
v_readlane_b32 s28, v46, s31
v_mfma_f32_16x16x32_bf16 v[216:219], a[184:187], a[164:167], v[216:219]
ds_read_b64_tr_b16 a[214:215], v55 offset:37376
v_mfma_f32_16x16x32_bf16 v[232:235], a[184:187], a[168:171], v[232:235]
buffer_load_dwordx4 v57, s[16:19], s29 offen offset:2048 sc1 lds
v_mfma_f32_16x16x32_bf16 v[248:251], a[184:187], a[172:175], v[248:251]
ds_read_b64_tr_b16 a[216:217], v54 offset:45056
v_mfma_f32_16x16x32_bf16 v[252:255], a[188:191], a[172:175], v[252:255]
ds_read_b64_tr_b16 a[218:219], v54 offset:45568
v_mfma_f32_16x16x32_bf16 v[236:239], a[188:191], a[168:171], v[236:239]
ds_read_b64_tr_b16 a[220:221], v55 offset:45056
v_mfma_f32_16x16x32_bf16 v[220:223], a[188:191], a[164:167], v[220:223]
buffer_load_dwordx4 v57, s[16:19], s29 offen offset:3072 sc1 lds
v_mfma_f32_16x16x32_bf16 v[204:207], a[188:191], a[160:163], v[204:207]
ds_read_b64_tr_b16 a[222:223], v55 offset:45568
s_waitcnt vmcnt(8) lgkmcnt(4)
v_mfma_f32_16x16x32_bf16 v[192:195], a[208:211], a[192:195], v[192:195]
s_barrier
ds_read_b64_tr_b16 a[176:177], v52 offset:0
v_mfma_f32_16x16x32_bf16 v[208:211], a[208:211], a[196:199], v[208:211]
ds_read_b64_tr_b16 a[178:179], v52 offset:512
s_add_u32 m0, s25, 65536
v_mfma_f32_16x16x32_bf16 v[224:227], a[208:211], a[200:203], v[224:227]
buffer_load_dwordx4 v40, s[44:47], s28 offen offset:0 lds
v_mfma_f32_16x16x32_bf16 v[240:243], a[208:211], a[204:207], v[240:243]
ds_read_b128 a[160:163], v26 offset:0
v_mfma_f32_16x16x32_bf16 v[244:247], a[212:215], a[204:207], v[244:247]
ds_read_b128 a[164:167], v26 offset:2048
v_mfma_f32_16x16x32_bf16 v[228:231], a[212:215], a[200:203], v[228:231]
ds_read_b128 a[168:171], v26 offset:4096
v_mfma_f32_16x16x32_bf16 v[212:215], a[212:215], a[196:199], v[212:215]
buffer_load_dwordx4 v41, s[44:47], s28 offen offset:1024 lds
v_mfma_f32_16x16x32_bf16 v[196:199], a[212:215], a[192:195], v[196:199]
ds_read_b128 a[172:175], v26 offset:6144
s_waitcnt lgkmcnt(4)
v_mfma_f32_16x16x32_bf16 v[200:203], a[216:219], a[192:195], v[200:203]
ds_read_b64_tr_b16 a[180:181], v53 offset:0
s_mul_hi_u32 s29, s28, 67108864
v_mfma_f32_16x16x32_bf16 v[216:219], a[216:219], a[196:199], v[216:219]
ds_read_b64_tr_b16 a[182:183], v53 offset:512
v_mfma_f32_16x16x32_bf16 v[232:235], a[216:219], a[200:203], v[232:235]
buffer_load_dwordx4 v42, s[44:47], s28 offen offset:2048 lds
v_mfma_f32_16x16x32_bf16 v[248:251], a[216:219], a[204:207], v[248:251]
ds_read_b64_tr_b16 a[184:185], v52 offset:8192
v_mfma_f32_16x16x32_bf16 v[252:255], a[220:223], a[204:207], v[252:255]
ds_read_b64_tr_b16 a[186:187], v52 offset:8704
v_mfma_f32_16x16x32_bf16 v[236:239], a[220:223], a[200:203], v[236:239]
ds_read_b64_tr_b16 a[188:189], v53 offset:8192
v_mfma_f32_16x16x32_bf16 v[220:223], a[220:223], a[196:199], v[220:223]
buffer_load_dwordx4 v43, s[44:47], s28 offen offset:3072 lds
v_mfma_f32_16x16x32_bf16 v[204:207], a[220:223], a[192:195], v[204:207]
ds_read_b64_tr_b16 a[190:191], v53 offset:8704
s_waitcnt lgkmcnt(4)
v_mfma_f32_16x16x32_bf16 v[192:195], a[176:179], a[160:163], v[192:195]
ds_read_b64_tr_b16 a[208:209], v52 offset:4096
v_mfma_f32_16x16x32_bf16 v[208:211], a[176:179], a[164:167], v[208:211]
ds_read_b64_tr_b16 a[210:211], v52 offset:4608
s_add_u32 m0, s24, 65536
v_mfma_f32_16x16x32_bf16 v[224:227], a[176:179], a[168:171], v[224:227]
buffer_load_dwordx4 v56, s[16:19], s29 offen offset:0 sc1 lds
v_mfma_f32_16x16x32_bf16 v[240:243], a[176:179], a[172:175], v[240:243]
ds_read_b128 a[192:195], v26 offset:1024
v_mfma_f32_16x16x32_bf16 v[244:247], a[180:183], a[172:175], v[244:247]
ds_read_b128 a[196:199], v26 offset:3072
s_add_u32 s31, s31, 1
v_mfma_f32_16x16x32_bf16 v[228:231], a[180:183], a[168:171], v[228:231]
ds_read_b128 a[200:203], v26 offset:5120
v_mfma_f32_16x16x32_bf16 v[212:215], a[180:183], a[164:167], v[212:215]
buffer_load_dwordx4 v56, s[16:19], s29 offen offset:1024 sc1 lds
v_mfma_f32_16x16x32_bf16 v[196:199], a[180:183], a[160:163], v[196:199]
ds_read_b128 a[204:207], v26 offset:7168
s_waitcnt lgkmcnt(4)
v_mfma_f32_16x16x32_bf16 v[200:203], a[184:187], a[160:163], v[200:203]
ds_read_b64_tr_b16 a[212:213], v53 offset:4096
v_readlane_b32 s28, v46, s31
v_mfma_f32_16x16x32_bf16 v[216:219], a[184:187], a[164:167], v[216:219]
ds_read_b64_tr_b16 a[214:215], v53 offset:4608
v_mfma_f32_16x16x32_bf16 v[232:235], a[184:187], a[168:171], v[232:235]
buffer_load_dwordx4 v57, s[16:19], s29 offen offset:2048 sc1 lds
v_mfma_f32_16x16x32_bf16 v[248:251], a[184:187], a[172:175], v[248:251]
ds_read_b64_tr_b16 a[216:217], v52 offset:12288
v_mfma_f32_16x16x32_bf16 v[252:255], a[188:191], a[172:175], v[252:255]
ds_read_b64_tr_b16 a[218:219], v52 offset:12800
v_mfma_f32_16x16x32_bf16 v[236:239], a[188:191], a[168:171], v[236:239]
ds_read_b64_tr_b16 a[220:221], v53 offset:12288
v_mfma_f32_16x16x32_bf16 v[220:223], a[188:191], a[164:167], v[220:223]
buffer_load_dwordx4 v57, s[16:19], s29 offen offset:3072 sc1 lds
v_mfma_f32_16x16x32_bf16 v[204:207], a[188:191], a[160:163], v[204:207]
ds_read_b64_tr_b16 a[222:223], v53 offset:12800
s_waitcnt vmcnt(8) lgkmcnt(4)
v_mfma_f32_16x16x32_bf16 v[192:195], a[208:211], a[192:195], v[192:195]
s_barrier
ds_read_b64_tr_b16 a[176:177], v52 offset:32768
v_mfma_f32_16x16x32_bf16 v[208:211], a[208:211], a[196:199], v[208:211]
ds_read_b64_tr_b16 a[178:179], v52 offset:33280
s_add_u32 m0, s25, 98304
v_mfma_f32_16x16x32_bf16 v[224:227], a[208:211], a[200:203], v[224:227]
buffer_load_dwordx4 v40, s[44:47], s28 offen offset:0 lds
v_mfma_f32_16x16x32_bf16 v[240:243], a[208:211], a[204:207], v[240:243]
ds_read_b128 a[160:163], v26 offset:32768
v_mfma_f32_16x16x32_bf16 v[244:247], a[212:215], a[204:207], v[244:247]
ds_read_b128 a[164:167], v26 offset:34816
v_mfma_f32_16x16x32_bf16 v[228:231], a[212:215], a[200:203], v[228:231]
ds_read_b128 a[168:171], v26 offset:36864
v_mfma_f32_16x16x32_bf16 v[212:215], a[212:215], a[196:199], v[212:215]
buffer_load_dwordx4 v41, s[44:47], s28 offen offset:1024 lds
v_mfma_f32_16x16x32_bf16 v[196:199], a[212:215], a[192:195], v[196:199]
ds_read_b128 a[172:175], v26 offset:38912
s_waitcnt lgkmcnt(4)
v_mfma_f32_16x16x32_bf16 v[200:203], a[216:219], a[192:195], v[200:203]
ds_read_b64_tr_b16 a[180:181], v53 offset:32768
s_mul_hi_u32 s29, s28, 67108864
v_mfma_f32_16x16x32_bf16 v[216:219], a[216:219], a[196:199], v[216:219]
ds_read_b64_tr_b16 a[182:183], v53 offset:33280
v_mfma_f32_16x16x32_bf16 v[232:235], a[216:219], a[200:203], v[232:235]
buffer_load_dwordx4 v42, s[44:47], s28 offen offset:2048 lds
v_mfma_f32_16x16x32_bf16 v[248:251], a[216:219], a[204:207], v[248:251]
ds_read_b64_tr_b16 a[184:185], v52 offset:40960
v_mfma_f32_16x16x32_bf16 v[252:255], a[220:223], a[204:207], v[252:255]
ds_read_b64_tr_b16 a[186:187], v52 offset:41472
v_mfma_f32_16x16x32_bf16 v[236:239], a[220:223], a[200:203], v[236:239]
ds_read_b64_tr_b16 a[188:189], v53 offset:40960
v_mfma_f32_16x16x32_bf16 v[220:223], a[220:223], a[196:199], v[220:223]
buffer_load_dwordx4 v43, s[44:47], s28 offen offset:3072 lds
v_mfma_f32_16x16x32_bf16 v[204:207], a[220:223], a[192:195], v[204:207]
ds_read_b64_tr_b16 a[190:191], v53 offset:41472
s_waitcnt lgkmcnt(4)
v_mfma_f32_16x16x32_bf16 v[192:195], a[176:179], a[160:163], v[192:195]
ds_read_b64_tr_b16 a[208:209], v52 offset:36864
v_mfma_f32_16x16x32_bf16 v[208:211], a[176:179], a[164:167], v[208:211]
ds_read_b64_tr_b16 a[210:211], v52 offset:37376
s_add_u32 m0, s24, 98304
v_mfma_f32_16x16x32_bf16 v[224:227], a[176:179], a[168:171], v[224:227]
buffer_load_dwordx4 v56, s[16:19], s29 offen offset:0 sc1 lds
v_mfma_f32_16x16x32_bf16 v[240:243], a[176:179], a[172:175], v[240:243]
ds_read_b128 a[192:195], v26 offset:33792
v_mfma_f32_16x16x32_bf16 v[244:247], a[180:183], a[172:175], v[244:247]
ds_read_b128 a[196:199], v26 offset:35840
s_add_u32 s31, s31, 1
v_mfma_f32_16x16x32_bf16 v[228:231], a[180:183], a[168:171], v[228:231]
ds_read_b128 a[200:203], v26 offset:37888
v_mfma_f32_16x16x32_bf16 v[212:215], a[180:183], a[164:167], v[212:215]
buffer_load_dwordx4 v56, s[16:19], s29 offen offset:1024 sc1 lds
v_mfma_f32_16x16x32_bf16 v[196:199], a[180:183], a[160:163], v[196:199]
ds_read_b128 a[204:207], v26 offset:39936
s_waitcnt lgkmcnt(4)
v_mfma_f32_16x16x32_bf16 v[200:203], a[184:187], a[160:163], v[200:203]
ds_read_b64_tr_b16 a[212:213], v53 offset:36864
v_readlane_b32 s28, v46, s31
v_mfma_f32_16x16x32_bf16 v[216:219], a[184:187], a[164:167], v[216:219]
ds_read_b64_tr_b16 a[214:215], v53 offset:37376
v_mfma_f32_16x16x32_bf16 v[232:235], a[184:187], a[168:171], v[232:235]
buffer_load_dwordx4 v57, s[16:19], s29 offen offset:2048 sc1 lds
v_mfma_f32_16x16x32_bf16 v[248:251], a[184:187], a[172:175], v[248:251]
ds_read_b64_tr_b16 a[216:217], v52 offset:45056
v_mfma_f32_16x16x32_bf16 v[252:255], a[188:191], a[172:175], v[252:255]
ds_read_b64_tr_b16 a[218:219], v52 offset:45568
v_mfma_f32_16x16x32_bf16 v[236:239], a[188:191], a[168:171], v[236:239]
ds_read_b64_tr_b16 a[220:221], v53 offset:45056
v_mfma_f32_16x16x32_bf16 v[220:223], a[188:191], a[164:167], v[220:223]
buffer_load_dwordx4 v57, s[16:19], s29 offen offset:3072 sc1 lds
v_mfma_f32_16x16x32_bf16 v[204:207], a[188:191], a[160:163], v[204:207]
ds_read_b64_tr_b16 a[222:223], v53 offset:45568
s_waitcnt vmcnt(8) lgkmcnt(4)
v_mfma_f32_16x16x32_bf16 v[192:195], a[208:211], a[192:195], v[192:195]
s_barrier
ds_read_b64_tr_b16 a[176:177], v54 offset:0
v_mfma_f32_16x16x32_bf16 v[208:211], a[208:211], a[196:199], v[208:211]
ds_read_b64_tr_b16 a[178:179], v54 offset:512
s_add_u32 m0, s25, 0
v_mfma_f32_16x16x32_bf16 v[224:227], a[208:211], a[200:203], v[224:227]
buffer_load_dwordx4 v40, s[44:47], s28 offen offset:0 lds
v_mfma_f32_16x16x32_bf16 v[240:243], a[208:211], a[204:207], v[240:243]
ds_read_b128 a[160:163], v31 offset:0
v_mfma_f32_16x16x32_bf16 v[244:247], a[212:215], a[204:207], v[244:247]
ds_read_b128 a[164:167], v31 offset:2048
v_mfma_f32_16x16x32_bf16 v[228:231], a[212:215], a[200:203], v[228:231]
ds_read_b128 a[168:171], v31 offset:4096
v_mfma_f32_16x16x32_bf16 v[212:215], a[212:215], a[196:199], v[212:215]
buffer_load_dwordx4 v41, s[44:47], s28 offen offset:1024 lds
v_mfma_f32_16x16x32_bf16 v[196:199], a[212:215], a[192:195], v[196:199]
ds_read_b128 a[172:175], v31 offset:6144
s_waitcnt lgkmcnt(4)
v_mfma_f32_16x16x32_bf16 v[200:203], a[216:219], a[192:195], v[200:203]
ds_read_b64_tr_b16 a[180:181], v55 offset:0
s_mul_hi_u32 s29, s28, 67108864
v_mfma_f32_16x16x32_bf16 v[216:219], a[216:219], a[196:199], v[216:219]
ds_read_b64_tr_b16 a[182:183], v55 offset:512
v_mfma_f32_16x16x32_bf16 v[232:235], a[216:219], a[200:203], v[232:235]
buffer_load_dwordx4 v42, s[44:47], s28 offen offset:2048 lds
v_mfma_f32_16x16x32_bf16 v[248:251], a[216:219], a[204:207], v[248:251]
ds_read_b64_tr_b16 a[184:185], v54 offset:8192
v_mfma_f32_16x16x32_bf16 v[252:255], a[220:223], a[204:207], v[252:255]
ds_read_b64_tr_b16 a[186:187], v54 offset:8704
v_mfma_f32_16x16x32_bf16 v[236:239], a[220:223], a[200:203], v[236:239]
ds_read_b64_tr_b16 a[188:189], v55 offset:8192
v_mfma_f32_16x16x32_bf16 v[220:223], a[220:223], a[196:199], v[220:223]
buffer_load_dwordx4 v43, s[44:47], s28 offen offset:3072 lds
v_mfma_f32_16x16x32_bf16 v[204:207], a[220:223], a[192:195], v[204:207]
ds_read_b64_tr_b16 a[190:191], v55 offset:8704
s_waitcnt lgkmcnt(4)
v_mfma_f32_16x16x32_bf16 v[192:195], a[176:179], a[160:163], v[192:195]
ds_read_b64_tr_b16 a[208:209], v54 offset:4096
v_mfma_f32_16x16x32_bf16 v[208:211], a[176:179], a[164:167], v[208:211]
ds_read_b64_tr_b16 a[210:211], v54 offset:4608
s_add_u32 m0, s24, 0
v_mfma_f32_16x16x32_bf16 v[224:227], a[176:179], a[168:171], v[224:227]
buffer_load_dwordx4 v56, s[16:19], s29 offen offset:0 sc1 lds
v_mfma_f32_16x16x32_bf16 v[240:243], a[176:179], a[172:175], v[240:243]
ds_read_b128 a[192:195], v31 offset:1024
v_mfma_f32_16x16x32_bf16 v[244:247], a[180:183], a[172:175], v[244:247]
ds_read_b128 a[196:199], v31 offset:3072
s_add_u32 s31, s31, 1
v_mfma_f32_16x16x32_bf16 v[228:231], a[180:183], a[168:171], v[228:231]
ds_read_b128 a[200:203], v31 offset:5120
v_mfma_f32_16x16x32_bf16 v[212:215], a[180:183], a[164:167], v[212:215]
buffer_load_dwordx4 v56, s[16:19], s29 offen offset:1024 sc1 lds
v_mfma_f32_16x16x32_bf16 v[196:199], a[180:183], a[160:163], v[196:199]
ds_read_b128 a[204:207], v31 offset:7168
s_waitcnt lgkmcnt(4)
v_mfma_f32_16x16x32_bf16 v[200:203], a[184:187], a[160:163], v[200:203]
ds_read_b64_tr_b16 a[212:213], v55 offset:4096
v_readlane_b32 s28, v46, s31
v_mfma_f32_16x16x32_bf16 v[216:219], a[184:187], a[164:167], v[216:219]
ds_read_b64_tr_b16 a[214:215], v55 offset:4608
v_mfma_f32_16x16x32_bf16 v[232:235], a[184:187], a[168:171], v[232:235]
buffer_load_dwordx4 v57, s[16:19], s29 offen offset:2048 sc1 lds
v_mfma_f32_16x16x32_bf16 v[248:251], a[184:187], a[172:175], v[248:251]
ds_read_b64_tr_b16 a[216:217], v54 offset:12288
v_mfma_f32_16x16x32_bf16 v[252:255], a[188:191], a[172:175], v[252:255]
ds_read_b64_tr_b16 a[218:219], v54 offset:12800
v_mfma_f32_16x16x32_bf16 v[236:239], a[188:191], a[168:171], v[236:239]
ds_read_b64_tr_b16 a[220:221], v55 offset:12288
v_mfma_f32_16x16x32_bf16 v[220:223], a[188:191], a[164:167], v[220:223]
buffer_load_dwordx4 v57, s[16:19], s29 offen offset:3072 sc1 lds
v_mfma_f32_16x16x32_bf16 v[204:207], a[188:191], a[160:163], v[204:207]
ds_read_b64_tr_b16 a[222:223], v55 offset:12800
s_waitcnt vmcnt(8) lgkmcnt(4)
v_mfma_f32_16x16x32_bf16 v[192:195], a[208:211], a[192:195], v[192:195]
s_barrier
ds_read_b64_tr_b16 a[176:177], v54 offset:32768
v_mfma_f32_16x16x32_bf16 v[208:211], a[208:211], a[196:199], v[208:211]
ds_read_b64_tr_b16 a[178:179], v54 offset:33280
s_add_u32 m0, s25, 32768
v_mfma_f32_16x16x32_bf16 v[224:227], a[208:211], a[200:203], v[224:227]
buffer_load_dwordx4 v40, s[44:47], s28 offen offset:0 lds
v_mfma_f32_16x16x32_bf16 v[240:243], a[208:211], a[204:207], v[240:243]
ds_read_b128 a[160:163], v31 offset:32768
v_mfma_f32_16x16x32_bf16 v[244:247], a[212:215], a[204:207], v[244:247]
ds_read_b128 a[164:167], v31 offset:34816
v_mfma_f32_16x16x32_bf16 v[228:231], a[212:215], a[200:203], v[228:231]
ds_read_b128 a[168:171], v31 offset:36864
v_mfma_f32_16x16x32_bf16 v[212:215], a[212:215], a[196:199], v[212:215]
buffer_load_dwordx4 v41, s[44:47], s28 offen offset:1024 lds
v_mfma_f32_16x16x32_bf16 v[196:199], a[212:215], a[192:195], v[196:199]
ds_read_b128 a[172:175], v31 offset:38912
s_waitcnt lgkmcnt(4)
v_mfma_f32_16x16x32_bf16 v[200:203], a[216:219], a[192:195], v[200:203]
ds_read_b64_tr_b16 a[180:181], v55 offset:32768
s_mul_hi_u32 s29, s28, 67108864
v_mfma_f32_16x16x32_bf16 v[216:219], a[216:219], a[196:199], v[216:219]
ds_read_b64_tr_b16 a[182:183], v55 offset:33280
v_mfma_f32_16x16x32_bf16 v[232:235], a[216:219], a[200:203], v[232:235]
buffer_load_dwordx4 v42, s[44:47], s28 offen offset:2048 lds
v_mfma_f32_16x16x32_bf16 v[248:251], a[216:219], a[204:207], v[248:251]
ds_read_b64_tr_b16 a[184:185], v54 offset:40960
v_mfma_f32_16x16x32_bf16 v[252:255], a[220:223], a[204:207], v[252:255]
ds_read_b64_tr_b16 a[186:187], v54 offset:41472
v_mfma_f32_16x16x32_bf16 v[236:239], a[220:223], a[200:203], v[236:239]
ds_read_b64_tr_b16 a[188:189], v55 offset:40960
v_mfma_f32_16x16x32_bf16 v[220:223], a[220:223], a[196:199], v[220:223]
buffer_load_dwordx4 v43, s[44:47], s28 offen offset:3072 lds
s_sub_u32 s30, s30, 1
v_mfma_f32_16x16x32_bf16 v[204:207], a[220:223], a[192:195], v[204:207]
ds_read_b64_tr_b16 a[190:191], v55 offset:41472
s_cbranch_scc0 Lg_loop1
s_waitcnt lgkmcnt(4)
v_mfma_f32_16x16x32_bf16 v[192:195], a[176:179], a[160:163], v[192:195]
ds_read_b64_tr_b16 a[208:209], v54 offset:36864
v_mfma_f32_16x16x32_bf16 v[208:211], a[176:179], a[164:167], v[208:211]
ds_read_b64_tr_b16 a[210:211], v54 offset:37376
s_add_u32 m0, s24, 32768
v_mfma_f32_16x16x32_bf16 v[224:227], a[176:179], a[168:171], v[224:227]
buffer_load_dwordx4 v56, s[16:19], s29 offen offset:0 sc1 lds
v_mfma_f32_16x16x32_bf16 v[240:243], a[176:179], a[172:175], v[240:243]
ds_read_b128 a[192:195], v31 offset:33792
v_mfma_f32_16x16x32_bf16 v[244:247], a[180:183], a[172:175], v[244:247]
ds_read_b128 a[196:199], v31 offset:35840
s_add_u32 s31, s31, 1
v_mfma_f32_16x16x32_bf16 v[228:231], a[180:183], a[168:171], v[228:231]
ds_read_b128 a[200:203], v31 offset:37888
v_mfma_f32_16x16x32_bf16 v[212:215], a[180:183], a[164:167], v[212:215]
buffer_load_dwordx4 v56, s[16:19], s29 offen offset:1024 sc1 lds
v_mfma_f32_16x16x32_bf16 v[196:199], a[180:183], a[160:163], v[196:199]
ds_read_b128 a[204:207], v31 offset:39936
s_waitcnt lgkmcnt(4)
v_mfma_f32_16x16x32_bf16 v[200:203], a[184:187], a[160:163], v[200:203]
ds_read_b64_tr_b16 a[212:213], v55 offset:36864
v_readlane_b32 s28, v46, s31
v_mfma_f32_16x16x32_bf16 v[216:219], a[184:187], a[164:167], v[216:219]
ds_read_b64_tr_b16 a[214:215], v55 offset:37376
v_mfma_f32_16x16x32_bf16 v[232:235], a[184:187], a[168:171], v[232:235]
buffer_load_dwordx4 v57, s[16:19], s29 offen offset:2048 sc1 lds
v_mfma_f32_16x16x32_bf16 v[248:251], a[184:187], a[172:175], v[248:251]
ds_read_b64_tr_b16 a[216:217], v54 offset:45056
v_mfma_f32_16x16x32_bf16 v[252:255], a[188:191], a[172:175], v[252:255]
ds_read_b64_tr_b16 a[218:219], v54 offset:45568
v_mfma_f32_16x16x32_bf16 v[236:239], a[188:191], a[168:171], v[236:239]
ds_read_b64_tr_b16 a[220:221], v55 offset:45056
v_mfma_f32_16x16x32_bf16 v[220:223], a[188:191], a[164:167], v[220:223]
buffer_load_dwordx4 v57, s[16:19], s29 offen offset:3072 sc1 lds
v_mfma_f32_16x16x32_bf16 v[204:207], a[188:191], a[160:163], v[204:207]
ds_read_b64_tr_b16 a[222:223], v55 offset:45568
s_waitcnt vmcnt(8) lgkmcnt(4)
v_mfma_f32_16x16x32_bf16 v[192:195], a[208:211], a[192:195], v[192:195]
s_barrier
ds_read_b64_tr_b16 a[176:177], v52 offset:0
v_mfma_f32_16x16x32_bf16 v[208:211], a[208:211], a[196:199], v[208:211]
ds_read_b64_tr_b16 a[178:179], v52 offset:512
s_add_u32 m0, s25, 65536
v_mfma_f32_16x16x32_bf16 v[224:227], a[208:211], a[200:203], v[224:227]
buffer_load_dwordx4 v40, s[44:47], s28 offen offset:0 lds
v_mfma_f32_16x16x32_bf16 v[240:243], a[208:211], a[204:207], v[240:243]
ds_read_b128 a[160:163], v26 offset:0
v_mfma_f32_16x16x32_bf16 v[244:247], a[212:215], a[204:207], v[244:247]
ds_read_b128 a[164:167], v26 offset:2048
v_mfma_f32_16x16x32_bf16 v[228:231], a[212:215], a[200:203], v[228:231]
ds_read_b128 a[168:171], v26 offset:4096
v_mfma_f32_16x16x32_bf16 v[212:215], a[212:215], a[196:199], v[212:215]
buffer_load_dwordx4 v41, s[44:47], s28 offen offset:1024 lds
v_mfma_f32_16x16x32_bf16 v[196:199], a[212:215], a[192:195], v[196:199]
ds_read_b128 a[172:175], v26 offset:6144
s_waitcnt lgkmcnt(4)
v_mfma_f32_16x16x32_bf16 v[200:203], a[216:219], a[192:195], v[200:203]
ds_read_b64_tr_b16 a[180:181], v53 offset:0
s_mul_hi_u32 s29, s28, 67108864
v_mfma_f32_16x16x32_bf16 v[216:219], a[216:219], a[196:199], v[216:219]
ds_read_b64_tr_b16 a[182:183], v53 offset:512
v_mfma_f32_16x16x32_bf16 v[232:235], a[216:219], a[200:203], v[232:235]
buffer_load_dwordx4 v42, s[44:47], s28 offen offset:2048 lds
v_mfma_f32_16x16x32_bf16 v[248:251], a[216:219], a[204:207], v[248:251]
ds_read_b64_tr_b16 a[184:185], v52 offset:8192
v_mfma_f32_16x16x32_bf16 v[252:255], a[220:223], a[204:207], v[252:255]
ds_read_b64_tr_b16 a[186:187], v52 offset:8704
v_mfma_f32_16x16x32_bf16 v[236:239], a[220:223], a[200:203], v[236:239]
ds_read_b64_tr_b16 a[188:189], v53 offset:8192
v_mfma_f32_16x16x32_bf16 v[220:223], a[220:223], a[196:199], v[220:223]
buffer_load_dwordx4 v43, s[44:47], s28 offen offset:3072 lds
v_mfma_f32_16x16x32_bf16 v[204:207], a[220:223], a[192:195], v[204:207]
ds_read_b64_tr_b16 a[190:191], v53 offset:8704
buffer_load_dword v58, v50, s[40:43], 0 offen sc1
s_waitcnt lgkmcnt(4)
v_mfma_f32_16x16x32_bf16 v[192:195], a[176:179], a[160:163], v[192:195]
ds_read_b64_tr_b16 a[208:209], v52 offset:4096
v_mfma_f32_16x16x32_bf16 v[208:211], a[176:179], a[164:167], v[208:211]
ds_read_b64_tr_b16 a[210:211], v52 offset:4608
s_add_u32 m0, s24, 65536
v_mfma_f32_16x16x32_bf16 v[224:227], a[176:179], a[168:171], v[224:227]
buffer_load_dwordx4 v56, s[16:19], s29 offen offset:0 sc1 lds
v_mfma_f32_16x16x32_bf16 v[240:243], a[176:179], a[172:175], v[240:243]
ds_read_b128 a[192:195], v26 offset:1024
v_mfma_f32_16x16x32_bf16 v[244:247], a[180:183], a[172:175], v[244:247]
ds_read_b128 a[196:199], v26 offset:3072
s_add_u32 s31, s31, 1
v_mfma_f32_16x16x32_bf16 v[228:231], a[180:183], a[168:171], v[228:231]
ds_read_b128 a[200:203], v26 offset:5120
v_mfma_f32_16x16x32_bf16 v[212:215], a[180:183], a[164:167], v[212:215]
buffer_load_dwordx4 v56, s[16:19], s29 offen offset:1024 sc1 lds
v_mfma_f32_16x16x32_bf16 v[196:199], a[180:183], a[160:163], v[196:199]
ds_read_b128 a[204:207], v26 offset:7168
s_waitcnt lgkmcnt(4)
v_mfma_f32_16x16x32_bf16 v[200:203], a[184:187], a[160:163], v[200:203]
ds_read_b64_tr_b16 a[212:213], v53 offset:4096
v_readlane_b32 s28, v46, s31
v_mfma_f32_16x16x32_bf16 v[216:219], a[184:187], a[164:167], v[216:219]
ds_read_b64_tr_b16 a[214:215], v53 offset:4608
v_mfma_f32_16x16x32_bf16 v[232:235], a[184:187], a[168:171], v[232:235]
buffer_load_dwordx4 v57, s[16:19], s29 offen offset:2048 sc1 lds
v_mfma_f32_16x16x32_bf16 v[248:251], a[184:187], a[172:175], v[248:251]
ds_read_b64_tr_b16 a[216:217], v52 offset:12288
v_mfma_f32_16x16x32_bf16 v[252:255], a[188:191], a[172:175], v[252:255]
ds_read_b64_tr_b16 a[218:219], v52 offset:12800
v_mfma_f32_16x16x32_bf16 v[236:239], a[188:191], a[168:171], v[236:239]
ds_read_b64_tr_b16 a[220:221], v53 offset:12288
v_mfma_f32_16x16x32_bf16 v[220:223], a[188:191], a[164:167], v[220:223]
buffer_load_dwordx4 v57, s[16:19], s29 offen offset:3072 sc1 lds
v_mfma_f32_16x16x32_bf16 v[204:207], a[188:191], a[160:163], v[204:207]
ds_read_b64_tr_b16 a[222:223], v53 offset:12800
s_waitcnt vmcnt(9) lgkmcnt(4)
v_mfma_f32_16x16x32_bf16 v[192:195], a[208:211], a[192:195], v[192:195]
s_barrier
ds_read_b64_tr_b16 a[176:177], v52 offset:32768
v_mfma_f32_16x16x32_bf16 v[208:211], a[208:211], a[196:199], v[208:211]
ds_read_b64_tr_b16 a[178:179], v52 offset:33280
s_add_u32 m0, s25, 98304
v_mfma_f32_16x16x32_bf16 v[224:227], a[208:211], a[200:203], v[224:227]
buffer_load_dwordx4 v40, s[44:47], s28 offen offset:0 lds
v_mfma_f32_16x16x32_bf16 v[240:243], a[208:211], a[204:207], v[240:243]
ds_read_b128 a[160:163], v26 offset:32768
v_mfma_f32_16x16x32_bf16 v[244:247], a[212:215], a[204:207], v[244:247]
ds_read_b128 a[164:167], v26 offset:34816
v_mfma_f32_16x16x32_bf16 v[228:231], a[212:215], a[200:203], v[228:231]
ds_read_b128 a[168:171], v26 offset:36864
v_mfma_f32_16x16x32_bf16 v[212:215], a[212:215], a[196:199], v[212:215]
buffer_load_dwordx4 v41, s[44:47], s28 offen offset:1024 lds
v_mfma_f32_16x16x32_bf16 v[196:199], a[212:215], a[192:195], v[196:199]
ds_read_b128 a[172:175], v26 offset:38912
s_waitcnt lgkmcnt(4)
v_mfma_f32_16x16x32_bf16 v[200:203], a[216:219], a[192:195], v[200:203]
ds_read_b64_tr_b16 a[180:181], v53 offset:32768
s_mul_hi_u32 s29, s28, 67108864
v_mfma_f32_16x16x32_bf16 v[216:219], a[216:219], a[196:199], v[216:219]
ds_read_b64_tr_b16 a[182:183], v53 offset:33280
v_mfma_f32_16x16x32_bf16 v[232:235], a[216:219], a[200:203], v[232:235]
buffer_load_dwordx4 v42, s[44:47], s28 offen offset:2048 lds
v_mfma_f32_16x16x32_bf16 v[248:251], a[216:219], a[204:207], v[248:251]
ds_read_b64_tr_b16 a[184:185], v52 offset:40960
v_mfma_f32_16x16x32_bf16 v[252:255], a[220:223], a[204:207], v[252:255]
ds_read_b64_tr_b16 a[186:187], v52 offset:41472
v_mfma_f32_16x16x32_bf16 v[236:239], a[220:223], a[200:203], v[236:239]
ds_read_b64_tr_b16 a[188:189], v53 offset:40960
v_mfma_f32_16x16x32_bf16 v[220:223], a[220:223], a[196:199], v[220:223]
buffer_load_dwordx4 v43, s[44:47], s28 offen offset:3072 lds
v_mfma_f32_16x16x32_bf16 v[204:207], a[220:223], a[192:195], v[204:207]
ds_read_b64_tr_b16 a[190:191], v53 offset:41472
s_waitcnt lgkmcnt(4)
v_mfma_f32_16x16x32_bf16 v[192:195], a[176:179], a[160:163], v[192:195]
ds_read_b64_tr_b16 a[208:209], v52 offset:36864
v_mfma_f32_16x16x32_bf16 v[208:211], a[176:179], a[164:167], v[208:211]
ds_read_b64_tr_b16 a[210:211], v52 offset:37376
s_add_u32 m0, s24, 98304
v_mfma_f32_16x16x32_bf16 v[224:227], a[176:179], a[168:171], v[224:227]
buffer_load_dwordx4 v56, s[16:19], s29 offen offset:0 sc1 lds
v_mfma_f32_16x16x32_bf16 v[240:243], a[176:179], a[172:175], v[240:243]
ds_read_b128 a[192:195], v26 offset:33792
v_mfma_f32_16x16x32_bf16 v[244:247], a[180:183], a[172:175], v[244:247]
ds_read_b128 a[196:199], v26 offset:35840
s_add_u32 s31, s31, 1
v_mfma_f32_16x16x32_bf16 v[228:231], a[180:183], a[168:171], v[228:231]
ds_read_b128 a[200:203], v26 offset:37888
v_mfma_f32_16x16x32_bf16 v[212:215], a[180:183], a[164:167], v[212:215]
buffer_load_dwordx4 v56, s[16:19], s29 offen offset:1024 sc1 lds
v_mfma_f32_16x16x32_bf16 v[196:199], a[180:183], a[160:163], v[196:199]
ds_read_b128 a[204:207], v26 offset:39936
s_waitcnt lgkmcnt(4)
v_mfma_f32_16x16x32_bf16 v[200:203], a[184:187], a[160:163], v[200:203]
ds_read_b64_tr_b16 a[212:213], v53 offset:36864
v_readlane_b32 s28, v46, s31
v_mfma_f32_16x16x32_bf16 v[216:219], a[184:187], a[164:167], v[216:219]
ds_read_b64_tr_b16 a[214:215], v53 offset:37376
v_mfma_f32_16x16x32_bf16 v[232:235], a[184:187], a[168:171], v[232:235]
buffer_load_dwordx4 v57, s[16:19], s29 offen offset:2048 sc1 lds
v_mfma_f32_16x16x32_bf16 v[248:251], a[184:187], a[172:175], v[248:251]
ds_read_b64_tr_b16 a[216:217], v52 offset:45056
v_mfma_f32_16x16x32_bf16 v[252:255], a[188:191], a[172:175], v[252:255]
ds_read_b64_tr_b16 a[218:219], v52 offset:45568
v_mfma_f32_16x16x32_bf16 v[236:239], a[188:191], a[168:171], v[236:239]
ds_read_b64_tr_b16 a[220:221], v53 offset:45056
v_mfma_f32_16x16x32_bf16 v[220:223], a[188:191], a[164:167], v[220:223]
buffer_load_dwordx4 v57, s[16:19], s29 offen offset:3072 sc1 lds
v_mfma_f32_16x16x32_bf16 v[204:207], a[188:191], a[160:163], v[204:207]
ds_read_b64_tr_b16 a[222:223], v53 offset:45568
s_waitcnt vmcnt(8) lgkmcnt(4)
v_mfma_f32_16x16x32_bf16 v[192:195], a[208:211], a[192:195], v[192:195]
s_barrier
ds_read_b64_tr_b16 a[176:177], v54 offset:0
v_mfma_f32_16x16x32_bf16 v[208:211], a[208:211], a[196:199], v[208:211]
ds_read_b64_tr_b16 a[178:179], v54 offset:512
s_add_u32 m0, s26, 0
v_mfma_f32_16x16x32_bf16 v[224:227], a[208:211], a[200:203], v[224:227]
buffer_load_dwordx4 v44, s[44:47], s28 offen offset:0 lds
v_mfma_f32_16x16x32_bf16 v[240:243], a[208:211], a[204:207], v[240:243]
ds_read_b128 a[160:163], v31 offset:0
v_mfma_f32_16x16x32_bf16 v[244:247], a[212:215], a[204:207], v[244:247]
ds_read_b128 a[164:167], v31 offset:2048
v_mfma_f32_16x16x32_bf16 v[228:231], a[212:215], a[200:203], v[228:231]
ds_read_b128 a[168:171], v31 offset:4096
v_mfma_f32_16x16x32_bf16 v[212:215], a[212:215], a[196:199], v[212:215]
buffer_load_dwordx4 v45, s[44:47], s28 offen offset:1024 lds
v_mfma_f32_16x16x32_bf16 v[196:199], a[212:215], a[192:195], v[196:199]
ds_read_b128 a[172:175], v31 offset:6144
s_waitcnt lgkmcnt(4)
v_mfma_f32_16x16x32_bf16 v[200:203], a[216:219], a[192:195], v[200:203]
ds_read_b64_tr_b16 a[180:181], v55 offset:0
s_mul_hi_u32 s29, s28, 67108864
v_mfma_f32_16x16x32_bf16 v[216:219], a[216:219], a[196:199], v[216:219]
ds_read_b64_tr_b16 a[182:183], v55 offset:512
v_mfma_f32_16x16x32_bf16 v[232:235], a[216:219], a[200:203], v[232:235]
v_mfma_f32_16x16x32_bf16 v[248:251], a[216:219], a[204:207], v[248:251]
ds_read_b64_tr_b16 a[184:185], v54 offset:8192
v_mfma_f32_16x16x32_bf16 v[252:255], a[220:223], a[204:207], v[252:255]
ds_read_b64_tr_b16 a[186:187], v54 offset:8704
v_mfma_f32_16x16x32_bf16 v[236:239], a[220:223], a[200:203], v[236:239]
ds_read_b64_tr_b16 a[188:189], v55 offset:8192
v_cmp_ne_u32 vcc, s78, v58
v_mfma_f32_16x16x32_bf16 v[220:223], a[220:223], a[196:199], v[220:223]
s_cbranch_vccz Lok_20
s_mov_b32 s79, 32768
Lspin_19:
buffer_load_dword v58, v50, s[40:43], 0 offen sc1
s_waitcnt vmcnt(0)
v_cmp_ne_u32 vcc, s78, v58
s_sub_u32 s79, s79, 1
s_cbranch_scc1 Lok_20
s_cbranch_vccnz Lspin_19
Lok_20:
v_mfma_f32_16x16x32_bf16 v[204:207], a[220:223], a[192:195], v[204:207]
ds_read_b64_tr_b16 a[190:191], v55 offset:8704
s_waitcnt lgkmcnt(4)
v_mfma_f32_16x16x32_bf16 v[192:195], a[176:179], a[160:163], v[192:195]
ds_read_b64_tr_b16 a[208:209], v54 offset:4096
v_lshrrev_b32 v3, 3, v0
v_mfma_f32_16x16x32_bf16 v[208:211], a[176:179], a[164:167], v[208:211]
ds_read_b64_tr_b16 a[210:211], v54 offset:4608
s_add_u32 m0, s24, 0
v_mfma_f32_16x16x32_bf16 v[224:227], a[176:179], a[168:171], v[224:227]
buffer_load_dwordx4 v56, s[16:19], s29 offen offset:0 sc1 lds
v_mfma_f32_16x16x32_bf16 v[240:243], a[176:179], a[172:175], v[240:243]
ds_read_b128 a[192:195], v31 offset:1024
s_lshl2_add_u32 s27, s80, s3
v_mfma_f32_16x16x32_bf16 v[244:247], a[180:183], a[172:175], v[244:247]
ds_read_b128 a[196:199], v31 offset:3072
s_add_u32 s31, s31, 1
v_mfma_f32_16x16x32_bf16 v[228:231], a[180:183], a[168:171], v[228:231]
ds_read_b128 a[200:203], v31 offset:5120
v_mfma_f32_16x16x32_bf16 v[212:215], a[180:183], a[164:167], v[212:215]
buffer_load_dwordx4 v56, s[16:19], s29 offen offset:1024 sc1 lds
v_mfma_f32_16x16x32_bf16 v[196:199], a[180:183], a[160:163], v[196:199]
ds_read_b128 a[204:207], v31 offset:7168
s_waitcnt lgkmcnt(4)
v_mfma_f32_16x16x32_bf16 v[200:203], a[184:187], a[160:163], v[200:203]
ds_read_b64_tr_b16 a[212:213], v55 offset:4096
v_readlane_b32 s28, v46, s31
v_mfma_f32_16x16x32_bf16 v[216:219], a[184:187], a[164:167], v[216:219]
ds_read_b64_tr_b16 a[214:215], v55 offset:4608
v_mfma_f32_16x16x32_bf16 v[232:235], a[184:187], a[168:171], v[232:235]
buffer_load_dwordx4 v57, s[16:19], s29 offen offset:2048 sc1 lds
v_mfma_f32_16x16x32_bf16 v[248:251], a[184:187], a[172:175], v[248:251]
ds_read_b64_tr_b16 a[216:217], v54 offset:12288
v_mfma_f32_16x16x32_bf16 v[252:255], a[188:191], a[172:175], v[252:255]
ds_read_b64_tr_b16 a[218:219], v54 offset:12800
v_mfma_f32_16x16x32_bf16 v[236:239], a[188:191], a[168:171], v[236:239]
ds_read_b64_tr_b16 a[220:221], v55 offset:12288
v_mfma_f32_16x16x32_bf16 v[220:223], a[188:191], a[164:167], v[220:223]
buffer_load_dwordx4 v57, s[16:19], s29 offen offset:3072 sc1 lds
v_mfma_f32_16x16x32_bf16 v[204:207], a[188:191], a[160:163], v[204:207]
ds_read_b64_tr_b16 a[222:223], v55 offset:12800
s_waitcnt vmcnt(6) lgkmcnt(4)
v_mfma_f32_16x16x32_bf16 v[192:195], a[208:211], a[192:195], v[192:195]
s_barrier
ds_read_b64_tr_b16 a[176:177], v54 offset:32768
v_mfma_f32_16x16x32_bf16 v[208:211], a[208:211], a[196:199], v[208:211]
ds_read_b64_tr_b16 a[178:179], v54 offset:33280
s_add_u32 m0, s26, 32768
v_mfma_f32_16x16x32_bf16 v[224:227], a[208:211], a[200:203], v[224:227]
buffer_load_dwordx4 v44, s[44:47], s28 offen offset:0 lds
v_mfma_f32_16x16x32_bf16 v[240:243], a[208:211], a[204:207], v[240:243]
ds_read_b128 a[160:163], v31 offset:32768
s_lshl_b32 s27, s27, 16
v_mfma_f32_16x16x32_bf16 v[244:247], a[212:215], a[204:207], v[244:247]
ds_read_b128 a[164:167], v31 offset:34816
v_lshl_add_u32 v12, v3, 11, s27
v_mfma_f32_16x16x32_bf16 v[228:231], a[212:215], a[200:203], v[228:231]
ds_read_b128 a[168:171], v31 offset:36864
v_xor_b32 v3, v3, v0
v_mfma_f32_16x16x32_bf16 v[212:215], a[212:215], a[196:199], v[212:215]
buffer_load_dwordx4 v45, s[44:47], s28 offen offset:1024 lds
v_mfma_f32_16x16x32_bf16 v[196:199], a[212:215], a[192:195], v[196:199]
ds_read_b128 a[172:175], v31 offset:38912
v_and_b32 v3, 7, v3
s_waitcnt lgkmcnt(4)
v_mfma_f32_16x16x32_bf16 v[200:203], a[216:219], a[192:195], v[200:203]
ds_read_b64_tr_b16 a[180:181], v55 offset:32768
s_mul_hi_u32 s29, s28, 67108864
v_mfma_f32_16x16x32_bf16 v[216:219], a[216:219], a[196:199], v[216:219]
ds_read_b64_tr_b16 a[182:183], v55 offset:33280
v_lshl_add_u32 v3, s82, 3, v3
v_mfma_f32_16x16x32_bf16 v[232:235], a[216:219], a[200:203], v[232:235]
v_mfma_f32_16x16x32_bf16 v[248:251], a[216:219], a[204:207], v[248:251]
ds_read_b64_tr_b16 a[184:185], v54 offset:40960
v_lshl_add_u32 v12, v3, 4, v12
v_mfma_f32_16x16x32_bf16 v[252:255], a[220:223], a[204:207], v[252:255]
ds_read_b64_tr_b16 a[186:187], v54 offset:41472
s_add_u32 s27, s24, 147456
v_mfma_f32_16x16x32_bf16 v[236:239], a[220:223], a[200:203], v[236:239]
ds_read_b64_tr_b16 a[188:189], v55 offset:40960
v_add_u32 v16, s27, v8
v_mfma_f32_16x16x32_bf16 v[220:223], a[220:223], a[196:199], v[220:223]
v_mfma_f32_16x16x32_bf16 v[204:207], a[220:223], a[192:195], v[204:207]
ds_read_b64_tr_b16 a[190:191], v55 offset:41472
s_waitcnt lgkmcnt(4)
v_mfma_f32_16x16x32_bf16 v[192:195], a[176:179], a[160:163], v[192:195]
ds_read_b64_tr_b16 a[208:209], v54 offset:36864
v_mfma_f32_16x16x32_bf16 v[208:211], a[176:179], a[164:167], v[208:211]
ds_read_b64_tr_b16 a[210:211], v54 offset:37376
s_add_u32 m0, s24, 32768
v_mfma_f32_16x16x32_bf16 v[224:227], a[176:179], a[168:171], v[224:227]
buffer_load_dwordx4 v56, s[16:19], s29 offen offset:0 sc1 lds
v_mfma_f32_16x16x32_bf16 v[240:243], a[176:179], a[172:175], v[240:243]
ds_read_b128 a[192:195], v31 offset:33792
v_add_u32 v13, 16384, v12
v_mfma_f32_16x16x32_bf16 v[244:247], a[180:183], a[172:175], v[244:247]
ds_read_b128 a[196:199], v31 offset:35840
s_add_u32 s31, s31, 1
v_mfma_f32_16x16x32_bf16 v[228:231], a[180:183], a[168:171], v[228:231]
ds_read_b128 a[200:203], v31 offset:37888
v_add_u32 v14, 32768, v12
v_mfma_f32_16x16x32_bf16 v[212:215], a[180:183], a[164:167], v[212:215]
buffer_load_dwordx4 v56, s[16:19], s29 offen offset:1024 sc1 lds
v_mfma_f32_16x16x32_bf16 v[196:199], a[180:183], a[160:163], v[196:199]
ds_read_b128 a[204:207], v31 offset:39936
v_add_u32 v15, 49152, v12
s_waitcnt lgkmcnt(4)
v_mfma_f32_16x16x32_bf16 v[200:203], a[184:187], a[160:163], v[200:203]
ds_read_b64_tr_b16 a[212:213], v55 offset:36864
v_readlane_b32 s28, v46, s31
v_mfma_f32_16x16x32_bf16 v[216:219], a[184:187], a[164:167], v[216:219]
ds_read_b64_tr_b16 a[214:215], v55 offset:37376
s_add_u32 s27, s37, 4096
v_mfma_f32_16x16x32_bf16 v[232:235], a[184:187], a[168:171], v[232:235]
buffer_load_dwordx4 v57, s[16:19], s29 offen offset:2048 sc1 lds
v_mfma_f32_16x16x32_bf16 v[248:251], a[184:187], a[172:175], v[248:251]
ds_read_b64_tr_b16 a[216:217], v54 offset:45056
v_mfma_f32_16x16x32_bf16 v[252:255], a[188:191], a[172:175], v[252:255]
ds_read_b64_tr_b16 a[218:219], v54 offset:45568
v_mfma_f32_16x16x32_bf16 v[236:239], a[188:191], a[168:171], v[236:239]
ds_read_b64_tr_b16 a[220:221], v55 offset:45056
v_mfma_f32_16x16x32_bf16 v[220:223], a[188:191], a[164:167], v[220:223]
buffer_load_dwordx4 v57, s[16:19], s29 offen offset:3072 sc1 lds
v_mfma_f32_16x16x32_bf16 v[204:207], a[188:191], a[160:163], v[204:207]
ds_read_b64_tr_b16 a[222:223], v55 offset:45568
s_waitcnt vmcnt(6) lgkmcnt(4)
v_mfma_f32_16x16x32_bf16 v[192:195], a[208:211], a[192:195], v[192:195]
s_barrier
v_mfma_f32_16x16x32_bf16 v[208:211], a[208:211], a[196:199], v[208:211]
ds_read_b64_tr_b16 a[176:177], v52 offset:0
s_add_u32 m0, s26, 65536
v_mfma_f32_16x16x32_bf16 v[224:227], a[208:211], a[200:203], v[224:227]
buffer_load_dwordx4 v44, s[44:47], s28 offen offset:0 lds
v_mfma_f32_16x16x32_bf16 v[240:243], a[208:211], a[204:207], v[240:243]
ds_read_b64_tr_b16 a[178:179], v52 offset:512
v_mfma_f32_16x16x32_bf16 v[244:247], a[212:215], a[204:207], v[244:247]
ds_read_b128 a[160:163], v26 offset:0
v_mfma_f32_16x16x32_bf16 v[228:231], a[212:215], a[200:203], v[228:231]
ds_read_b128 a[164:167], v26 offset:2048
v_mfma_f32_16x16x32_bf16 v[212:215], a[212:215], a[196:199], v[212:215]
buffer_load_dwordx4 v45, s[44:47], s28 offen offset:1024 lds
v_mfma_f32_16x16x32_bf16 v[196:199], a[212:215], a[192:195], v[196:199]
ds_read_b128 a[168:171], v26 offset:4096
s_waitcnt lgkmcnt(4)
v_mfma_f32_16x16x32_bf16 v[200:203], a[216:219], a[192:195], v[200:203]
ds_read_b128 a[172:175], v26 offset:6144
s_mul_hi_u32 s29, s28, 67108864
v_mfma_f32_16x16x32_bf16 v[216:219], a[216:219], a[196:199], v[216:219]
v_mfma_f32_16x16x32_bf16 v[232:235], a[216:219], a[200:203], v[232:235]
v_mfma_f32_16x16x32_bf16 v[248:251], a[216:219], a[204:207], v[248:251]
ds_read_b64_tr_b16 a[180:181], v53 offset:0
v_mfma_f32_16x16x32_bf16 v[252:255], a[220:223], a[204:207], v[252:255]
ds_read_b64_tr_b16 a[182:183], v53 offset:512
v_mfma_f32_16x16x32_bf16 v[236:239], a[220:223], a[200:203], v[236:239]
v_mfma_f32_16x16x32_bf16 v[220:223], a[220:223], a[196:199], v[220:223]
v_mfma_f32_16x16x32_bf16 v[204:207], a[220:223], a[192:195], v[204:207]
s_waitcnt lgkmcnt(2)
v_mfma_f32_16x16x32_bf16 v[192:195], a[176:179], a[160:163], v[192:195]
ds_read_b64_tr_b16 a[208:209], v52 offset:4096
s_add_u32 m0, s24, 65536
v_cvt_pk_bf16_f32 v64, v248, v249
v_cvt_pk_bf16_f32 v65, v250, v251
v_mfma_f32_16x16x32_bf16 v[208:211], a[176:179], a[164:167], v[208:211]
ds_read_b64_tr_b16 a[210:211], v52 offset:4608
buffer_load_dwordx4 v56, s[16:19], s29 offen offset:0 sc1 lds
s_add_u32 s31, s31, 1
v_cvt_pk_bf16_f32 v66, v252, v253
v_cvt_pk_bf16_f32 v67, v254, v255
buffer_store_dwordx4 v[64:67], v8, s[32:35], s36 offen offset:0 sc1
v_mfma_f32_16x16x32_bf16 v[224:227], a[176:179], a[168:171], v[224:227]
ds_read_b128 a[192:195], v26 offset:1024
v_readlane_b32 s28, v46, s31
v_cvt_pk_bf16_f32 v68, v232, v233
v_cvt_pk_bf16_f32 v69, v234, v235
v_mfma_f32_16x16x32_bf16 v[240:243], a[176:179], a[172:175], v[240:243]
ds_read_b128 a[196:199], v26 offset:3072
buffer_load_dwordx4 v56, s[16:19], s29 offen offset:1024 sc1 lds
v_cvt_pk_bf16_f32 v70, v236, v237
v_cvt_pk_bf16_f32 v71, v238, v239
buffer_store_dwordx4 v[68:71], v8, s[32:35], s36 offen offset:1024 sc1
s_waitcnt lgkmcnt(4)
v_mfma_f32_16x16x32_bf16 v[244:247], a[180:183], a[172:175], v[244:247]
ds_read_b128 a[200:203], v26 offset:5120
v_cvt_pk_bf16_f32 v72, v216, v217
v_cvt_pk_bf16_f32 v73, v218, v219
v_mfma_f32_16x16x32_bf16 v[228:231], a[180:183], a[168:171], v[228:231]
ds_read_b128 a[204:207], v26 offset:7168
buffer_load_dwordx4 v57, s[16:19], s29 offen offset:2048 sc1 lds
v_cvt_pk_bf16_f32 v74, v220, v221
v_cvt_pk_bf16_f32 v75, v222, v223
buffer_store_dwordx4 v[72:75], v8, s[32:35], s36 offen offset:2048 sc1
v_mfma_f32_16x16x32_bf16 v[212:215], a[180:183], a[164:167], v[212:215]
ds_read_b64_tr_b16 a[212:213], v53 offset:4096
v_cvt_pk_bf16_f32 v76, v200, v201
v_cvt_pk_bf16_f32 v77, v202, v203
v_mfma_f32_16x16x32_bf16 v[196:199], a[180:183], a[160:163], v[196:199]
ds_read_b64_tr_b16 a[214:215], v53 offset:4608
buffer_load_dwordx4 v57, s[16:19], s29 offen offset:3072 sc1 lds
v_cvt_pk_bf16_f32 v78, v204, v205
v_cvt_pk_bf16_f32 v79, v206, v207
buffer_store_dwordx4 v[76:79], v8, s[32:35], s36 offen offset:3072 sc1
s_waitcnt vmcnt(10) lgkmcnt(5)
v_mfma_f32_16x16x32_bf16 v[192:195], a[208:211], a[192:195], v[192:195]
s_barrier
ds_read_b64_tr_b16 a[176:177], v52 offset:32768
s_add_u32 m0, s26, 98304
s_waitcnt lgkmcnt(5)
v_mfma_f32_16x16x32_bf16 v[208:211], a[208:211], a[196:199], v[208:211]
ds_read_b64_tr_b16 a[178:179], v52 offset:33280
buffer_load_dwordx4 v44, s[44:47], s28 offen offset:0 lds
s_waitcnt lgkmcnt(5)
v_mfma_f32_16x16x32_bf16 v[224:227], a[208:211], a[200:203], v[224:227]
ds_read_b128 a[160:163], v26 offset:32768
s_waitcnt lgkmcnt(5)
v_mfma_f32_16x16x32_bf16 v[240:243], a[208:211], a[204:207], v[240:243]
ds_read_b128 a[164:167], v26 offset:34816
s_waitcnt lgkmcnt(4)
v_mfma_f32_16x16x32_bf16 v[244:247], a[212:215], a[204:207], v[244:247]
ds_read_b128 a[168:171], v26 offset:36864
s_mul_hi_u32 s29, s28, 67108864
v_mfma_f32_16x16x32_bf16 v[228:231], a[212:215], a[200:203], v[228:231]
ds_read_b128 a[172:175], v26 offset:38912
buffer_load_dwordx4 v45, s[44:47], s28 offen offset:1024 lds
v_mfma_f32_16x16x32_bf16 v[212:215], a[212:215], a[196:199], v[212:215]
ds_read_b64_tr_b16 a[180:181], v53 offset:32768
v_mfma_f32_16x16x32_bf16 v[196:199], a[212:215], a[192:195], v[196:199]
ds_read_b64_tr_b16 a[182:183], v53 offset:33280
s_waitcnt lgkmcnt(5)
v_mfma_f32_16x16x32_bf16 v[192:195], a[176:179], a[160:163], v[192:195]
ds_read_b64_tr_b16 a[208:209], v52 offset:36864
s_add_u32 m0, s24, 98304
s_waitcnt lgkmcnt(5)
v_mfma_f32_16x16x32_bf16 v[208:211], a[176:179], a[164:167], v[208:211]
ds_read_b64_tr_b16 a[210:211], v52 offset:37376
buffer_load_dwordx4 v56, s[16:19], s29 offen offset:0 sc1 lds
s_waitcnt lgkmcnt(5)
v_mfma_f32_16x16x32_bf16 v[224:227], a[176:179], a[168:171], v[224:227]
ds_read_b128 a[192:195], v26 offset:33792
s_waitcnt lgkmcnt(5)
v_mfma_f32_16x16x32_bf16 v[240:243], a[176:179], a[172:175], v[240:243]
ds_read_b128 a[196:199], v26 offset:35840
buffer_load_dwordx4 v56, s[16:19], s29 offen offset:1024 sc1 lds
s_waitcnt lgkmcnt(4)
v_mfma_f32_16x16x32_bf16 v[244:247], a[180:183], a[172:175], v[244:247]
ds_read_b128 a[200:203], v26 offset:37888
v_mfma_f32_16x16x32_bf16 v[228:231], a[180:183], a[168:171], v[228:231]
ds_read_b128 a[204:207], v26 offset:39936
buffer_load_dwordx4 v57, s[16:19], s29 offen offset:2048 sc1 lds
v_mfma_f32_16x16x32_bf16 v[212:215], a[180:183], a[164:167], v[212:215]
ds_read_b64_tr_b16 a[212:213], v53 offset:36864
v_mfma_f32_16x16x32_bf16 v[196:199], a[180:183], a[160:163], v[196:199]
ds_read_b64_tr_b16 a[214:215], v53 offset:37376
buffer_load_dwordx4 v57, s[16:19], s29 offen offset:3072 sc1 lds
s_waitcnt vmcnt(6) lgkmcnt(5)
v_mfma_f32_16x16x32_bf16 v[192:195], a[208:211], a[192:195], v[192:195]
s_barrier
ds_read_b64_tr_b16 a[176:177], v54 offset:0
s_waitcnt lgkmcnt(5)
v_mfma_f32_16x16x32_bf16 v[208:211], a[208:211], a[196:199], v[208:211]
ds_read_b64_tr_b16 a[178:179], v54 offset:512
s_waitcnt lgkmcnt(5)
v_mfma_f32_16x16x32_bf16 v[224:227], a[208:211], a[200:203], v[224:227]
ds_read_b128 a[160:163], v31 offset:0
s_waitcnt lgkmcnt(5)
v_mfma_f32_16x16x32_bf16 v[240:243], a[208:211], a[204:207], v[240:243]
ds_read_b128 a[164:167], v31 offset:2048
v_mov_b32 v1, s78
s_waitcnt lgkmcnt(4)
v_mfma_f32_16x16x32_bf16 v[244:247], a[212:215], a[204:207], v[244:247]
ds_read_b128 a[168:171], v31 offset:4096
buffer_store_dword v1, off, s[40:43], s1 offset:384 sc1
v_mfma_f32_16x16x32_bf16 v[228:231], a[212:215], a[200:203], v[228:231]
ds_read_b128 a[172:175], v31 offset:6144
v_mfma_f32_16x16x32_bf16 v[212:215], a[212:215], a[196:199], v[212:215]
ds_read_b64_tr_b16 a[180:181], v55 offset:0
v_mfma_f32_16x16x32_bf16 v[196:199], a[212:215], a[192:195], v[196:199]
ds_read_b64_tr_b16 a[182:183], v55 offset:512
buffer_load_dword v58, v51, s[40:43], 0 offen sc1
s_waitcnt lgkmcnt(5)
v_mfma_f32_16x16x32_bf16 v[192:195], a[176:179], a[160:163], v[192:195]
ds_read_b64_tr_b16 a[208:209], v54 offset:4096
s_waitcnt lgkmcnt(5)
v_mfma_f32_16x16x32_bf16 v[208:211], a[176:179], a[164:167], v[208:211]
ds_read_b64_tr_b16 a[210:211], v54 offset:4608
s_waitcnt lgkmcnt(5)
v_mfma_f32_16x16x32_bf16 v[224:227], a[176:179], a[168:171], v[224:227]
ds_read_b128 a[192:195], v31 offset:1024
s_waitcnt lgkmcnt(5)
v_mfma_f32_16x16x32_bf16 v[240:243], a[176:179], a[172:175], v[240:243]
ds_read_b128 a[196:199], v31 offset:3072
s_waitcnt lgkmcnt(4)
v_mfma_f32_16x16x32_bf16 v[244:247], a[180:183], a[172:175], v[244:247]
ds_read_b128 a[200:203], v31 offset:5120
v_mfma_f32_16x16x32_bf16 v[228:231], a[180:183], a[168:171], v[228:231]
ds_read_b128 a[204:207], v31 offset:7168
v_mfma_f32_16x16x32_bf16 v[212:215], a[180:183], a[164:167], v[212:215]
ds_read_b64_tr_b16 a[212:213], v55 offset:4096
v_mfma_f32_16x16x32_bf16 v[196:199], a[180:183], a[160:163], v[196:199]
ds_read_b64_tr_b16 a[214:215], v55 offset:4608
s_waitcnt vmcnt(2) lgkmcnt(5)
v_mfma_f32_16x16x32_bf16 v[192:195], a[208:211], a[192:195], v[192:195]
s_barrier
ds_read_b64_tr_b16 a[176:177], v54 offset:32768
s_waitcnt lgkmcnt(5)
v_mfma_f32_16x16x32_bf16 v[208:211], a[208:211], a[196:199], v[208:211]
ds_read_b64_tr_b16 a[178:179], v54 offset:33280
s_waitcnt lgkmcnt(5)
v_mfma_f32_16x16x32_bf16 v[224:227], a[208:211], a[200:203], v[224:227]
ds_read_b128 a[160:163], v31 offset:32768
s_waitcnt lgkmcnt(5)
v_mfma_f32_16x16x32_bf16 v[240:243], a[208:211], a[204:207], v[240:243]
ds_read_b128 a[164:167], v31 offset:34816
s_waitcnt lgkmcnt(4)
v_mfma_f32_16x16x32_bf16 v[244:247], a[212:215], a[204:207], v[244:247]
ds_read_b128 a[168:171], v31 offset:36864
v_mfma_f32_16x16x32_bf16 v[228:231], a[212:215], a[200:203], v[228:231]
ds_read_b128 a[172:175], v31 offset:38912
s_waitcnt vmcnt(0)
v_cmp_ne_u32 vcc, s78, v58
v_mfma_f32_16x16x32_bf16 v[212:215], a[212:215], a[196:199], v[212:215]
ds_read_b64_tr_b16 a[180:181], v55 offset:32768
s_cbranch_vccz Lok_22
s_mov_b32 s79, 32768
Lspin_21:
buffer_load_dword v58, v51, s[40:43], 0 offen sc1
s_waitcnt vmcnt(0)
v_cmp_ne_u32 vcc, s78, v58
s_sub_u32 s79, s79, 1
s_cbranch_scc1 Lok_22
s_cbranch_vccnz Lspin_21
Lok_22:
v_mfma_f32_16x16x32_bf16 v[196:199], a[212:215], a[192:195], v[196:199]
ds_read_b64_tr_b16 a[182:183], v55 offset:33280
s_waitcnt lgkmcnt(5)
v_mfma_f32_16x16x32_bf16 v[192:195], a[176:179], a[160:163], v[192:195]
ds_read_b64_tr_b16 a[208:209], v54 offset:36864
s_waitcnt lgkmcnt(5)
v_mfma_f32_16x16x32_bf16 v[208:211], a[176:179], a[164:167], v[208:211]
ds_read_b64_tr_b16 a[210:211], v54 offset:37376
buffer_load_dwordx4 v[88:91], v8, s[32:35], s37 offen offset:0 sc1
s_waitcnt lgkmcnt(5)
v_mfma_f32_16x16x32_bf16 v[224:227], a[176:179], a[168:171], v[224:227]
ds_read_b128 a[192:195], v31 offset:33792
buffer_load_dwordx4 v[92:95], v8, s[32:35], s37 offen offset:1024 sc1
s_waitcnt lgkmcnt(5)
v_mfma_f32_16x16x32_bf16 v[240:243], a[176:179], a[172:175], v[240:243]
ds_read_b128 a[196:199], v31 offset:35840
buffer_load_dwordx4 v[96:99], v8, s[32:35], s37 offen offset:2048 sc1
s_waitcnt lgkmcnt(4)
v_mfma_f32_16x16x32_bf16 v[244:247], a[180:183], a[172:175], v[244:247]
ds_read_b128 a[200:203], v31 offset:37888
buffer_load_dwordx4 v[100:103], v8, s[32:35], s37 offen offset:3072 sc1
v_mfma_f32_16x16x32_bf16 v[228:231], a[180:183], a[168:171], v[228:231]
ds_read_b128 a[204:207], v31 offset:39936
v_mfma_f32_16x16x32_bf16 v[212:215], a[180:183], a[164:167], v[212:215]
ds_read_b64_tr_b16 a[212:213], v55 offset:36864
v_mfma_f32_16x16x32_bf16 v[196:199], a[180:183], a[160:163], v[196:199]
ds_read_b64_tr_b16 a[214:215], v55 offset:37376
s_waitcnt lgkmcnt(5)
v_mfma_f32_16x16x32_bf16 v[192:195], a[208:211], a[192:195], v[192:195]
s_waitcnt lgkmcnt(4)
v_mfma_f32_16x16x32_bf16 v[208:211], a[208:211], a[196:199], v[208:211]
s_waitcnt lgkmcnt(3)
v_mfma_f32_16x16x32_bf16 v[224:227], a[208:211], a[200:203], v[224:227]
s_waitcnt lgkmcnt(2)
v_mfma_f32_16x16x32_bf16 v[240:243], a[208:211], a[204:207], v[240:243]
s_waitcnt lgkmcnt(0)
v_mfma_f32_16x16x32_bf16 v[244:247], a[212:215], a[204:207], v[244:247]
v_mfma_f32_16x16x32_bf16 v[228:231], a[212:215], a[200:203], v[228:231]
v_mfma_f32_16x16x32_bf16 v[212:215], a[212:215], a[196:199], v[212:215]
v_mfma_f32_16x16x32_bf16 v[196:199], a[212:215], a[192:195], v[196:199]
s_waitcnt vmcnt(3)
s_nop 1
v_dot2_f32_bf16 v240, v88, s38, v240
v_dot2_f32_bf16 v241, v88, s39, v241
v_dot2_f32_bf16 v242, v89, s38, v242
v_dot2_f32_bf16 v243, v89, s39, v243
v_dot2_f32_bf16 v244, v90, s38, v244
v_dot2_f32_bf16 v245, v90, s39, v245
v_dot2_f32_bf16 v246, v91, s38, v246
v_dot2_f32_bf16 v247, v91, s39, v247
s_waitcnt vmcnt(2)
v_dot2_f32_bf16 v224, v92, s38, v224
v_dot2_f32_bf16 v225, v92, s39, v225
v_cvt_pk_bf16_f32 v240, v240, v241
v_cvt_pk_bf16_f32 v241, v242, v243
v_cvt_pk_bf16_f32 v242, v244, v245
v_cvt_pk_bf16_f32 v243, v246, v247
ds_write_b64 v4, v[240:241] offset:6144
v_dot2_f32_bf16 v226, v93, s38, v226
v_dot2_f32_bf16 v227, v93, s39, v227
ds_write_b64 v5, v[242:243] offset:6144
v_dot2_f32_bf16 v228, v94, s38, v228
v_dot2_f32_bf16 v229, v94, s39, v229
v_dot2_f32_bf16 v230, v95, s38, v230
v_dot2_f32_bf16 v231, v95, s39, v231
s_waitcnt vmcnt(1)
v_dot2_f32_bf16 v208, v96, s38, v208
v_dot2_f32_bf16 v209, v96, s39, v209
v_cvt_pk_bf16_f32 v224, v224, v225
v_cvt_pk_bf16_f32 v225, v226, v227
v_cvt_pk_bf16_f32 v226, v228, v229
v_cvt_pk_bf16_f32 v227, v230, v231
ds_write_b64 v4, v[224:225] offset:4096
v_dot2_f32_bf16 v210, v97, s38, v210
v_dot2_f32_bf16 v211, v97, s39, v211
ds_write_b64 v5, v[226:227] offset:4096
v_dot2_f32_bf16 v212, v98, s38, v212
v_dot2_f32_bf16 v213, v98, s39, v213
v_dot2_f32_bf16 v214, v99, s38, v214
v_dot2_f32_bf16 v215, v99, s39, v215
s_waitcnt vmcnt(0)
v_dot2_f32_bf16 v192, v100, s38, v192
v_dot2_f32_bf16 v193, v100, s39, v193
v_cvt_pk_bf16_f32 v208, v208, v209
v_cvt_pk_bf16_f32 v209, v210, v211
v_cvt_pk_bf16_f32 v210, v212, v213
v_cvt_pk_bf16_f32 v211, v214, v215
ds_write_b64 v4, v[208:209] offset:2048
v_dot2_f32_bf16 v194, v101, s38, v194
v_dot2_f32_bf16 v195, v101, s39, v195
ds_write_b64 v5, v[210:211] offset:2048
v_dot2_f32_bf16 v196, v102, s38, v196
v_dot2_f32_bf16 v197, v102, s39, v197
v_dot2_f32_bf16 v198, v103, s38, v198
v_dot2_f32_bf16 v199, v103, s39, v199
v_cvt_pk_bf16_f32 v192, v192, v193
v_cvt_pk_bf16_f32 v193, v194, v195
v_cvt_pk_bf16_f32 v194, v196, v197
v_cvt_pk_bf16_f32 v195, v198, v199
ds_write_b64 v4, v[192:193] offset:0
ds_write_b64 v5, v[194:195] offset:0
s_waitcnt lgkmcnt(0)
s_barrier
ds_read_b128 v[64:67], v16 offset:0
ds_read_b128 v[68:71], v16 offset:1024
ds_read_b128 v[72:75], v16 offset:2048
ds_read_b128 v[76:79], v16 offset:3072
s_waitcnt lgkmcnt(3)
buffer_store_dwordx4 v[64:67], v12, s[52:55], 0 offen nt
s_waitcnt lgkmcnt(2)
buffer_store_dwordx4 v[68:71], v13, s[52:55], 0 offen nt
s_waitcnt lgkmcnt(1)
buffer_store_dwordx4 v[72:75], v14, s[52:55], 0 offen nt
s_waitcnt lgkmcnt(0)
buffer_store_dwordx4 v[76:79], v15, s[52:55], 0 offen nt
s_endpgm
L_idle:
s_waitcnt vmcnt(0)
s_barrier
v_mov_b32 v1, s78
buffer_store_dword v1, off, s[40:43], s1 offset:128 sc1
s_barrier
v_accvgpr_read_b32 v47, a247
v_accvgpr_read_b32 v16, a224
v_accvgpr_read_b32 v17, a225
v_accvgpr_read_b32 v18, a226
v_accvgpr_read_b32 v19, a227
v_accvgpr_read_b32 v20, a228
v_accvgpr_read_b32 v21, a229
v_accvgpr_read_b32 v32, a235
v_accvgpr_read_b32 v33, a236
v_accvgpr_read_b32 v34, a237
v_accvgpr_read_b32 v38, a238
v_accvgpr_read_b32 v39, a239
v_accvgpr_read_b32 v40, a240
v_accvgpr_read_b32 v41, a241
v_accvgpr_read_b32 v42, a242
v_accvgpr_read_b32 v43, a243
v_accvgpr_read_b32 v44, a244
v_accvgpr_read_b32 v45, a245
v_accvgpr_read_b32 v46, a246
v_accvgpr_read_b32 v48, a248
v_accvgpr_read_b32 v49, a249
v_accvgpr_read_b32 v50, a250
v_accvgpr_read_b32 v51, a251
v_accvgpr_read_b32 v52, a252
v_accvgpr_read_b32 v53, a253
v_add_u32 v35, 65536, v32
v_add_u32 v36, 65536, v33
v_add_u32 v37, 65536, v34
v_add_u32 v54, 65536, v52
v_add_u32 v55, 65536, v53
v_add_u32 v56, 32768, v38
v_add_u32 v57, 32768, v39
s_mov_b32 s12, s60
s_mov_b32 s13, s61
s_mov_b32 s14, 2097152
s_mov_b32 s15, 0x20000
s_mov_b32 s44, s70
s_mov_b32 s45, s71
s_mov_b32 s46, 3670016
s_mov_b32 s47, 0x20000
s_lshl_b32 s27, s80, 18
s_lshl_b32 s36, s3, 16
s_add_u32 s27, s27, s36
v_lshrrev_b32 v2, 5, v0
v_and_b32 v3, 31, v0
v_lshlrev_b32 v2, 15, v2
v_lshl_add_u32 v2, v3, 7, v2
s_lshl_b32 s27, s80, 19
s_lshl_b32 s36, s3, 17
s_add_u32 s27, s27, s36
v_lshrrev_b32 v2, 1, v0
v_and_b32 v3, 1, v0
v_lshlrev_b32 v2, 12, v2
v_lshl_add_u32 v2, v3, 7, v2
s_sub_u32 s36, s2, 224
s_lshl2_add_u32 s36, s36, s3
s_lshl_b32 s36, s36, 13
v_lshl_add_u32 v3, v0, 7, s36
buffer_load_dword v60, v2, s[48:51], s27 offen offset:0
buffer_load_dword v60, v2, s[48:51], s27 offen offset:256
buffer_load_dword v60, v2, s[48:51], s27 offen offset:512
buffer_load_dword v60, v2, s[48:51], s27 offen offset:768
buffer_load_dword v60, v2, s[48:51], s27 offen offset:1024
buffer_load_dword v60, v2, s[48:51], s27 offen offset:1280
buffer_load_dword v60, v2, s[48:51], s27 offen offset:1536
s_getpc_b64 s[32:33]
L_pc3:
s_sub_u32 s32, s32, L_pc3-L_p2
s_subb_u32 s33, s33, 0
s_mov_b32 s34, L_end-L_p2
s_mov_b32 s35, 0x20000
s_lshl2_add_u32 s36, s5, s3
s_sub_u32 s36, s36, 112
s_mul_i32 s36, s36, 2304
v_mul_u32_u24 v4, 36, v0
buffer_load_dword v60, v4, s[32:35], s36 offen
buffer_load_dword v60, v2, s[48:51], s27 offen offset:1792
buffer_load_dword v60, v2, s[48:51], s27 offen offset:2048
buffer_load_dword v60, v2, s[48:51], s27 offen offset:2304
buffer_load_dword v60, v2, s[48:51], s27 offen offset:2560
buffer_load_dword v60, v2, s[48:51], s27 offen offset:2816
buffer_load_dword v60, v2, s[48:51], s27 offen offset:3072
buffer_load_dword v60, v2, s[48:51], s27 offen offset:3328
buffer_load_dword v60, v2, s[48:51], s27 offen offset:3584
buffer_load_dword v60, v2, s[48:51], s27 offen offset:3840
s_mov_b32 s36, 0
buffer_load_dword v60, v3, s[44:47], s36 offen
s_mov_b32 s36, 1048576
buffer_load_dword v60, v3, s[44:47], s36 offen
s_mov_b32 s36, 2097152
buffer_load_dword v60, v3, s[44:47], s36 offen
s_mov_b32 s36, 3145728
buffer_load_dword v60, v3, s[44:47], s36 offen
s_lshl2_add_u32 s36, s5, s3
s_sub_u32 s36, s36, 112
s_mul_i32 s36, s36, 2304
buffer_load_dword v60, v4, s[32:35], s36 offen
v_and_b32 v3, 15, v0
s_lshl_b32 s27, s83, 13
s_add_u32 s27, s27, 147456
v_lshl_add_u32 v4, v3, 7, s27
v_lshrrev_b32 v5, 5, v0
v_lshl_add_u32 v5, s84, 2, v5
v_xor_b32 v5, v5, v3
v_and_b32 v5, 7, v5
v_lshl_add_u32 v4, v5, 4, v4
v_bfe_u32 v5, v0, 4, 1
v_lshl_add_u32 v4, v5, 3, v4
v_xor_b32 v5, 32, v4
ds_read_b64 v[194:195], v4 offset:0
ds_read_b64 v[210:211], v4 offset:2048
ds_read_b64 v[226:227], v4 offset:4096
ds_read_b64 v[242:243], v4 offset:6144
ds_read_b64 v[198:199], v5 offset:0
ds_read_b64 v[214:215], v5 offset:2048
ds_read_b64 v[230:231], v5 offset:4096
ds_read_b64 v[246:247], v5 offset:6144
s_waitcnt lgkmcnt(7)
v_lshlrev_b32 v192, 16, v194
v_and_b32 v193, 0xffff0000, v194
v_lshlrev_b32 v194, 16, v195
v_and_b32 v195, 0xffff0000, v195
s_waitcnt lgkmcnt(6)
v_lshlrev_b32 v208, 16, v210
v_and_b32 v209, 0xffff0000, v210
v_lshlrev_b32 v210, 16, v211
v_and_b32 v211, 0xffff0000, v211
s_waitcnt lgkmcnt(5)
v_lshlrev_b32 v224, 16, v226
v_and_b32 v225, 0xffff0000, v226
v_lshlrev_b32 v226, 16, v227
v_and_b32 v227, 0xffff0000, v227
s_waitcnt lgkmcnt(4)
v_lshlrev_b32 v240, 16, v242
v_and_b32 v241, 0xffff0000, v242
v_lshlrev_b32 v242, 16, v243
v_and_b32 v243, 0xffff0000, v243
s_waitcnt lgkmcnt(3)
v_lshlrev_b32 v196, 16, v198
v_and_b32 v197, 0xffff0000, v198
v_lshlrev_b32 v198, 16, v199
v_and_b32 v199, 0xffff0000, v199
s_waitcnt lgkmcnt(2)
v_lshlrev_b32 v212, 16, v214
v_and_b32 v213, 0xffff0000, v214
v_lshlrev_b32 v214, 16, v215
v_and_b32 v215, 0xffff0000, v215
s_waitcnt lgkmcnt(1)
v_lshlrev_b32 v228, 16, v230
v_and_b32 v229, 0xffff0000, v230
v_lshlrev_b32 v230, 16, v231
v_and_b32 v231, 0xffff0000, v231
s_waitcnt lgkmcnt(0)
v_lshlrev_b32 v244, 16, v246
v_and_b32 v245, 0xffff0000, v246
v_lshlrev_b32 v246, 16, v247
v_and_b32 v247, 0xffff0000, v247
s_mov_b32 s79, 32768
Lspin_23:
buffer_load_dword v58, v48, s[40:43], 0 offen sc1
s_waitcnt vmcnt(0)
v_cmp_ne_u32 vcc, s78, v58
s_sub_u32 s79, s79, 1
s_cbranch_scc1 Lok_24
s_cbranch_vccnz Lspin_23
Lok_24:
s_mov_b32 s31, 0
v_readlane_b32 s28, v46, s31
s_nop 0
s_mul_hi_u32 s29, s28, 67108864
s_add_u32 m0, s25, 0
s_nop 1
buffer_load_dwordx4 v40, s[12:15], s28 offen offset:0 lds
buffer_load_dwordx4 v41, s[12:15], s28 offen offset:1024 lds
buffer_load_dwordx4 v42, s[12:15], s28 offen offset:2048 lds
buffer_load_dwordx4 v43, s[12:15], s28 offen offset:3072 lds
s_add_u32 m0, s24, 0
s_nop 0
buffer_load_dwordx4 v38, s[16:19], s29 offen offset:0 sc1 lds
buffer_load_dwordx4 v38, s[16:19], s29 offen offset:1024 sc1 lds
buffer_load_dwordx4 v39, s[16:19], s29 offen offset:2048 sc1 lds
buffer_load_dwordx4 v39, s[16:19], s29 offen offset:3072 sc1 lds
s_add_u32 s31, s31, 1
v_readlane_b32 s28, v46, s31
s_nop 0
s_mul_hi_u32 s29, s28, 67108864
s_add_u32 m0, s25, 32768
s_nop 1
buffer_load_dwordx4 v40, s[12:15], s28 offen offset:0 lds
buffer_load_dwordx4 v41, s[12:15], s28 offen offset:1024 lds
buffer_load_dwordx4 v42, s[12:15], s28 offen offset:2048 lds
buffer_load_dwordx4 v43, s[12:15], s28 offen offset:3072 lds
s_add_u32 m0, s24, 32768
s_nop 0
buffer_load_dwordx4 v38, s[16:19], s29 offen offset:0 sc1 lds
buffer_load_dwordx4 v38, s[16:19], s29 offen offset:1024 sc1 lds
buffer_load_dwordx4 v39, s[16:19], s29 offen offset:2048 sc1 lds
buffer_load_dwordx4 v39, s[16:19], s29 offen offset:3072 sc1 lds
s_add_u32 s31, s31, 1
v_readlane_b32 s28, v46, s31
s_nop 0
s_mul_hi_u32 s29, s28, 67108864
s_add_u32 m0, s25, 65536
s_nop 1
buffer_load_dwordx4 v40, s[12:15], s28 offen offset:0 lds
buffer_load_dwordx4 v41, s[12:15], s28 offen offset:1024 lds
buffer_load_dwordx4 v42, s[12:15], s28 offen offset:2048 lds
buffer_load_dwordx4 v43, s[12:15], s28 offen offset:3072 lds
s_waitcnt vmcnt(0)
s_barrier
ds_read_b64_tr_b16 a[176:177], v52 offset:0
ds_read_b64_tr_b16 a[178:179], v52 offset:512
ds_read_b128 a[160:163], v26 offset:0
ds_read_b128 a[164:167], v26 offset:2048
ds_read_b128 a[168:171], v26 offset:4096
ds_read_b128 a[172:175], v26 offset:6144
ds_read_b64_tr_b16 a[180:181], v53 offset:0
ds_read_b64_tr_b16 a[182:183], v53 offset:512
ds_read_b64_tr_b16 a[184:185], v52 offset:8192
ds_read_b64_tr_b16 a[186:187], v52 offset:8704
ds_read_b64_tr_b16 a[188:189], v53 offset:8192
ds_read_b64_tr_b16 a[190:191], v53 offset:8704
s_waitcnt lgkmcnt(0)
s_branch L_p3
L_end:
s_endpgm
.section .rodata,"a"
.p2align 6
.amdhsa_kernel parallel_sum__sliding_local_dilated__mixer_gmlp__prompt_kernel
  .amdhsa_next_free_vgpr 512
  .amdhsa_next_free_sgpr 102
  .amdhsa_accum_offset 256
  .amdhsa_group_segment_fixed_size 0
  .amdhsa_kernarg_size 88
  .amdhsa_user_sgpr_count 2
  .amdhsa_user_sgpr_kernarg_segment_ptr 1
  .amdhsa_system_sgpr_workgroup_id_x 1
  .amdhsa_float_denorm_mode_32 3
.end_amdhsa_kernel
```
